```python
import torch

def _softmax(x, axis=-1):
    return torch.softmax(x, dim=axis)

def _gelu(x):
    return torch.nn.functional.gelu(x, approximate='tanh')

def _silu(x):
    return torch.nn.functional.silu(x)

def _sigmoid(x):
    return torch.sigmoid(x)

def _layernorm(x, axis=-1, eps=1e-05):
    m = x.mean(dim=axis, keepdim=True)
    v = x.var(dim=axis, keepdim=True, unbiased=False)
    return (x - m) / torch.sqrt(v + eps)

def _scatter_add(tgt, idx, src, axis=0):
    return tgt.clone().index_add_(axis, idx, src)

def _segment_sum(src, seg, n):
    out = torch.zeros((n,) + src.shape[1:], dtype=src.dtype)
    return out.index_add_(0, seg, src)

def _pad(x, pw):
    flat = tuple((v for pair in reversed(pw) for v in pair))
    return torch.nn.functional.pad(x, flat)
kernel_name = 'adaLN_cond__softmax_full_mha__glu_gated_geglu__prompt'

def setup_inputs():

    _w = lambda a: (lambda t: t.to(torch.bfloat16) if t.is_floating_point() else t)(torch.as_tensor(a))

    def _A_setup():
        B, S, D = (1, 2048, 640)
        return {'x': _w((lambda *s: torch.randn(*s, dtype=torch.bfloat16) * 0.05)(B, S, D)), 'wqkv': _w((lambda *s: torch.randn(*s, dtype=torch.bfloat16) * 0.05)(D, 3 * D)), 'wo': _w((lambda *s: torch.randn(*s, dtype=torch.bfloat16) * 0.05)(D, D))}
    _A_in = _A_setup()

    def _B_setup():
        B, S, Dm, Df = (1, 2048, 640, 1536)
        return {'x': _w((lambda *s: torch.randn(*s, dtype=torch.bfloat16) * 0.05)(B, S, Dm)), 'w_gate': _w((lambda *s: torch.randn(*s, dtype=torch.bfloat16) * 0.8)(Dm, Df) * Dm ** (-0.5)), 'w_up': _w((lambda *s: torch.randn(*s, dtype=torch.bfloat16) * 0.8)(Dm, Df) * Dm ** (-0.5)), 'w_down': _w((lambda *s: torch.randn(*s, dtype=torch.bfloat16) * 0.8)(Df, Dm) * Df ** (-0.5))}
    _B_in = _B_setup()
    return {'A_x': _A_in['x'], 'A_wqkv': _A_in['wqkv'], 'A_wo': _A_in['wo'], 'B_x': _B_in['x'], 'B_w_gate': _B_in['w_gate'], 'B_w_up': _B_in['w_up'], 'B_w_down': _B_in['w_down'], 'c': _w((lambda *s: torch.randn(*s, dtype=torch.bfloat16) * 0.1)(1, 640) * 8.0), 'w_mod': _w((lambda *s: torch.randn(*s, dtype=torch.bfloat16) * 0.1)(640, 6 * 640) * 640 ** (-0.5) * 8.0)}

def reference(A_x, A_wqkv, A_wo, B_x, B_w_gate, B_w_up, B_w_down, c, w_mod):

    def _A_ref(x, wqkv, wo):
        B, S, D = x.shape
        H = 32
        Dh = D // H
        qkv = (lambda x, *d: x.permute(*d))((x @ wqkv).reshape(B, S, 3, H, Dh), 2, 0, 3, 1, 4)
        q, k, v = (qkv[0], qkv[1], qkv[2])
        scale = Dh ** (-0.5)
        scores = torch.einsum('bhqd,bhkd->bhqk', q, k) * scale
        p = _softmax(scores, axis=-1)
        o = torch.einsum('bhqk,bhkd->bhqd', p, v)
        return (lambda x, *d: x.permute(*d))(o, 0, 2, 1, 3).reshape(B, S, D) @ wo

    def _B_ref(x, w_gate, w_up, w_down):
        g = torch.einsum('bsd,df->bsf', x, w_gate)
        u = torch.einsum('bsd,df->bsf', x, w_up)
        h = _gelu(g) * u
        return torch.einsum('bsf,fd->bsd', h, w_down)
    x = A_x
    mod = (_silu(c) @ w_mod).reshape(c.shape[0], 6, 1, -1)
    sa, ca, ga, sb, cb, gb = (mod[:, 0].clone(), mod[:, 1].clone(), mod[:, 2].clone(), mod[:, 3].clone(), mod[:, 4].clone(), mod[:, 5].clone())
    h = _layernorm(x, axis=-1) * (1 + ca) + sa
    x = x + ga * _A_ref(h, A_wqkv, A_wo)
    h = _layernorm(x, axis=-1) * (1 + cb) + sb
    x = x + gb * _B_ref(h, B_w_gate, B_w_up, B_w_down)
    return x
```

```asm
; @launch kernel=front_kernel grid=(256,1,1) block=(256,1,1) lds=163840
; @launch kernel=back_kernel grid=(256,1,1) block=(256,1,1) lds=157696
.amdgcn_target "amdgcn-amd-amdhsa--gfx950"
.text
.globl front_kernel
.p2align 8
.type front_kernel,@function
front_kernel:
    s_cmp_ge_u32 s2, 256
    s_cbranch_scc1 L_front_end_1
    s_load_dwordx2 s[12:13], s[0:1], 56
    s_load_dwordx2 s[16:17], s[0:1], 64
    s_load_dwordx2 s[6:7], s[0:1], 88
    s_load_dwordx2 s[8:9], s[0:1], 0
    s_load_dwordx2 s[4:5], s[0:1], 8
    s_load_dwordx2 s[24:25], s[0:1], 80
    s_getpc_b64 s[46:47]
L_front_pc_9:
    s_and_b32 s3, s2, 0xf8
    v_lshrrev_b32 v1, 5, v0
    v_add_lshl_u32 v1, s3, v1, 7
    global_load_dword v255, v1, s[46:47]
    v_lshrrev_b32 v16, 6, v0
    v_and_b32 v17, 63, v0
    v_readfirstlane_b32 s29, v16
    s_mov_b32 s22, 0x2000000
    s_mov_b32 s23, 0x20000
    s_mov_b32 s26, 256
    s_mov_b32 s27, 0x20000
    s_mov_b32 s45, 0xffff0000
    v_and_b32 v12, 7, v17
    v_lshlrev_b32 v12, 2, v12
    v_and_b32 v13, 1, v17
    v_lshlrev_b32 v13, 7, v13
    s_mov_b32 s14, 1280
    s_mov_b32 s15, 0x20000
    s_mov_b32 s18, 4915200
    s_mov_b32 s19, 0x20000
    s_sub_u32 s59, s2, 64
    s_cbranch_scc1 L_front_helper_2
    s_lshr_b32 s38, s59, 6
    s_lshl_b32 s38, s38, 5
    s_and_b32 s41, s2, 31
    s_add_u32 s38, s38, s41
    s_add_u32 s59, s59, 96
    s_bitcmp1_b32 s2, 5
    s_cselect_b32 s59, s38, s59
    s_cmp_ge_u32 s59, 100
    s_cbranch_scc1 L_front_nounit_4
    s_mul_i32 s38, s59, 103
    s_lshr_b32 s38, s38, 9
    s_mul_i32 s41, s38, 5
    s_sub_u32 s41, s59, s41
    s_lshl_b32 s39, s38, 7
    v_lshrrev_b32 v19, 3, v0
    v_lshl_add_u32 v19, s41, 5, v19
    v_mul_u32_u24 v20, 8, v19
    v_mul_u32_u24 v21, 30720, v19
    v_lshl_add_u32 v21, v12, 2, v21
    s_mov_b32 s40, s39
    s_mul_i32 s42, s41, 5120
    s_lshl1_add_u32 s42, s39, s42
    s_add_u32 s42, s42, 32768
    s_lshl_b32 s43, s59, 11
    s_add_u32 s43, s43, 327680
    s_lshl4_add_u32 s44, s29, s59
    s_cmp_lt_u32 s44, 16
    s_cselect_b32 s43, s43, 0x40000000
    s_cmp_eq_u32 s29, 0
    s_cselect_b32 s42, s42, 0x40000000
    v_lshlrev_b32 v2, 2, v17
    v_lshlrev_b32 v3, 5, v12
    v_mov_b32 v4, -1
    v_mov_b32 v5, 0
    s_waitcnt lgkmcnt(0)
    s_add_u32 s20, s6, 0x2000000
    s_cselect_b32 s20, 0x2000000, 0
    s_add_u32 s6, s6, s20
    s_addc_u32 s7, s7, 0
    s_mov_b32 s20, s6
    s_mov_b32 s21, s7
    buffer_store_dword v4, v2, s[20:23], s42 offen sc1
    buffer_store_dword v5, v3, s[20:23], s43 offen sc1
    buffer_load_dwordx2 v[80:81], v20, s[12:15], 0 offen offset:0
    buffer_load_dwordx4 v[92:95], v21, s[16:19], s40 offen
    s_add_u32 s40, s40, 7680
    buffer_load_dwordx4 v[96:99], v21, s[16:19], s40 offen
    s_add_u32 s40, s40, 7680
    buffer_load_dwordx4 v[100:103], v21, s[16:19], s40 offen
    s_add_u32 s40, s40, 7680
    buffer_load_dwordx4 v[104:107], v21, s[16:19], s40 offen
    v_lshlrev_b32 v2, 24, v0
    v_mov_b32 v3, 1
    s_and_b32 s42, s59, 1
    s_lshl_b32 s42, s42, 7
    s_waitcnt vmcnt(5)
    buffer_atomic_add v3, v2, s[24:27], s42 offen sc1
    s_waitcnt vmcnt(5)
    v_lshlrev_b32 v24, 16, v80
    v_and_b32 v25, s45, v80
    v_lshlrev_b32 v26, 16, v81
    v_and_b32 v27, s45, v81
    v_mul_f32 v60, 0xbfb8aa3b, v24
    v_mul_f32 v61, 0xbfb8aa3b, v25
    v_mul_f32 v62, 0xbfb8aa3b, v26
    v_mul_f32 v63, 0xbfb8aa3b, v27
    v_exp_f32 v60, v60
    v_exp_f32 v61, v61
    v_exp_f32 v62, v62
    v_exp_f32 v63, v63
    v_pk_add_f32 v[60:61], v[60:61], 1.0 op_sel_hi:[1,0]
    v_pk_add_f32 v[62:63], v[62:63], 1.0 op_sel_hi:[1,0]
    v_rcp_f32 v60, v60
    v_rcp_f32 v61, v61
    v_rcp_f32 v62, v62
    v_rcp_f32 v63, v63
    v_pk_mul_f32 v[60:61], v[60:61], v[24:25]
    v_pk_mul_f32 v[62:63], v[62:63], v[26:27]
    v_cvt_pk_bf16_f32 v80, v60, v61
    v_cvt_pk_bf16_f32 v81, v62, v63
    v_lshlrev_b32 v24, 16, v80
    v_and_b32 v25, s45, v80
    v_lshlrev_b32 v26, 16, v81
    v_and_b32 v27, s45, v81
    v_lshrrev_b32 v19, 4, v0
    v_lshlrev_b32 v19, 8, v19
    v_lshl_add_u32 v19, v12, 3, v19
    v_add_u32 v19, 159744, v19
    v_and_b32 v20, 63, v0
    v_lshlrev_b32 v20, 2, v20
    v_add_u32 v21, 159744, v20
    s_waitcnt vmcnt(4)
    v_lshlrev_b32 v52, 16, v92
    v_and_b32 v53, s45, v92
    v_lshlrev_b32 v54, 16, v93
    v_and_b32 v55, s45, v93
    v_lshlrev_b32 v56, 16, v94
    v_and_b32 v57, s45, v94
    v_lshlrev_b32 v58, 16, v95
    v_and_b32 v59, s45, v95
    v_pk_mul_f32 v[44:45], v[52:53], v[24:25] op_sel:[0,0] op_sel_hi:[1,0]
    v_pk_mul_f32 v[46:47], v[54:55], v[24:25] op_sel:[0,0] op_sel_hi:[1,0]
    v_pk_mul_f32 v[48:49], v[56:57], v[24:25] op_sel:[0,0] op_sel_hi:[1,0]
    v_pk_mul_f32 v[50:51], v[58:59], v[24:25] op_sel:[0,0] op_sel_hi:[1,0]
    s_waitcnt vmcnt(3)
    v_lshlrev_b32 v52, 16, v96
    v_and_b32 v53, s45, v96
    v_lshlrev_b32 v54, 16, v97
    v_and_b32 v55, s45, v97
    v_lshlrev_b32 v56, 16, v98
    v_and_b32 v57, s45, v98
    v_lshlrev_b32 v58, 16, v99
    v_and_b32 v59, s45, v99
    v_pk_fma_f32 v[44:45], v[52:53], v[24:25], v[44:45] op_sel:[0,1,0] op_sel_hi:[1,1,1]
    v_pk_fma_f32 v[46:47], v[54:55], v[24:25], v[46:47] op_sel:[0,1,0] op_sel_hi:[1,1,1]
    v_pk_fma_f32 v[48:49], v[56:57], v[24:25], v[48:49] op_sel:[0,1,0] op_sel_hi:[1,1,1]
    v_pk_fma_f32 v[50:51], v[58:59], v[24:25], v[50:51] op_sel:[0,1,0] op_sel_hi:[1,1,1]
    s_waitcnt vmcnt(2)
    v_lshlrev_b32 v52, 16, v100
    v_and_b32 v53, s45, v100
    v_lshlrev_b32 v54, 16, v101
    v_and_b32 v55, s45, v101
    v_lshlrev_b32 v56, 16, v102
    v_and_b32 v57, s45, v102
    v_lshlrev_b32 v58, 16, v103
    v_and_b32 v59, s45, v103
    v_pk_fma_f32 v[44:45], v[52:53], v[26:27], v[44:45] op_sel:[0,0,0] op_sel_hi:[1,0,1]
    v_pk_fma_f32 v[46:47], v[54:55], v[26:27], v[46:47] op_sel:[0,0,0] op_sel_hi:[1,0,1]
    v_pk_fma_f32 v[48:49], v[56:57], v[26:27], v[48:49] op_sel:[0,0,0] op_sel_hi:[1,0,1]
    v_pk_fma_f32 v[50:51], v[58:59], v[26:27], v[50:51] op_sel:[0,0,0] op_sel_hi:[1,0,1]
    s_waitcnt vmcnt(1)
    v_lshlrev_b32 v52, 16, v104
    v_and_b32 v53, s45, v104
    v_lshlrev_b32 v54, 16, v105
    v_and_b32 v55, s45, v105
    v_lshlrev_b32 v56, 16, v106
    v_and_b32 v57, s45, v106
    v_lshlrev_b32 v58, 16, v107
    v_and_b32 v59, s45, v107
    v_pk_fma_f32 v[44:45], v[52:53], v[26:27], v[44:45] op_sel:[0,1,0] op_sel_hi:[1,1,1]
    v_pk_fma_f32 v[46:47], v[54:55], v[26:27], v[46:47] op_sel:[0,1,0] op_sel_hi:[1,1,1]
    v_pk_fma_f32 v[48:49], v[56:57], v[26:27], v[48:49] op_sel:[0,1,0] op_sel_hi:[1,1,1]
    v_pk_fma_f32 v[50:51], v[58:59], v[26:27], v[50:51] op_sel:[0,1,0] op_sel_hi:[1,1,1]
    v_add_f32_dpp v44, v44, v44 row_ror:8 row_mask:0xf bank_mask:0xf
    v_add_f32_dpp v45, v45, v45 row_ror:8 row_mask:0xf bank_mask:0xf
    v_add_f32_dpp v46, v46, v46 row_ror:8 row_mask:0xf bank_mask:0xf
    v_add_f32_dpp v47, v47, v47 row_ror:8 row_mask:0xf bank_mask:0xf
    v_add_f32_dpp v48, v48, v48 row_ror:8 row_mask:0xf bank_mask:0xf
    v_add_f32_dpp v49, v49, v49 row_ror:8 row_mask:0xf bank_mask:0xf
    v_add_f32_dpp v50, v50, v50 row_ror:8 row_mask:0xf bank_mask:0xf
    v_add_f32_dpp v51, v51, v51 row_ror:8 row_mask:0xf bank_mask:0xf
    ds_write_b128 v19, v[44:47]
    ds_write_b128 v19, v[48:51] offset:16
    s_waitcnt lgkmcnt(0)
    s_barrier
    ds_read2st64_b32 v[60:61], v21 offset0:0 offset1:1
    ds_read2st64_b32 v[62:63], v21 offset0:2 offset1:3
    ds_read2st64_b32 v[64:65], v21 offset0:4 offset1:5
    ds_read2st64_b32 v[66:67], v21 offset0:6 offset1:7
    ds_read2st64_b32 v[68:69], v21 offset0:8 offset1:9
    ds_read2st64_b32 v[70:71], v21 offset0:10 offset1:11
    ds_read2st64_b32 v[72:73], v21 offset0:12 offset1:13
    ds_read2st64_b32 v[74:75], v21 offset0:14 offset1:15
    s_mul_i32 s40, s41, 5120
    s_lshl1_add_u32 s40, s39, s40
    s_add_u32 s40, s40, 32768
    s_cmp_eq_u32 s29, 0
    s_cselect_b32 s40, s40, 0x40000000
    s_waitcnt lgkmcnt(0)
    v_pk_add_f32 v[60:61], v[60:61], v[62:63]
    v_pk_add_f32 v[60:61], v[60:61], v[64:65]
    v_pk_add_f32 v[60:61], v[60:61], v[66:67]
    v_pk_add_f32 v[60:61], v[60:61], v[68:69]
    v_pk_add_f32 v[60:61], v[60:61], v[70:71]
    v_pk_add_f32 v[60:61], v[60:61], v[72:73]
    v_pk_add_f32 v[60:61], v[60:61], v[74:75]
    v_add_f32 v60, v60, v61
    buffer_store_dword v60, v20, s[20:23], s40 offen sc1
    s_branch L_front_w_8
L_front_nounit_4:
    s_waitcnt lgkmcnt(0)
    s_add_u32 s20, s6, 0x2000000
    s_cselect_b32 s20, 0x2000000, 0
    s_add_u32 s6, s6, s20
    s_addc_u32 s7, s7, 0
    s_mov_b32 s20, s6
    s_mov_b32 s21, s7
L_front_w_8:
    s_and_b32 s28, s2, 1
    s_bfe_u32 s30, s2, 0x30003
    s_lshl3_add_u32 s28, s28, s30
    s_bfe_u32 s31, s2, 0x10006
    s_cmp_lt_u32 s2, 128
    s_cselect_b32 s31, 2, s31
    s_bfe_u32 s32, s2, 0x20001
    s_lshl2_add_u32 s30, s31, s32
    s_mul_i32 s35, s30, 320
    v_lshrrev_b32 v18, 4, v17
    v_lshlrev_b32 v1, 4, v17
    v_bfe_u32 v19, v17, 2, 2
    v_and_b32 v20, 3, v17
    v_lshl_add_u32 v21, v16, 4, v19
    s_mul_i32 s56, s28, 13
    s_lshr_b32 s56, s56, 6
    s_mul_i32 s56, s56, 5
    s_sub_u32 s56, s28, s56
    s_mul_i32 s57, s56, 491520
    s_add_u32 s35, s35, s57
    s_add_u32 s4, s4, s35
    s_addc_u32 s5, s5, 0
    s_lshl_b32 s57, s56, 1
    s_sub_u32 s57, 10, s57
    s_lshr_b32 s33, s29, 1
    s_and_b32 s34, s29, 1
    s_mul_i32 s36, s29, 5120
    s_add_u32 s36, s36, 61440
    s_lshl_b32 s37, s28, 11
    s_add_u32 s37, s37, 327680
    v_add_u32 v22, 0, v18
    v_mul_u32_u24 v23, 13, v22
    v_lshrrev_b32 v23, 6, v23
    v_mul_u32_u24 v24, 5, v23
    v_sub_u32 v22, v22, v24
    v_and_b32 v24, 2, v23
    v_xor_b32 v24, v24, v20
    v_lshl_add_u32 v23, v23, 2, v21
    v_mul_u32_u24 v23, 3840, v23
    v_lshl_add_u32 v23, v22, 6, v23
    s_add_u32 m0, s36, 0
    v_lshl_add_u32 v2, v24, 4, v23
    global_load_lds_dwordx4 v2, s[4:5]
    v_add_u32 v22, 4, v18
    v_mul_u32_u24 v23, 13, v22
    v_lshrrev_b32 v23, 6, v23
    v_mul_u32_u24 v24, 5, v23
    v_sub_u32 v22, v22, v24
    v_and_b32 v24, 2, v23
    v_xor_b32 v24, v24, v20
    v_lshl_add_u32 v23, v23, 2, v21
    v_mul_u32_u24 v23, 3840, v23
    v_lshl_add_u32 v23, v22, 6, v23
    s_add_u32 m0, s36, 1024
    v_lshl_add_u32 v3, v24, 4, v23
    global_load_lds_dwordx4 v3, s[4:5]
    v_add_u32 v22, 8, v18
    v_mul_u32_u24 v23, 13, v22
    v_lshrrev_b32 v23, 6, v23
    v_mul_u32_u24 v24, 5, v23
    v_sub_u32 v22, v22, v24
    v_and_b32 v24, 2, v23
    v_xor_b32 v24, v24, v20
    v_lshl_add_u32 v23, v23, 2, v21
    v_mul_u32_u24 v23, 3840, v23
    v_lshl_add_u32 v23, v22, 6, v23
    s_add_u32 m0, s36, 2048
    v_lshl_add_u32 v4, v24, 4, v23
    global_load_lds_dwordx4 v4, s[4:5]
    v_add_u32 v22, 12, v18
    v_mul_u32_u24 v23, 13, v22
    v_lshrrev_b32 v23, 6, v23
    v_mul_u32_u24 v24, 5, v23
    v_sub_u32 v22, v22, v24
    v_and_b32 v24, 2, v23
    v_xor_b32 v24, v24, v20
    v_lshl_add_u32 v23, v23, 2, v21
    v_mul_u32_u24 v23, 3840, v23
    v_lshl_add_u32 v23, v22, 6, v23
    s_add_u32 m0, s36, 3072
    v_lshl_add_u32 v5, v24, 4, v23
    global_load_lds_dwordx4 v5, s[4:5]
    v_add_u32 v22, 16, v18
    v_mul_u32_u24 v23, 13, v22
    v_lshrrev_b32 v23, 6, v23
    v_mul_u32_u24 v24, 5, v23
    v_sub_u32 v22, v22, v24
    v_and_b32 v24, 2, v23
    v_xor_b32 v24, v24, v20
    v_lshl_add_u32 v23, v23, 2, v21
    v_mul_u32_u24 v23, 3840, v23
    v_lshl_add_u32 v23, v22, 6, v23
    s_add_u32 m0, s36, 4096
    v_lshl_add_u32 v6, v24, 4, v23
    global_load_lds_dwordx4 v6, s[4:5]
    s_add_u32 s4, s4, 245760
    s_addc_u32 s5, s5, 0
    v_mul_u32_u24 v22, 2560, v18
    v_lshl_add_u32 v22, v19, 6, v22
    v_add_u32 v22, 61440, v22
    v_and_b32 v23, 1, v18
    v_lshlrev_b32 v23, 2, v23
    s_mul_i32 s38, s34, 20
    v_add3_u32 v24, s38, v20, 0
    v_lshrrev_b32 v25, 3, v24
    v_and_b32 v24, 7, v24
    v_xor_b32 v24, v24, v23
    v_lshl_add_u32 v25, v25, 8, v22
    v_lshl_add_u32 v7, v24, 3, v25
    v_add3_u32 v24, s38, v20, 5
    v_lshrrev_b32 v25, 3, v24
    v_and_b32 v24, 7, v24
    v_xor_b32 v24, v24, v23
    v_lshl_add_u32 v25, v25, 8, v22
    v_lshl_add_u32 v8, v24, 3, v25
    v_add3_u32 v24, s38, v20, 10
    v_lshrrev_b32 v25, 3, v24
    v_and_b32 v24, 7, v24
    v_xor_b32 v24, v24, v23
    v_lshl_add_u32 v25, v25, 8, v22
    v_lshl_add_u32 v9, v24, 3, v25
    v_add3_u32 v24, s38, v20, 15
    v_lshrrev_b32 v25, 3, v24
    v_and_b32 v24, 7, v24
    v_xor_b32 v24, v24, v23
    v_lshl_add_u32 v25, v25, 8, v22
    v_lshl_add_u32 v10, v24, 3, v25
    v_mul_u32_u24 v24, 5, v20
    v_add3_u32 v24, s38, v24, 4
    v_lshrrev_b32 v25, 3, v24
    v_and_b32 v24, 7, v24
    v_xor_b32 v24, v24, v23
    v_lshl_add_u32 v25, v25, 8, v22
    v_lshl_add_u32 v11, v24, 3, v25
    s_add_u32 m0, s36, 20480
    s_nop 0
    global_load_lds_dwordx4 v2, s[4:5]
    s_add_u32 m0, s36, 21504
    s_nop 0
    global_load_lds_dwordx4 v3, s[4:5]
    s_add_u32 m0, s36, 22528
    s_nop 0
    global_load_lds_dwordx4 v4, s[4:5]
    s_add_u32 m0, s36, 23552
    s_nop 0
    global_load_lds_dwordx4 v5, s[4:5]
    s_add_u32 m0, s36, 24576
    s_nop 0
    global_load_lds_dwordx4 v6, s[4:5]
    s_cmp_eq_u32 s57, 2
    s_cselect_b32 s3, 2457600, 0
    s_add_u32 s4, s4, 245760
    s_addc_u32 s5, s5, 0
    s_sub_u32 s4, s4, s3
    s_subb_u32 s5, s5, 0
    s_lshl_b32 s42, s28, 2
    s_lshl1_add_u32 s42, s33, s42
    s_mul_i32 s40, s42, 40960
    s_lshl_b32 s41, s34, 12
    s_add_u32 s40, s40, s41
    s_add_u32 s40, s40, 524288
    s_add_u32 s40, s40, s6
    s_mov_b32 s41, s7
    s_add_u32 s58, s56, 0
    s_cmp_ge_u32 s58, 5
    s_cselect_b32 s38, 5, 0
    s_sub_u32 s58, s58, s38
    s_lshl_b32 s58, s58, 13
    s_add_u32 s58, s58, s40
    s_add_u32 s59, s56, 1
    s_cmp_ge_u32 s59, 5
    s_cselect_b32 s38, 5, 0
    s_sub_u32 s59, s59, s38
    s_lshl_b32 s59, s59, 13
    s_add_u32 s59, s59, s40
    s_add_u32 s60, s56, 2
    s_cmp_ge_u32 s60, 5
    s_cselect_b32 s38, 5, 0
    s_sub_u32 s60, s60, s38
    s_lshl_b32 s60, s60, 13
    s_add_u32 s60, s60, s40
    s_add_u32 s61, s56, 3
    s_cmp_ge_u32 s61, 5
    s_cselect_b32 s38, 5, 0
    s_sub_u32 s61, s61, s38
    s_lshl_b32 s61, s61, 13
    s_add_u32 s61, s61, s40
    s_add_u32 s62, s56, 4
    s_cmp_ge_u32 s62, 5
    s_cselect_b32 s38, 5, 0
    s_sub_u32 s62, s62, s38
    s_lshl_b32 s62, s62, 13
    s_add_u32 s62, s62, s40
    s_lshl_b32 s44, s29, 12
    v_and_b32 v24, 15, v17
    v_lshlrev_b32 v25, 4, v24
    v_lshl_add_u32 v25, v18, 9, v25
    s_lshl_b32 s38, s33, 13
    v_add_u32 v19, s38, v25
    v_add_u32 v20, 65536, v19
    v_add_u32 v21, 131072, v19
    s_mov_b32 s47, 2688
    s_mov_b32 s48, 5767168
    s_cmp_eq_u32 s31, 0
    s_cselect_b32 s47, 1280, s47
    s_cselect_b32 s48, 3145728, s48
    s_cselect_b32 s50, 0x3ea52b5c, 1.0
    s_mov_b32 s51, s50
    s_lshl_b32 s46, s47, 6
    s_mul_i32 s42, s42, s47
    s_add_u32 s48, s48, s42
    s_lshl1_add_u32 s42, s32, s34
    s_lshl_b32 s42, s42, 2
    s_mul_i32 s42, s42, s46
    s_add_u32 s52, s48, s42
    s_add_u32 s53, s52, s46
    s_add_u32 s54, s53, s46
    s_add_u32 s55, s54, s46
    v_mul_lo_u32 v16, s46, v18
    v_lshl_add_u32 v16, v24, 3, v16
    v_lshrrev_b32 v26, 2, v24
    v_mul_lo_u32 v26, s46, v26
    v_lshl_add_u32 v26, v18, 6, v26
    v_and_b32 v27, 3, v24
    v_lshl_add_u32 v22, v27, 4, v26
    v_lshrrev_b32 v26, 3, v17
    v_mul_lo_u32 v26, s46, v26
    v_lshl_add_u32 v26, v12, 2, v26
    v_lshrrev_b32 v27, 5, v17
    v_lshl_add_u32 v23, v27, 30, v26
    v_mov_b32 v108, 0x3f803f80
    v_mov_b32 v109, 0x3f803f80
    v_mov_b32 v110, 0x3f803f80
    v_mov_b32 v111, 0x3f803f80
    v_and_b32 v15, 3, v17
    v_lshlrev_b32 v15, 7, v15
    s_add_u32 m0, s36, 40960
    s_nop 0
    global_load_lds_dwordx4 v2, s[4:5]
    s_add_u32 m0, s36, 41984
    s_nop 0
    global_load_lds_dwordx4 v3, s[4:5]
    s_add_u32 m0, s36, 43008
    s_nop 0
    global_load_lds_dwordx4 v4, s[4:5]
    s_add_u32 m0, s36, 44032
    s_nop 0
    global_load_lds_dwordx4 v5, s[4:5]
    s_add_u32 m0, s36, 45056
    s_nop 0
    global_load_lds_dwordx4 v6, s[4:5]
    s_cmp_eq_u32 s57, 3
    s_cselect_b32 s3, 2457600, 0
    s_add_u32 s4, s4, 245760
    s_addc_u32 s5, s5, 0
    s_sub_u32 s4, s4, s3
    s_subb_u32 s5, s5, 0
    s_add_u32 m0, s36, 61440
    s_nop 0
    global_load_lds_dwordx4 v2, s[4:5]
    s_add_u32 m0, s36, 62464
    s_nop 0
    global_load_lds_dwordx4 v3, s[4:5]
    s_add_u32 m0, s36, 63488
    s_nop 0
    global_load_lds_dwordx4 v4, s[4:5]
    s_add_u32 m0, s36, 64512
    s_nop 0
    global_load_lds_dwordx4 v5, s[4:5]
    s_add_u32 m0, s36, 65536
    s_nop 0
    global_load_lds_dwordx4 v6, s[4:5]
    s_cmp_eq_u32 s57, 4
    s_cselect_b32 s3, 2457600, 0
    s_add_u32 s4, s4, 245760
    s_addc_u32 s5, s5, 0
    s_sub_u32 s4, s4, s3
    s_subb_u32 s5, s5, 0
    s_waitcnt vmcnt(15)
    s_barrier
    s_add_u32 m0, s36, 81920
    ds_read_b64_tr_b16 a[0:1], v7 offset:0
    ds_read_b64_tr_b16 a[2:3], v7 offset:1280
    global_load_lds_dwordx4 v2, s[4:5]
    ds_read_b64_tr_b16 a[4:5], v8 offset:0
    ds_read_b64_tr_b16 a[6:7], v8 offset:1280
    s_add_u32 m0, s36, 82944
    ds_read_b64_tr_b16 a[8:9], v9 offset:0
    ds_read_b64_tr_b16 a[10:11], v9 offset:1280
    global_load_lds_dwordx4 v3, s[4:5]
    ds_read_b64_tr_b16 a[12:13], v10 offset:0
    ds_read_b64_tr_b16 a[14:15], v10 offset:1280
    s_add_u32 m0, s36, 83968
    ds_read_b64_tr_b16 a[16:17], v11 offset:0
    ds_read_b64_tr_b16 a[18:19], v11 offset:1280
    global_load_lds_dwordx4 v4, s[4:5]
    ds_read_b64_tr_b16 a[20:21], v7 offset:10240
    ds_read_b64_tr_b16 a[22:23], v7 offset:11520
    s_add_u32 m0, s36, 84992
    ds_read_b64_tr_b16 a[24:25], v8 offset:10240
    ds_read_b64_tr_b16 a[26:27], v8 offset:11520
    global_load_lds_dwordx4 v5, s[4:5]
    ds_read_b64_tr_b16 a[28:29], v9 offset:10240
    ds_read_b64_tr_b16 a[30:31], v9 offset:11520
    s_add_u32 m0, s36, 86016
    ds_read_b64_tr_b16 a[32:33], v10 offset:10240
    ds_read_b64_tr_b16 a[34:35], v10 offset:11520
    global_load_lds_dwordx4 v6, s[4:5]
    ds_read_b64_tr_b16 a[36:37], v11 offset:10240
    ds_read_b64_tr_b16 a[38:39], v11 offset:11520
    s_cmp_eq_u32 s57, 5
    s_cselect_b32 s3, 2457600, 0
    s_add_u32 s4, s4, 245760
    s_addc_u32 s5, s5, 0
    s_sub_u32 s4, s4, s3
    s_subb_u32 s5, s5, 0
    v_add_u32 v7, 20480, v7
    v_add_u32 v8, 20480, v8
    v_add_u32 v9, 20480, v9
    v_add_u32 v10, 20480, v10
    v_add_u32 v11, 20480, v11
    s_waitcnt vmcnt(15) lgkmcnt(0)
    s_barrier
    s_add_u32 m0, s36, 0
    ds_read_b64_tr_b16 a[40:41], v7 offset:0
    ds_read_b64_tr_b16 a[42:43], v7 offset:1280
    global_load_lds_dwordx4 v2, s[4:5]
    ds_read_b64_tr_b16 a[44:45], v8 offset:0
    ds_read_b64_tr_b16 a[46:47], v8 offset:1280
    s_add_u32 m0, s36, 1024
    ds_read_b64_tr_b16 a[48:49], v9 offset:0
    ds_read_b64_tr_b16 a[50:51], v9 offset:1280
    global_load_lds_dwordx4 v3, s[4:5]
    ds_read_b64_tr_b16 a[52:53], v10 offset:0
    ds_read_b64_tr_b16 a[54:55], v10 offset:1280
    s_add_u32 m0, s36, 2048
    ds_read_b64_tr_b16 a[56:57], v11 offset:0
    ds_read_b64_tr_b16 a[58:59], v11 offset:1280
    global_load_lds_dwordx4 v4, s[4:5]
    ds_read_b64_tr_b16 a[60:61], v7 offset:10240
    ds_read_b64_tr_b16 a[62:63], v7 offset:11520
    s_add_u32 m0, s36, 3072
    ds_read_b64_tr_b16 a[64:65], v8 offset:10240
    ds_read_b64_tr_b16 a[66:67], v8 offset:11520
    global_load_lds_dwordx4 v5, s[4:5]
    ds_read_b64_tr_b16 a[68:69], v9 offset:10240
    ds_read_b64_tr_b16 a[70:71], v9 offset:11520
    s_add_u32 m0, s36, 4096
    ds_read_b64_tr_b16 a[72:73], v10 offset:10240
    ds_read_b64_tr_b16 a[74:75], v10 offset:11520
    global_load_lds_dwordx4 v6, s[4:5]
    ds_read_b64_tr_b16 a[76:77], v11 offset:10240
    ds_read_b64_tr_b16 a[78:79], v11 offset:11520
    s_cmp_eq_u32 s57, 6
    s_cselect_b32 s3, 2457600, 0
    s_add_u32 s4, s4, 245760
    s_addc_u32 s5, s5, 0
    s_sub_u32 s4, s4, s3
    s_subb_u32 s5, s5, 0
    v_add_u32 v7, 20480, v7
    v_add_u32 v8, 20480, v8
    v_add_u32 v9, 20480, v9
    v_add_u32 v10, 20480, v10
    v_add_u32 v11, 20480, v11
    buffer_load_dword v14, v13, s[24:27], 0 offen sc1
    s_waitcnt vmcnt(16) lgkmcnt(0)
    s_barrier
    s_add_u32 m0, s36, 20480
    ds_read_b64_tr_b16 a[80:81], v7 offset:0
    ds_read_b64_tr_b16 a[82:83], v7 offset:1280
    global_load_lds_dwordx4 v2, s[4:5]
    ds_read_b64_tr_b16 a[84:85], v8 offset:0
    ds_read_b64_tr_b16 a[86:87], v8 offset:1280
    s_add_u32 m0, s36, 21504
    ds_read_b64_tr_b16 a[88:89], v9 offset:0
    ds_read_b64_tr_b16 a[90:91], v9 offset:1280
    global_load_lds_dwordx4 v3, s[4:5]
    ds_read_b64_tr_b16 a[92:93], v10 offset:0
    ds_read_b64_tr_b16 a[94:95], v10 offset:1280
    s_add_u32 m0, s36, 22528
    ds_read_b64_tr_b16 a[96:97], v11 offset:0
    ds_read_b64_tr_b16 a[98:99], v11 offset:1280
    global_load_lds_dwordx4 v4, s[4:5]
    ds_read_b64_tr_b16 a[100:101], v7 offset:10240
    ds_read_b64_tr_b16 a[102:103], v7 offset:11520
    s_add_u32 m0, s36, 23552
    ds_read_b64_tr_b16 a[104:105], v8 offset:10240
    ds_read_b64_tr_b16 a[106:107], v8 offset:11520
    global_load_lds_dwordx4 v5, s[4:5]
    ds_read_b64_tr_b16 a[108:109], v9 offset:10240
    ds_read_b64_tr_b16 a[110:111], v9 offset:11520
    s_add_u32 m0, s36, 24576
    ds_read_b64_tr_b16 a[112:113], v10 offset:10240
    ds_read_b64_tr_b16 a[114:115], v10 offset:11520
    global_load_lds_dwordx4 v6, s[4:5]
    ds_read_b64_tr_b16 a[116:117], v11 offset:10240
    ds_read_b64_tr_b16 a[118:119], v11 offset:11520
    s_cmp_eq_u32 s57, 7
    s_cselect_b32 s3, 2457600, 0
    s_add_u32 s4, s4, 245760
    s_addc_u32 s5, s5, 0
    s_sub_u32 s4, s4, s3
    s_subb_u32 s5, s5, 0
    v_add_u32 v7, 20480, v7
    v_add_u32 v8, 20480, v8
    v_add_u32 v9, 20480, v9
    v_add_u32 v10, 20480, v10
    v_add_u32 v11, 20480, v11
    s_waitcnt vmcnt(16) lgkmcnt(0)
    s_barrier
    s_add_u32 m0, s36, 40960
    ds_read_b64_tr_b16 a[120:121], v7 offset:0
    ds_read_b64_tr_b16 a[122:123], v7 offset:1280
    global_load_lds_dwordx4 v2, s[4:5]
    ds_read_b64_tr_b16 a[124:125], v8 offset:0
    ds_read_b64_tr_b16 a[126:127], v8 offset:1280
    s_add_u32 m0, s36, 41984
    ds_read_b64_tr_b16 a[128:129], v9 offset:0
    ds_read_b64_tr_b16 a[130:131], v9 offset:1280
    global_load_lds_dwordx4 v3, s[4:5]
    ds_read_b64_tr_b16 a[132:133], v10 offset:0
    ds_read_b64_tr_b16 a[134:135], v10 offset:1280
    s_add_u32 m0, s36, 43008
    ds_read_b64_tr_b16 a[136:137], v11 offset:0
    ds_read_b64_tr_b16 a[138:139], v11 offset:1280
    global_load_lds_dwordx4 v4, s[4:5]
    ds_read_b64_tr_b16 a[140:141], v7 offset:10240
    ds_read_b64_tr_b16 a[142:143], v7 offset:11520
    s_add_u32 m0, s36, 44032
    ds_read_b64_tr_b16 a[144:145], v8 offset:10240
    ds_read_b64_tr_b16 a[146:147], v8 offset:11520
    global_load_lds_dwordx4 v5, s[4:5]
    ds_read_b64_tr_b16 a[148:149], v9 offset:10240
    ds_read_b64_tr_b16 a[150:151], v9 offset:11520
    s_add_u32 m0, s36, 45056
    ds_read_b64_tr_b16 a[152:153], v10 offset:10240
    ds_read_b64_tr_b16 a[154:155], v10 offset:11520
    global_load_lds_dwordx4 v6, s[4:5]
    ds_read_b64_tr_b16 a[156:157], v11 offset:10240
    ds_read_b64_tr_b16 a[158:159], v11 offset:11520
    s_cmp_eq_u32 s57, 8
    s_cselect_b32 s3, 2457600, 0
    s_add_u32 s4, s4, 245760
    s_addc_u32 s5, s5, 0
    s_sub_u32 s4, s4, s3
    s_subb_u32 s5, s5, 0
    v_add_u32 v7, 20480, v7
    v_add_u32 v8, 20480, v8
    v_add_u32 v9, 20480, v9
    v_add_u32 v10, 20480, v10
    v_add_u32 v11, 20480, v11
    s_waitcnt vmcnt(16) lgkmcnt(0)
    s_barrier
    s_add_u32 m0, s36, 61440
    ds_read_b64_tr_b16 a[160:161], v7 offset:0
    ds_read_b64_tr_b16 a[162:163], v7 offset:1280
    global_load_lds_dwordx4 v2, s[4:5]
    ds_read_b64_tr_b16 a[164:165], v8 offset:0
    ds_read_b64_tr_b16 a[166:167], v8 offset:1280
    s_add_u32 m0, s36, 62464
    ds_read_b64_tr_b16 a[168:169], v9 offset:0
    ds_read_b64_tr_b16 a[170:171], v9 offset:1280
    global_load_lds_dwordx4 v3, s[4:5]
    ds_read_b64_tr_b16 a[172:173], v10 offset:0
    ds_read_b64_tr_b16 a[174:175], v10 offset:1280
    s_add_u32 m0, s36, 63488
    ds_read_b64_tr_b16 a[176:177], v11 offset:0
    ds_read_b64_tr_b16 a[178:179], v11 offset:1280
    global_load_lds_dwordx4 v4, s[4:5]
    ds_read_b64_tr_b16 a[180:181], v7 offset:10240
    ds_read_b64_tr_b16 a[182:183], v7 offset:11520
    s_add_u32 m0, s36, 64512
    ds_read_b64_tr_b16 a[184:185], v8 offset:10240
    ds_read_b64_tr_b16 a[186:187], v8 offset:11520
    global_load_lds_dwordx4 v5, s[4:5]
    ds_read_b64_tr_b16 a[188:189], v9 offset:10240
    ds_read_b64_tr_b16 a[190:191], v9 offset:11520
    s_add_u32 m0, s36, 65536
    ds_read_b64_tr_b16 a[192:193], v10 offset:10240
    ds_read_b64_tr_b16 a[194:195], v10 offset:11520
    global_load_lds_dwordx4 v6, s[4:5]
    ds_read_b64_tr_b16 a[196:197], v11 offset:10240
    ds_read_b64_tr_b16 a[198:199], v11 offset:11520
    s_cmp_eq_u32 s57, 9
    s_cselect_b32 s3, 2457600, 0
    s_add_u32 s4, s4, 245760
    s_addc_u32 s5, s5, 0
    s_sub_u32 s4, s4, s3
    s_subb_u32 s5, s5, 0
    v_subrev_u32 v7, 81920, v7
    v_subrev_u32 v8, 81920, v8
    v_subrev_u32 v9, 81920, v9
    v_subrev_u32 v10, 81920, v10
    v_subrev_u32 v11, 81920, v11
    s_waitcnt vmcnt(16) lgkmcnt(0)
    s_barrier
    s_add_u32 m0, s36, 81920
    ds_read_b64_tr_b16 a[200:201], v7 offset:0
    ds_read_b64_tr_b16 a[202:203], v7 offset:1280
    global_load_lds_dwordx4 v2, s[4:5]
    ds_read_b64_tr_b16 a[204:205], v8 offset:0
    ds_read_b64_tr_b16 a[206:207], v8 offset:1280
    s_add_u32 m0, s36, 82944
    ds_read_b64_tr_b16 a[208:209], v9 offset:0
    ds_read_b64_tr_b16 a[210:211], v9 offset:1280
    global_load_lds_dwordx4 v3, s[4:5]
    ds_read_b64_tr_b16 a[212:213], v10 offset:0
    ds_read_b64_tr_b16 a[214:215], v10 offset:1280
    s_add_u32 m0, s36, 83968
    ds_read_b64_tr_b16 a[216:217], v11 offset:0
    ds_read_b64_tr_b16 a[218:219], v11 offset:1280
    global_load_lds_dwordx4 v4, s[4:5]
    ds_read_b64_tr_b16 a[220:221], v7 offset:10240
    ds_read_b64_tr_b16 a[222:223], v7 offset:11520
    s_add_u32 m0, s36, 84992
    ds_read_b64_tr_b16 a[224:225], v8 offset:10240
    ds_read_b64_tr_b16 a[226:227], v8 offset:11520
    global_load_lds_dwordx4 v5, s[4:5]
    ds_read_b64_tr_b16 a[228:229], v9 offset:10240
    ds_read_b64_tr_b16 a[230:231], v9 offset:11520
    s_add_u32 m0, s36, 86016
    ds_read_b64_tr_b16 a[232:233], v10 offset:10240
    ds_read_b64_tr_b16 a[234:235], v10 offset:11520
    global_load_lds_dwordx4 v6, s[4:5]
    ds_read_b64_tr_b16 a[236:237], v11 offset:10240
    ds_read_b64_tr_b16 a[238:239], v11 offset:11520
    s_cmp_eq_u32 s57, 10
    s_cselect_b32 s3, 2457600, 0
    s_add_u32 s4, s4, 245760
    s_addc_u32 s5, s5, 0
    s_sub_u32 s4, s4, s3
    s_subb_u32 s5, s5, 0
    v_add_u32 v7, 20480, v7
    v_add_u32 v8, 20480, v8
    v_add_u32 v9, 20480, v9
    v_add_u32 v10, 20480, v10
    v_add_u32 v11, 20480, v11
    s_waitcnt vmcnt(20)
    v_cmp_ne_u32 vcc, 50, v14
    s_cbranch_vccnz L_front_poll_12
L_front_ok_13:
    buffer_load_dword v14, v15, s[20:23], s37 offen sc1
    s_waitcnt vmcnt(16) lgkmcnt(0)
    s_barrier
    ds_read_b64_tr_b16 a[240:241], v7 offset:0
    ds_read_b64_tr_b16 a[242:243], v7 offset:1280
    ds_read_b64_tr_b16 a[244:245], v8 offset:0
    ds_read_b64_tr_b16 a[246:247], v8 offset:1280
    ds_read_b64_tr_b16 a[248:249], v9 offset:0
    ds_read_b64_tr_b16 a[250:251], v9 offset:1280
    ds_read_b64_tr_b16 a[252:253], v10 offset:0
    ds_read_b64_tr_b16 a[254:255], v10 offset:1280
    ds_read_b64_tr_b16 v[112:113], v11 offset:0
    ds_read_b64_tr_b16 v[114:115], v11 offset:1280
    ds_read_b64_tr_b16 v[116:117], v7 offset:10240
    ds_read_b64_tr_b16 v[118:119], v7 offset:11520
    ds_read_b64_tr_b16 v[120:121], v8 offset:10240
    ds_read_b64_tr_b16 v[122:123], v8 offset:11520
    ds_read_b64_tr_b16 v[124:125], v9 offset:10240
    ds_read_b64_tr_b16 v[126:127], v9 offset:11520
    ds_read_b64_tr_b16 v[128:129], v10 offset:10240
    ds_read_b64_tr_b16 v[130:131], v10 offset:11520
    ds_read_b64_tr_b16 v[132:133], v11 offset:10240
    ds_read_b64_tr_b16 v[134:135], v11 offset:11520
    v_add_u32 v7, 20480, v7
    v_add_u32 v8, 20480, v8
    v_add_u32 v9, 20480, v9
    v_add_u32 v10, 20480, v10
    v_add_u32 v11, 20480, v11
    s_waitcnt vmcnt(11) lgkmcnt(0)
    s_barrier
    ds_read_b64_tr_b16 v[136:137], v7 offset:0
    ds_read_b64_tr_b16 v[138:139], v7 offset:1280
    ds_read_b64_tr_b16 v[140:141], v8 offset:0
    ds_read_b64_tr_b16 v[142:143], v8 offset:1280
    ds_read_b64_tr_b16 v[144:145], v9 offset:0
    ds_read_b64_tr_b16 v[146:147], v9 offset:1280
    ds_read_b64_tr_b16 v[148:149], v10 offset:0
    ds_read_b64_tr_b16 v[150:151], v10 offset:1280
    ds_read_b64_tr_b16 v[152:153], v11 offset:0
    ds_read_b64_tr_b16 v[154:155], v11 offset:1280
    ds_read_b64_tr_b16 v[156:157], v7 offset:10240
    ds_read_b64_tr_b16 v[158:159], v7 offset:11520
    ds_read_b64_tr_b16 v[160:161], v8 offset:10240
    ds_read_b64_tr_b16 v[162:163], v8 offset:11520
    ds_read_b64_tr_b16 v[164:165], v9 offset:10240
    ds_read_b64_tr_b16 v[166:167], v9 offset:11520
    ds_read_b64_tr_b16 v[168:169], v10 offset:10240
    ds_read_b64_tr_b16 v[170:171], v10 offset:11520
    ds_read_b64_tr_b16 v[172:173], v11 offset:10240
    ds_read_b64_tr_b16 v[174:175], v11 offset:11520
    v_add_u32 v7, 20480, v7
    v_add_u32 v8, 20480, v8
    v_add_u32 v9, 20480, v9
    v_add_u32 v10, 20480, v10
    v_add_u32 v11, 20480, v11
    s_waitcnt vmcnt(0)
    s_mov_b32 s63, 0
    v_cmp_ne_u32 vcc, 1, v14
    s_cbranch_vccnz L_front_late_10
    s_mov_b32 s63, 1
    s_add_u32 m0, s44, 0
    s_add_u32 s40, s58, 0
    global_load_lds_dwordx4 v1, s[40:41] offset:0 sc1
    global_load_lds_dwordx4 v1, s[40:41] offset:1024 sc1
    global_load_lds_dwordx4 v1, s[40:41] offset:2048 sc1
    global_load_lds_dwordx4 v1, s[40:41] offset:3072 sc1
    s_add_u32 m0, s44, 16384
    s_add_u32 s40, s59, 0
    global_load_lds_dwordx4 v1, s[40:41] offset:0 sc1
    global_load_lds_dwordx4 v1, s[40:41] offset:1024 sc1
    global_load_lds_dwordx4 v1, s[40:41] offset:2048 sc1
    global_load_lds_dwordx4 v1, s[40:41] offset:3072 sc1
    s_add_u32 m0, s44, 32768
    s_add_u32 s40, s60, 0
    global_load_lds_dwordx4 v1, s[40:41] offset:0 sc1
    global_load_lds_dwordx4 v1, s[40:41] offset:1024 sc1
    global_load_lds_dwordx4 v1, s[40:41] offset:2048 sc1
    global_load_lds_dwordx4 v1, s[40:41] offset:3072 sc1
L_front_late_10:
    s_waitcnt lgkmcnt(0)
    s_barrier
    ds_read_b64_tr_b16 v[176:177], v7 offset:0
    ds_read_b64_tr_b16 v[178:179], v7 offset:1280
    ds_read_b64_tr_b16 v[180:181], v8 offset:0
    ds_read_b64_tr_b16 v[182:183], v8 offset:1280
    ds_read_b64_tr_b16 v[184:185], v9 offset:0
    ds_read_b64_tr_b16 v[186:187], v9 offset:1280
    ds_read_b64_tr_b16 v[188:189], v10 offset:0
    ds_read_b64_tr_b16 v[190:191], v10 offset:1280
    ds_read_b64_tr_b16 v[192:193], v11 offset:0
    ds_read_b64_tr_b16 v[194:195], v11 offset:1280
    ds_read_b64_tr_b16 v[196:197], v7 offset:10240
    ds_read_b64_tr_b16 v[198:199], v7 offset:11520
    ds_read_b64_tr_b16 v[200:201], v8 offset:10240
    ds_read_b64_tr_b16 v[202:203], v8 offset:11520
    ds_read_b64_tr_b16 v[204:205], v9 offset:10240
    ds_read_b64_tr_b16 v[206:207], v9 offset:11520
    ds_read_b64_tr_b16 v[208:209], v10 offset:10240
    ds_read_b64_tr_b16 v[210:211], v10 offset:11520
    ds_read_b64_tr_b16 v[212:213], v11 offset:10240
    ds_read_b64_tr_b16 v[214:215], v11 offset:11520
    v_add_u32 v7, 20480, v7
    v_add_u32 v8, 20480, v8
    v_add_u32 v9, 20480, v9
    v_add_u32 v10, 20480, v10
    v_add_u32 v11, 20480, v11
    s_waitcnt lgkmcnt(0)
    s_barrier
    ds_read_b64_tr_b16 v[216:217], v7 offset:0
    ds_read_b64_tr_b16 v[218:219], v7 offset:1280
    ds_read_b64_tr_b16 v[220:221], v8 offset:0
    ds_read_b64_tr_b16 v[222:223], v8 offset:1280
    ds_read_b64_tr_b16 v[224:225], v9 offset:0
    ds_read_b64_tr_b16 v[226:227], v9 offset:1280
    ds_read_b64_tr_b16 v[228:229], v10 offset:0
    ds_read_b64_tr_b16 v[230:231], v10 offset:1280
    ds_read_b64_tr_b16 v[232:233], v11 offset:0
    ds_read_b64_tr_b16 v[234:235], v11 offset:1280
    ds_read_b64_tr_b16 v[236:237], v7 offset:10240
    ds_read_b64_tr_b16 v[238:239], v7 offset:11520
    ds_read_b64_tr_b16 v[240:241], v8 offset:10240
    ds_read_b64_tr_b16 v[242:243], v8 offset:11520
    ds_read_b64_tr_b16 v[244:245], v9 offset:10240
    ds_read_b64_tr_b16 v[246:247], v9 offset:11520
    ds_read_b64_tr_b16 v[248:249], v10 offset:10240
    ds_read_b64_tr_b16 v[250:251], v10 offset:11520
    ds_read_b64_tr_b16 v[252:253], v11 offset:10240
    ds_read_b64_tr_b16 v[254:255], v11 offset:11520
    s_cmp_eq_u32 s63, 1
    s_cbranch_scc1 L_front_early_11
    buffer_load_dword v14, v15, s[20:23], s37 offen sc1
    s_waitcnt vmcnt(0)
    v_cmp_ne_u32 vcc, 1, v14
    s_cbranch_vccnz L_front_poll_14
L_front_ok_15:
    s_add_u32 m0, s44, 0
    s_add_u32 s40, s58, 0
    global_load_lds_dwordx4 v1, s[40:41] offset:0 sc1
    global_load_lds_dwordx4 v1, s[40:41] offset:1024 sc1
    global_load_lds_dwordx4 v1, s[40:41] offset:2048 sc1
    global_load_lds_dwordx4 v1, s[40:41] offset:3072 sc1
    s_add_u32 m0, s44, 16384
    s_add_u32 s40, s59, 0
    global_load_lds_dwordx4 v1, s[40:41] offset:0 sc1
    global_load_lds_dwordx4 v1, s[40:41] offset:1024 sc1
    global_load_lds_dwordx4 v1, s[40:41] offset:2048 sc1
    global_load_lds_dwordx4 v1, s[40:41] offset:3072 sc1
    s_add_u32 m0, s44, 32768
    s_add_u32 s40, s60, 0
    global_load_lds_dwordx4 v1, s[40:41] offset:0 sc1
    global_load_lds_dwordx4 v1, s[40:41] offset:1024 sc1
    global_load_lds_dwordx4 v1, s[40:41] offset:2048 sc1
    global_load_lds_dwordx4 v1, s[40:41] offset:3072 sc1
L_front_early_11:
    s_cmp_eq_u32 s31, 2
    s_cbranch_scc1 L_front_vtype_3
    s_waitcnt vmcnt(8) lgkmcnt(0)
    s_barrier
    ds_read_b128 v[84:87], v19 offset:0
    ds_read_b128 v[88:91], v19 offset:256
    ds_read_b128 v[92:95], v19 offset:2048
    ds_read_b128 v[96:99], v19 offset:2304
    s_waitcnt lgkmcnt(2)
    v_mfma_f32_16x16x32_bf16 v[24:27], a[0:3], v[84:87], 0
    ds_read_b128 v[100:103], v19 offset:4096
    s_add_u32 m0, s44, 49152
    v_mfma_f32_16x16x32_bf16 v[28:31], a[4:7], v[84:87], 0
    ds_read_b128 v[104:107], v19 offset:4352
    s_add_u32 s40, s61, 0
    v_mfma_f32_16x16x32_bf16 v[32:35], a[8:11], v[84:87], 0
    v_mfma_f32_16x16x32_bf16 v[36:39], a[12:15], v[84:87], 0
    v_mfma_f32_16x16x32_bf16 v[40:43], a[16:19], v[84:87], 0
    global_load_lds_dwordx4 v1, s[40:41] offset:0 sc1
    v_mfma_f32_16x16x32_bf16 v[44:47], a[0:3], v[88:91], 0
    v_mfma_f32_16x16x32_bf16 v[48:51], a[4:7], v[88:91], 0
    v_mfma_f32_16x16x32_bf16 v[52:55], a[8:11], v[88:91], 0
    v_mfma_f32_16x16x32_bf16 v[56:59], a[12:15], v[88:91], 0
    global_load_lds_dwordx4 v1, s[40:41] offset:1024 sc1
    v_mfma_f32_16x16x32_bf16 v[60:63], a[16:19], v[88:91], 0
    s_waitcnt lgkmcnt(2)
    v_mfma_f32_16x16x32_bf16 v[24:27], a[20:23], v[92:95], v[24:27]
    buffer_load_dword v14, v15, s[20:23], s37 offen offset:512 sc1
    v_mfma_f32_16x16x32_bf16 v[28:31], a[24:27], v[92:95], v[28:31]
    ds_read_b128 v[84:87], v19 offset:6144
    v_mfma_f32_16x16x32_bf16 v[32:35], a[28:31], v[92:95], v[32:35]
    ds_read_b128 v[88:91], v19 offset:6400
    v_mfma_f32_16x16x32_bf16 v[36:39], a[32:35], v[92:95], v[36:39]
    global_load_lds_dwordx4 v1, s[40:41] offset:2048 sc1
    v_mfma_f32_16x16x32_bf16 v[40:43], a[36:39], v[92:95], v[40:43]
    v_mfma_f32_16x16x32_bf16 v[44:47], a[20:23], v[96:99], v[44:47]
    v_mfma_f32_16x16x32_bf16 v[48:51], a[24:27], v[96:99], v[48:51]
    global_load_lds_dwordx4 v1, s[40:41] offset:3072 sc1
    v_mfma_f32_16x16x32_bf16 v[52:55], a[28:31], v[96:99], v[52:55]
    v_mfma_f32_16x16x32_bf16 v[56:59], a[32:35], v[96:99], v[56:59]
    s_waitcnt vmcnt(9)
    s_barrier
    v_mfma_f32_16x16x32_bf16 v[60:63], a[36:39], v[96:99], v[60:63]
    s_waitcnt lgkmcnt(2)
    v_mfma_f32_16x16x32_bf16 v[24:27], a[40:43], v[100:103], v[24:27]
    ds_read_b128 v[92:95], v19 offset:16384
    s_add_u32 m0, s44, 65536
    v_mfma_f32_16x16x32_bf16 v[28:31], a[44:47], v[100:103], v[28:31]
    ds_read_b128 v[96:99], v19 offset:16640
    s_add_u32 s40, s62, 0
    v_mfma_f32_16x16x32_bf16 v[32:35], a[48:51], v[100:103], v[32:35]
    v_mfma_f32_16x16x32_bf16 v[36:39], a[52:55], v[100:103], v[36:39]
    v_mfma_f32_16x16x32_bf16 v[40:43], a[56:59], v[100:103], v[40:43]
    global_load_lds_dwordx4 v1, s[40:41] offset:0 sc1
    v_mfma_f32_16x16x32_bf16 v[44:47], a[40:43], v[104:107], v[44:47]
    v_mfma_f32_16x16x32_bf16 v[48:51], a[44:47], v[104:107], v[48:51]
    v_mfma_f32_16x16x32_bf16 v[52:55], a[48:51], v[104:107], v[52:55]
    v_mfma_f32_16x16x32_bf16 v[56:59], a[52:55], v[104:107], v[56:59]
    global_load_lds_dwordx4 v1, s[40:41] offset:1024 sc1
    v_mfma_f32_16x16x32_bf16 v[60:63], a[56:59], v[104:107], v[60:63]
    s_waitcnt lgkmcnt(2)
    v_mfma_f32_16x16x32_bf16 v[24:27], a[60:63], v[84:87], v[24:27]
    ds_read_b128 v[100:103], v19 offset:18432
    v_mfma_f32_16x16x32_bf16 v[28:31], a[64:67], v[84:87], v[28:31]
    ds_read_b128 v[104:107], v19 offset:18688
    v_mfma_f32_16x16x32_bf16 v[32:35], a[68:71], v[84:87], v[32:35]
    global_load_lds_dwordx4 v1, s[40:41] offset:2048 sc1
    v_mfma_f32_16x16x32_bf16 v[36:39], a[72:75], v[84:87], v[36:39]
    v_mfma_f32_16x16x32_bf16 v[40:43], a[76:79], v[84:87], v[40:43]
    v_mfma_f32_16x16x32_bf16 v[44:47], a[60:63], v[88:91], v[44:47]
    v_mfma_f32_16x16x32_bf16 v[48:51], a[64:67], v[88:91], v[48:51]
    global_load_lds_dwordx4 v1, s[40:41] offset:3072 sc1
    v_mfma_f32_16x16x32_bf16 v[52:55], a[68:71], v[88:91], v[52:55]
    v_mfma_f32_16x16x32_bf16 v[56:59], a[72:75], v[88:91], v[56:59]
    v_mfma_f32_16x16x32_bf16 v[60:63], a[76:79], v[88:91], v[60:63]
    s_waitcnt lgkmcnt(2)
    v_mfma_f32_16x16x32_bf16 v[24:27], a[80:83], v[92:95], v[24:27]
    ds_read_b128 v[84:87], v19 offset:20480
    v_mfma_f32_16x16x32_bf16 v[28:31], a[84:87], v[92:95], v[28:31]
    ds_read_b128 v[88:91], v19 offset:20736
    v_mfma_f32_16x16x32_bf16 v[32:35], a[88:91], v[92:95], v[32:35]
    v_mfma_f32_16x16x32_bf16 v[36:39], a[92:95], v[92:95], v[36:39]
    v_mfma_f32_16x16x32_bf16 v[40:43], a[96:99], v[92:95], v[40:43]
    v_mfma_f32_16x16x32_bf16 v[44:47], a[80:83], v[96:99], v[44:47]
    v_mfma_f32_16x16x32_bf16 v[48:51], a[84:87], v[96:99], v[48:51]
    v_mfma_f32_16x16x32_bf16 v[52:55], a[88:91], v[96:99], v[52:55]
    v_mfma_f32_16x16x32_bf16 v[56:59], a[92:95], v[96:99], v[56:59]
    v_mfma_f32_16x16x32_bf16 v[60:63], a[96:99], v[96:99], v[60:63]
    s_waitcnt lgkmcnt(2)
    v_mfma_f32_16x16x32_bf16 v[24:27], a[100:103], v[100:103], v[24:27]
    ds_read_b128 v[92:95], v19 offset:22528
    v_mfma_f32_16x16x32_bf16 v[28:31], a[104:107], v[100:103], v[28:31]
    ds_read_b128 v[96:99], v19 offset:22784
    v_mfma_f32_16x16x32_bf16 v[32:35], a[108:111], v[100:103], v[32:35]
    v_mfma_f32_16x16x32_bf16 v[36:39], a[112:115], v[100:103], v[36:39]
    v_mfma_f32_16x16x32_bf16 v[40:43], a[116:119], v[100:103], v[40:43]
    v_mfma_f32_16x16x32_bf16 v[44:47], a[100:103], v[104:107], v[44:47]
    v_mfma_f32_16x16x32_bf16 v[48:51], a[104:107], v[104:107], v[48:51]
    v_mfma_f32_16x16x32_bf16 v[52:55], a[108:111], v[104:107], v[52:55]
    v_mfma_f32_16x16x32_bf16 v[56:59], a[112:115], v[104:107], v[56:59]
    s_waitcnt vmcnt(9)
    s_barrier
    v_mfma_f32_16x16x32_bf16 v[60:63], a[116:119], v[104:107], v[60:63]
    s_waitcnt lgkmcnt(2)
    v_mfma_f32_16x16x32_bf16 v[24:27], a[120:123], v[84:87], v[24:27]
    ds_read_b128 v[100:103], v19 offset:32768
    v_mfma_f32_16x16x32_bf16 v[28:31], a[124:127], v[84:87], v[28:31]
    ds_read_b128 v[104:107], v19 offset:33024
    v_mfma_f32_16x16x32_bf16 v[32:35], a[128:131], v[84:87], v[32:35]
    v_mfma_f32_16x16x32_bf16 v[36:39], a[132:135], v[84:87], v[36:39]
    v_mfma_f32_16x16x32_bf16 v[40:43], a[136:139], v[84:87], v[40:43]
    v_mfma_f32_16x16x32_bf16 v[44:47], a[120:123], v[88:91], v[44:47]
    v_mfma_f32_16x16x32_bf16 v[48:51], a[124:127], v[88:91], v[48:51]
    v_mfma_f32_16x16x32_bf16 v[52:55], a[128:131], v[88:91], v[52:55]
    v_mfma_f32_16x16x32_bf16 v[56:59], a[132:135], v[88:91], v[56:59]
    v_mfma_f32_16x16x32_bf16 v[60:63], a[136:139], v[88:91], v[60:63]
    s_waitcnt lgkmcnt(2)
    v_mfma_f32_16x16x32_bf16 v[24:27], a[140:143], v[92:95], v[24:27]
    ds_read_b128 v[84:87], v19 offset:34816
    v_mfma_f32_16x16x32_bf16 v[28:31], a[144:147], v[92:95], v[28:31]
    ds_read_b128 v[88:91], v19 offset:35072
    v_mfma_f32_16x16x32_bf16 v[32:35], a[148:151], v[92:95], v[32:35]
    v_mfma_f32_16x16x32_bf16 v[36:39], a[152:155], v[92:95], v[36:39]
    v_mfma_f32_16x16x32_bf16 v[40:43], a[156:159], v[92:95], v[40:43]
    v_mfma_f32_16x16x32_bf16 v[44:47], a[140:143], v[96:99], v[44:47]
    v_mfma_f32_16x16x32_bf16 v[48:51], a[144:147], v[96:99], v[48:51]
    v_mfma_f32_16x16x32_bf16 v[52:55], a[148:151], v[96:99], v[52:55]
    s_waitcnt vmcnt(6)
    v_cmp_ne_u32 vcc, 1, v14
    s_cbranch_vccnz L_front_poll_16
L_front_ok_17:
    v_mfma_f32_16x16x32_bf16 v[56:59], a[152:155], v[96:99], v[56:59]
    v_mfma_f32_16x16x32_bf16 v[60:63], a[156:159], v[96:99], v[60:63]
    s_waitcnt lgkmcnt(2)
    v_mfma_f32_16x16x32_bf16 v[24:27], a[160:163], v[100:103], v[24:27]
    ds_read_b128 v[92:95], v19 offset:36864
    s_add_u32 m0, s44, 81920
    v_mfma_f32_16x16x32_bf16 v[28:31], a[164:167], v[100:103], v[28:31]
    ds_read_b128 v[96:99], v19 offset:37120
    s_add_u32 s40, s58, 40960
    v_mfma_f32_16x16x32_bf16 v[32:35], a[168:171], v[100:103], v[32:35]
    v_mfma_f32_16x16x32_bf16 v[36:39], a[172:175], v[100:103], v[36:39]
    v_mfma_f32_16x16x32_bf16 v[40:43], a[176:179], v[100:103], v[40:43]
    global_load_lds_dwordx4 v1, s[40:41] offset:0 sc1
    v_mfma_f32_16x16x32_bf16 v[44:47], a[160:163], v[104:107], v[44:47]
    v_mfma_f32_16x16x32_bf16 v[48:51], a[164:167], v[104:107], v[48:51]
    v_mfma_f32_16x16x32_bf16 v[52:55], a[168:171], v[104:107], v[52:55]
    v_mfma_f32_16x16x32_bf16 v[56:59], a[172:175], v[104:107], v[56:59]
    global_load_lds_dwordx4 v1, s[40:41] offset:1024 sc1
    v_mfma_f32_16x16x32_bf16 v[60:63], a[176:179], v[104:107], v[60:63]
    s_waitcnt lgkmcnt(2)
    v_mfma_f32_16x16x32_bf16 v[24:27], a[180:183], v[84:87], v[24:27]
    ds_read_b128 v[100:103], v19 offset:38912
    v_mfma_f32_16x16x32_bf16 v[28:31], a[184:187], v[84:87], v[28:31]
    ds_read_b128 v[104:107], v19 offset:39168
    v_mfma_f32_16x16x32_bf16 v[32:35], a[188:191], v[84:87], v[32:35]
    global_load_lds_dwordx4 v1, s[40:41] offset:2048 sc1
    v_mfma_f32_16x16x32_bf16 v[36:39], a[192:195], v[84:87], v[36:39]
    v_mfma_f32_16x16x32_bf16 v[40:43], a[196:199], v[84:87], v[40:43]
    v_mfma_f32_16x16x32_bf16 v[44:47], a[180:183], v[88:91], v[44:47]
    v_mfma_f32_16x16x32_bf16 v[48:51], a[184:187], v[88:91], v[48:51]
    global_load_lds_dwordx4 v1, s[40:41] offset:3072 sc1
    v_mfma_f32_16x16x32_bf16 v[52:55], a[188:191], v[88:91], v[52:55]
    v_mfma_f32_16x16x32_bf16 v[56:59], a[192:195], v[88:91], v[56:59]
    s_waitcnt vmcnt(8)
    s_barrier
    v_mfma_f32_16x16x32_bf16 v[60:63], a[196:199], v[88:91], v[60:63]
    s_waitcnt lgkmcnt(2)
    v_mfma_f32_16x16x32_bf16 v[24:27], a[200:203], v[92:95], v[24:27]
    ds_read_b128 v[84:87], v19 offset:49152
    s_add_u32 m0, s44, 98304
    v_mfma_f32_16x16x32_bf16 v[28:31], a[204:207], v[92:95], v[28:31]
    ds_read_b128 v[88:91], v19 offset:49408
    s_add_u32 s40, s59, 40960
    v_mfma_f32_16x16x32_bf16 v[32:35], a[208:211], v[92:95], v[32:35]
    v_mfma_f32_16x16x32_bf16 v[36:39], a[212:215], v[92:95], v[36:39]
    v_mfma_f32_16x16x32_bf16 v[40:43], a[216:219], v[92:95], v[40:43]
    global_load_lds_dwordx4 v1, s[40:41] offset:0 sc1
    v_mfma_f32_16x16x32_bf16 v[44:47], a[200:203], v[96:99], v[44:47]
    v_mfma_f32_16x16x32_bf16 v[48:51], a[204:207], v[96:99], v[48:51]
    v_mfma_f32_16x16x32_bf16 v[52:55], a[208:211], v[96:99], v[52:55]
    v_mfma_f32_16x16x32_bf16 v[56:59], a[212:215], v[96:99], v[56:59]
    global_load_lds_dwordx4 v1, s[40:41] offset:1024 sc1
    v_mfma_f32_16x16x32_bf16 v[60:63], a[216:219], v[96:99], v[60:63]
    s_waitcnt lgkmcnt(2)
    v_mfma_f32_16x16x32_bf16 v[24:27], a[220:223], v[100:103], v[24:27]
    ds_read_b128 v[92:95], v19 offset:51200
    v_mfma_f32_16x16x32_bf16 v[28:31], a[224:227], v[100:103], v[28:31]
    ds_read_b128 v[96:99], v19 offset:51456
    v_mfma_f32_16x16x32_bf16 v[32:35], a[228:231], v[100:103], v[32:35]
    global_load_lds_dwordx4 v1, s[40:41] offset:2048 sc1
    v_mfma_f32_16x16x32_bf16 v[36:39], a[232:235], v[100:103], v[36:39]
    v_mfma_f32_16x16x32_bf16 v[40:43], a[236:239], v[100:103], v[40:43]
    v_mfma_f32_16x16x32_bf16 v[44:47], a[220:223], v[104:107], v[44:47]
    v_mfma_f32_16x16x32_bf16 v[48:51], a[224:227], v[104:107], v[48:51]
    global_load_lds_dwordx4 v1, s[40:41] offset:3072 sc1
    v_mfma_f32_16x16x32_bf16 v[52:55], a[228:231], v[104:107], v[52:55]
    v_mfma_f32_16x16x32_bf16 v[56:59], a[232:235], v[104:107], v[56:59]
    v_mfma_f32_16x16x32_bf16 v[60:63], a[236:239], v[104:107], v[60:63]
    s_waitcnt lgkmcnt(2)
    v_mfma_f32_16x16x32_bf16 v[24:27], a[240:243], v[84:87], v[24:27]
    ds_read_b128 v[100:103], v19 offset:53248
    s_add_u32 m0, s44, 114688
    v_mfma_f32_16x16x32_bf16 v[28:31], a[244:247], v[84:87], v[28:31]
    ds_read_b128 v[104:107], v19 offset:53504
    s_add_u32 s40, s60, 40960
    v_mfma_f32_16x16x32_bf16 v[32:35], a[248:251], v[84:87], v[32:35]
    v_mfma_f32_16x16x32_bf16 v[36:39], a[252:255], v[84:87], v[36:39]
    v_mfma_f32_16x16x32_bf16 v[40:43], v[112:115], v[84:87], v[40:43]
    global_load_lds_dwordx4 v1, s[40:41] offset:0 sc1
    v_mfma_f32_16x16x32_bf16 v[44:47], a[240:243], v[88:91], v[44:47]
    v_mfma_f32_16x16x32_bf16 v[48:51], a[244:247], v[88:91], v[48:51]
    v_mfma_f32_16x16x32_bf16 v[52:55], a[248:251], v[88:91], v[52:55]
    v_mfma_f32_16x16x32_bf16 v[56:59], a[252:255], v[88:91], v[56:59]
    global_load_lds_dwordx4 v1, s[40:41] offset:1024 sc1
    v_mfma_f32_16x16x32_bf16 v[60:63], v[112:115], v[88:91], v[60:63]
    s_waitcnt lgkmcnt(2)
    v_mfma_f32_16x16x32_bf16 v[24:27], v[116:119], v[92:95], v[24:27]
    ds_read_b128 v[84:87], v19 offset:55296
    v_mfma_f32_16x16x32_bf16 v[28:31], v[120:123], v[92:95], v[28:31]
    ds_read_b128 v[88:91], v19 offset:55552
    v_mfma_f32_16x16x32_bf16 v[32:35], v[124:127], v[92:95], v[32:35]
    global_load_lds_dwordx4 v1, s[40:41] offset:2048 sc1
    v_mfma_f32_16x16x32_bf16 v[36:39], v[128:131], v[92:95], v[36:39]
    v_mfma_f32_16x16x32_bf16 v[40:43], v[132:135], v[92:95], v[40:43]
    v_mfma_f32_16x16x32_bf16 v[44:47], v[116:119], v[96:99], v[44:47]
    v_mfma_f32_16x16x32_bf16 v[48:51], v[120:123], v[96:99], v[48:51]
    global_load_lds_dwordx4 v1, s[40:41] offset:3072 sc1
    v_mfma_f32_16x16x32_bf16 v[52:55], v[124:127], v[96:99], v[52:55]
    v_mfma_f32_16x16x32_bf16 v[56:59], v[128:131], v[96:99], v[56:59]
    s_waitcnt vmcnt(12)
    s_barrier
    v_mfma_f32_16x16x32_bf16 v[60:63], v[132:135], v[96:99], v[60:63]
    s_waitcnt lgkmcnt(2)
    v_mfma_f32_16x16x32_bf16 v[24:27], v[136:139], v[100:103], v[24:27]
    ds_read_b128 v[92:95], v20 offset:0
    s_add_u32 m0, s44, 131072
    v_mfma_f32_16x16x32_bf16 v[28:31], v[140:143], v[100:103], v[28:31]
    ds_read_b128 v[96:99], v20 offset:256
    s_add_u32 s40, s61, 40960
    v_mfma_f32_16x16x32_bf16 v[32:35], v[144:147], v[100:103], v[32:35]
    v_mfma_f32_16x16x32_bf16 v[36:39], v[148:151], v[100:103], v[36:39]
    v_mfma_f32_16x16x32_bf16 v[40:43], v[152:155], v[100:103], v[40:43]
    global_load_lds_dwordx4 v1, s[40:41] offset:0 sc1
    v_mfma_f32_16x16x32_bf16 v[44:47], v[136:139], v[104:107], v[44:47]
    v_mfma_f32_16x16x32_bf16 v[48:51], v[140:143], v[104:107], v[48:51]
    v_mfma_f32_16x16x32_bf16 v[52:55], v[144:147], v[104:107], v[52:55]
    v_mfma_f32_16x16x32_bf16 v[56:59], v[148:151], v[104:107], v[56:59]
    global_load_lds_dwordx4 v1, s[40:41] offset:1024 sc1
    v_mfma_f32_16x16x32_bf16 v[60:63], v[152:155], v[104:107], v[60:63]
    s_waitcnt lgkmcnt(2)
    v_mfma_f32_16x16x32_bf16 v[24:27], v[156:159], v[84:87], v[24:27]
    ds_read_b128 v[100:103], v20 offset:2048
    v_mfma_f32_16x16x32_bf16 v[28:31], v[160:163], v[84:87], v[28:31]
    ds_read_b128 v[104:107], v20 offset:2304
    v_mfma_f32_16x16x32_bf16 v[32:35], v[164:167], v[84:87], v[32:35]
    global_load_lds_dwordx4 v1, s[40:41] offset:2048 sc1
    v_mfma_f32_16x16x32_bf16 v[36:39], v[168:171], v[84:87], v[36:39]
    v_mfma_f32_16x16x32_bf16 v[40:43], v[172:175], v[84:87], v[40:43]
    v_mfma_f32_16x16x32_bf16 v[44:47], v[156:159], v[88:91], v[44:47]
    v_mfma_f32_16x16x32_bf16 v[48:51], v[160:163], v[88:91], v[48:51]
    global_load_lds_dwordx4 v1, s[40:41] offset:3072 sc1
    v_mfma_f32_16x16x32_bf16 v[52:55], v[164:167], v[88:91], v[52:55]
    v_mfma_f32_16x16x32_bf16 v[56:59], v[168:171], v[88:91], v[56:59]
    v_mfma_f32_16x16x32_bf16 v[60:63], v[172:175], v[88:91], v[60:63]
    s_waitcnt lgkmcnt(2)
    v_mfma_f32_16x16x32_bf16 v[24:27], v[176:179], v[92:95], v[24:27]
    ds_read_b128 v[84:87], v20 offset:4096
    s_add_u32 m0, s44, 147456
    v_mfma_f32_16x16x32_bf16 v[28:31], v[180:183], v[92:95], v[28:31]
    ds_read_b128 v[88:91], v20 offset:4352
    s_add_u32 s40, s62, 40960
    v_mfma_f32_16x16x32_bf16 v[32:35], v[184:187], v[92:95], v[32:35]
    v_mfma_f32_16x16x32_bf16 v[36:39], v[188:191], v[92:95], v[36:39]
    v_mfma_f32_16x16x32_bf16 v[40:43], v[192:195], v[92:95], v[40:43]
    global_load_lds_dwordx4 v1, s[40:41] offset:0 sc1
    v_mfma_f32_16x16x32_bf16 v[44:47], v[176:179], v[96:99], v[44:47]
    v_mfma_f32_16x16x32_bf16 v[48:51], v[180:183], v[96:99], v[48:51]
    v_mfma_f32_16x16x32_bf16 v[52:55], v[184:187], v[96:99], v[52:55]
    v_mfma_f32_16x16x32_bf16 v[56:59], v[188:191], v[96:99], v[56:59]
    global_load_lds_dwordx4 v1, s[40:41] offset:1024 sc1
    v_mfma_f32_16x16x32_bf16 v[60:63], v[192:195], v[96:99], v[60:63]
    s_waitcnt lgkmcnt(2)
    v_mfma_f32_16x16x32_bf16 v[24:27], v[196:199], v[100:103], v[24:27]
    ds_read_b128 v[92:95], v20 offset:6144
    v_mfma_f32_16x16x32_bf16 v[28:31], v[200:203], v[100:103], v[28:31]
    ds_read_b128 v[96:99], v20 offset:6400
    v_mfma_f32_16x16x32_bf16 v[32:35], v[204:207], v[100:103], v[32:35]
    global_load_lds_dwordx4 v1, s[40:41] offset:2048 sc1
    v_mfma_f32_16x16x32_bf16 v[36:39], v[208:211], v[100:103], v[36:39]
    v_mfma_f32_16x16x32_bf16 v[40:43], v[212:215], v[100:103], v[40:43]
    v_mfma_f32_16x16x32_bf16 v[44:47], v[196:199], v[104:107], v[44:47]
    v_mfma_f32_16x16x32_bf16 v[48:51], v[200:203], v[104:107], v[48:51]
    global_load_lds_dwordx4 v1, s[40:41] offset:3072 sc1
    v_mfma_f32_16x16x32_bf16 v[52:55], v[204:207], v[104:107], v[52:55]
    v_mfma_f32_16x16x32_bf16 v[56:59], v[208:211], v[104:107], v[56:59]
    s_waitcnt vmcnt(16)
    s_barrier
    v_mfma_f32_16x16x32_bf16 v[60:63], v[212:215], v[104:107], v[60:63]
    s_waitcnt lgkmcnt(2)
    v_mfma_f32_16x16x32_bf16 v[24:27], v[216:219], v[84:87], v[24:27]
    ds_read_b128 v[100:103], v20 offset:16384
    v_mfma_f32_16x16x32_bf16 v[28:31], v[220:223], v[84:87], v[28:31]
    ds_read_b128 v[104:107], v20 offset:16640
    v_mfma_f32_16x16x32_bf16 v[32:35], v[224:227], v[84:87], v[32:35]
    v_mfma_f32_16x16x32_bf16 v[36:39], v[228:231], v[84:87], v[36:39]
    v_mfma_f32_16x16x32_bf16 v[40:43], v[232:235], v[84:87], v[40:43]
    v_mfma_f32_16x16x32_bf16 v[44:47], v[216:219], v[88:91], v[44:47]
    v_mfma_f32_16x16x32_bf16 v[48:51], v[220:223], v[88:91], v[48:51]
    v_mfma_f32_16x16x32_bf16 v[52:55], v[224:227], v[88:91], v[52:55]
    v_mfma_f32_16x16x32_bf16 v[56:59], v[228:231], v[88:91], v[56:59]
    v_mfma_f32_16x16x32_bf16 v[60:63], v[232:235], v[88:91], v[60:63]
    s_waitcnt lgkmcnt(2)
    v_mfma_f32_16x16x32_bf16 v[24:27], v[236:239], v[92:95], v[24:27]
    ds_read_b128 v[84:87], v20 offset:18432
    v_mfma_f32_16x16x32_bf16 v[28:31], v[240:243], v[92:95], v[28:31]
    ds_read_b128 v[88:91], v20 offset:18688
    v_mfma_f32_16x16x32_bf16 v[32:35], v[244:247], v[92:95], v[32:35]
    v_mfma_f32_16x16x32_bf16 v[36:39], v[248:251], v[92:95], v[36:39]
    v_mfma_f32_16x16x32_bf16 v[40:43], v[252:255], v[92:95], v[40:43]
    v_mfma_f32_16x16x32_bf16 v[44:47], v[236:239], v[96:99], v[44:47]
    v_mfma_f32_16x16x32_bf16 v[48:51], v[240:243], v[96:99], v[48:51]
    v_mfma_f32_16x16x32_bf16 v[52:55], v[244:247], v[96:99], v[52:55]
    v_mfma_f32_16x16x32_bf16 v[56:59], v[248:251], v[96:99], v[56:59]
    v_mfma_f32_16x16x32_bf16 v[60:63], v[252:255], v[96:99], v[60:63]
    s_waitcnt lgkmcnt(2)
    v_mul_f32 v24, s50, v24
    v_mul_f32 v25, s50, v25
    v_mul_f32 v26, s50, v26
    v_mul_f32 v27, s50, v27
    v_cvt_pk_bf16_f32 v64, v24, v25
    v_cvt_pk_bf16_f32 v65, v26, v27
    v_mfma_f32_16x16x32_bf16 v[24:27], a[0:3], v[100:103], 0
    ds_read_b128 v[92:95], v20 offset:20480
    v_mul_f32 v28, s50, v28
    v_mul_f32 v29, s50, v29
    v_mul_f32 v30, s50, v30
    v_mul_f32 v31, s50, v31
    v_cvt_pk_bf16_f32 v68, v28, v29
    v_cvt_pk_bf16_f32 v69, v30, v31
    v_mfma_f32_16x16x32_bf16 v[28:31], a[4:7], v[100:103], 0
    v_mul_f32 v32, s50, v32
    v_mul_f32 v33, s50, v33
    v_mul_f32 v34, s50, v34
    v_mul_f32 v35, s50, v35
    v_cvt_pk_bf16_f32 v72, v32, v33
    v_cvt_pk_bf16_f32 v73, v34, v35
    v_mfma_f32_16x16x32_bf16 v[32:35], a[8:11], v[100:103], 0
    v_mul_f32 v36, s50, v36
    v_mul_f32 v37, s50, v37
    v_mul_f32 v38, s50, v38
    v_mul_f32 v39, s50, v39
    v_cvt_pk_bf16_f32 v76, v36, v37
    v_cvt_pk_bf16_f32 v77, v38, v39
    v_mfma_f32_16x16x32_bf16 v[36:39], a[12:15], v[100:103], 0
    v_mul_f32 v40, s50, v40
    v_mul_f32 v41, s50, v41
    v_mul_f32 v42, s50, v42
    v_mul_f32 v43, s50, v43
    v_cvt_pk_bf16_f32 v80, v40, v41
    v_cvt_pk_bf16_f32 v81, v42, v43
    v_mfma_f32_16x16x32_bf16 v[40:43], a[16:19], v[100:103], 0
    v_mul_f32 v44, s50, v44
    v_mul_f32 v45, s50, v45
    v_mul_f32 v46, s50, v46
    v_mul_f32 v47, s50, v47
    v_cvt_pk_bf16_f32 v66, v44, v45
    v_cvt_pk_bf16_f32 v67, v46, v47
    v_mfma_f32_16x16x32_bf16 v[44:47], a[0:3], v[104:107], 0
    ds_read_b128 v[96:99], v20 offset:20736
    v_mul_f32 v48, s50, v48
    v_mul_f32 v49, s50, v49
    v_mul_f32 v50, s50, v50
    v_mul_f32 v51, s50, v51
    v_cvt_pk_bf16_f32 v70, v48, v49
    v_cvt_pk_bf16_f32 v71, v50, v51
    v_mfma_f32_16x16x32_bf16 v[48:51], a[4:7], v[104:107], 0
    v_mul_f32 v52, s50, v52
    v_mul_f32 v53, s50, v53
    v_mul_f32 v54, s50, v54
    v_mul_f32 v55, s50, v55
    v_cvt_pk_bf16_f32 v74, v52, v53
    v_cvt_pk_bf16_f32 v75, v54, v55
    v_mfma_f32_16x16x32_bf16 v[52:55], a[8:11], v[104:107], 0
    v_mul_f32 v56, s50, v56
    v_mul_f32 v57, s50, v57
    v_mul_f32 v58, s50, v58
    v_mul_f32 v59, s50, v59
    v_cvt_pk_bf16_f32 v78, v56, v57
    v_cvt_pk_bf16_f32 v79, v58, v59
    v_mfma_f32_16x16x32_bf16 v[56:59], a[12:15], v[104:107], 0
    v_mul_f32 v60, s50, v60
    v_mul_f32 v61, s50, v61
    v_mul_f32 v62, s50, v62
    v_mul_f32 v63, s50, v63
    v_cvt_pk_bf16_f32 v82, v60, v61
    v_cvt_pk_bf16_f32 v83, v62, v63
    v_mfma_f32_16x16x32_bf16 v[60:63], a[16:19], v[104:107], 0
    s_waitcnt lgkmcnt(2)
    v_mfma_f32_16x16x32_bf16 v[24:27], a[20:23], v[84:87], v[24:27]
    v_permlane16_swap_b32 v64, v66
    v_mfma_f32_16x16x32_bf16 v[28:31], a[24:27], v[84:87], v[28:31]
    v_permlane16_swap_b32 v65, v67
    v_mfma_f32_16x16x32_bf16 v[32:35], a[28:31], v[84:87], v[32:35]
    buffer_store_dwordx4 v[64:67], v1, s[20:23], s52 offen offset:0 sc1
    v_mfma_f32_16x16x32_bf16 v[36:39], a[32:35], v[84:87], v[36:39]
    ds_read_b128 v[100:103], v20 offset:22528
    v_mfma_f32_16x16x32_bf16 v[40:43], a[36:39], v[84:87], v[40:43]
    ds_read_b128 v[104:107], v20 offset:22784
    v_mfma_f32_16x16x32_bf16 v[44:47], a[20:23], v[88:91], v[44:47]
    v_permlane16_swap_b32 v68, v70
    v_mfma_f32_16x16x32_bf16 v[48:51], a[24:27], v[88:91], v[48:51]
    v_permlane16_swap_b32 v69, v71
    v_mfma_f32_16x16x32_bf16 v[52:55], a[28:31], v[88:91], v[52:55]
    v_permlane16_swap_b32 v72, v74
    v_mfma_f32_16x16x32_bf16 v[56:59], a[32:35], v[88:91], v[56:59]
    s_waitcnt vmcnt(13)
    s_barrier
    v_permlane16_swap_b32 v73, v75
    v_mfma_f32_16x16x32_bf16 v[60:63], a[36:39], v[88:91], v[60:63]
    s_waitcnt lgkmcnt(2)
    v_permlane16_swap_b32 v76, v78
    v_mfma_f32_16x16x32_bf16 v[24:27], a[40:43], v[92:95], v[24:27]
    v_permlane16_swap_b32 v77, v79
    v_mfma_f32_16x16x32_bf16 v[28:31], a[44:47], v[92:95], v[28:31]
    buffer_store_dwordx4 v[68:71], v1, s[20:23], s53 offen offset:0 sc1
    s_add_u32 s53, s53, s47
    v_mfma_f32_16x16x32_bf16 v[32:35], a[48:51], v[92:95], v[32:35]
    buffer_store_dwordx4 v[72:75], v1, s[20:23], s54 offen offset:0 sc1
    s_add_u32 s54, s54, s47
    v_mfma_f32_16x16x32_bf16 v[36:39], a[52:55], v[92:95], v[36:39]
    ds_read_b128 v[84:87], v20 offset:32768
    v_mfma_f32_16x16x32_bf16 v[40:43], a[56:59], v[92:95], v[40:43]
    ds_read_b128 v[88:91], v20 offset:33024
    v_mfma_f32_16x16x32_bf16 v[44:47], a[40:43], v[96:99], v[44:47]
    buffer_store_dwordx4 v[76:79], v1, s[20:23], s55 offen offset:0 sc1
    s_add_u32 s55, s55, s47
    v_mfma_f32_16x16x32_bf16 v[48:51], a[44:47], v[96:99], v[48:51]
    buffer_store_dwordx2 v[80:81], v16, s[20:23], s52 offen offset:1024 sc1
    v_mfma_f32_16x16x32_bf16 v[52:55], a[48:51], v[96:99], v[52:55]
    buffer_store_dwordx2 v[82:83], v16, s[20:23], s52 offen offset:1152 sc1
    s_add_u32 s52, s52, s47
    v_mfma_f32_16x16x32_bf16 v[56:59], a[52:55], v[96:99], v[56:59]
    v_mfma_f32_16x16x32_bf16 v[60:63], a[56:59], v[96:99], v[60:63]
    s_waitcnt lgkmcnt(2)
    v_mfma_f32_16x16x32_bf16 v[24:27], a[60:63], v[100:103], v[24:27]
    ds_read_b128 v[92:95], v20 offset:34816
    v_mfma_f32_16x16x32_bf16 v[28:31], a[64:67], v[100:103], v[28:31]
    ds_read_b128 v[96:99], v20 offset:35072
    v_mfma_f32_16x16x32_bf16 v[32:35], a[68:71], v[100:103], v[32:35]
    v_mfma_f32_16x16x32_bf16 v[36:39], a[72:75], v[100:103], v[36:39]
    v_mfma_f32_16x16x32_bf16 v[40:43], a[76:79], v[100:103], v[40:43]
    v_mfma_f32_16x16x32_bf16 v[44:47], a[60:63], v[104:107], v[44:47]
    v_mfma_f32_16x16x32_bf16 v[48:51], a[64:67], v[104:107], v[48:51]
    v_mfma_f32_16x16x32_bf16 v[52:55], a[68:71], v[104:107], v[52:55]
    v_mfma_f32_16x16x32_bf16 v[56:59], a[72:75], v[104:107], v[56:59]
    v_mfma_f32_16x16x32_bf16 v[60:63], a[76:79], v[104:107], v[60:63]
    s_waitcnt lgkmcnt(2)
    v_mfma_f32_16x16x32_bf16 v[24:27], a[80:83], v[84:87], v[24:27]
    ds_read_b128 v[100:103], v20 offset:36864
    v_mfma_f32_16x16x32_bf16 v[28:31], a[84:87], v[84:87], v[28:31]
    ds_read_b128 v[104:107], v20 offset:37120
    v_mfma_f32_16x16x32_bf16 v[32:35], a[88:91], v[84:87], v[32:35]
    v_mfma_f32_16x16x32_bf16 v[36:39], a[92:95], v[84:87], v[36:39]
    v_mfma_f32_16x16x32_bf16 v[40:43], a[96:99], v[84:87], v[40:43]
    v_mfma_f32_16x16x32_bf16 v[44:47], a[80:83], v[88:91], v[44:47]
    v_mfma_f32_16x16x32_bf16 v[48:51], a[84:87], v[88:91], v[48:51]
    v_mfma_f32_16x16x32_bf16 v[52:55], a[88:91], v[88:91], v[52:55]
    v_mfma_f32_16x16x32_bf16 v[56:59], a[92:95], v[88:91], v[56:59]
    v_mfma_f32_16x16x32_bf16 v[60:63], a[96:99], v[88:91], v[60:63]
    s_waitcnt lgkmcnt(2)
    v_mfma_f32_16x16x32_bf16 v[24:27], a[100:103], v[92:95], v[24:27]
    ds_read_b128 v[84:87], v20 offset:38912
    v_mfma_f32_16x16x32_bf16 v[28:31], a[104:107], v[92:95], v[28:31]
    ds_read_b128 v[88:91], v20 offset:39168
    v_mfma_f32_16x16x32_bf16 v[32:35], a[108:111], v[92:95], v[32:35]
    v_mfma_f32_16x16x32_bf16 v[36:39], a[112:115], v[92:95], v[36:39]
    v_mfma_f32_16x16x32_bf16 v[40:43], a[116:119], v[92:95], v[40:43]
    v_mfma_f32_16x16x32_bf16 v[44:47], a[100:103], v[96:99], v[44:47]
    v_mfma_f32_16x16x32_bf16 v[48:51], a[104:107], v[96:99], v[48:51]
    v_mfma_f32_16x16x32_bf16 v[52:55], a[108:111], v[96:99], v[52:55]
    v_mfma_f32_16x16x32_bf16 v[56:59], a[112:115], v[96:99], v[56:59]
    s_waitcnt vmcnt(14)
    s_barrier
    v_mfma_f32_16x16x32_bf16 v[60:63], a[116:119], v[96:99], v[60:63]
    s_waitcnt lgkmcnt(2)
    v_mfma_f32_16x16x32_bf16 v[24:27], a[120:123], v[100:103], v[24:27]
    ds_read_b128 v[92:95], v20 offset:49152
    v_mfma_f32_16x16x32_bf16 v[28:31], a[124:127], v[100:103], v[28:31]
    ds_read_b128 v[96:99], v20 offset:49408
    v_mfma_f32_16x16x32_bf16 v[32:35], a[128:131], v[100:103], v[32:35]
    v_mfma_f32_16x16x32_bf16 v[36:39], a[132:135], v[100:103], v[36:39]
    v_mfma_f32_16x16x32_bf16 v[40:43], a[136:139], v[100:103], v[40:43]
    v_mfma_f32_16x16x32_bf16 v[44:47], a[120:123], v[104:107], v[44:47]
    v_mfma_f32_16x16x32_bf16 v[48:51], a[124:127], v[104:107], v[48:51]
    v_mfma_f32_16x16x32_bf16 v[52:55], a[128:131], v[104:107], v[52:55]
    v_mfma_f32_16x16x32_bf16 v[56:59], a[132:135], v[104:107], v[56:59]
    v_mfma_f32_16x16x32_bf16 v[60:63], a[136:139], v[104:107], v[60:63]
    s_waitcnt lgkmcnt(2)
    v_mfma_f32_16x16x32_bf16 v[24:27], a[140:143], v[84:87], v[24:27]
    ds_read_b128 v[100:103], v20 offset:51200
    v_mfma_f32_16x16x32_bf16 v[28:31], a[144:147], v[84:87], v[28:31]
    ds_read_b128 v[104:107], v20 offset:51456
    v_mfma_f32_16x16x32_bf16 v[32:35], a[148:151], v[84:87], v[32:35]
    v_mfma_f32_16x16x32_bf16 v[36:39], a[152:155], v[84:87], v[36:39]
    v_mfma_f32_16x16x32_bf16 v[40:43], a[156:159], v[84:87], v[40:43]
    v_mfma_f32_16x16x32_bf16 v[44:47], a[140:143], v[88:91], v[44:47]
    v_mfma_f32_16x16x32_bf16 v[48:51], a[144:147], v[88:91], v[48:51]
    v_mfma_f32_16x16x32_bf16 v[52:55], a[148:151], v[88:91], v[52:55]
    v_mfma_f32_16x16x32_bf16 v[56:59], a[152:155], v[88:91], v[56:59]
    v_mfma_f32_16x16x32_bf16 v[60:63], a[156:159], v[88:91], v[60:63]
    s_waitcnt lgkmcnt(2)
    v_mfma_f32_16x16x32_bf16 v[24:27], a[160:163], v[92:95], v[24:27]
    ds_read_b128 v[84:87], v20 offset:53248
    v_mfma_f32_16x16x32_bf16 v[28:31], a[164:167], v[92:95], v[28:31]
    ds_read_b128 v[88:91], v20 offset:53504
    v_mfma_f32_16x16x32_bf16 v[32:35], a[168:171], v[92:95], v[32:35]
    v_mfma_f32_16x16x32_bf16 v[36:39], a[172:175], v[92:95], v[36:39]
    v_mfma_f32_16x16x32_bf16 v[40:43], a[176:179], v[92:95], v[40:43]
    v_mfma_f32_16x16x32_bf16 v[44:47], a[160:163], v[96:99], v[44:47]
    v_mfma_f32_16x16x32_bf16 v[48:51], a[164:167], v[96:99], v[48:51]
    v_mfma_f32_16x16x32_bf16 v[52:55], a[168:171], v[96:99], v[52:55]
    v_mfma_f32_16x16x32_bf16 v[56:59], a[172:175], v[96:99], v[56:59]
    v_mfma_f32_16x16x32_bf16 v[60:63], a[176:179], v[96:99], v[60:63]
    s_waitcnt lgkmcnt(2)
    v_mfma_f32_16x16x32_bf16 v[24:27], a[180:183], v[100:103], v[24:27]
    ds_read_b128 v[92:95], v20 offset:55296
    v_mfma_f32_16x16x32_bf16 v[28:31], a[184:187], v[100:103], v[28:31]
    ds_read_b128 v[96:99], v20 offset:55552
    v_mfma_f32_16x16x32_bf16 v[32:35], a[188:191], v[100:103], v[32:35]
    v_mfma_f32_16x16x32_bf16 v[36:39], a[192:195], v[100:103], v[36:39]
    v_mfma_f32_16x16x32_bf16 v[40:43], a[196:199], v[100:103], v[40:43]
    v_mfma_f32_16x16x32_bf16 v[44:47], a[180:183], v[104:107], v[44:47]
    v_mfma_f32_16x16x32_bf16 v[48:51], a[184:187], v[104:107], v[48:51]
    v_mfma_f32_16x16x32_bf16 v[52:55], a[188:191], v[104:107], v[52:55]
    v_mfma_f32_16x16x32_bf16 v[56:59], a[192:195], v[104:107], v[56:59]
    s_waitcnt vmcnt(10)
    s_barrier
    v_mfma_f32_16x16x32_bf16 v[60:63], a[196:199], v[104:107], v[60:63]
    s_waitcnt lgkmcnt(2)
    v_mfma_f32_16x16x32_bf16 v[24:27], a[200:203], v[84:87], v[24:27]
    ds_read_b128 v[100:103], v21 offset:0
    v_mfma_f32_16x16x32_bf16 v[28:31], a[204:207], v[84:87], v[28:31]
    ds_read_b128 v[104:107], v21 offset:256
    v_mfma_f32_16x16x32_bf16 v[32:35], a[208:211], v[84:87], v[32:35]
    v_mfma_f32_16x16x32_bf16 v[36:39], a[212:215], v[84:87], v[36:39]
    v_mfma_f32_16x16x32_bf16 v[40:43], a[216:219], v[84:87], v[40:43]
    v_mfma_f32_16x16x32_bf16 v[44:47], a[200:203], v[88:91], v[44:47]
    v_mfma_f32_16x16x32_bf16 v[48:51], a[204:207], v[88:91], v[48:51]
    v_mfma_f32_16x16x32_bf16 v[52:55], a[208:211], v[88:91], v[52:55]
    v_mfma_f32_16x16x32_bf16 v[56:59], a[212:215], v[88:91], v[56:59]
    v_mfma_f32_16x16x32_bf16 v[60:63], a[216:219], v[88:91], v[60:63]
    s_waitcnt lgkmcnt(2)
    v_mfma_f32_16x16x32_bf16 v[24:27], a[220:223], v[92:95], v[24:27]
    ds_read_b128 v[84:87], v21 offset:2048
    v_mfma_f32_16x16x32_bf16 v[28:31], a[224:227], v[92:95], v[28:31]
    ds_read_b128 v[88:91], v21 offset:2304
    v_mfma_f32_16x16x32_bf16 v[32:35], a[228:231], v[92:95], v[32:35]
    v_mfma_f32_16x16x32_bf16 v[36:39], a[232:235], v[92:95], v[36:39]
    v_mfma_f32_16x16x32_bf16 v[40:43], a[236:239], v[92:95], v[40:43]
    v_mfma_f32_16x16x32_bf16 v[44:47], a[220:223], v[96:99], v[44:47]
    v_mfma_f32_16x16x32_bf16 v[48:51], a[224:227], v[96:99], v[48:51]
    v_mfma_f32_16x16x32_bf16 v[52:55], a[228:231], v[96:99], v[52:55]
    v_mfma_f32_16x16x32_bf16 v[56:59], a[232:235], v[96:99], v[56:59]
    v_mfma_f32_16x16x32_bf16 v[60:63], a[236:239], v[96:99], v[60:63]
    s_waitcnt lgkmcnt(2)
    v_mfma_f32_16x16x32_bf16 v[24:27], a[240:243], v[100:103], v[24:27]
    ds_read_b128 v[92:95], v21 offset:4096
    v_mfma_f32_16x16x32_bf16 v[28:31], a[244:247], v[100:103], v[28:31]
    ds_read_b128 v[96:99], v21 offset:4352
    v_mfma_f32_16x16x32_bf16 v[32:35], a[248:251], v[100:103], v[32:35]
    v_mfma_f32_16x16x32_bf16 v[36:39], a[252:255], v[100:103], v[36:39]
    v_mfma_f32_16x16x32_bf16 v[40:43], v[112:115], v[100:103], v[40:43]
    v_mfma_f32_16x16x32_bf16 v[44:47], a[240:243], v[104:107], v[44:47]
    v_mfma_f32_16x16x32_bf16 v[48:51], a[244:247], v[104:107], v[48:51]
    v_mfma_f32_16x16x32_bf16 v[52:55], a[248:251], v[104:107], v[52:55]
    v_mfma_f32_16x16x32_bf16 v[56:59], a[252:255], v[104:107], v[56:59]
    v_mfma_f32_16x16x32_bf16 v[60:63], v[112:115], v[104:107], v[60:63]
    s_waitcnt lgkmcnt(2)
    v_mfma_f32_16x16x32_bf16 v[24:27], v[116:119], v[84:87], v[24:27]
    ds_read_b128 v[100:103], v21 offset:6144
    v_mfma_f32_16x16x32_bf16 v[28:31], v[120:123], v[84:87], v[28:31]
    ds_read_b128 v[104:107], v21 offset:6400
    v_mfma_f32_16x16x32_bf16 v[32:35], v[124:127], v[84:87], v[32:35]
    v_mfma_f32_16x16x32_bf16 v[36:39], v[128:131], v[84:87], v[36:39]
    v_mfma_f32_16x16x32_bf16 v[40:43], v[132:135], v[84:87], v[40:43]
    v_mfma_f32_16x16x32_bf16 v[44:47], v[116:119], v[88:91], v[44:47]
    v_mfma_f32_16x16x32_bf16 v[48:51], v[120:123], v[88:91], v[48:51]
    v_mfma_f32_16x16x32_bf16 v[52:55], v[124:127], v[88:91], v[52:55]
    v_mfma_f32_16x16x32_bf16 v[56:59], v[128:131], v[88:91], v[56:59]
    s_waitcnt vmcnt(6)
    s_barrier
    v_mfma_f32_16x16x32_bf16 v[60:63], v[132:135], v[88:91], v[60:63]
    s_waitcnt lgkmcnt(2)
    v_mfma_f32_16x16x32_bf16 v[24:27], v[136:139], v[92:95], v[24:27]
    ds_read_b128 v[84:87], v21 offset:16384
    v_mfma_f32_16x16x32_bf16 v[28:31], v[140:143], v[92:95], v[28:31]
    ds_read_b128 v[88:91], v21 offset:16640
    v_mfma_f32_16x16x32_bf16 v[32:35], v[144:147], v[92:95], v[32:35]
    v_mfma_f32_16x16x32_bf16 v[36:39], v[148:151], v[92:95], v[36:39]
    v_mfma_f32_16x16x32_bf16 v[40:43], v[152:155], v[92:95], v[40:43]
    v_mfma_f32_16x16x32_bf16 v[44:47], v[136:139], v[96:99], v[44:47]
    v_mfma_f32_16x16x32_bf16 v[48:51], v[140:143], v[96:99], v[48:51]
    v_mfma_f32_16x16x32_bf16 v[52:55], v[144:147], v[96:99], v[52:55]
    v_mfma_f32_16x16x32_bf16 v[56:59], v[148:151], v[96:99], v[56:59]
    v_mfma_f32_16x16x32_bf16 v[60:63], v[152:155], v[96:99], v[60:63]
    s_waitcnt lgkmcnt(2)
    v_mfma_f32_16x16x32_bf16 v[24:27], v[156:159], v[100:103], v[24:27]
    ds_read_b128 v[92:95], v21 offset:18432
    v_mfma_f32_16x16x32_bf16 v[28:31], v[160:163], v[100:103], v[28:31]
    ds_read_b128 v[96:99], v21 offset:18688
    v_mfma_f32_16x16x32_bf16 v[32:35], v[164:167], v[100:103], v[32:35]
    v_mfma_f32_16x16x32_bf16 v[36:39], v[168:171], v[100:103], v[36:39]
    v_mfma_f32_16x16x32_bf16 v[40:43], v[172:175], v[100:103], v[40:43]
    v_mfma_f32_16x16x32_bf16 v[44:47], v[156:159], v[104:107], v[44:47]
    v_mfma_f32_16x16x32_bf16 v[48:51], v[160:163], v[104:107], v[48:51]
    v_mfma_f32_16x16x32_bf16 v[52:55], v[164:167], v[104:107], v[52:55]
    v_mfma_f32_16x16x32_bf16 v[56:59], v[168:171], v[104:107], v[56:59]
    v_mfma_f32_16x16x32_bf16 v[60:63], v[172:175], v[104:107], v[60:63]
    s_waitcnt lgkmcnt(2)
    v_mfma_f32_16x16x32_bf16 v[24:27], v[176:179], v[84:87], v[24:27]
    ds_read_b128 v[100:103], v21 offset:20480
    v_mfma_f32_16x16x32_bf16 v[28:31], v[180:183], v[84:87], v[28:31]
    ds_read_b128 v[104:107], v21 offset:20736
    v_mfma_f32_16x16x32_bf16 v[32:35], v[184:187], v[84:87], v[32:35]
    v_mfma_f32_16x16x32_bf16 v[36:39], v[188:191], v[84:87], v[36:39]
    v_mfma_f32_16x16x32_bf16 v[40:43], v[192:195], v[84:87], v[40:43]
    v_mfma_f32_16x16x32_bf16 v[44:47], v[176:179], v[88:91], v[44:47]
    v_mfma_f32_16x16x32_bf16 v[48:51], v[180:183], v[88:91], v[48:51]
    v_mfma_f32_16x16x32_bf16 v[52:55], v[184:187], v[88:91], v[52:55]
    v_mfma_f32_16x16x32_bf16 v[56:59], v[188:191], v[88:91], v[56:59]
    v_mfma_f32_16x16x32_bf16 v[60:63], v[192:195], v[88:91], v[60:63]
    s_waitcnt lgkmcnt(2)
    v_mfma_f32_16x16x32_bf16 v[24:27], v[196:199], v[92:95], v[24:27]
    ds_read_b128 v[84:87], v21 offset:22528
    v_mfma_f32_16x16x32_bf16 v[28:31], v[200:203], v[92:95], v[28:31]
    ds_read_b128 v[88:91], v21 offset:22784
    v_mfma_f32_16x16x32_bf16 v[32:35], v[204:207], v[92:95], v[32:35]
    v_mfma_f32_16x16x32_bf16 v[36:39], v[208:211], v[92:95], v[36:39]
    v_mfma_f32_16x16x32_bf16 v[40:43], v[212:215], v[92:95], v[40:43]
    v_mfma_f32_16x16x32_bf16 v[44:47], v[196:199], v[96:99], v[44:47]
    v_mfma_f32_16x16x32_bf16 v[48:51], v[200:203], v[96:99], v[48:51]
    v_mfma_f32_16x16x32_bf16 v[52:55], v[204:207], v[96:99], v[52:55]
    v_mfma_f32_16x16x32_bf16 v[56:59], v[208:211], v[96:99], v[56:59]
    v_mfma_f32_16x16x32_bf16 v[60:63], v[212:215], v[96:99], v[60:63]
    s_waitcnt lgkmcnt(2)
    v_mfma_f32_16x16x32_bf16 v[24:27], v[216:219], v[100:103], v[24:27]
    v_mfma_f32_16x16x32_bf16 v[28:31], v[220:223], v[100:103], v[28:31]
    v_mfma_f32_16x16x32_bf16 v[32:35], v[224:227], v[100:103], v[32:35]
    v_mfma_f32_16x16x32_bf16 v[36:39], v[228:231], v[100:103], v[36:39]
    v_mfma_f32_16x16x32_bf16 v[40:43], v[232:235], v[100:103], v[40:43]
    v_mfma_f32_16x16x32_bf16 v[44:47], v[216:219], v[104:107], v[44:47]
    v_mfma_f32_16x16x32_bf16 v[48:51], v[220:223], v[104:107], v[48:51]
    v_mfma_f32_16x16x32_bf16 v[52:55], v[224:227], v[104:107], v[52:55]
    v_mfma_f32_16x16x32_bf16 v[56:59], v[228:231], v[104:107], v[56:59]
    v_mfma_f32_16x16x32_bf16 v[60:63], v[232:235], v[104:107], v[60:63]
    s_waitcnt lgkmcnt(0)
    v_mfma_f32_16x16x32_bf16 v[24:27], v[236:239], v[84:87], v[24:27]
    v_mfma_f32_16x16x32_bf16 v[28:31], v[240:243], v[84:87], v[28:31]
    v_mfma_f32_16x16x32_bf16 v[32:35], v[244:247], v[84:87], v[32:35]
    v_mfma_f32_16x16x32_bf16 v[36:39], v[248:251], v[84:87], v[36:39]
    v_mfma_f32_16x16x32_bf16 v[40:43], v[252:255], v[84:87], v[40:43]
    v_mfma_f32_16x16x32_bf16 v[44:47], v[236:239], v[88:91], v[44:47]
    v_mfma_f32_16x16x32_bf16 v[48:51], v[240:243], v[88:91], v[48:51]
    v_mfma_f32_16x16x32_bf16 v[52:55], v[244:247], v[88:91], v[52:55]
    v_mfma_f32_16x16x32_bf16 v[56:59], v[248:251], v[88:91], v[56:59]
    v_mfma_f32_16x16x32_bf16 v[60:63], v[252:255], v[88:91], v[60:63]
    v_pk_mul_f32 v[24:25], v[24:25], s[50:51]
    v_pk_mul_f32 v[26:27], v[26:27], s[50:51]
    v_cvt_pk_bf16_f32 v64, v24, v25
    v_cvt_pk_bf16_f32 v65, v26, v27
    v_pk_mul_f32 v[44:45], v[44:45], s[50:51]
    v_pk_mul_f32 v[46:47], v[46:47], s[50:51]
    v_cvt_pk_bf16_f32 v66, v44, v45
    v_cvt_pk_bf16_f32 v67, v46, v47
    v_pk_mul_f32 v[28:29], v[28:29], s[50:51]
    v_pk_mul_f32 v[30:31], v[30:31], s[50:51]
    v_cvt_pk_bf16_f32 v68, v28, v29
    v_cvt_pk_bf16_f32 v69, v30, v31
    v_pk_mul_f32 v[48:49], v[48:49], s[50:51]
    v_pk_mul_f32 v[50:51], v[50:51], s[50:51]
    v_cvt_pk_bf16_f32 v70, v48, v49
    v_cvt_pk_bf16_f32 v71, v50, v51
    v_permlane16_swap_b32 v64, v66
    v_permlane16_swap_b32 v65, v67
    buffer_store_dwordx4 v[64:67], v1, s[20:23], s52 offen offset:0 sc1
    v_pk_mul_f32 v[32:33], v[32:33], s[50:51]
    v_pk_mul_f32 v[34:35], v[34:35], s[50:51]
    v_cvt_pk_bf16_f32 v72, v32, v33
    v_cvt_pk_bf16_f32 v73, v34, v35
    v_pk_mul_f32 v[52:53], v[52:53], s[50:51]
    v_pk_mul_f32 v[54:55], v[54:55], s[50:51]
    v_cvt_pk_bf16_f32 v74, v52, v53
    v_cvt_pk_bf16_f32 v75, v54, v55
    v_permlane16_swap_b32 v68, v70
    v_permlane16_swap_b32 v69, v71
    buffer_store_dwordx4 v[68:71], v1, s[20:23], s53 offen offset:0 sc1
    v_pk_mul_f32 v[36:37], v[36:37], s[50:51]
    v_pk_mul_f32 v[38:39], v[38:39], s[50:51]
    v_cvt_pk_bf16_f32 v76, v36, v37
    v_cvt_pk_bf16_f32 v77, v38, v39
    v_pk_mul_f32 v[56:57], v[56:57], s[50:51]
    v_pk_mul_f32 v[58:59], v[58:59], s[50:51]
    v_cvt_pk_bf16_f32 v78, v56, v57
    v_cvt_pk_bf16_f32 v79, v58, v59
    v_permlane16_swap_b32 v72, v74
    v_permlane16_swap_b32 v73, v75
    buffer_store_dwordx4 v[72:75], v1, s[20:23], s54 offen offset:0 sc1
    v_pk_mul_f32 v[40:41], v[40:41], s[50:51]
    v_pk_mul_f32 v[42:43], v[42:43], s[50:51]
    v_cvt_pk_bf16_f32 v80, v40, v41
    v_cvt_pk_bf16_f32 v81, v42, v43
    v_pk_mul_f32 v[60:61], v[60:61], s[50:51]
    v_pk_mul_f32 v[62:63], v[62:63], s[50:51]
    v_cvt_pk_bf16_f32 v82, v60, v61
    v_cvt_pk_bf16_f32 v83, v62, v63
    v_permlane16_swap_b32 v76, v78
    v_permlane16_swap_b32 v77, v79
    buffer_store_dwordx4 v[76:79], v1, s[20:23], s55 offen offset:0 sc1
    buffer_store_dwordx2 v[80:81], v16, s[20:23], s52 offen offset:1024 sc1
    buffer_store_dwordx2 v[82:83], v16, s[20:23], s52 offen offset:1152 sc1
    s_endpgm
L_front_vtype_3:
    s_waitcnt vmcnt(8) lgkmcnt(0)
    s_barrier
    ds_read_b128 v[84:87], v19 offset:0
    ds_read_b128 v[88:91], v19 offset:256
    ds_read_b128 v[92:95], v19 offset:2048
    ds_read_b128 v[96:99], v19 offset:2304
    s_waitcnt lgkmcnt(2)
    v_mfma_f32_16x16x32_bf16 v[24:27], v[84:87], a[0:3], 0
    ds_read_b128 v[100:103], v19 offset:4096
    s_add_u32 m0, s44, 49152
    v_mfma_f32_16x16x32_bf16 v[28:31], v[84:87], a[4:7], 0
    ds_read_b128 v[104:107], v19 offset:4352
    s_add_u32 s40, s61, 0
    v_mfma_f32_16x16x32_bf16 v[32:35], v[84:87], a[8:11], 0
    v_mfma_f32_16x16x32_bf16 v[36:39], v[84:87], a[12:15], 0
    v_mfma_f32_16x16x32_bf16 v[40:43], v[84:87], a[16:19], 0
    global_load_lds_dwordx4 v1, s[40:41] offset:0 sc1
    v_mfma_f32_16x16x32_bf16 v[44:47], v[88:91], a[0:3], 0
    v_mfma_f32_16x16x32_bf16 v[48:51], v[88:91], a[4:7], 0
    v_mfma_f32_16x16x32_bf16 v[52:55], v[88:91], a[8:11], 0
    v_mfma_f32_16x16x32_bf16 v[56:59], v[88:91], a[12:15], 0
    global_load_lds_dwordx4 v1, s[40:41] offset:1024 sc1
    v_mfma_f32_16x16x32_bf16 v[60:63], v[88:91], a[16:19], 0
    s_waitcnt lgkmcnt(2)
    v_mfma_f32_16x16x32_bf16 v[24:27], v[92:95], a[20:23], v[24:27]
    buffer_load_dword v14, v15, s[20:23], s37 offen offset:512 sc1
    v_mfma_f32_16x16x32_bf16 v[28:31], v[92:95], a[24:27], v[28:31]
    ds_read_b128 v[84:87], v19 offset:6144
    v_mfma_f32_16x16x32_bf16 v[32:35], v[92:95], a[28:31], v[32:35]
    ds_read_b128 v[88:91], v19 offset:6400
    v_mfma_f32_16x16x32_bf16 v[36:39], v[92:95], a[32:35], v[36:39]
    global_load_lds_dwordx4 v1, s[40:41] offset:2048 sc1
    v_mfma_f32_16x16x32_bf16 v[40:43], v[92:95], a[36:39], v[40:43]
    v_mfma_f32_16x16x32_bf16 v[44:47], v[96:99], a[20:23], v[44:47]
    v_mfma_f32_16x16x32_bf16 v[48:51], v[96:99], a[24:27], v[48:51]
    global_load_lds_dwordx4 v1, s[40:41] offset:3072 sc1
    v_mfma_f32_16x16x32_bf16 v[52:55], v[96:99], a[28:31], v[52:55]
    v_mfma_f32_16x16x32_bf16 v[56:59], v[96:99], a[32:35], v[56:59]
    s_waitcnt vmcnt(9)
    s_barrier
    v_mfma_f32_16x16x32_bf16 v[60:63], v[96:99], a[36:39], v[60:63]
    s_waitcnt lgkmcnt(2)
    v_mfma_f32_16x16x32_bf16 v[24:27], v[100:103], a[40:43], v[24:27]
    ds_read_b128 v[92:95], v19 offset:16384
    s_add_u32 m0, s44, 65536
    v_mfma_f32_16x16x32_bf16 v[28:31], v[100:103], a[44:47], v[28:31]
    ds_read_b128 v[96:99], v19 offset:16640
    s_add_u32 s40, s62, 0
    v_mfma_f32_16x16x32_bf16 v[32:35], v[100:103], a[48:51], v[32:35]
    v_mfma_f32_16x16x32_bf16 v[36:39], v[100:103], a[52:55], v[36:39]
    v_mfma_f32_16x16x32_bf16 v[40:43], v[100:103], a[56:59], v[40:43]
    global_load_lds_dwordx4 v1, s[40:41] offset:0 sc1
    v_mfma_f32_16x16x32_bf16 v[44:47], v[104:107], a[40:43], v[44:47]
    v_mfma_f32_16x16x32_bf16 v[48:51], v[104:107], a[44:47], v[48:51]
    v_mfma_f32_16x16x32_bf16 v[52:55], v[104:107], a[48:51], v[52:55]
    v_mfma_f32_16x16x32_bf16 v[56:59], v[104:107], a[52:55], v[56:59]
    global_load_lds_dwordx4 v1, s[40:41] offset:1024 sc1
    v_mfma_f32_16x16x32_bf16 v[60:63], v[104:107], a[56:59], v[60:63]
    s_waitcnt lgkmcnt(2)
    v_mfma_f32_16x16x32_bf16 v[24:27], v[84:87], a[60:63], v[24:27]
    ds_read_b128 v[100:103], v19 offset:18432
    v_mfma_f32_16x16x32_bf16 v[28:31], v[84:87], a[64:67], v[28:31]
    ds_read_b128 v[104:107], v19 offset:18688
    v_mfma_f32_16x16x32_bf16 v[32:35], v[84:87], a[68:71], v[32:35]
    global_load_lds_dwordx4 v1, s[40:41] offset:2048 sc1
    v_mfma_f32_16x16x32_bf16 v[36:39], v[84:87], a[72:75], v[36:39]
    v_mfma_f32_16x16x32_bf16 v[40:43], v[84:87], a[76:79], v[40:43]
    v_mfma_f32_16x16x32_bf16 v[44:47], v[88:91], a[60:63], v[44:47]
    v_mfma_f32_16x16x32_bf16 v[48:51], v[88:91], a[64:67], v[48:51]
    global_load_lds_dwordx4 v1, s[40:41] offset:3072 sc1
    v_mfma_f32_16x16x32_bf16 v[52:55], v[88:91], a[68:71], v[52:55]
    v_mfma_f32_16x16x32_bf16 v[56:59], v[88:91], a[72:75], v[56:59]
    v_mfma_f32_16x16x32_bf16 v[60:63], v[88:91], a[76:79], v[60:63]
    s_waitcnt lgkmcnt(2)
    v_mfma_f32_16x16x32_bf16 v[24:27], v[92:95], a[80:83], v[24:27]
    ds_read_b128 v[84:87], v19 offset:20480
    v_mfma_f32_16x16x32_bf16 v[28:31], v[92:95], a[84:87], v[28:31]
    ds_read_b128 v[88:91], v19 offset:20736
    v_mfma_f32_16x16x32_bf16 v[32:35], v[92:95], a[88:91], v[32:35]
    v_mfma_f32_16x16x32_bf16 v[36:39], v[92:95], a[92:95], v[36:39]
    v_mfma_f32_16x16x32_bf16 v[40:43], v[92:95], a[96:99], v[40:43]
    v_mfma_f32_16x16x32_bf16 v[44:47], v[96:99], a[80:83], v[44:47]
    v_mfma_f32_16x16x32_bf16 v[48:51], v[96:99], a[84:87], v[48:51]
    v_mfma_f32_16x16x32_bf16 v[52:55], v[96:99], a[88:91], v[52:55]
    v_mfma_f32_16x16x32_bf16 v[56:59], v[96:99], a[92:95], v[56:59]
    v_mfma_f32_16x16x32_bf16 v[60:63], v[96:99], a[96:99], v[60:63]
    s_waitcnt lgkmcnt(2)
    v_mfma_f32_16x16x32_bf16 v[24:27], v[100:103], a[100:103], v[24:27]
    ds_read_b128 v[92:95], v19 offset:22528
    v_mfma_f32_16x16x32_bf16 v[28:31], v[100:103], a[104:107], v[28:31]
    ds_read_b128 v[96:99], v19 offset:22784
    v_mfma_f32_16x16x32_bf16 v[32:35], v[100:103], a[108:111], v[32:35]
    v_mfma_f32_16x16x32_bf16 v[36:39], v[100:103], a[112:115], v[36:39]
    v_mfma_f32_16x16x32_bf16 v[40:43], v[100:103], a[116:119], v[40:43]
    v_mfma_f32_16x16x32_bf16 v[44:47], v[104:107], a[100:103], v[44:47]
    v_mfma_f32_16x16x32_bf16 v[48:51], v[104:107], a[104:107], v[48:51]
    v_mfma_f32_16x16x32_bf16 v[52:55], v[104:107], a[108:111], v[52:55]
    v_mfma_f32_16x16x32_bf16 v[56:59], v[104:107], a[112:115], v[56:59]
    s_waitcnt vmcnt(9)
    s_barrier
    v_mfma_f32_16x16x32_bf16 v[60:63], v[104:107], a[116:119], v[60:63]
    s_waitcnt lgkmcnt(2)
    v_mfma_f32_16x16x32_bf16 v[24:27], v[84:87], a[120:123], v[24:27]
    ds_read_b128 v[100:103], v19 offset:32768
    v_mfma_f32_16x16x32_bf16 v[28:31], v[84:87], a[124:127], v[28:31]
    ds_read_b128 v[104:107], v19 offset:33024
    v_mfma_f32_16x16x32_bf16 v[32:35], v[84:87], a[128:131], v[32:35]
    v_mfma_f32_16x16x32_bf16 v[36:39], v[84:87], a[132:135], v[36:39]
    v_mfma_f32_16x16x32_bf16 v[40:43], v[84:87], a[136:139], v[40:43]
    v_mfma_f32_16x16x32_bf16 v[44:47], v[88:91], a[120:123], v[44:47]
    v_mfma_f32_16x16x32_bf16 v[48:51], v[88:91], a[124:127], v[48:51]
    v_mfma_f32_16x16x32_bf16 v[52:55], v[88:91], a[128:131], v[52:55]
    v_mfma_f32_16x16x32_bf16 v[56:59], v[88:91], a[132:135], v[56:59]
    v_mfma_f32_16x16x32_bf16 v[60:63], v[88:91], a[136:139], v[60:63]
    s_waitcnt lgkmcnt(2)
    v_mfma_f32_16x16x32_bf16 v[24:27], v[92:95], a[140:143], v[24:27]
    ds_read_b128 v[84:87], v19 offset:34816
    v_mfma_f32_16x16x32_bf16 v[28:31], v[92:95], a[144:147], v[28:31]
    ds_read_b128 v[88:91], v19 offset:35072
    v_mfma_f32_16x16x32_bf16 v[32:35], v[92:95], a[148:151], v[32:35]
    v_mfma_f32_16x16x32_bf16 v[36:39], v[92:95], a[152:155], v[36:39]
    v_mfma_f32_16x16x32_bf16 v[40:43], v[92:95], a[156:159], v[40:43]
    v_mfma_f32_16x16x32_bf16 v[44:47], v[96:99], a[140:143], v[44:47]
    v_mfma_f32_16x16x32_bf16 v[48:51], v[96:99], a[144:147], v[48:51]
    v_mfma_f32_16x16x32_bf16 v[52:55], v[96:99], a[148:151], v[52:55]
    s_waitcnt vmcnt(6)
    v_cmp_ne_u32 vcc, 1, v14
    s_cbranch_vccnz L_front_poll_18
L_front_ok_19:
    v_mfma_f32_16x16x32_bf16 v[56:59], v[96:99], a[152:155], v[56:59]
    v_mfma_f32_16x16x32_bf16 v[60:63], v[96:99], a[156:159], v[60:63]
    s_waitcnt lgkmcnt(2)
    v_mfma_f32_16x16x32_bf16 v[24:27], v[100:103], a[160:163], v[24:27]
    ds_read_b128 v[92:95], v19 offset:36864
    s_add_u32 m0, s44, 81920
    v_mfma_f32_16x16x32_bf16 v[28:31], v[100:103], a[164:167], v[28:31]
    ds_read_b128 v[96:99], v19 offset:37120
    s_add_u32 s40, s58, 40960
    v_mfma_f32_16x16x32_bf16 v[32:35], v[100:103], a[168:171], v[32:35]
    v_mfma_f32_16x16x32_bf16 v[36:39], v[100:103], a[172:175], v[36:39]
    v_mfma_f32_16x16x32_bf16 v[40:43], v[100:103], a[176:179], v[40:43]
    global_load_lds_dwordx4 v1, s[40:41] offset:0 sc1
    v_mfma_f32_16x16x32_bf16 v[44:47], v[104:107], a[160:163], v[44:47]
    v_mfma_f32_16x16x32_bf16 v[48:51], v[104:107], a[164:167], v[48:51]
    v_mfma_f32_16x16x32_bf16 v[52:55], v[104:107], a[168:171], v[52:55]
    v_mfma_f32_16x16x32_bf16 v[56:59], v[104:107], a[172:175], v[56:59]
    global_load_lds_dwordx4 v1, s[40:41] offset:1024 sc1
    v_mfma_f32_16x16x32_bf16 v[60:63], v[104:107], a[176:179], v[60:63]
    s_waitcnt lgkmcnt(2)
    v_mfma_f32_16x16x32_bf16 v[24:27], v[84:87], a[180:183], v[24:27]
    ds_read_b128 v[100:103], v19 offset:38912
    v_mfma_f32_16x16x32_bf16 v[28:31], v[84:87], a[184:187], v[28:31]
    ds_read_b128 v[104:107], v19 offset:39168
    v_mfma_f32_16x16x32_bf16 v[32:35], v[84:87], a[188:191], v[32:35]
    global_load_lds_dwordx4 v1, s[40:41] offset:2048 sc1
    v_mfma_f32_16x16x32_bf16 v[36:39], v[84:87], a[192:195], v[36:39]
    v_mfma_f32_16x16x32_bf16 v[40:43], v[84:87], a[196:199], v[40:43]
    v_mfma_f32_16x16x32_bf16 v[44:47], v[88:91], a[180:183], v[44:47]
    v_mfma_f32_16x16x32_bf16 v[48:51], v[88:91], a[184:187], v[48:51]
    global_load_lds_dwordx4 v1, s[40:41] offset:3072 sc1
    v_mfma_f32_16x16x32_bf16 v[52:55], v[88:91], a[188:191], v[52:55]
    v_mfma_f32_16x16x32_bf16 v[56:59], v[88:91], a[192:195], v[56:59]
    s_waitcnt vmcnt(8)
    s_barrier
    v_mfma_f32_16x16x32_bf16 v[60:63], v[88:91], a[196:199], v[60:63]
    s_waitcnt lgkmcnt(2)
    v_mfma_f32_16x16x32_bf16 v[24:27], v[92:95], a[200:203], v[24:27]
    ds_read_b128 v[84:87], v19 offset:49152
    s_add_u32 m0, s44, 98304
    v_mfma_f32_16x16x32_bf16 v[28:31], v[92:95], a[204:207], v[28:31]
    ds_read_b128 v[88:91], v19 offset:49408
    s_add_u32 s40, s59, 40960
    v_mfma_f32_16x16x32_bf16 v[32:35], v[92:95], a[208:211], v[32:35]
    v_mfma_f32_16x16x32_bf16 v[36:39], v[92:95], a[212:215], v[36:39]
    v_mfma_f32_16x16x32_bf16 v[40:43], v[92:95], a[216:219], v[40:43]
    global_load_lds_dwordx4 v1, s[40:41] offset:0 sc1
    v_mfma_f32_16x16x32_bf16 v[44:47], v[96:99], a[200:203], v[44:47]
    v_mfma_f32_16x16x32_bf16 v[48:51], v[96:99], a[204:207], v[48:51]
    v_mfma_f32_16x16x32_bf16 v[52:55], v[96:99], a[208:211], v[52:55]
    v_mfma_f32_16x16x32_bf16 v[56:59], v[96:99], a[212:215], v[56:59]
    global_load_lds_dwordx4 v1, s[40:41] offset:1024 sc1
    v_mfma_f32_16x16x32_bf16 v[60:63], v[96:99], a[216:219], v[60:63]
    s_waitcnt lgkmcnt(2)
    v_mfma_f32_16x16x32_bf16 v[24:27], v[100:103], a[220:223], v[24:27]
    ds_read_b128 v[92:95], v19 offset:51200
    v_mfma_f32_16x16x32_bf16 v[28:31], v[100:103], a[224:227], v[28:31]
    ds_read_b128 v[96:99], v19 offset:51456
    v_mfma_f32_16x16x32_bf16 v[32:35], v[100:103], a[228:231], v[32:35]
    global_load_lds_dwordx4 v1, s[40:41] offset:2048 sc1
    v_mfma_f32_16x16x32_bf16 v[36:39], v[100:103], a[232:235], v[36:39]
    v_mfma_f32_16x16x32_bf16 v[40:43], v[100:103], a[236:239], v[40:43]
    v_mfma_f32_16x16x32_bf16 v[44:47], v[104:107], a[220:223], v[44:47]
    v_mfma_f32_16x16x32_bf16 v[48:51], v[104:107], a[224:227], v[48:51]
    global_load_lds_dwordx4 v1, s[40:41] offset:3072 sc1
    v_mfma_f32_16x16x32_bf16 v[52:55], v[104:107], a[228:231], v[52:55]
    v_mfma_f32_16x16x32_bf16 v[56:59], v[104:107], a[232:235], v[56:59]
    v_mfma_f32_16x16x32_bf16 v[60:63], v[104:107], a[236:239], v[60:63]
    s_waitcnt lgkmcnt(2)
    v_mfma_f32_16x16x32_bf16 v[24:27], v[84:87], a[240:243], v[24:27]
    ds_read_b128 v[100:103], v19 offset:53248
    s_add_u32 m0, s44, 114688
    v_mfma_f32_16x16x32_bf16 v[28:31], v[84:87], a[244:247], v[28:31]
    ds_read_b128 v[104:107], v19 offset:53504
    s_add_u32 s40, s60, 40960
    v_mfma_f32_16x16x32_bf16 v[32:35], v[84:87], a[248:251], v[32:35]
    v_mfma_f32_16x16x32_bf16 v[36:39], v[84:87], a[252:255], v[36:39]
    v_mfma_f32_16x16x32_bf16 v[40:43], v[84:87], v[112:115], v[40:43]
    global_load_lds_dwordx4 v1, s[40:41] offset:0 sc1
    v_mfma_f32_16x16x32_bf16 v[44:47], v[88:91], a[240:243], v[44:47]
    v_mfma_f32_16x16x32_bf16 v[48:51], v[88:91], a[244:247], v[48:51]
    v_mfma_f32_16x16x32_bf16 v[52:55], v[88:91], a[248:251], v[52:55]
    v_mfma_f32_16x16x32_bf16 v[56:59], v[88:91], a[252:255], v[56:59]
    global_load_lds_dwordx4 v1, s[40:41] offset:1024 sc1
    v_mfma_f32_16x16x32_bf16 v[60:63], v[88:91], v[112:115], v[60:63]
    s_waitcnt lgkmcnt(2)
    v_mfma_f32_16x16x32_bf16 v[24:27], v[92:95], v[116:119], v[24:27]
    ds_read_b128 v[84:87], v19 offset:55296
    v_mfma_f32_16x16x32_bf16 v[28:31], v[92:95], v[120:123], v[28:31]
    ds_read_b128 v[88:91], v19 offset:55552
    v_mfma_f32_16x16x32_bf16 v[32:35], v[92:95], v[124:127], v[32:35]
    global_load_lds_dwordx4 v1, s[40:41] offset:2048 sc1
    v_mfma_f32_16x16x32_bf16 v[36:39], v[92:95], v[128:131], v[36:39]
    v_mfma_f32_16x16x32_bf16 v[40:43], v[92:95], v[132:135], v[40:43]
    v_mfma_f32_16x16x32_bf16 v[44:47], v[96:99], v[116:119], v[44:47]
    v_mfma_f32_16x16x32_bf16 v[48:51], v[96:99], v[120:123], v[48:51]
    global_load_lds_dwordx4 v1, s[40:41] offset:3072 sc1
    v_mfma_f32_16x16x32_bf16 v[52:55], v[96:99], v[124:127], v[52:55]
    v_mfma_f32_16x16x32_bf16 v[56:59], v[96:99], v[128:131], v[56:59]
    s_waitcnt vmcnt(12)
    s_barrier
    v_mfma_f32_16x16x32_bf16 v[60:63], v[96:99], v[132:135], v[60:63]
    s_waitcnt lgkmcnt(2)
    v_mfma_f32_16x16x32_bf16 v[24:27], v[100:103], v[136:139], v[24:27]
    ds_read_b128 v[92:95], v20 offset:0
    s_add_u32 m0, s44, 131072
    v_mfma_f32_16x16x32_bf16 v[28:31], v[100:103], v[140:143], v[28:31]
    ds_read_b128 v[96:99], v20 offset:256
    s_add_u32 s40, s61, 40960
    v_mfma_f32_16x16x32_bf16 v[32:35], v[100:103], v[144:147], v[32:35]
    v_mfma_f32_16x16x32_bf16 v[36:39], v[100:103], v[148:151], v[36:39]
    v_mfma_f32_16x16x32_bf16 v[40:43], v[100:103], v[152:155], v[40:43]
    global_load_lds_dwordx4 v1, s[40:41] offset:0 sc1
    v_mfma_f32_16x16x32_bf16 v[44:47], v[104:107], v[136:139], v[44:47]
    v_mfma_f32_16x16x32_bf16 v[48:51], v[104:107], v[140:143], v[48:51]
    v_mfma_f32_16x16x32_bf16 v[52:55], v[104:107], v[144:147], v[52:55]
    v_mfma_f32_16x16x32_bf16 v[56:59], v[104:107], v[148:151], v[56:59]
    global_load_lds_dwordx4 v1, s[40:41] offset:1024 sc1
    v_mfma_f32_16x16x32_bf16 v[60:63], v[104:107], v[152:155], v[60:63]
    s_waitcnt lgkmcnt(2)
    v_mfma_f32_16x16x32_bf16 v[24:27], v[84:87], v[156:159], v[24:27]
    ds_read_b128 v[100:103], v20 offset:2048
    v_mfma_f32_16x16x32_bf16 v[28:31], v[84:87], v[160:163], v[28:31]
    ds_read_b128 v[104:107], v20 offset:2304
    v_mfma_f32_16x16x32_bf16 v[32:35], v[84:87], v[164:167], v[32:35]
    global_load_lds_dwordx4 v1, s[40:41] offset:2048 sc1
    v_mfma_f32_16x16x32_bf16 v[36:39], v[84:87], v[168:171], v[36:39]
    v_mfma_f32_16x16x32_bf16 v[40:43], v[84:87], v[172:175], v[40:43]
    v_mfma_f32_16x16x32_bf16 v[44:47], v[88:91], v[156:159], v[44:47]
    v_mfma_f32_16x16x32_bf16 v[48:51], v[88:91], v[160:163], v[48:51]
    global_load_lds_dwordx4 v1, s[40:41] offset:3072 sc1
    v_mfma_f32_16x16x32_bf16 v[52:55], v[88:91], v[164:167], v[52:55]
    v_mfma_f32_16x16x32_bf16 v[56:59], v[88:91], v[168:171], v[56:59]
    v_mfma_f32_16x16x32_bf16 v[60:63], v[88:91], v[172:175], v[60:63]
    s_waitcnt lgkmcnt(2)
    v_mfma_f32_16x16x32_bf16 v[24:27], v[92:95], v[176:179], v[24:27]
    ds_read_b128 v[84:87], v20 offset:4096
    s_add_u32 m0, s44, 147456
    v_mfma_f32_16x16x32_bf16 v[28:31], v[92:95], v[180:183], v[28:31]
    ds_read_b128 v[88:91], v20 offset:4352
    s_add_u32 s40, s62, 40960
    v_mfma_f32_16x16x32_bf16 v[32:35], v[92:95], v[184:187], v[32:35]
    v_mfma_f32_16x16x32_bf16 v[36:39], v[92:95], v[188:191], v[36:39]
    v_mfma_f32_16x16x32_bf16 v[40:43], v[92:95], v[192:195], v[40:43]
    global_load_lds_dwordx4 v1, s[40:41] offset:0 sc1
    v_mfma_f32_16x16x32_bf16 v[44:47], v[96:99], v[176:179], v[44:47]
    v_mfma_f32_16x16x32_bf16 v[48:51], v[96:99], v[180:183], v[48:51]
    v_mfma_f32_16x16x32_bf16 v[52:55], v[96:99], v[184:187], v[52:55]
    v_mfma_f32_16x16x32_bf16 v[56:59], v[96:99], v[188:191], v[56:59]
    global_load_lds_dwordx4 v1, s[40:41] offset:1024 sc1
    v_mfma_f32_16x16x32_bf16 v[60:63], v[96:99], v[192:195], v[60:63]
    s_waitcnt lgkmcnt(2)
    v_mfma_f32_16x16x32_bf16 v[24:27], v[100:103], v[196:199], v[24:27]
    ds_read_b128 v[92:95], v20 offset:6144
    v_mfma_f32_16x16x32_bf16 v[28:31], v[100:103], v[200:203], v[28:31]
    ds_read_b128 v[96:99], v20 offset:6400
    v_mfma_f32_16x16x32_bf16 v[32:35], v[100:103], v[204:207], v[32:35]
    global_load_lds_dwordx4 v1, s[40:41] offset:2048 sc1
    v_mfma_f32_16x16x32_bf16 v[36:39], v[100:103], v[208:211], v[36:39]
    v_mfma_f32_16x16x32_bf16 v[40:43], v[100:103], v[212:215], v[40:43]
    v_mfma_f32_16x16x32_bf16 v[44:47], v[104:107], v[196:199], v[44:47]
    v_mfma_f32_16x16x32_bf16 v[48:51], v[104:107], v[200:203], v[48:51]
    global_load_lds_dwordx4 v1, s[40:41] offset:3072 sc1
    v_mfma_f32_16x16x32_bf16 v[52:55], v[104:107], v[204:207], v[52:55]
    v_mfma_f32_16x16x32_bf16 v[56:59], v[104:107], v[208:211], v[56:59]
    s_waitcnt vmcnt(16)
    s_barrier
    v_mfma_f32_16x16x32_bf16 v[60:63], v[104:107], v[212:215], v[60:63]
    s_waitcnt lgkmcnt(2)
    v_mfma_f32_16x16x32_bf16 v[24:27], v[84:87], v[216:219], v[24:27]
    ds_read_b128 v[100:103], v20 offset:16384
    v_mfma_f32_16x16x32_bf16 v[28:31], v[84:87], v[220:223], v[28:31]
    ds_read_b128 v[104:107], v20 offset:16640
    v_mfma_f32_16x16x32_bf16 v[32:35], v[84:87], v[224:227], v[32:35]
    v_mfma_f32_16x16x32_bf16 v[36:39], v[84:87], v[228:231], v[36:39]
    v_mfma_f32_16x16x32_bf16 v[40:43], v[84:87], v[232:235], v[40:43]
    v_mfma_f32_16x16x32_bf16 v[44:47], v[88:91], v[216:219], v[44:47]
    v_mfma_f32_16x16x32_bf16 v[48:51], v[88:91], v[220:223], v[48:51]
    v_mfma_f32_16x16x32_bf16 v[52:55], v[88:91], v[224:227], v[52:55]
    v_mfma_f32_16x16x32_bf16 v[56:59], v[88:91], v[228:231], v[56:59]
    v_mfma_f32_16x16x32_bf16 v[60:63], v[88:91], v[232:235], v[60:63]
    s_waitcnt lgkmcnt(2)
    v_mfma_f32_16x16x32_bf16 v[24:27], v[92:95], v[236:239], v[24:27]
    ds_read_b128 v[84:87], v20 offset:18432
    v_mfma_f32_16x16x32_bf16 v[28:31], v[92:95], v[240:243], v[28:31]
    ds_read_b128 v[88:91], v20 offset:18688
    v_mfma_f32_16x16x32_bf16 v[32:35], v[92:95], v[244:247], v[32:35]
    v_mfma_f32_16x16x32_bf16 v[36:39], v[92:95], v[248:251], v[36:39]
    v_mfma_f32_16x16x32_bf16 v[40:43], v[92:95], v[252:255], v[40:43]
    v_mfma_f32_16x16x32_bf16 v[44:47], v[96:99], v[236:239], v[44:47]
    v_mfma_f32_16x16x32_bf16 v[48:51], v[96:99], v[240:243], v[48:51]
    v_mfma_f32_16x16x32_bf16 v[52:55], v[96:99], v[244:247], v[52:55]
    v_mfma_f32_16x16x32_bf16 v[56:59], v[96:99], v[248:251], v[56:59]
    v_mfma_f32_16x16x32_bf16 v[60:63], v[96:99], v[252:255], v[60:63]
    s_waitcnt lgkmcnt(2)
    v_cvt_pk_bf16_f32 v64, v24, v25
    v_cvt_pk_bf16_f32 v65, v26, v27
    v_mfma_f32_16x16x32_bf16 v[24:27], v[100:103], a[0:3], 0
    ds_read_b128 v[92:95], v20 offset:20480
    v_cvt_pk_bf16_f32 v68, v28, v29
    v_cvt_pk_bf16_f32 v69, v30, v31
    v_mfma_f32_16x16x32_bf16 v[28:31], v[100:103], a[4:7], 0
    v_cvt_pk_bf16_f32 v72, v32, v33
    v_cvt_pk_bf16_f32 v73, v34, v35
    v_mfma_f32_16x16x32_bf16 v[32:35], v[100:103], a[8:11], 0
    v_cvt_pk_bf16_f32 v76, v36, v37
    v_cvt_pk_bf16_f32 v77, v38, v39
    v_mfma_f32_16x16x32_bf16 v[36:39], v[100:103], a[12:15], 0
    v_cvt_pk_bf16_f32 v80, v40, v41
    v_cvt_pk_bf16_f32 v81, v42, v43
    v_mfma_f32_16x16x32_bf16 v[40:43], v[100:103], a[16:19], 0
    v_cvt_pk_bf16_f32 v66, v44, v45
    v_cvt_pk_bf16_f32 v67, v46, v47
    v_mfma_f32_16x16x32_bf16 v[44:47], v[104:107], a[0:3], 0
    ds_read_b128 v[96:99], v20 offset:20736
    v_cvt_pk_bf16_f32 v70, v48, v49
    v_cvt_pk_bf16_f32 v71, v50, v51
    v_mfma_f32_16x16x32_bf16 v[48:51], v[104:107], a[4:7], 0
    v_cvt_pk_bf16_f32 v74, v52, v53
    v_cvt_pk_bf16_f32 v75, v54, v55
    v_mfma_f32_16x16x32_bf16 v[52:55], v[104:107], a[8:11], 0
    v_cvt_pk_bf16_f32 v78, v56, v57
    v_cvt_pk_bf16_f32 v79, v58, v59
    v_mfma_f32_16x16x32_bf16 v[56:59], v[104:107], a[12:15], 0
    v_cvt_pk_bf16_f32 v82, v60, v61
    v_cvt_pk_bf16_f32 v83, v62, v63
    v_mfma_f32_16x16x32_bf16 v[60:63], v[104:107], a[16:19], 0
    s_waitcnt lgkmcnt(2)
    v_mfma_f32_16x16x32_bf16 v[24:27], v[84:87], a[20:23], v[24:27]
    v_permlane16_swap_b32 v64, v66
    v_mfma_f32_16x16x32_bf16 v[28:31], v[84:87], a[24:27], v[28:31]
    v_permlane16_swap_b32 v65, v67
    v_mfma_f32_16x16x32_bf16 v[32:35], v[84:87], a[28:31], v[32:35]
    buffer_store_dwordx4 v[64:67], v1, s[20:23], s52 offen offset:1280 sc1
    v_mfma_f32_16x16x32_bf16 v[36:39], v[84:87], a[32:35], v[36:39]
    ds_read_b128 v[100:103], v20 offset:22528
    v_mfma_f32_16x16x32_bf16 v[40:43], v[84:87], a[36:39], v[40:43]
    ds_read_b128 v[104:107], v20 offset:22784
    v_mfma_f32_16x16x32_bf16 v[44:47], v[88:91], a[20:23], v[44:47]
    v_permlane16_swap_b32 v68, v70
    v_mfma_f32_16x16x32_bf16 v[48:51], v[88:91], a[24:27], v[48:51]
    v_permlane16_swap_b32 v69, v71
    v_mfma_f32_16x16x32_bf16 v[52:55], v[88:91], a[28:31], v[52:55]
    v_permlane16_swap_b32 v72, v74
    v_mfma_f32_16x16x32_bf16 v[56:59], v[88:91], a[32:35], v[56:59]
    s_waitcnt vmcnt(13)
    s_barrier
    v_permlane16_swap_b32 v73, v75
    v_mfma_f32_16x16x32_bf16 v[60:63], v[88:91], a[36:39], v[60:63]
    s_waitcnt lgkmcnt(2)
    v_permlane16_swap_b32 v76, v78
    v_mfma_f32_16x16x32_bf16 v[24:27], v[92:95], a[40:43], v[24:27]
    v_permlane16_swap_b32 v77, v79
    v_mfma_f32_16x16x32_bf16 v[28:31], v[92:95], a[44:47], v[28:31]
    v_permlane16_swap_b32 v80, v82
    v_mfma_f32_16x16x32_bf16 v[32:35], v[92:95], a[48:51], v[32:35]
    buffer_store_dwordx4 v[68:71], v1, s[20:23], s53 offen offset:1280 sc1
    s_add_u32 s53, s53, s47
    v_mfma_f32_16x16x32_bf16 v[36:39], v[92:95], a[52:55], v[36:39]
    ds_read_b128 v[84:87], v20 offset:32768
    v_mfma_f32_16x16x32_bf16 v[40:43], v[92:95], a[56:59], v[40:43]
    ds_read_b128 v[88:91], v20 offset:33024
    v_mfma_f32_16x16x32_bf16 v[44:47], v[96:99], a[40:43], v[44:47]
    v_permlane16_swap_b32 v81, v83
    v_mfma_f32_16x16x32_bf16 v[48:51], v[96:99], a[44:47], v[48:51]
    buffer_store_dwordx4 v[72:75], v1, s[20:23], s54 offen offset:1280 sc1
    s_add_u32 s54, s54, s47
    v_mfma_f32_16x16x32_bf16 v[52:55], v[96:99], a[48:51], v[52:55]
    buffer_store_dwordx4 v[76:79], v1, s[20:23], s55 offen offset:1280 sc1
    s_add_u32 s55, s55, s47
    v_mfma_f32_16x16x32_bf16 v[56:59], v[96:99], a[52:55], v[56:59]
    buffer_store_dwordx4 v[80:83], v22, s[20:23], s52 offen offset:2304 sc1
    v_mfma_f32_16x16x32_bf16 v[60:63], v[96:99], a[56:59], v[60:63]
    buffer_store_dwordx4 v[108:111], v23, s[20:23], s52 offen offset:2560 sc1
    s_waitcnt lgkmcnt(2)
    v_mfma_f32_16x16x32_bf16 v[24:27], v[100:103], a[60:63], v[24:27]
    ds_read_b128 v[92:95], v20 offset:34816
    s_add_u32 s52, s52, s47
    v_mfma_f32_16x16x32_bf16 v[28:31], v[100:103], a[64:67], v[28:31]
    ds_read_b128 v[96:99], v20 offset:35072
    v_mfma_f32_16x16x32_bf16 v[32:35], v[100:103], a[68:71], v[32:35]
    v_mfma_f32_16x16x32_bf16 v[36:39], v[100:103], a[72:75], v[36:39]
    v_mfma_f32_16x16x32_bf16 v[40:43], v[100:103], a[76:79], v[40:43]
    v_mfma_f32_16x16x32_bf16 v[44:47], v[104:107], a[60:63], v[44:47]
    v_mfma_f32_16x16x32_bf16 v[48:51], v[104:107], a[64:67], v[48:51]
    v_mfma_f32_16x16x32_bf16 v[52:55], v[104:107], a[68:71], v[52:55]
    v_mfma_f32_16x16x32_bf16 v[56:59], v[104:107], a[72:75], v[56:59]
    v_mfma_f32_16x16x32_bf16 v[60:63], v[104:107], a[76:79], v[60:63]
    s_waitcnt lgkmcnt(2)
    v_mfma_f32_16x16x32_bf16 v[24:27], v[84:87], a[80:83], v[24:27]
    ds_read_b128 v[100:103], v20 offset:36864
    v_mfma_f32_16x16x32_bf16 v[28:31], v[84:87], a[84:87], v[28:31]
    ds_read_b128 v[104:107], v20 offset:37120
    v_mfma_f32_16x16x32_bf16 v[32:35], v[84:87], a[88:91], v[32:35]
    v_mfma_f32_16x16x32_bf16 v[36:39], v[84:87], a[92:95], v[36:39]
    v_mfma_f32_16x16x32_bf16 v[40:43], v[84:87], a[96:99], v[40:43]
    v_mfma_f32_16x16x32_bf16 v[44:47], v[88:91], a[80:83], v[44:47]
    v_mfma_f32_16x16x32_bf16 v[48:51], v[88:91], a[84:87], v[48:51]
    v_mfma_f32_16x16x32_bf16 v[52:55], v[88:91], a[88:91], v[52:55]
    v_mfma_f32_16x16x32_bf16 v[56:59], v[88:91], a[92:95], v[56:59]
    v_mfma_f32_16x16x32_bf16 v[60:63], v[88:91], a[96:99], v[60:63]
    s_waitcnt lgkmcnt(2)
    v_mfma_f32_16x16x32_bf16 v[24:27], v[92:95], a[100:103], v[24:27]
    ds_read_b128 v[84:87], v20 offset:38912
    v_mfma_f32_16x16x32_bf16 v[28:31], v[92:95], a[104:107], v[28:31]
    ds_read_b128 v[88:91], v20 offset:39168
    v_mfma_f32_16x16x32_bf16 v[32:35], v[92:95], a[108:111], v[32:35]
    v_mfma_f32_16x16x32_bf16 v[36:39], v[92:95], a[112:115], v[36:39]
    v_mfma_f32_16x16x32_bf16 v[40:43], v[92:95], a[116:119], v[40:43]
    v_mfma_f32_16x16x32_bf16 v[44:47], v[96:99], a[100:103], v[44:47]
    v_mfma_f32_16x16x32_bf16 v[48:51], v[96:99], a[104:107], v[48:51]
    v_mfma_f32_16x16x32_bf16 v[52:55], v[96:99], a[108:111], v[52:55]
    v_mfma_f32_16x16x32_bf16 v[56:59], v[96:99], a[112:115], v[56:59]
    s_waitcnt vmcnt(14)
    s_barrier
    v_mfma_f32_16x16x32_bf16 v[60:63], v[96:99], a[116:119], v[60:63]
    s_waitcnt lgkmcnt(2)
    v_mfma_f32_16x16x32_bf16 v[24:27], v[100:103], a[120:123], v[24:27]
    ds_read_b128 v[92:95], v20 offset:49152
    v_mfma_f32_16x16x32_bf16 v[28:31], v[100:103], a[124:127], v[28:31]
    ds_read_b128 v[96:99], v20 offset:49408
    v_mfma_f32_16x16x32_bf16 v[32:35], v[100:103], a[128:131], v[32:35]
    v_mfma_f32_16x16x32_bf16 v[36:39], v[100:103], a[132:135], v[36:39]
    v_mfma_f32_16x16x32_bf16 v[40:43], v[100:103], a[136:139], v[40:43]
    v_mfma_f32_16x16x32_bf16 v[44:47], v[104:107], a[120:123], v[44:47]
    v_mfma_f32_16x16x32_bf16 v[48:51], v[104:107], a[124:127], v[48:51]
    v_mfma_f32_16x16x32_bf16 v[52:55], v[104:107], a[128:131], v[52:55]
    v_mfma_f32_16x16x32_bf16 v[56:59], v[104:107], a[132:135], v[56:59]
    v_mfma_f32_16x16x32_bf16 v[60:63], v[104:107], a[136:139], v[60:63]
    s_waitcnt lgkmcnt(2)
    v_mfma_f32_16x16x32_bf16 v[24:27], v[84:87], a[140:143], v[24:27]
    ds_read_b128 v[100:103], v20 offset:51200
    v_mfma_f32_16x16x32_bf16 v[28:31], v[84:87], a[144:147], v[28:31]
    ds_read_b128 v[104:107], v20 offset:51456
    v_mfma_f32_16x16x32_bf16 v[32:35], v[84:87], a[148:151], v[32:35]
    v_mfma_f32_16x16x32_bf16 v[36:39], v[84:87], a[152:155], v[36:39]
    v_mfma_f32_16x16x32_bf16 v[40:43], v[84:87], a[156:159], v[40:43]
    v_mfma_f32_16x16x32_bf16 v[44:47], v[88:91], a[140:143], v[44:47]
    v_mfma_f32_16x16x32_bf16 v[48:51], v[88:91], a[144:147], v[48:51]
    v_mfma_f32_16x16x32_bf16 v[52:55], v[88:91], a[148:151], v[52:55]
    v_mfma_f32_16x16x32_bf16 v[56:59], v[88:91], a[152:155], v[56:59]
    v_mfma_f32_16x16x32_bf16 v[60:63], v[88:91], a[156:159], v[60:63]
    s_waitcnt lgkmcnt(2)
    v_mfma_f32_16x16x32_bf16 v[24:27], v[92:95], a[160:163], v[24:27]
    ds_read_b128 v[84:87], v20 offset:53248
    v_mfma_f32_16x16x32_bf16 v[28:31], v[92:95], a[164:167], v[28:31]
    ds_read_b128 v[88:91], v20 offset:53504
    v_mfma_f32_16x16x32_bf16 v[32:35], v[92:95], a[168:171], v[32:35]
    v_mfma_f32_16x16x32_bf16 v[36:39], v[92:95], a[172:175], v[36:39]
    v_mfma_f32_16x16x32_bf16 v[40:43], v[92:95], a[176:179], v[40:43]
    v_mfma_f32_16x16x32_bf16 v[44:47], v[96:99], a[160:163], v[44:47]
    v_mfma_f32_16x16x32_bf16 v[48:51], v[96:99], a[164:167], v[48:51]
    v_mfma_f32_16x16x32_bf16 v[52:55], v[96:99], a[168:171], v[52:55]
    v_mfma_f32_16x16x32_bf16 v[56:59], v[96:99], a[172:175], v[56:59]
    v_mfma_f32_16x16x32_bf16 v[60:63], v[96:99], a[176:179], v[60:63]
    s_waitcnt lgkmcnt(2)
    v_mfma_f32_16x16x32_bf16 v[24:27], v[100:103], a[180:183], v[24:27]
    ds_read_b128 v[92:95], v20 offset:55296
    v_mfma_f32_16x16x32_bf16 v[28:31], v[100:103], a[184:187], v[28:31]
    ds_read_b128 v[96:99], v20 offset:55552
    v_mfma_f32_16x16x32_bf16 v[32:35], v[100:103], a[188:191], v[32:35]
    v_mfma_f32_16x16x32_bf16 v[36:39], v[100:103], a[192:195], v[36:39]
    v_mfma_f32_16x16x32_bf16 v[40:43], v[100:103], a[196:199], v[40:43]
    v_mfma_f32_16x16x32_bf16 v[44:47], v[104:107], a[180:183], v[44:47]
    v_mfma_f32_16x16x32_bf16 v[48:51], v[104:107], a[184:187], v[48:51]
    v_mfma_f32_16x16x32_bf16 v[52:55], v[104:107], a[188:191], v[52:55]
    v_mfma_f32_16x16x32_bf16 v[56:59], v[104:107], a[192:195], v[56:59]
    s_waitcnt vmcnt(10)
    s_barrier
    v_mfma_f32_16x16x32_bf16 v[60:63], v[104:107], a[196:199], v[60:63]
    s_waitcnt lgkmcnt(2)
    v_mfma_f32_16x16x32_bf16 v[24:27], v[84:87], a[200:203], v[24:27]
    ds_read_b128 v[100:103], v21 offset:0
    v_mfma_f32_16x16x32_bf16 v[28:31], v[84:87], a[204:207], v[28:31]
    ds_read_b128 v[104:107], v21 offset:256
    v_mfma_f32_16x16x32_bf16 v[32:35], v[84:87], a[208:211], v[32:35]
    v_mfma_f32_16x16x32_bf16 v[36:39], v[84:87], a[212:215], v[36:39]
    v_mfma_f32_16x16x32_bf16 v[40:43], v[84:87], a[216:219], v[40:43]
    v_mfma_f32_16x16x32_bf16 v[44:47], v[88:91], a[200:203], v[44:47]
    v_mfma_f32_16x16x32_bf16 v[48:51], v[88:91], a[204:207], v[48:51]
    v_mfma_f32_16x16x32_bf16 v[52:55], v[88:91], a[208:211], v[52:55]
    v_mfma_f32_16x16x32_bf16 v[56:59], v[88:91], a[212:215], v[56:59]
    v_mfma_f32_16x16x32_bf16 v[60:63], v[88:91], a[216:219], v[60:63]
    s_waitcnt lgkmcnt(2)
    v_mfma_f32_16x16x32_bf16 v[24:27], v[92:95], a[220:223], v[24:27]
    ds_read_b128 v[84:87], v21 offset:2048
    v_mfma_f32_16x16x32_bf16 v[28:31], v[92:95], a[224:227], v[28:31]
    ds_read_b128 v[88:91], v21 offset:2304
    v_mfma_f32_16x16x32_bf16 v[32:35], v[92:95], a[228:231], v[32:35]
    v_mfma_f32_16x16x32_bf16 v[36:39], v[92:95], a[232:235], v[36:39]
    v_mfma_f32_16x16x32_bf16 v[40:43], v[92:95], a[236:239], v[40:43]
    v_mfma_f32_16x16x32_bf16 v[44:47], v[96:99], a[220:223], v[44:47]
    v_mfma_f32_16x16x32_bf16 v[48:51], v[96:99], a[224:227], v[48:51]
    v_mfma_f32_16x16x32_bf16 v[52:55], v[96:99], a[228:231], v[52:55]
    v_mfma_f32_16x16x32_bf16 v[56:59], v[96:99], a[232:235], v[56:59]
    v_mfma_f32_16x16x32_bf16 v[60:63], v[96:99], a[236:239], v[60:63]
    s_waitcnt lgkmcnt(2)
    v_mfma_f32_16x16x32_bf16 v[24:27], v[100:103], a[240:243], v[24:27]
    ds_read_b128 v[92:95], v21 offset:4096
    v_mfma_f32_16x16x32_bf16 v[28:31], v[100:103], a[244:247], v[28:31]
    ds_read_b128 v[96:99], v21 offset:4352
    v_mfma_f32_16x16x32_bf16 v[32:35], v[100:103], a[248:251], v[32:35]
    v_mfma_f32_16x16x32_bf16 v[36:39], v[100:103], a[252:255], v[36:39]
    v_mfma_f32_16x16x32_bf16 v[40:43], v[100:103], v[112:115], v[40:43]
    v_mfma_f32_16x16x32_bf16 v[44:47], v[104:107], a[240:243], v[44:47]
    v_mfma_f32_16x16x32_bf16 v[48:51], v[104:107], a[244:247], v[48:51]
    v_mfma_f32_16x16x32_bf16 v[52:55], v[104:107], a[248:251], v[52:55]
    v_mfma_f32_16x16x32_bf16 v[56:59], v[104:107], a[252:255], v[56:59]
    v_mfma_f32_16x16x32_bf16 v[60:63], v[104:107], v[112:115], v[60:63]
    s_waitcnt lgkmcnt(2)
    v_mfma_f32_16x16x32_bf16 v[24:27], v[84:87], v[116:119], v[24:27]
    ds_read_b128 v[100:103], v21 offset:6144
    v_mfma_f32_16x16x32_bf16 v[28:31], v[84:87], v[120:123], v[28:31]
    ds_read_b128 v[104:107], v21 offset:6400
    v_mfma_f32_16x16x32_bf16 v[32:35], v[84:87], v[124:127], v[32:35]
    v_mfma_f32_16x16x32_bf16 v[36:39], v[84:87], v[128:131], v[36:39]
    v_mfma_f32_16x16x32_bf16 v[40:43], v[84:87], v[132:135], v[40:43]
    v_mfma_f32_16x16x32_bf16 v[44:47], v[88:91], v[116:119], v[44:47]
    v_mfma_f32_16x16x32_bf16 v[48:51], v[88:91], v[120:123], v[48:51]
    v_mfma_f32_16x16x32_bf16 v[52:55], v[88:91], v[124:127], v[52:55]
    v_mfma_f32_16x16x32_bf16 v[56:59], v[88:91], v[128:131], v[56:59]
    s_waitcnt vmcnt(6)
    s_barrier
    v_mfma_f32_16x16x32_bf16 v[60:63], v[88:91], v[132:135], v[60:63]
    s_waitcnt lgkmcnt(2)
    v_mfma_f32_16x16x32_bf16 v[24:27], v[92:95], v[136:139], v[24:27]
    ds_read_b128 v[84:87], v21 offset:16384
    v_mfma_f32_16x16x32_bf16 v[28:31], v[92:95], v[140:143], v[28:31]
    ds_read_b128 v[88:91], v21 offset:16640
    v_mfma_f32_16x16x32_bf16 v[32:35], v[92:95], v[144:147], v[32:35]
    v_mfma_f32_16x16x32_bf16 v[36:39], v[92:95], v[148:151], v[36:39]
    v_mfma_f32_16x16x32_bf16 v[40:43], v[92:95], v[152:155], v[40:43]
    v_mfma_f32_16x16x32_bf16 v[44:47], v[96:99], v[136:139], v[44:47]
    v_mfma_f32_16x16x32_bf16 v[48:51], v[96:99], v[140:143], v[48:51]
    v_mfma_f32_16x16x32_bf16 v[52:55], v[96:99], v[144:147], v[52:55]
    v_mfma_f32_16x16x32_bf16 v[56:59], v[96:99], v[148:151], v[56:59]
    v_mfma_f32_16x16x32_bf16 v[60:63], v[96:99], v[152:155], v[60:63]
    s_waitcnt lgkmcnt(2)
    v_mfma_f32_16x16x32_bf16 v[24:27], v[100:103], v[156:159], v[24:27]
    ds_read_b128 v[92:95], v21 offset:18432
    v_mfma_f32_16x16x32_bf16 v[28:31], v[100:103], v[160:163], v[28:31]
    ds_read_b128 v[96:99], v21 offset:18688
    v_mfma_f32_16x16x32_bf16 v[32:35], v[100:103], v[164:167], v[32:35]
    v_mfma_f32_16x16x32_bf16 v[36:39], v[100:103], v[168:171], v[36:39]
    v_mfma_f32_16x16x32_bf16 v[40:43], v[100:103], v[172:175], v[40:43]
    v_mfma_f32_16x16x32_bf16 v[44:47], v[104:107], v[156:159], v[44:47]
    v_mfma_f32_16x16x32_bf16 v[48:51], v[104:107], v[160:163], v[48:51]
    v_mfma_f32_16x16x32_bf16 v[52:55], v[104:107], v[164:167], v[52:55]
    v_mfma_f32_16x16x32_bf16 v[56:59], v[104:107], v[168:171], v[56:59]
    v_mfma_f32_16x16x32_bf16 v[60:63], v[104:107], v[172:175], v[60:63]
    s_waitcnt lgkmcnt(2)
    v_mfma_f32_16x16x32_bf16 v[24:27], v[84:87], v[176:179], v[24:27]
    ds_read_b128 v[100:103], v21 offset:20480
    v_mfma_f32_16x16x32_bf16 v[28:31], v[84:87], v[180:183], v[28:31]
    ds_read_b128 v[104:107], v21 offset:20736
    v_mfma_f32_16x16x32_bf16 v[32:35], v[84:87], v[184:187], v[32:35]
    v_mfma_f32_16x16x32_bf16 v[36:39], v[84:87], v[188:191], v[36:39]
    v_mfma_f32_16x16x32_bf16 v[40:43], v[84:87], v[192:195], v[40:43]
    v_mfma_f32_16x16x32_bf16 v[44:47], v[88:91], v[176:179], v[44:47]
    v_mfma_f32_16x16x32_bf16 v[48:51], v[88:91], v[180:183], v[48:51]
    v_mfma_f32_16x16x32_bf16 v[52:55], v[88:91], v[184:187], v[52:55]
    v_mfma_f32_16x16x32_bf16 v[56:59], v[88:91], v[188:191], v[56:59]
    v_mfma_f32_16x16x32_bf16 v[60:63], v[88:91], v[192:195], v[60:63]
    s_waitcnt lgkmcnt(2)
    v_mfma_f32_16x16x32_bf16 v[24:27], v[92:95], v[196:199], v[24:27]
    ds_read_b128 v[84:87], v21 offset:22528
    v_mfma_f32_16x16x32_bf16 v[28:31], v[92:95], v[200:203], v[28:31]
    ds_read_b128 v[88:91], v21 offset:22784
    v_mfma_f32_16x16x32_bf16 v[32:35], v[92:95], v[204:207], v[32:35]
    v_mfma_f32_16x16x32_bf16 v[36:39], v[92:95], v[208:211], v[36:39]
    v_mfma_f32_16x16x32_bf16 v[40:43], v[92:95], v[212:215], v[40:43]
    v_mfma_f32_16x16x32_bf16 v[44:47], v[96:99], v[196:199], v[44:47]
    v_mfma_f32_16x16x32_bf16 v[48:51], v[96:99], v[200:203], v[48:51]
    v_mfma_f32_16x16x32_bf16 v[52:55], v[96:99], v[204:207], v[52:55]
    v_mfma_f32_16x16x32_bf16 v[56:59], v[96:99], v[208:211], v[56:59]
    v_mfma_f32_16x16x32_bf16 v[60:63], v[96:99], v[212:215], v[60:63]
    s_waitcnt lgkmcnt(2)
    v_mfma_f32_16x16x32_bf16 v[24:27], v[100:103], v[216:219], v[24:27]
    v_mfma_f32_16x16x32_bf16 v[28:31], v[100:103], v[220:223], v[28:31]
    v_mfma_f32_16x16x32_bf16 v[32:35], v[100:103], v[224:227], v[32:35]
    v_mfma_f32_16x16x32_bf16 v[36:39], v[100:103], v[228:231], v[36:39]
    v_mfma_f32_16x16x32_bf16 v[40:43], v[100:103], v[232:235], v[40:43]
    v_mfma_f32_16x16x32_bf16 v[44:47], v[104:107], v[216:219], v[44:47]
    v_mfma_f32_16x16x32_bf16 v[48:51], v[104:107], v[220:223], v[48:51]
    v_mfma_f32_16x16x32_bf16 v[52:55], v[104:107], v[224:227], v[52:55]
    v_mfma_f32_16x16x32_bf16 v[56:59], v[104:107], v[228:231], v[56:59]
    v_mfma_f32_16x16x32_bf16 v[60:63], v[104:107], v[232:235], v[60:63]
    s_waitcnt lgkmcnt(0)
    v_mfma_f32_16x16x32_bf16 v[24:27], v[84:87], v[236:239], v[24:27]
    v_mfma_f32_16x16x32_bf16 v[28:31], v[84:87], v[240:243], v[28:31]
    v_mfma_f32_16x16x32_bf16 v[32:35], v[84:87], v[244:247], v[32:35]
    v_mfma_f32_16x16x32_bf16 v[36:39], v[84:87], v[248:251], v[36:39]
    v_mfma_f32_16x16x32_bf16 v[40:43], v[84:87], v[252:255], v[40:43]
    v_mfma_f32_16x16x32_bf16 v[44:47], v[88:91], v[236:239], v[44:47]
    v_mfma_f32_16x16x32_bf16 v[48:51], v[88:91], v[240:243], v[48:51]
    v_mfma_f32_16x16x32_bf16 v[52:55], v[88:91], v[244:247], v[52:55]
    v_mfma_f32_16x16x32_bf16 v[56:59], v[88:91], v[248:251], v[56:59]
    v_mfma_f32_16x16x32_bf16 v[60:63], v[88:91], v[252:255], v[60:63]
    v_cvt_pk_bf16_f32 v64, v24, v25
    v_cvt_pk_bf16_f32 v65, v26, v27
    s_nop 0
    s_nop 0
    v_cvt_pk_bf16_f32 v66, v44, v45
    v_cvt_pk_bf16_f32 v67, v46, v47
    v_cvt_pk_bf16_f32 v68, v28, v29
    v_cvt_pk_bf16_f32 v69, v30, v31
    v_cvt_pk_bf16_f32 v70, v48, v49
    v_cvt_pk_bf16_f32 v71, v50, v51
    v_permlane16_swap_b32 v64, v66
    v_permlane16_swap_b32 v65, v67
    buffer_store_dwordx4 v[64:67], v1, s[20:23], s52 offen offset:1280 sc1
    v_cvt_pk_bf16_f32 v72, v32, v33
    v_cvt_pk_bf16_f32 v73, v34, v35
    v_cvt_pk_bf16_f32 v74, v52, v53
    v_cvt_pk_bf16_f32 v75, v54, v55
    v_permlane16_swap_b32 v68, v70
    v_permlane16_swap_b32 v69, v71
    buffer_store_dwordx4 v[68:71], v1, s[20:23], s53 offen offset:1280 sc1
    v_cvt_pk_bf16_f32 v76, v36, v37
    v_cvt_pk_bf16_f32 v77, v38, v39
    v_cvt_pk_bf16_f32 v78, v56, v57
    v_cvt_pk_bf16_f32 v79, v58, v59
    v_permlane16_swap_b32 v72, v74
    v_permlane16_swap_b32 v73, v75
    buffer_store_dwordx4 v[72:75], v1, s[20:23], s54 offen offset:1280 sc1
    v_cvt_pk_bf16_f32 v80, v40, v41
    v_cvt_pk_bf16_f32 v81, v42, v43
    v_cvt_pk_bf16_f32 v82, v60, v61
    v_cvt_pk_bf16_f32 v83, v62, v63
    v_permlane16_swap_b32 v76, v78
    v_permlane16_swap_b32 v77, v79
    buffer_store_dwordx4 v[76:79], v1, s[20:23], s55 offen offset:1280 sc1
    v_permlane16_swap_b32 v80, v82
    v_permlane16_swap_b32 v81, v83
    buffer_store_dwordx4 v[80:83], v22, s[20:23], s52 offen offset:2304 sc1
    buffer_store_dwordx4 v[108:111], v23, s[20:23], s52 offen offset:2560 sc1
    s_endpgm
L_front_helper_2:
    s_mov_b32 s10, 2621440
    s_mov_b32 s11, 0x20000
    s_lshr_b32 s42, s2, 1
    s_and_b32 s43, s2, 1
    s_lshl2_add_u32 s38, s42, s43
    s_mul_i32 s38, s38, 20480
    s_mul_i32 s39, s29, 320
    s_add_u32 s38, s38, s39
    s_mul_i32 s40, s29, 10240
    v_add_u32 v22, 0, v17
    v_mul_u32_u24 v23, 205, v22
    v_lshrrev_b32 v23, 12, v23
    v_mul_u32_u24 v23, 960, v23
    v_lshl_add_u32 v244, v22, 4, v23
    v_add_u32 v22, 64, v17
    v_mul_u32_u24 v23, 205, v22
    v_lshrrev_b32 v23, 12, v23
    v_mul_u32_u24 v23, 960, v23
    v_lshl_add_u32 v245, v22, 4, v23
    v_add_u32 v22, 128, v17
    v_mul_u32_u24 v23, 205, v22
    v_lshrrev_b32 v23, 12, v23
    v_mul_u32_u24 v23, 960, v23
    v_lshl_add_u32 v246, v22, 4, v23
    v_add_u32 v22, 192, v17
    v_mul_u32_u24 v23, 205, v22
    v_lshrrev_b32 v23, 12, v23
    v_mul_u32_u24 v23, 960, v23
    v_lshl_add_u32 v247, v22, 4, v23
    v_add_u32 v22, 256, v17
    v_mul_u32_u24 v23, 205, v22
    v_lshrrev_b32 v23, 12, v23
    v_mul_u32_u24 v23, 960, v23
    v_lshl_add_u32 v248, v22, 4, v23
    s_add_u32 s41, s38, 40960
    s_waitcnt lgkmcnt(0)
    s_add_u32 m0, s40, 0
    s_nop 0
    buffer_load_dwordx4 v244, s[8:11], s38 offen lds
    s_add_u32 m0, s40, 1024
    s_nop 0
    buffer_load_dwordx4 v245, s[8:11], s38 offen lds
    s_add_u32 m0, s40, 2048
    s_nop 0
    buffer_load_dwordx4 v246, s[8:11], s38 offen lds
    s_add_u32 m0, s40, 3072
    s_nop 0
    buffer_load_dwordx4 v247, s[8:11], s38 offen lds
    s_add_u32 m0, s40, 4096
    s_nop 0
    buffer_load_dwordx4 v248, s[8:11], s38 offen lds
    s_add_u32 m0, s40, 5120
    s_nop 0
    buffer_load_dwordx4 v244, s[8:11], s41 offen lds
    s_add_u32 m0, s40, 6144
    s_nop 0
    buffer_load_dwordx4 v245, s[8:11], s41 offen lds
    s_add_u32 m0, s40, 7168
    s_nop 0
    buffer_load_dwordx4 v246, s[8:11], s41 offen lds
    s_add_u32 m0, s40, 8192
    s_nop 0
    buffer_load_dwordx4 v247, s[8:11], s41 offen lds
    s_add_u32 m0, s40, 9216
    s_nop 0
    buffer_load_dwordx4 v248, s[8:11], s41 offen lds
    s_waitcnt lgkmcnt(0)
    s_add_u32 s20, s6, 0x2000000
    s_cselect_b32 s20, 0x2000000, 0
    s_add_u32 s6, s6, s20
    s_addc_u32 s7, s7, 0
    s_mov_b32 s20, s6
    s_mov_b32 s21, s7
    v_lshrrev_b32 v18, 4, v17
    v_and_b32 v19, 15, v17
    v_mul_u32_u24 v20, 320, v19
    v_lshl_add_u32 v20, v18, 4, v20
    v_add_u32 v20, s40, v20
    s_lshl_b32 s39, s39, 1
    s_add_u32 s50, s39, 32768
    s_add_u32 s51, s39, 37888
    s_add_u32 s52, s39, 43008
    s_add_u32 s53, s39, 48128
    s_add_u32 s54, s39, 53248
    s_lshl_b32 s39, s39, 1
    s_add_u32 s39, s39, 40960
    v_min_u32 v15, 39, v17
    v_lshlrev_b32 v15, 4, v15
    v_add_u32 v22, s39, v15
    v_lshl_add_u32 v23, v18, 5, s39
    v_lshlrev_b32 v21, 2, v19
    v_lshrrev_b32 v3, 1, v18
    v_lshl_add_u32 v3, v3, 6, v21
    v_lshl_add_u32 v3, v16, 7, v3
    v_lshlrev_b32 v2, 4, v19
    v_lshl_add_u32 v2, v18, 9, v2
    s_mul_i32 s42, s42, 81920
    s_lshl_b32 s43, s43, 8
    s_add_u32 s42, s42, s43
    s_add_u32 s42, s42, s40
    s_add_u32 s42, s42, 524288
    s_lshr_b32 s43, s2, 2
    s_lshl_b32 s43, s43, 4
    s_and_b32 s44, s2, 3
    s_add_u32 s43, s43, s44
    s_lshl_b32 s43, s43, 7
    s_add_u32 s43, s43, 327680
    v_cmp_eq_u32 vcc, 0, v0
    v_mov_b32 v249, 0x40000000
    v_mov_b32 v250, 1
    v_cndmask_b32_e64 v249, v249, 0, vcc
    s_waitcnt vmcnt(5)
    ds_read_b128 v[24:27], v20 offset:0
    ds_read_b128 v[28:31], v20 offset:64
    ds_read_b128 v[32:35], v20 offset:128
    ds_read_b128 v[36:39], v20 offset:192
    ds_read_b128 v[40:43], v20 offset:256
    s_waitcnt lgkmcnt(4)
    v_lshlrev_b32 v44, 16, v24
    v_and_b32 v45, s45, v24
    v_lshlrev_b32 v46, 16, v25
    v_and_b32 v47, s45, v25
    v_lshlrev_b32 v48, 16, v26
    v_and_b32 v49, s45, v26
    v_lshlrev_b32 v50, 16, v27
    v_and_b32 v51, s45, v27
    v_pk_add_f32 v[4:5], v[44:45], v[46:47]
    v_pk_mul_f32 v[6:7], v[44:45], v[44:45]
    v_pk_fma_f32 v[6:7], v[46:47], v[46:47], v[6:7]
    v_pk_add_f32 v[4:5], v[4:5], v[48:49]
    v_pk_fma_f32 v[6:7], v[48:49], v[48:49], v[6:7]
    v_pk_add_f32 v[4:5], v[4:5], v[50:51]
    v_pk_fma_f32 v[6:7], v[50:51], v[50:51], v[6:7]
    s_waitcnt lgkmcnt(3)
    v_lshlrev_b32 v52, 16, v28
    v_and_b32 v53, s45, v28
    v_lshlrev_b32 v54, 16, v29
    v_and_b32 v55, s45, v29
    v_lshlrev_b32 v56, 16, v30
    v_and_b32 v57, s45, v30
    v_lshlrev_b32 v58, 16, v31
    v_and_b32 v59, s45, v31
    v_pk_add_f32 v[4:5], v[4:5], v[52:53]
    v_pk_fma_f32 v[6:7], v[52:53], v[52:53], v[6:7]
    v_pk_add_f32 v[4:5], v[4:5], v[54:55]
    v_pk_fma_f32 v[6:7], v[54:55], v[54:55], v[6:7]
    v_pk_add_f32 v[4:5], v[4:5], v[56:57]
    v_pk_fma_f32 v[6:7], v[56:57], v[56:57], v[6:7]
    v_pk_add_f32 v[4:5], v[4:5], v[58:59]
    v_pk_fma_f32 v[6:7], v[58:59], v[58:59], v[6:7]
    s_waitcnt lgkmcnt(2)
    v_lshlrev_b32 v60, 16, v32
    v_and_b32 v61, s45, v32
    v_lshlrev_b32 v62, 16, v33
    v_and_b32 v63, s45, v33
    v_lshlrev_b32 v64, 16, v34
    v_and_b32 v65, s45, v34
    v_lshlrev_b32 v66, 16, v35
    v_and_b32 v67, s45, v35
    v_pk_add_f32 v[4:5], v[4:5], v[60:61]
    v_pk_fma_f32 v[6:7], v[60:61], v[60:61], v[6:7]
    v_pk_add_f32 v[4:5], v[4:5], v[62:63]
    v_pk_fma_f32 v[6:7], v[62:63], v[62:63], v[6:7]
    v_pk_add_f32 v[4:5], v[4:5], v[64:65]
    v_pk_fma_f32 v[6:7], v[64:65], v[64:65], v[6:7]
    v_pk_add_f32 v[4:5], v[4:5], v[66:67]
    v_pk_fma_f32 v[6:7], v[66:67], v[66:67], v[6:7]
    s_waitcnt lgkmcnt(1)
    v_lshlrev_b32 v68, 16, v36
    v_and_b32 v69, s45, v36
    v_lshlrev_b32 v70, 16, v37
    v_and_b32 v71, s45, v37
    v_lshlrev_b32 v72, 16, v38
    v_and_b32 v73, s45, v38
    v_lshlrev_b32 v74, 16, v39
    v_and_b32 v75, s45, v39
    v_pk_add_f32 v[4:5], v[4:5], v[68:69]
    v_pk_fma_f32 v[6:7], v[68:69], v[68:69], v[6:7]
    v_pk_add_f32 v[4:5], v[4:5], v[70:71]
    v_pk_fma_f32 v[6:7], v[70:71], v[70:71], v[6:7]
    v_pk_add_f32 v[4:5], v[4:5], v[72:73]
    v_pk_fma_f32 v[6:7], v[72:73], v[72:73], v[6:7]
    v_pk_add_f32 v[4:5], v[4:5], v[74:75]
    v_pk_fma_f32 v[6:7], v[74:75], v[74:75], v[6:7]
    s_waitcnt lgkmcnt(0)
    v_lshlrev_b32 v76, 16, v40
    v_and_b32 v77, s45, v40
    v_lshlrev_b32 v78, 16, v41
    v_and_b32 v79, s45, v41
    v_lshlrev_b32 v80, 16, v42
    v_and_b32 v81, s45, v42
    v_lshlrev_b32 v82, 16, v43
    v_and_b32 v83, s45, v43
    v_pk_add_f32 v[4:5], v[4:5], v[76:77]
    v_pk_fma_f32 v[6:7], v[76:77], v[76:77], v[6:7]
    v_pk_add_f32 v[4:5], v[4:5], v[78:79]
    v_pk_fma_f32 v[6:7], v[78:79], v[78:79], v[6:7]
    v_pk_add_f32 v[4:5], v[4:5], v[80:81]
    v_pk_fma_f32 v[6:7], v[80:81], v[80:81], v[6:7]
    v_pk_add_f32 v[4:5], v[4:5], v[82:83]
    v_pk_fma_f32 v[6:7], v[82:83], v[82:83], v[6:7]
    v_add_f32 v4, v4, v5
    v_add_f32 v5, v6, v7
    s_nop 0
    s_nop 0
    v_permlane32_swap_b32 v4, v5
    v_add_f32 v6, v4, v5
    v_add_f32 v7, v4, v5
    s_nop 0
    s_nop 0
    v_permlane16_swap_b32 v6, v7
    v_add_f32 v6, v6, v7
    ds_write_b32 v3, v6 offset:46080
    s_waitcnt lgkmcnt(0)
    s_barrier
    ds_read_b32 v4, v21 offset:46080
    ds_read_b32 v5, v21 offset:46144
    ds_read_b32 v6, v21 offset:46208
    ds_read_b32 v7, v21 offset:46272
    ds_read_b32 v8, v21 offset:46336
    ds_read_b32 v9, v21 offset:46400
    ds_read_b32 v10, v21 offset:46464
    ds_read_b32 v11, v21 offset:46528
    s_waitcnt lgkmcnt(0)
    v_pk_add_f32 v[4:5], v[4:5], v[6:7]
    v_pk_add_f32 v[4:5], v[4:5], v[8:9]
    v_pk_add_f32 v[4:5], v[4:5], v[10:11]
    v_mul_f32 v4, 0xbacccccd, v4
    v_mul_f32 v5, 0x3acccccd, v5
    v_fma_f32 v5, -v4, v4, v5
    v_max_f32 v5, 0, v5
    v_add_f32 v5, 0x3727c5ac, v5
    v_rsq_f32 v5, v5
    s_nop 0
    v_mul_f32 v4, v4, v5
    v_pk_fma_f32 v[44:45], v[44:45], v[4:5], v[4:5] op_sel:[0,1,0] op_sel_hi:[1,1,0]
    v_pk_fma_f32 v[46:47], v[46:47], v[4:5], v[4:5] op_sel:[0,1,0] op_sel_hi:[1,1,0]
    v_pk_fma_f32 v[48:49], v[48:49], v[4:5], v[4:5] op_sel:[0,1,0] op_sel_hi:[1,1,0]
    v_pk_fma_f32 v[50:51], v[50:51], v[4:5], v[4:5] op_sel:[0,1,0] op_sel_hi:[1,1,0]
    v_pk_fma_f32 v[52:53], v[52:53], v[4:5], v[4:5] op_sel:[0,1,0] op_sel_hi:[1,1,0]
    v_pk_fma_f32 v[54:55], v[54:55], v[4:5], v[4:5] op_sel:[0,1,0] op_sel_hi:[1,1,0]
    v_pk_fma_f32 v[56:57], v[56:57], v[4:5], v[4:5] op_sel:[0,1,0] op_sel_hi:[1,1,0]
    v_pk_fma_f32 v[58:59], v[58:59], v[4:5], v[4:5] op_sel:[0,1,0] op_sel_hi:[1,1,0]
    v_pk_fma_f32 v[60:61], v[60:61], v[4:5], v[4:5] op_sel:[0,1,0] op_sel_hi:[1,1,0]
    v_pk_fma_f32 v[62:63], v[62:63], v[4:5], v[4:5] op_sel:[0,1,0] op_sel_hi:[1,1,0]
    v_pk_fma_f32 v[64:65], v[64:65], v[4:5], v[4:5] op_sel:[0,1,0] op_sel_hi:[1,1,0]
    v_pk_fma_f32 v[66:67], v[66:67], v[4:5], v[4:5] op_sel:[0,1,0] op_sel_hi:[1,1,0]
    v_pk_fma_f32 v[68:69], v[68:69], v[4:5], v[4:5] op_sel:[0,1,0] op_sel_hi:[1,1,0]
    v_pk_fma_f32 v[70:71], v[70:71], v[4:5], v[4:5] op_sel:[0,1,0] op_sel_hi:[1,1,0]
    v_pk_fma_f32 v[72:73], v[72:73], v[4:5], v[4:5] op_sel:[0,1,0] op_sel_hi:[1,1,0]
    v_pk_fma_f32 v[74:75], v[74:75], v[4:5], v[4:5] op_sel:[0,1,0] op_sel_hi:[1,1,0]
    v_pk_fma_f32 v[76:77], v[76:77], v[4:5], v[4:5] op_sel:[0,1,0] op_sel_hi:[1,1,0]
    v_pk_fma_f32 v[78:79], v[78:79], v[4:5], v[4:5] op_sel:[0,1,0] op_sel_hi:[1,1,0]
    v_pk_fma_f32 v[80:81], v[80:81], v[4:5], v[4:5] op_sel:[0,1,0] op_sel_hi:[1,1,0]
    v_pk_fma_f32 v[82:83], v[82:83], v[4:5], v[4:5] op_sel:[0,1,0] op_sel_hi:[1,1,0]
    buffer_load_dword v14, v13, s[24:27], 0 offen sc1
    s_waitcnt vmcnt(0)
    v_cmp_ne_u32 vcc, 50, v14
    s_cbranch_vccnz L_front_poll_20
L_front_ok_21:
    buffer_load_dwordx4 v[124:127], v15, s[20:23], s50 offen offset:0 sc1
    buffer_load_dwordx4 v[128:131], v15, s[20:23], s50 offen offset:2560 sc1
    buffer_load_dwordx4 v[132:135], v15, s[20:23], s51 offen offset:0 sc1
    buffer_load_dwordx4 v[136:139], v15, s[20:23], s51 offen offset:2560 sc1
    buffer_load_dwordx4 v[140:143], v15, s[20:23], s52 offen offset:0 sc1
    buffer_load_dwordx4 v[144:147], v15, s[20:23], s52 offen offset:2560 sc1
    buffer_load_dwordx4 v[148:151], v15, s[20:23], s53 offen offset:0 sc1
    buffer_load_dwordx4 v[152:155], v15, s[20:23], s53 offen offset:2560 sc1
    buffer_load_dwordx4 v[156:159], v15, s[20:23], s54 offen offset:0 sc1
    buffer_load_dwordx4 v[160:163], v15, s[20:23], s54 offen offset:2560 sc1
    ds_read_b128 v[24:27], v20 offset:5120
    ds_read_b128 v[28:31], v20 offset:5184
    ds_read_b128 v[32:35], v20 offset:5248
    ds_read_b128 v[36:39], v20 offset:5312
    ds_read_b128 v[40:43], v20 offset:5376
    s_waitcnt lgkmcnt(4)
    v_lshlrev_b32 v84, 16, v24
    v_and_b32 v85, s45, v24
    v_lshlrev_b32 v86, 16, v25
    v_and_b32 v87, s45, v25
    v_lshlrev_b32 v88, 16, v26
    v_and_b32 v89, s45, v26
    v_lshlrev_b32 v90, 16, v27
    v_and_b32 v91, s45, v27
    v_pk_add_f32 v[4:5], v[84:85], v[86:87]
    v_pk_mul_f32 v[6:7], v[84:85], v[84:85]
    v_pk_fma_f32 v[6:7], v[86:87], v[86:87], v[6:7]
    v_pk_add_f32 v[4:5], v[4:5], v[88:89]
    v_pk_fma_f32 v[6:7], v[88:89], v[88:89], v[6:7]
    v_pk_add_f32 v[4:5], v[4:5], v[90:91]
    v_pk_fma_f32 v[6:7], v[90:91], v[90:91], v[6:7]
    s_waitcnt lgkmcnt(3)
    v_lshlrev_b32 v92, 16, v28
    v_and_b32 v93, s45, v28
    v_lshlrev_b32 v94, 16, v29
    v_and_b32 v95, s45, v29
    v_lshlrev_b32 v96, 16, v30
    v_and_b32 v97, s45, v30
    v_lshlrev_b32 v98, 16, v31
    v_and_b32 v99, s45, v31
    v_pk_add_f32 v[4:5], v[4:5], v[92:93]
    v_pk_fma_f32 v[6:7], v[92:93], v[92:93], v[6:7]
    v_pk_add_f32 v[4:5], v[4:5], v[94:95]
    v_pk_fma_f32 v[6:7], v[94:95], v[94:95], v[6:7]
    v_pk_add_f32 v[4:5], v[4:5], v[96:97]
    v_pk_fma_f32 v[6:7], v[96:97], v[96:97], v[6:7]
    v_pk_add_f32 v[4:5], v[4:5], v[98:99]
    v_pk_fma_f32 v[6:7], v[98:99], v[98:99], v[6:7]
    s_waitcnt lgkmcnt(2)
    v_lshlrev_b32 v100, 16, v32
    v_and_b32 v101, s45, v32
    v_lshlrev_b32 v102, 16, v33
    v_and_b32 v103, s45, v33
    v_lshlrev_b32 v104, 16, v34
    v_and_b32 v105, s45, v34
    v_lshlrev_b32 v106, 16, v35
    v_and_b32 v107, s45, v35
    v_pk_add_f32 v[4:5], v[4:5], v[100:101]
    v_pk_fma_f32 v[6:7], v[100:101], v[100:101], v[6:7]
    v_pk_add_f32 v[4:5], v[4:5], v[102:103]
    v_pk_fma_f32 v[6:7], v[102:103], v[102:103], v[6:7]
    v_pk_add_f32 v[4:5], v[4:5], v[104:105]
    v_pk_fma_f32 v[6:7], v[104:105], v[104:105], v[6:7]
    v_pk_add_f32 v[4:5], v[4:5], v[106:107]
    v_pk_fma_f32 v[6:7], v[106:107], v[106:107], v[6:7]
    s_waitcnt lgkmcnt(1)
    v_lshlrev_b32 v108, 16, v36
    v_and_b32 v109, s45, v36
    v_lshlrev_b32 v110, 16, v37
    v_and_b32 v111, s45, v37
    v_lshlrev_b32 v112, 16, v38
    v_and_b32 v113, s45, v38
    v_lshlrev_b32 v114, 16, v39
    v_and_b32 v115, s45, v39
    v_pk_add_f32 v[4:5], v[4:5], v[108:109]
    v_pk_fma_f32 v[6:7], v[108:109], v[108:109], v[6:7]
    v_pk_add_f32 v[4:5], v[4:5], v[110:111]
    v_pk_fma_f32 v[6:7], v[110:111], v[110:111], v[6:7]
    v_pk_add_f32 v[4:5], v[4:5], v[112:113]
    v_pk_fma_f32 v[6:7], v[112:113], v[112:113], v[6:7]
    v_pk_add_f32 v[4:5], v[4:5], v[114:115]
    v_pk_fma_f32 v[6:7], v[114:115], v[114:115], v[6:7]
    s_waitcnt lgkmcnt(0)
    v_lshlrev_b32 v116, 16, v40
    v_and_b32 v117, s45, v40
    v_lshlrev_b32 v118, 16, v41
    v_and_b32 v119, s45, v41
    v_lshlrev_b32 v120, 16, v42
    v_and_b32 v121, s45, v42
    v_lshlrev_b32 v122, 16, v43
    v_and_b32 v123, s45, v43
    v_pk_add_f32 v[4:5], v[4:5], v[116:117]
    v_pk_fma_f32 v[6:7], v[116:117], v[116:117], v[6:7]
    v_pk_add_f32 v[4:5], v[4:5], v[118:119]
    v_pk_fma_f32 v[6:7], v[118:119], v[118:119], v[6:7]
    v_pk_add_f32 v[4:5], v[4:5], v[120:121]
    v_pk_fma_f32 v[6:7], v[120:121], v[120:121], v[6:7]
    v_pk_add_f32 v[4:5], v[4:5], v[122:123]
    v_pk_fma_f32 v[6:7], v[122:123], v[122:123], v[6:7]
    v_add_f32 v4, v4, v5
    v_add_f32 v5, v6, v7
    s_nop 0
    s_nop 0
    v_permlane32_swap_b32 v4, v5
    v_add_f32 v6, v4, v5
    v_add_f32 v7, v4, v5
    s_nop 0
    s_nop 0
    v_permlane16_swap_b32 v6, v7
    v_add_f32 v6, v6, v7
    ds_write_b32 v3, v6 offset:46592
    s_waitcnt lgkmcnt(0)
    s_barrier
    ds_read_b32 v4, v21 offset:46592
    ds_read_b32 v5, v21 offset:46656
    ds_read_b32 v6, v21 offset:46720
    ds_read_b32 v7, v21 offset:46784
    ds_read_b32 v8, v21 offset:46848
    ds_read_b32 v9, v21 offset:46912
    ds_read_b32 v10, v21 offset:46976
    ds_read_b32 v11, v21 offset:47040
    s_waitcnt lgkmcnt(0)
    v_pk_add_f32 v[4:5], v[4:5], v[6:7]
    v_pk_add_f32 v[4:5], v[4:5], v[8:9]
    v_pk_add_f32 v[4:5], v[4:5], v[10:11]
    v_mul_f32 v4, 0xbacccccd, v4
    v_mul_f32 v5, 0x3acccccd, v5
    v_fma_f32 v5, -v4, v4, v5
    v_max_f32 v5, 0, v5
    v_add_f32 v5, 0x3727c5ac, v5
    v_rsq_f32 v5, v5
    s_nop 0
    v_mul_f32 v4, v4, v5
    v_pk_fma_f32 v[84:85], v[84:85], v[4:5], v[4:5] op_sel:[0,1,0] op_sel_hi:[1,1,0]
    v_pk_fma_f32 v[86:87], v[86:87], v[4:5], v[4:5] op_sel:[0,1,0] op_sel_hi:[1,1,0]
    v_pk_fma_f32 v[88:89], v[88:89], v[4:5], v[4:5] op_sel:[0,1,0] op_sel_hi:[1,1,0]
    v_pk_fma_f32 v[90:91], v[90:91], v[4:5], v[4:5] op_sel:[0,1,0] op_sel_hi:[1,1,0]
    v_pk_fma_f32 v[92:93], v[92:93], v[4:5], v[4:5] op_sel:[0,1,0] op_sel_hi:[1,1,0]
    v_pk_fma_f32 v[94:95], v[94:95], v[4:5], v[4:5] op_sel:[0,1,0] op_sel_hi:[1,1,0]
    v_pk_fma_f32 v[96:97], v[96:97], v[4:5], v[4:5] op_sel:[0,1,0] op_sel_hi:[1,1,0]
    v_pk_fma_f32 v[98:99], v[98:99], v[4:5], v[4:5] op_sel:[0,1,0] op_sel_hi:[1,1,0]
    v_pk_fma_f32 v[100:101], v[100:101], v[4:5], v[4:5] op_sel:[0,1,0] op_sel_hi:[1,1,0]
    v_pk_fma_f32 v[102:103], v[102:103], v[4:5], v[4:5] op_sel:[0,1,0] op_sel_hi:[1,1,0]
    v_pk_fma_f32 v[104:105], v[104:105], v[4:5], v[4:5] op_sel:[0,1,0] op_sel_hi:[1,1,0]
    v_pk_fma_f32 v[106:107], v[106:107], v[4:5], v[4:5] op_sel:[0,1,0] op_sel_hi:[1,1,0]
    v_pk_fma_f32 v[108:109], v[108:109], v[4:5], v[4:5] op_sel:[0,1,0] op_sel_hi:[1,1,0]
    v_pk_fma_f32 v[110:111], v[110:111], v[4:5], v[4:5] op_sel:[0,1,0] op_sel_hi:[1,1,0]
    v_pk_fma_f32 v[112:113], v[112:113], v[4:5], v[4:5] op_sel:[0,1,0] op_sel_hi:[1,1,0]
    v_pk_fma_f32 v[114:115], v[114:115], v[4:5], v[4:5] op_sel:[0,1,0] op_sel_hi:[1,1,0]
    v_pk_fma_f32 v[116:117], v[116:117], v[4:5], v[4:5] op_sel:[0,1,0] op_sel_hi:[1,1,0]
    v_pk_fma_f32 v[118:119], v[118:119], v[4:5], v[4:5] op_sel:[0,1,0] op_sel_hi:[1,1,0]
    v_pk_fma_f32 v[120:121], v[120:121], v[4:5], v[4:5] op_sel:[0,1,0] op_sel_hi:[1,1,0]
    v_pk_fma_f32 v[122:123], v[122:123], v[4:5], v[4:5] op_sel:[0,1,0] op_sel_hi:[1,1,0]
    s_waitcnt vmcnt(0)
    v_max3_u32 v14, v124, v125, v126
    v_max3_u32 v14, v14, v127, v128
    v_max3_u32 v14, v14, v129, v130
    v_max3_u32 v14, v14, v131, v132
    v_max3_u32 v14, v14, v133, v134
    v_max3_u32 v14, v14, v135, v136
    v_max3_u32 v14, v14, v137, v138
    v_max3_u32 v14, v14, v139, v140
    v_max3_u32 v14, v14, v141, v142
    v_max3_u32 v14, v14, v143, v144
    v_max3_u32 v14, v14, v145, v146
    v_max3_u32 v14, v14, v147, v148
    v_max3_u32 v14, v14, v149, v150
    v_max3_u32 v14, v14, v151, v152
    v_max3_u32 v14, v14, v153, v154
    v_max3_u32 v14, v14, v155, v156
    v_max3_u32 v14, v14, v157, v158
    v_max3_u32 v14, v14, v159, v160
    v_max3_u32 v14, v14, v161, v162
    v_max_u32 v14, v14, v163
    v_cmp_eq_u32 vcc, -1, v14
    s_cbranch_vccnz L_front_poll_22
L_front_ok_23:
    v_pk_add_f32 v[124:125], v[124:125], v[132:133]
    v_pk_add_f32 v[126:127], v[126:127], v[134:135]
    v_pk_add_f32 v[128:129], v[128:129], v[136:137]
    v_pk_add_f32 v[130:131], v[130:131], v[138:139]
    v_pk_add_f32 v[124:125], v[124:125], v[140:141]
    v_pk_add_f32 v[126:127], v[126:127], v[142:143]
    v_pk_add_f32 v[128:129], v[128:129], v[144:145]
    v_pk_add_f32 v[130:131], v[130:131], v[146:147]
    v_pk_add_f32 v[124:125], v[124:125], v[148:149]
    v_pk_add_f32 v[126:127], v[126:127], v[150:151]
    v_pk_add_f32 v[128:129], v[128:129], v[152:153]
    v_pk_add_f32 v[130:131], v[130:131], v[154:155]
    v_pk_add_f32 v[124:125], v[124:125], v[156:157]
    v_pk_add_f32 v[126:127], v[126:127], v[158:159]
    v_pk_add_f32 v[128:129], v[128:129], v[160:161]
    v_pk_add_f32 v[130:131], v[130:131], v[162:163]
    v_cvt_pk_bf16_f32 v132, v124, v125
    v_cvt_pk_bf16_f32 v133, v126, v127
    v_cvt_pk_bf16_f32 v134, v128, v129
    v_cvt_pk_bf16_f32 v135, v130, v131
    v_lshlrev_b32 v124, 16, v132
    v_and_b32 v125, s45, v132
    v_lshlrev_b32 v126, 16, v133
    v_and_b32 v127, s45, v133
    v_lshlrev_b32 v128, 16, v134
    v_and_b32 v129, s45, v134
    v_lshlrev_b32 v130, 16, v135
    v_and_b32 v131, s45, v135
    ds_write_b128 v22, v[124:127]
    v_pk_add_f32 v[128:129], v[128:129], 1.0 op_sel_hi:[1,0]
    v_pk_add_f32 v[130:131], v[130:131], 1.0 op_sel_hi:[1,0]
    v_cvt_pk_bf16_f32 v134, v128, v129
    v_cvt_pk_bf16_f32 v135, v130, v131
    v_lshlrev_b32 v128, 16, v134
    v_and_b32 v129, s45, v134
    v_lshlrev_b32 v130, 16, v135
    v_and_b32 v131, s45, v135
    ds_write_b128 v22, v[128:131] offset:640
    ds_read_b128 v[164:167], v23 offset:0
    ds_read_b128 v[168:171], v23 offset:16
    ds_read_b128 v[172:175], v23 offset:640
    ds_read_b128 v[176:179], v23 offset:656
    ds_read_b128 v[180:183], v23 offset:128
    ds_read_b128 v[184:187], v23 offset:144
    ds_read_b128 v[188:191], v23 offset:768
    ds_read_b128 v[192:195], v23 offset:784
    ds_read_b128 v[196:199], v23 offset:256
    ds_read_b128 v[200:203], v23 offset:272
    ds_read_b128 v[204:207], v23 offset:896
    ds_read_b128 v[208:211], v23 offset:912
    ds_read_b128 v[212:215], v23 offset:384
    ds_read_b128 v[216:219], v23 offset:400
    ds_read_b128 v[220:223], v23 offset:1024
    ds_read_b128 v[224:227], v23 offset:1040
    ds_read_b128 v[228:231], v23 offset:512
    ds_read_b128 v[232:235], v23 offset:528
    ds_read_b128 v[236:239], v23 offset:1152
    ds_read_b128 v[240:243], v23 offset:1168
    s_waitcnt lgkmcnt(15)
    v_pk_fma_f32 v[44:45], v[44:45], v[172:173], v[164:165]
    v_pk_fma_f32 v[46:47], v[46:47], v[174:175], v[166:167]
    v_pk_fma_f32 v[48:49], v[48:49], v[176:177], v[168:169]
    v_pk_fma_f32 v[50:51], v[50:51], v[178:179], v[170:171]
    v_cvt_pk_bf16_f32 v44, v44, v45
    v_cvt_pk_bf16_f32 v45, v46, v47
    v_cvt_pk_bf16_f32 v46, v48, v49
    v_cvt_pk_bf16_f32 v47, v50, v51
    buffer_store_dwordx4 v[44:47], v2, s[20:23], s42 offen offset:0 sc1
    s_waitcnt lgkmcnt(12)
    v_pk_fma_f32 v[52:53], v[52:53], v[188:189], v[180:181]
    v_pk_fma_f32 v[54:55], v[54:55], v[190:191], v[182:183]
    v_pk_fma_f32 v[56:57], v[56:57], v[192:193], v[184:185]
    v_pk_fma_f32 v[58:59], v[58:59], v[194:195], v[186:187]
    v_cvt_pk_bf16_f32 v52, v52, v53
    v_cvt_pk_bf16_f32 v53, v54, v55
    v_cvt_pk_bf16_f32 v54, v56, v57
    v_cvt_pk_bf16_f32 v55, v58, v59
    buffer_store_dwordx4 v[52:55], v2, s[20:23], s42 offen offset:2048 sc1
    s_add_u32 s42, s42, 4096
    s_waitcnt lgkmcnt(8)
    v_pk_fma_f32 v[60:61], v[60:61], v[204:205], v[196:197]
    v_pk_fma_f32 v[62:63], v[62:63], v[206:207], v[198:199]
    v_pk_fma_f32 v[64:65], v[64:65], v[208:209], v[200:201]
    v_pk_fma_f32 v[66:67], v[66:67], v[210:211], v[202:203]
    v_cvt_pk_bf16_f32 v60, v60, v61
    v_cvt_pk_bf16_f32 v61, v62, v63
    v_cvt_pk_bf16_f32 v62, v64, v65
    v_cvt_pk_bf16_f32 v63, v66, v67
    buffer_store_dwordx4 v[60:63], v2, s[20:23], s42 offen offset:0 sc1
    s_waitcnt lgkmcnt(4)
    v_pk_fma_f32 v[68:69], v[68:69], v[220:221], v[212:213]
    v_pk_fma_f32 v[70:71], v[70:71], v[222:223], v[214:215]
    v_pk_fma_f32 v[72:73], v[72:73], v[224:225], v[216:217]
    v_pk_fma_f32 v[74:75], v[74:75], v[226:227], v[218:219]
    v_cvt_pk_bf16_f32 v68, v68, v69
    v_cvt_pk_bf16_f32 v69, v70, v71
    v_cvt_pk_bf16_f32 v70, v72, v73
    v_cvt_pk_bf16_f32 v71, v74, v75
    buffer_store_dwordx4 v[68:71], v2, s[20:23], s42 offen offset:2048 sc1
    s_add_u32 s42, s42, 4096
    s_waitcnt lgkmcnt(0)
    v_pk_fma_f32 v[76:77], v[76:77], v[236:237], v[228:229]
    v_pk_fma_f32 v[78:79], v[78:79], v[238:239], v[230:231]
    v_pk_fma_f32 v[80:81], v[80:81], v[240:241], v[232:233]
    v_pk_fma_f32 v[82:83], v[82:83], v[242:243], v[234:235]
    v_cvt_pk_bf16_f32 v76, v76, v77
    v_cvt_pk_bf16_f32 v77, v78, v79
    v_cvt_pk_bf16_f32 v78, v80, v81
    v_cvt_pk_bf16_f32 v79, v82, v83
    buffer_store_dwordx4 v[76:79], v2, s[20:23], s42 offen offset:0 sc1
    s_add_u32 s42, s42, 32768
    v_pk_fma_f32 v[84:85], v[84:85], v[172:173], v[164:165]
    v_pk_fma_f32 v[86:87], v[86:87], v[174:175], v[166:167]
    v_pk_fma_f32 v[88:89], v[88:89], v[176:177], v[168:169]
    v_pk_fma_f32 v[90:91], v[90:91], v[178:179], v[170:171]
    v_cvt_pk_bf16_f32 v84, v84, v85
    v_cvt_pk_bf16_f32 v85, v86, v87
    v_cvt_pk_bf16_f32 v86, v88, v89
    v_cvt_pk_bf16_f32 v87, v90, v91
    v_pk_fma_f32 v[92:93], v[92:93], v[188:189], v[180:181]
    v_pk_fma_f32 v[94:95], v[94:95], v[190:191], v[182:183]
    v_pk_fma_f32 v[96:97], v[96:97], v[192:193], v[184:185]
    v_pk_fma_f32 v[98:99], v[98:99], v[194:195], v[186:187]
    v_cvt_pk_bf16_f32 v92, v92, v93
    v_cvt_pk_bf16_f32 v93, v94, v95
    v_cvt_pk_bf16_f32 v94, v96, v97
    v_cvt_pk_bf16_f32 v95, v98, v99
    v_pk_fma_f32 v[100:101], v[100:101], v[204:205], v[196:197]
    v_pk_fma_f32 v[102:103], v[102:103], v[206:207], v[198:199]
    v_pk_fma_f32 v[104:105], v[104:105], v[208:209], v[200:201]
    v_pk_fma_f32 v[106:107], v[106:107], v[210:211], v[202:203]
    v_cvt_pk_bf16_f32 v100, v100, v101
    v_cvt_pk_bf16_f32 v101, v102, v103
    v_cvt_pk_bf16_f32 v102, v104, v105
    v_cvt_pk_bf16_f32 v103, v106, v107
    v_pk_fma_f32 v[108:109], v[108:109], v[220:221], v[212:213]
    v_pk_fma_f32 v[110:111], v[110:111], v[222:223], v[214:215]
    v_pk_fma_f32 v[112:113], v[112:113], v[224:225], v[216:217]
    v_pk_fma_f32 v[114:115], v[114:115], v[226:227], v[218:219]
    v_cvt_pk_bf16_f32 v108, v108, v109
    v_cvt_pk_bf16_f32 v109, v110, v111
    v_cvt_pk_bf16_f32 v110, v112, v113
    v_cvt_pk_bf16_f32 v111, v114, v115
    v_pk_fma_f32 v[116:117], v[116:117], v[236:237], v[228:229]
    v_pk_fma_f32 v[118:119], v[118:119], v[238:239], v[230:231]
    v_pk_fma_f32 v[120:121], v[120:121], v[240:241], v[232:233]
    v_pk_fma_f32 v[122:123], v[122:123], v[242:243], v[234:235]
    v_cvt_pk_bf16_f32 v116, v116, v117
    v_cvt_pk_bf16_f32 v117, v118, v119
    v_cvt_pk_bf16_f32 v118, v120, v121
    v_cvt_pk_bf16_f32 v119, v122, v123
    s_waitcnt vmcnt(0)
    s_barrier
    buffer_store_dword v250, v249, s[20:23], s43 offen offset:0 sc1
    buffer_store_dwordx4 v[84:87], v2, s[20:23], s42 offen offset:0 sc1
    buffer_store_dwordx4 v[92:95], v2, s[20:23], s42 offen offset:2048 sc1
    s_add_u32 s42, s42, 4096
    buffer_store_dwordx4 v[100:103], v2, s[20:23], s42 offen offset:0 sc1
    buffer_store_dwordx4 v[108:111], v2, s[20:23], s42 offen offset:2048 sc1
    s_add_u32 s42, s42, 4096
    buffer_store_dwordx4 v[116:119], v2, s[20:23], s42 offen offset:0 sc1
    s_add_u32 s42, s42, 32768
    s_min_u32 s41, s2, 59
    s_mul_i32 s38, s41, 43
    s_lshr_b32 s38, s38, 7
    s_mul_i32 s39, s38, 3
    s_sub_u32 s41, s41, s39
    s_add_u32 s38, s38, 10
    v_and_b32 v12, 15, v0
    v_lshlrev_b32 v12, 2, v12
    v_lshrrev_b32 v18, 4, v17
    v_lshlrev_b32 v1, 4, v17
    s_add_u32 s3, s2, 32
    s_load_dwordx2 s[48:49], s[0:1], 32
    s_load_dwordx2 s[52:53], s[0:1], 40
    s_mov_b32 s50, 1966080
    s_mov_b32 s51, 0x20000
    s_mov_b32 s54, 1966080
    s_mov_b32 s55, 0x20000
    v_bfe_u32 v24, v17, 2, 2
    v_and_b32 v25, 3, v17
    v_add_u32 v26, 0, v18
    v_mul_u32_u24 v27, 11, v26
    v_lshrrev_b32 v27, 6, v27
    v_lshl_add_u32 v28, v27, 2, v24
    v_mul_u32_u24 v28, 3072, v28
    v_mul_u32_u24 v27, 6, v27
    v_sub_u32 v26, v26, v27
    v_lshl_add_u32 v28, v26, 6, v28
    v_lshl_add_u32 v32, v25, 4, v28
    v_add_u32 v26, 4, v18
    v_mul_u32_u24 v27, 11, v26
    v_lshrrev_b32 v27, 6, v27
    v_lshl_add_u32 v28, v27, 2, v24
    v_mul_u32_u24 v28, 3072, v28
    v_mul_u32_u24 v27, 6, v27
    v_sub_u32 v26, v26, v27
    v_lshl_add_u32 v28, v26, 6, v28
    v_lshl_add_u32 v33, v25, 4, v28
    v_add_u32 v26, 8, v18
    v_mul_u32_u24 v27, 11, v26
    v_lshrrev_b32 v27, 6, v27
    v_lshl_add_u32 v28, v27, 2, v24
    v_mul_u32_u24 v28, 3072, v28
    v_mul_u32_u24 v27, 6, v27
    v_sub_u32 v26, v26, v27
    v_lshl_add_u32 v28, v26, 6, v28
    v_lshl_add_u32 v34, v25, 4, v28
    v_mul_u32_u24 v28, 6144, v18
    v_lshl_add_u32 v28, v24, 6, v28
    s_mul_i32 s32, s29, 12
    v_add3_u32 v26, s32, v25, 0
    v_mov_b32 v29, 0
    v_lshrrev_b32 v27, 3, v26
    v_and_b32 v26, 7, v26
    v_lshl_add_u32 v27, v27, 8, v28
    v_lshl_add_u32 v27, v26, 3, v27
    v_add_u32 v35, v27, v29
    v_and_b32 v26, 1, v25
    v_add3_u32 v26, s32, v26, 4
    v_lshrrev_b32 v29, 1, v25
    v_mul_u32_u24 v29, 3072, v29
    v_lshrrev_b32 v27, 3, v26
    v_and_b32 v26, 7, v26
    v_lshl_add_u32 v27, v27, 8, v28
    v_lshl_add_u32 v27, v26, 3, v27
    v_add_u32 v36, v27, v29
    v_add3_u32 v26, s32, v25, 6
    v_mov_b32 v29, 0
    v_lshrrev_b32 v27, 3, v26
    v_and_b32 v26, 7, v26
    v_lshl_add_u32 v27, v27, 8, v28
    v_lshl_add_u32 v27, v26, 3, v27
    v_add_u32 v37, v27, v29
    v_and_b32 v26, 1, v25
    v_add3_u32 v26, s32, v26, 10
    v_lshrrev_b32 v29, 1, v25
    v_mul_u32_u24 v29, 3072, v29
    v_lshrrev_b32 v27, 3, v26
    v_and_b32 v26, 7, v26
    v_lshl_add_u32 v27, v27, 8, v28
    v_lshl_add_u32 v27, v26, 3, v27
    v_add_u32 v38, v27, v29
    s_lshr_b32 s34, s3, 3
    s_and_b32 s35, s3, 7
    s_lshl2_add_u32 s32, s34, s29
    s_mul_i32 s32, s32, 24576
    s_mul_i32 s33, s35, 384
    s_add_u32 s32, s32, s33
    s_mul_i32 s33, s29, 6144
    s_lshl2_add_u32 s35, s35, s29
    s_mul_i32 s35, s35, 40
    s_add_u32 s34, s34, s35
    s_mul_i32 s34, s34, 3072
    s_add_u32 s34, s34, 28213248
    s_cmp_lt_u32 s3, 160
    s_cselect_b32 s34, s34, 0x40000000
    s_add_u32 s35, s34, 61440
    s_waitcnt lgkmcnt(0)
    s_lshl_b32 s39, s38, 8
    v_lshrrev_b32 v19, 4, v0
    v_lshl_add_u32 v19, s41, 4, v19
    v_mul_u32_u24 v20, 28, v19
    v_mul_u32_u24 v21, 107520, v19
    v_lshl_add_u32 v21, v12, 2, v21
    s_mov_b32 s40, s39
    buffer_load_dwordx4 v[120:123], v20, s[12:15], 0 offen offset:0
    buffer_load_dwordx3 v[124:126], v20, s[12:15], 0 offen offset:16
    buffer_load_dwordx4 v[132:135], v21, s[16:19], s40 offen
    s_add_u32 s40, s40, 7680
    buffer_load_dwordx4 v[136:139], v21, s[16:19], s40 offen
    s_add_u32 s40, s40, 7680
    buffer_load_dwordx4 v[140:143], v21, s[16:19], s40 offen
    s_add_u32 s40, s40, 7680
    buffer_load_dwordx4 v[144:147], v21, s[16:19], s40 offen
    s_add_u32 s40, s40, 7680
    buffer_load_dwordx4 v[148:151], v21, s[16:19], s40 offen
    s_add_u32 s40, s40, 7680
    buffer_load_dwordx4 v[152:155], v21, s[16:19], s40 offen
    s_add_u32 s40, s40, 7680
    s_waitcnt vmcnt(8)
    s_barrier
    buffer_store_dword v250, v249, s[20:23], s43 offen offset:512 sc1
    buffer_load_dwordx4 v[156:159], v21, s[16:19], s40 offen
    s_add_u32 s40, s40, 7680
    buffer_load_dwordx4 v[160:163], v21, s[16:19], s40 offen
    s_add_u32 s40, s40, 7680
    buffer_load_dwordx4 v[164:167], v21, s[16:19], s40 offen
    s_add_u32 s40, s40, 7680
    buffer_load_dwordx4 v[168:171], v21, s[16:19], s40 offen
    s_add_u32 s40, s40, 7680
    buffer_load_dwordx4 v[172:175], v21, s[16:19], s40 offen
    s_add_u32 s40, s40, 7680
    buffer_load_dwordx4 v[176:179], v21, s[16:19], s40 offen
    s_add_u32 s40, s40, 7680
    buffer_load_dwordx4 v[180:183], v21, s[16:19], s40 offen
    s_add_u32 s40, s40, 7680
    buffer_load_dwordx4 v[184:187], v21, s[16:19], s40 offen
    s_add_u32 m0, s33, 0
    s_nop 0
    buffer_load_dwordx4 v32, s[48:51], s32 offen lds
    s_add_u32 m0, s33, 1024
    s_nop 0
    buffer_load_dwordx4 v33, s[48:51], s32 offen lds
    s_add_u32 m0, s33, 2048
    s_nop 0
    buffer_load_dwordx4 v34, s[48:51], s32 offen lds
    s_add_u32 m0, s33, 3072
    s_nop 0
    buffer_load_dwordx4 v32, s[52:55], s32 offen lds
    s_add_u32 m0, s33, 4096
    s_nop 0
    buffer_load_dwordx4 v33, s[52:55], s32 offen lds
    s_add_u32 m0, s33, 5120
    s_nop 0
    buffer_load_dwordx4 v34, s[52:55], s32 offen lds
    s_add_u32 s32, s32, 786432
    s_add_u32 s33, s33, 24576
    s_add_u32 m0, s33, 0
    s_nop 0
    buffer_load_dwordx4 v32, s[48:51], s32 offen lds
    s_add_u32 m0, s33, 1024
    s_nop 0
    buffer_load_dwordx4 v33, s[48:51], s32 offen lds
    s_add_u32 m0, s33, 2048
    s_nop 0
    buffer_load_dwordx4 v34, s[48:51], s32 offen lds
    s_add_u32 m0, s33, 3072
    s_nop 0
    buffer_load_dwordx4 v32, s[52:55], s32 offen lds
    s_add_u32 m0, s33, 4096
    s_nop 0
    buffer_load_dwordx4 v33, s[52:55], s32 offen lds
    s_add_u32 m0, s33, 5120
    s_nop 0
    buffer_load_dwordx4 v34, s[52:55], s32 offen lds
    s_getpc_b64 s[56:57]
L_front_pc_24:
    s_lshr_b32 s58, s2, 3
    s_lshl2_add_u32 s58, s58, s29
    s_lshl_b32 s59, s58, 11
    s_add_u32 s59, s59, back_kernel-L_front_pc_24
    v_and_b32 v2, 15, v0
    v_lshl_add_u32 v2, v2, 7, s59
    global_load_dword v3, v2, s[56:57]
    s_and_b32 s59, s2, 7
    s_lshl3_add_u32 s58, s58, s59
    s_lshl_b32 s58, s58, 9
    s_add_u32 s58, s58, L_wavetab-L_front_pc_24
    v_and_b32 v2, 3, v0
    v_lshl_add_u32 v2, v2, 7, s58
    global_load_dword v3, v2, s[56:57]
    s_waitcnt vmcnt(29)
    v_lshlrev_b32 v64, 16, v120
    v_and_b32 v65, s45, v120
    v_lshlrev_b32 v66, 16, v121
    v_and_b32 v67, s45, v121
    v_lshlrev_b32 v68, 16, v122
    v_and_b32 v69, s45, v122
    v_lshlrev_b32 v70, 16, v123
    v_and_b32 v71, s45, v123
    v_lshlrev_b32 v72, 16, v124
    v_and_b32 v73, s45, v124
    v_lshlrev_b32 v74, 16, v125
    v_and_b32 v75, s45, v125
    v_lshlrev_b32 v76, 16, v126
    v_and_b32 v77, s45, v126
    v_mul_f32 v100, 0xbfb8aa3b, v64
    v_mul_f32 v101, 0xbfb8aa3b, v65
    v_mul_f32 v102, 0xbfb8aa3b, v66
    v_mul_f32 v103, 0xbfb8aa3b, v67
    v_mul_f32 v104, 0xbfb8aa3b, v68
    v_mul_f32 v105, 0xbfb8aa3b, v69
    v_mul_f32 v106, 0xbfb8aa3b, v70
    v_mul_f32 v107, 0xbfb8aa3b, v71
    v_mul_f32 v108, 0xbfb8aa3b, v72
    v_mul_f32 v109, 0xbfb8aa3b, v73
    v_mul_f32 v110, 0xbfb8aa3b, v74
    v_mul_f32 v111, 0xbfb8aa3b, v75
    v_mul_f32 v112, 0xbfb8aa3b, v76
    v_mul_f32 v113, 0xbfb8aa3b, v77
    v_exp_f32 v100, v100
    v_exp_f32 v101, v101
    v_exp_f32 v102, v102
    v_exp_f32 v103, v103
    v_exp_f32 v104, v104
    v_exp_f32 v105, v105
    v_exp_f32 v106, v106
    v_exp_f32 v107, v107
    v_exp_f32 v108, v108
    v_exp_f32 v109, v109
    v_exp_f32 v110, v110
    v_exp_f32 v111, v111
    v_exp_f32 v112, v112
    v_exp_f32 v113, v113
    v_pk_add_f32 v[100:101], v[100:101], 1.0 op_sel_hi:[1,0]
    v_pk_add_f32 v[102:103], v[102:103], 1.0 op_sel_hi:[1,0]
    v_pk_add_f32 v[104:105], v[104:105], 1.0 op_sel_hi:[1,0]
    v_pk_add_f32 v[106:107], v[106:107], 1.0 op_sel_hi:[1,0]
    v_pk_add_f32 v[108:109], v[108:109], 1.0 op_sel_hi:[1,0]
    v_pk_add_f32 v[110:111], v[110:111], 1.0 op_sel_hi:[1,0]
    v_pk_add_f32 v[112:113], v[112:113], 1.0 op_sel_hi:[1,0]
    v_rcp_f32 v100, v100
    v_rcp_f32 v101, v101
    v_rcp_f32 v102, v102
    v_rcp_f32 v103, v103
    v_rcp_f32 v104, v104
    v_rcp_f32 v105, v105
    v_rcp_f32 v106, v106
    v_rcp_f32 v107, v107
    v_rcp_f32 v108, v108
    v_rcp_f32 v109, v109
    v_rcp_f32 v110, v110
    v_rcp_f32 v111, v111
    v_rcp_f32 v112, v112
    v_rcp_f32 v113, v113
    v_pk_mul_f32 v[100:101], v[100:101], v[64:65]
    v_pk_mul_f32 v[102:103], v[102:103], v[66:67]
    v_pk_mul_f32 v[104:105], v[104:105], v[68:69]
    v_pk_mul_f32 v[106:107], v[106:107], v[70:71]
    v_pk_mul_f32 v[108:109], v[108:109], v[72:73]
    v_pk_mul_f32 v[110:111], v[110:111], v[74:75]
    v_pk_mul_f32 v[112:113], v[112:113], v[76:77]
    v_cvt_pk_bf16_f32 v120, v100, v101
    v_cvt_pk_bf16_f32 v121, v102, v103
    v_cvt_pk_bf16_f32 v122, v104, v105
    v_cvt_pk_bf16_f32 v123, v106, v107
    v_cvt_pk_bf16_f32 v124, v108, v109
    v_cvt_pk_bf16_f32 v125, v110, v111
    v_cvt_pk_bf16_f32 v126, v112, v113
    v_lshlrev_b32 v64, 16, v120
    v_and_b32 v65, s45, v120
    v_lshlrev_b32 v66, 16, v121
    v_and_b32 v67, s45, v121
    v_lshlrev_b32 v68, 16, v122
    v_and_b32 v69, s45, v122
    v_lshlrev_b32 v70, 16, v123
    v_and_b32 v71, s45, v123
    v_lshlrev_b32 v72, 16, v124
    v_and_b32 v73, s45, v124
    v_lshlrev_b32 v74, 16, v125
    v_and_b32 v75, s45, v125
    v_lshlrev_b32 v76, 16, v126
    v_and_b32 v77, s45, v126
    v_lshrrev_b32 v19, 4, v0
    v_lshlrev_b32 v19, 9, v19
    v_lshl_add_u32 v19, v12, 3, v19
    v_add_u32 v19, 155648, v19
    v_and_b32 v20, 127, v0
    v_lshlrev_b32 v20, 2, v20
    v_add_u32 v21, 155648, v20
    s_waitcnt vmcnt(28)
    v_lshlrev_b32 v92, 16, v132
    v_and_b32 v93, s45, v132
    v_lshlrev_b32 v94, 16, v133
    v_and_b32 v95, s45, v133
    v_lshlrev_b32 v96, 16, v134
    v_and_b32 v97, s45, v134
    v_lshlrev_b32 v98, 16, v135
    v_and_b32 v99, s45, v135
    v_pk_mul_f32 v[84:85], v[92:93], v[64:65] op_sel:[0,0] op_sel_hi:[1,0]
    v_pk_mul_f32 v[86:87], v[94:95], v[64:65] op_sel:[0,0] op_sel_hi:[1,0]
    v_pk_mul_f32 v[88:89], v[96:97], v[64:65] op_sel:[0,0] op_sel_hi:[1,0]
    v_pk_mul_f32 v[90:91], v[98:99], v[64:65] op_sel:[0,0] op_sel_hi:[1,0]
    s_waitcnt vmcnt(27)
    v_lshlrev_b32 v92, 16, v136
    v_and_b32 v93, s45, v136
    v_lshlrev_b32 v94, 16, v137
    v_and_b32 v95, s45, v137
    v_lshlrev_b32 v96, 16, v138
    v_and_b32 v97, s45, v138
    v_lshlrev_b32 v98, 16, v139
    v_and_b32 v99, s45, v139
    v_pk_fma_f32 v[84:85], v[92:93], v[64:65], v[84:85] op_sel:[0,1,0] op_sel_hi:[1,1,1]
    v_pk_fma_f32 v[86:87], v[94:95], v[64:65], v[86:87] op_sel:[0,1,0] op_sel_hi:[1,1,1]
    v_pk_fma_f32 v[88:89], v[96:97], v[64:65], v[88:89] op_sel:[0,1,0] op_sel_hi:[1,1,1]
    v_pk_fma_f32 v[90:91], v[98:99], v[64:65], v[90:91] op_sel:[0,1,0] op_sel_hi:[1,1,1]
    s_waitcnt vmcnt(26)
    v_lshlrev_b32 v92, 16, v140
    v_and_b32 v93, s45, v140
    v_lshlrev_b32 v94, 16, v141
    v_and_b32 v95, s45, v141
    v_lshlrev_b32 v96, 16, v142
    v_and_b32 v97, s45, v142
    v_lshlrev_b32 v98, 16, v143
    v_and_b32 v99, s45, v143
    v_pk_fma_f32 v[84:85], v[92:93], v[66:67], v[84:85] op_sel:[0,0,0] op_sel_hi:[1,0,1]
    v_pk_fma_f32 v[86:87], v[94:95], v[66:67], v[86:87] op_sel:[0,0,0] op_sel_hi:[1,0,1]
    v_pk_fma_f32 v[88:89], v[96:97], v[66:67], v[88:89] op_sel:[0,0,0] op_sel_hi:[1,0,1]
    v_pk_fma_f32 v[90:91], v[98:99], v[66:67], v[90:91] op_sel:[0,0,0] op_sel_hi:[1,0,1]
    s_waitcnt vmcnt(25)
    v_lshlrev_b32 v92, 16, v144
    v_and_b32 v93, s45, v144
    v_lshlrev_b32 v94, 16, v145
    v_and_b32 v95, s45, v145
    v_lshlrev_b32 v96, 16, v146
    v_and_b32 v97, s45, v146
    v_lshlrev_b32 v98, 16, v147
    v_and_b32 v99, s45, v147
    v_pk_fma_f32 v[84:85], v[92:93], v[66:67], v[84:85] op_sel:[0,1,0] op_sel_hi:[1,1,1]
    v_pk_fma_f32 v[86:87], v[94:95], v[66:67], v[86:87] op_sel:[0,1,0] op_sel_hi:[1,1,1]
    v_pk_fma_f32 v[88:89], v[96:97], v[66:67], v[88:89] op_sel:[0,1,0] op_sel_hi:[1,1,1]
    v_pk_fma_f32 v[90:91], v[98:99], v[66:67], v[90:91] op_sel:[0,1,0] op_sel_hi:[1,1,1]
    s_waitcnt vmcnt(24)
    v_lshlrev_b32 v92, 16, v148
    v_and_b32 v93, s45, v148
    v_lshlrev_b32 v94, 16, v149
    v_and_b32 v95, s45, v149
    v_lshlrev_b32 v96, 16, v150
    v_and_b32 v97, s45, v150
    v_lshlrev_b32 v98, 16, v151
    v_and_b32 v99, s45, v151
    v_pk_fma_f32 v[84:85], v[92:93], v[68:69], v[84:85] op_sel:[0,0,0] op_sel_hi:[1,0,1]
    v_pk_fma_f32 v[86:87], v[94:95], v[68:69], v[86:87] op_sel:[0,0,0] op_sel_hi:[1,0,1]
    v_pk_fma_f32 v[88:89], v[96:97], v[68:69], v[88:89] op_sel:[0,0,0] op_sel_hi:[1,0,1]
    v_pk_fma_f32 v[90:91], v[98:99], v[68:69], v[90:91] op_sel:[0,0,0] op_sel_hi:[1,0,1]
    s_waitcnt vmcnt(23)
    v_lshlrev_b32 v92, 16, v152
    v_and_b32 v93, s45, v152
    v_lshlrev_b32 v94, 16, v153
    v_and_b32 v95, s45, v153
    v_lshlrev_b32 v96, 16, v154
    v_and_b32 v97, s45, v154
    v_lshlrev_b32 v98, 16, v155
    v_and_b32 v99, s45, v155
    v_pk_fma_f32 v[84:85], v[92:93], v[68:69], v[84:85] op_sel:[0,1,0] op_sel_hi:[1,1,1]
    v_pk_fma_f32 v[86:87], v[94:95], v[68:69], v[86:87] op_sel:[0,1,0] op_sel_hi:[1,1,1]
    v_pk_fma_f32 v[88:89], v[96:97], v[68:69], v[88:89] op_sel:[0,1,0] op_sel_hi:[1,1,1]
    v_pk_fma_f32 v[90:91], v[98:99], v[68:69], v[90:91] op_sel:[0,1,0] op_sel_hi:[1,1,1]
    s_waitcnt vmcnt(21)
    v_lshlrev_b32 v92, 16, v156
    v_and_b32 v93, s45, v156
    v_lshlrev_b32 v94, 16, v157
    v_and_b32 v95, s45, v157
    v_lshlrev_b32 v96, 16, v158
    v_and_b32 v97, s45, v158
    v_lshlrev_b32 v98, 16, v159
    v_and_b32 v99, s45, v159
    v_pk_fma_f32 v[84:85], v[92:93], v[70:71], v[84:85] op_sel:[0,0,0] op_sel_hi:[1,0,1]
    v_pk_fma_f32 v[86:87], v[94:95], v[70:71], v[86:87] op_sel:[0,0,0] op_sel_hi:[1,0,1]
    v_pk_fma_f32 v[88:89], v[96:97], v[70:71], v[88:89] op_sel:[0,0,0] op_sel_hi:[1,0,1]
    v_pk_fma_f32 v[90:91], v[98:99], v[70:71], v[90:91] op_sel:[0,0,0] op_sel_hi:[1,0,1]
    s_waitcnt vmcnt(20)
    v_lshlrev_b32 v92, 16, v160
    v_and_b32 v93, s45, v160
    v_lshlrev_b32 v94, 16, v161
    v_and_b32 v95, s45, v161
    v_lshlrev_b32 v96, 16, v162
    v_and_b32 v97, s45, v162
    v_lshlrev_b32 v98, 16, v163
    v_and_b32 v99, s45, v163
    v_pk_fma_f32 v[84:85], v[92:93], v[70:71], v[84:85] op_sel:[0,1,0] op_sel_hi:[1,1,1]
    v_pk_fma_f32 v[86:87], v[94:95], v[70:71], v[86:87] op_sel:[0,1,0] op_sel_hi:[1,1,1]
    v_pk_fma_f32 v[88:89], v[96:97], v[70:71], v[88:89] op_sel:[0,1,0] op_sel_hi:[1,1,1]
    v_pk_fma_f32 v[90:91], v[98:99], v[70:71], v[90:91] op_sel:[0,1,0] op_sel_hi:[1,1,1]
    s_waitcnt vmcnt(19)
    v_lshlrev_b32 v92, 16, v164
    v_and_b32 v93, s45, v164
    v_lshlrev_b32 v94, 16, v165
    v_and_b32 v95, s45, v165
    v_lshlrev_b32 v96, 16, v166
    v_and_b32 v97, s45, v166
    v_lshlrev_b32 v98, 16, v167
    v_and_b32 v99, s45, v167
    v_pk_fma_f32 v[84:85], v[92:93], v[72:73], v[84:85] op_sel:[0,0,0] op_sel_hi:[1,0,1]
    v_pk_fma_f32 v[86:87], v[94:95], v[72:73], v[86:87] op_sel:[0,0,0] op_sel_hi:[1,0,1]
    v_pk_fma_f32 v[88:89], v[96:97], v[72:73], v[88:89] op_sel:[0,0,0] op_sel_hi:[1,0,1]
    v_pk_fma_f32 v[90:91], v[98:99], v[72:73], v[90:91] op_sel:[0,0,0] op_sel_hi:[1,0,1]
    s_waitcnt vmcnt(18)
    v_lshlrev_b32 v92, 16, v168
    v_and_b32 v93, s45, v168
    v_lshlrev_b32 v94, 16, v169
    v_and_b32 v95, s45, v169
    v_lshlrev_b32 v96, 16, v170
    v_and_b32 v97, s45, v170
    v_lshlrev_b32 v98, 16, v171
    v_and_b32 v99, s45, v171
    v_pk_fma_f32 v[84:85], v[92:93], v[72:73], v[84:85] op_sel:[0,1,0] op_sel_hi:[1,1,1]
    v_pk_fma_f32 v[86:87], v[94:95], v[72:73], v[86:87] op_sel:[0,1,0] op_sel_hi:[1,1,1]
    v_pk_fma_f32 v[88:89], v[96:97], v[72:73], v[88:89] op_sel:[0,1,0] op_sel_hi:[1,1,1]
    v_pk_fma_f32 v[90:91], v[98:99], v[72:73], v[90:91] op_sel:[0,1,0] op_sel_hi:[1,1,1]
    s_waitcnt vmcnt(17)
    v_lshlrev_b32 v92, 16, v172
    v_and_b32 v93, s45, v172
    v_lshlrev_b32 v94, 16, v173
    v_and_b32 v95, s45, v173
    v_lshlrev_b32 v96, 16, v174
    v_and_b32 v97, s45, v174
    v_lshlrev_b32 v98, 16, v175
    v_and_b32 v99, s45, v175
    v_pk_fma_f32 v[84:85], v[92:93], v[74:75], v[84:85] op_sel:[0,0,0] op_sel_hi:[1,0,1]
    v_pk_fma_f32 v[86:87], v[94:95], v[74:75], v[86:87] op_sel:[0,0,0] op_sel_hi:[1,0,1]
    v_pk_fma_f32 v[88:89], v[96:97], v[74:75], v[88:89] op_sel:[0,0,0] op_sel_hi:[1,0,1]
    v_pk_fma_f32 v[90:91], v[98:99], v[74:75], v[90:91] op_sel:[0,0,0] op_sel_hi:[1,0,1]
    s_waitcnt vmcnt(16)
    v_lshlrev_b32 v92, 16, v176
    v_and_b32 v93, s45, v176
    v_lshlrev_b32 v94, 16, v177
    v_and_b32 v95, s45, v177
    v_lshlrev_b32 v96, 16, v178
    v_and_b32 v97, s45, v178
    v_lshlrev_b32 v98, 16, v179
    v_and_b32 v99, s45, v179
    v_pk_fma_f32 v[84:85], v[92:93], v[74:75], v[84:85] op_sel:[0,1,0] op_sel_hi:[1,1,1]
    v_pk_fma_f32 v[86:87], v[94:95], v[74:75], v[86:87] op_sel:[0,1,0] op_sel_hi:[1,1,1]
    v_pk_fma_f32 v[88:89], v[96:97], v[74:75], v[88:89] op_sel:[0,1,0] op_sel_hi:[1,1,1]
    v_pk_fma_f32 v[90:91], v[98:99], v[74:75], v[90:91] op_sel:[0,1,0] op_sel_hi:[1,1,1]
    s_waitcnt vmcnt(15)
    v_lshlrev_b32 v92, 16, v180
    v_and_b32 v93, s45, v180
    v_lshlrev_b32 v94, 16, v181
    v_and_b32 v95, s45, v181
    v_lshlrev_b32 v96, 16, v182
    v_and_b32 v97, s45, v182
    v_lshlrev_b32 v98, 16, v183
    v_and_b32 v99, s45, v183
    v_pk_fma_f32 v[84:85], v[92:93], v[76:77], v[84:85] op_sel:[0,0,0] op_sel_hi:[1,0,1]
    v_pk_fma_f32 v[86:87], v[94:95], v[76:77], v[86:87] op_sel:[0,0,0] op_sel_hi:[1,0,1]
    v_pk_fma_f32 v[88:89], v[96:97], v[76:77], v[88:89] op_sel:[0,0,0] op_sel_hi:[1,0,1]
    v_pk_fma_f32 v[90:91], v[98:99], v[76:77], v[90:91] op_sel:[0,0,0] op_sel_hi:[1,0,1]
    s_waitcnt vmcnt(14)
    v_lshlrev_b32 v92, 16, v184
    v_and_b32 v93, s45, v184
    v_lshlrev_b32 v94, 16, v185
    v_and_b32 v95, s45, v185
    v_lshlrev_b32 v96, 16, v186
    v_and_b32 v97, s45, v186
    v_lshlrev_b32 v98, 16, v187
    v_and_b32 v99, s45, v187
    v_pk_fma_f32 v[84:85], v[92:93], v[76:77], v[84:85] op_sel:[0,1,0] op_sel_hi:[1,1,1]
    v_pk_fma_f32 v[86:87], v[94:95], v[76:77], v[86:87] op_sel:[0,1,0] op_sel_hi:[1,1,1]
    v_pk_fma_f32 v[88:89], v[96:97], v[76:77], v[88:89] op_sel:[0,1,0] op_sel_hi:[1,1,1]
    v_pk_fma_f32 v[90:91], v[98:99], v[76:77], v[90:91] op_sel:[0,1,0] op_sel_hi:[1,1,1]
    ds_write_b128 v19, v[84:87]
    ds_write_b128 v19, v[88:91] offset:16
    s_waitcnt lgkmcnt(0)
    s_barrier
    ds_read2st64_b32 v[100:101], v21 offset0:0 offset1:2
    ds_read2st64_b32 v[102:103], v21 offset0:4 offset1:6
    ds_read2st64_b32 v[104:105], v21 offset0:8 offset1:10
    ds_read2st64_b32 v[106:107], v21 offset0:12 offset1:14
    ds_read2st64_b32 v[108:109], v21 offset0:16 offset1:18
    ds_read2st64_b32 v[110:111], v21 offset0:20 offset1:22
    ds_read2st64_b32 v[112:113], v21 offset0:24 offset1:26
    ds_read2st64_b32 v[114:115], v21 offset0:28 offset1:30
    s_mul_i32 s40, s41, 10240
    s_lshl1_add_u32 s40, s39, s40
    s_sub_u32 s40, s40, 5120
    s_cmp_lt_u32 s29, 2
    s_cselect_b32 s40, s40, 0x40000000
    s_waitcnt lgkmcnt(0)
    v_pk_add_f32 v[100:101], v[100:101], v[102:103]
    v_pk_add_f32 v[100:101], v[100:101], v[104:105]
    v_pk_add_f32 v[100:101], v[100:101], v[106:107]
    v_pk_add_f32 v[100:101], v[100:101], v[108:109]
    v_pk_add_f32 v[100:101], v[100:101], v[110:111]
    v_pk_add_f32 v[100:101], v[100:101], v[112:113]
    v_pk_add_f32 v[100:101], v[100:101], v[114:115]
    v_add_f32 v100, v100, v101
    buffer_store_dword v100, v20, s[20:23], s40 offen sc1
    s_waitcnt vmcnt(3)
    s_barrier
    ds_read_b64_tr_b16 v[40:41], v35 offset:0
    ds_read_b64_tr_b16 v[42:43], v35 offset:1536
    ds_read_b64_tr_b16 v[44:45], v35 offset:3072
    ds_read_b64_tr_b16 v[46:47], v35 offset:4608
    ds_read_b64_tr_b16 v[48:49], v36 offset:0
    ds_read_b64_tr_b16 v[50:51], v36 offset:1536
    ds_read_b64_tr_b16 v[52:53], v37 offset:0
    ds_read_b64_tr_b16 v[54:55], v37 offset:1536
    ds_read_b64_tr_b16 v[56:57], v37 offset:3072
    ds_read_b64_tr_b16 v[58:59], v37 offset:4608
    ds_read_b64_tr_b16 v[60:61], v38 offset:0
    ds_read_b64_tr_b16 v[62:63], v38 offset:1536
    v_add_u32 v35, 24576, v35
    v_add_u32 v36, 24576, v36
    v_add_u32 v37, 24576, v37
    v_add_u32 v38, 24576, v38
    ds_read_b64_tr_b16 v[64:65], v35 offset:0
    ds_read_b64_tr_b16 v[66:67], v35 offset:1536
    ds_read_b64_tr_b16 v[68:69], v35 offset:3072
    ds_read_b64_tr_b16 v[70:71], v35 offset:4608
    ds_read_b64_tr_b16 v[72:73], v36 offset:0
    ds_read_b64_tr_b16 v[74:75], v36 offset:1536
    ds_read_b64_tr_b16 v[76:77], v37 offset:0
    ds_read_b64_tr_b16 v[78:79], v37 offset:1536
    ds_read_b64_tr_b16 v[80:81], v37 offset:3072
    ds_read_b64_tr_b16 v[82:83], v37 offset:4608
    ds_read_b64_tr_b16 v[84:85], v38 offset:0
    ds_read_b64_tr_b16 v[86:87], v38 offset:1536
    s_waitcnt lgkmcnt(0)
    buffer_store_dwordx4 v[40:43], v1, s[20:23], s34 offen offset:0 sc1
    buffer_store_dwordx4 v[44:47], v1, s[20:23], s34 offen offset:1024 sc1
    buffer_store_dwordx4 v[48:51], v1, s[20:23], s34 offen offset:2048 sc1
    buffer_store_dwordx4 v[52:55], v1, s[20:23], s35 offen offset:0 sc1
    buffer_store_dwordx4 v[56:59], v1, s[20:23], s35 offen offset:1024 sc1
    buffer_store_dwordx4 v[60:63], v1, s[20:23], s35 offen offset:2048 sc1
    s_add_u32 s34, s34, 24576
    s_add_u32 s35, s35, 24576
    buffer_store_dwordx4 v[64:67], v1, s[20:23], s34 offen offset:0 sc1
    buffer_store_dwordx4 v[68:71], v1, s[20:23], s34 offen offset:1024 sc1
    buffer_store_dwordx4 v[72:75], v1, s[20:23], s34 offen offset:2048 sc1
    buffer_store_dwordx4 v[76:79], v1, s[20:23], s35 offen offset:0 sc1
    buffer_store_dwordx4 v[80:83], v1, s[20:23], s35 offen offset:1024 sc1
    buffer_store_dwordx4 v[84:87], v1, s[20:23], s35 offen offset:2048 sc1
    v_mov_b32 v4, 0
    v_lshlrev_b32 v2, 2, v0
    s_lshl_b32 s13, s2, 10
    s_add_u32 s13, s13, 262144
    buffer_store_dword v4, v2, s[20:23], s13 offen
L_front_end_1:
    s_endpgm
L_front_poll_12:
    s_mov_b32 s49, 0
L_front_poll_12b:
    s_add_u32 s49, s49, 1
    buffer_load_dword v14, v13, s[24:27], 0 offen sc1
    s_waitcnt vmcnt(0)
    v_cmp_ne_u32 vcc, 50, v14
    s_cbranch_vccz L_front_ok_13
    s_cmp_lt_u32 s49, 0x10000
    s_cbranch_scc1 L_front_poll_12b
    s_branch L_front_ok_13
L_front_poll_14:
    s_mov_b32 s49, 0
L_front_poll_14b:
    s_add_u32 s49, s49, 1
    buffer_load_dword v14, v15, s[20:23], s37 offen sc1
    s_waitcnt vmcnt(0)
    v_cmp_ne_u32 vcc, 1, v14
    s_cbranch_vccz L_front_ok_15
    s_cmp_lt_u32 s49, 0x10000
    s_cbranch_scc1 L_front_poll_14b
    s_branch L_front_ok_15
L_front_poll_16:
    s_mov_b32 s49, 0
L_front_poll_16b:
    s_add_u32 s49, s49, 1
    buffer_load_dword v14, v15, s[20:23], s37 offen offset:512 sc1
    s_waitcnt vmcnt(0)
    v_cmp_ne_u32 vcc, 1, v14
    s_cbranch_vccz L_front_ok_17
    s_cmp_lt_u32 s49, 0x10000
    s_cbranch_scc1 L_front_poll_16b
    s_branch L_front_ok_17
L_front_poll_18:
    s_mov_b32 s49, 0
L_front_poll_18b:
    s_add_u32 s49, s49, 1
    buffer_load_dword v14, v15, s[20:23], s37 offen offset:512 sc1
    s_waitcnt vmcnt(0)
    v_cmp_ne_u32 vcc, 1, v14
    s_cbranch_vccz L_front_ok_19
    s_cmp_lt_u32 s49, 0x10000
    s_cbranch_scc1 L_front_poll_18b
    s_branch L_front_ok_19
L_front_poll_20:
    s_mov_b32 s49, 0
L_front_poll_20b:
    s_add_u32 s49, s49, 1
    buffer_load_dword v14, v13, s[24:27], 0 offen sc1
    s_waitcnt vmcnt(0)
    v_cmp_ne_u32 vcc, 50, v14
    s_cbranch_vccz L_front_ok_21
    s_cmp_lt_u32 s49, 0x10000
    s_cbranch_scc1 L_front_poll_20b
    s_branch L_front_ok_21
L_front_poll_22:
    s_mov_b32 s49, 0
L_front_poll_22b:
    s_add_u32 s49, s49, 1
    buffer_load_dwordx4 v[124:127], v15, s[20:23], s50 offen offset:0 sc1
    buffer_load_dwordx4 v[128:131], v15, s[20:23], s50 offen offset:2560 sc1
    buffer_load_dwordx4 v[132:135], v15, s[20:23], s51 offen offset:0 sc1
    buffer_load_dwordx4 v[136:139], v15, s[20:23], s51 offen offset:2560 sc1
    buffer_load_dwordx4 v[140:143], v15, s[20:23], s52 offen offset:0 sc1
    buffer_load_dwordx4 v[144:147], v15, s[20:23], s52 offen offset:2560 sc1
    buffer_load_dwordx4 v[148:151], v15, s[20:23], s53 offen offset:0 sc1
    buffer_load_dwordx4 v[152:155], v15, s[20:23], s53 offen offset:2560 sc1
    buffer_load_dwordx4 v[156:159], v15, s[20:23], s54 offen offset:0 sc1
    buffer_load_dwordx4 v[160:163], v15, s[20:23], s54 offen offset:2560 sc1
    s_waitcnt vmcnt(0)
    v_max3_u32 v14, v124, v125, v126
    v_max3_u32 v14, v14, v127, v128
    v_max3_u32 v14, v14, v129, v130
    v_max3_u32 v14, v14, v131, v132
    v_max3_u32 v14, v14, v133, v134
    v_max3_u32 v14, v14, v135, v136
    v_max3_u32 v14, v14, v137, v138
    v_max3_u32 v14, v14, v139, v140
    v_max3_u32 v14, v14, v141, v142
    v_max3_u32 v14, v14, v143, v144
    v_max3_u32 v14, v14, v145, v146
    v_max3_u32 v14, v14, v147, v148
    v_max3_u32 v14, v14, v149, v150
    v_max3_u32 v14, v14, v151, v152
    v_max3_u32 v14, v14, v153, v154
    v_max3_u32 v14, v14, v155, v156
    v_max3_u32 v14, v14, v157, v158
    v_max3_u32 v14, v14, v159, v160
    v_max3_u32 v14, v14, v161, v162
    v_max_u32 v14, v14, v163
    v_cmp_eq_u32 vcc, -1, v14
    s_cbranch_vccz L_front_ok_23
    s_cmp_lt_u32 s49, 0x10000
    s_cbranch_scc1 L_front_poll_22b
    s_branch L_front_ok_23
.text
.globl back_kernel
.p2align 8
.type back_kernel,@function
back_kernel:
    s_cmp_ge_u32 s2, 256
    s_cbranch_scc1 L_back_end_1
    s_load_dwordx2 s[6:7], s[0:1], 88
    s_load_dwordx2 s[4:5], s[0:1], 0
    s_load_dwordx2 s[8:9], s[0:1], 72
    s_load_dwordx2 s[24:25], s[0:1], 16
    s_load_dwordx4 s[32:35], s[0:1], 32
    s_load_dwordx2 s[42:43], s[0:1], 48
    s_branch L_back_page
.p2align 12
L_back_page:
    v_lshrrev_b32 v16, 6, v0
    v_and_b32 v17, 63, v0
    v_readfirstlane_b32 s29, v16
    s_and_b32 s12, s2, 7
    s_bfe_u32 s13, s2, 0x20003
    s_lshl2_add_u32 s12, s12, s13
    s_lshr_b32 s13, s2, 5
    s_and_b32 s14, s29, 1
    s_lshl1_add_u32 s13, s13, s14
    s_lshl4_add_u32 s13, s12, s13
    s_mul_i32 s38, s13, 5120
    s_add_u32 s38, s38, 3145728
    s_and_b32 s14, s29, 2
    s_mul_i32 s14, s14, 1280
    s_add_u32 s39, s38, s14
    s_sub_u32 s38, s38, s14
    s_add_u32 s38, s38, 2560
    s_mul_i32 s40, s12, 172032
    s_add_u32 s40, s40, 5767168
    s_lshr_b32 s14, s29, 1
    s_mul_i32 s41, s14, 86016
    s_add_u32 s41, s41, s40
    v_and_b32 v18, 31, v17
    v_lshrrev_b32 v19, 5, v17
    v_cmp_lt_u32 vcc, 31, v17
    v_lshlrev_b32 v27, 3, v18
    v_add_u32 v20, 1024, v27
    v_mov_b32 v21, 2560
    v_cndmask_b32 v244, v20, v21, vcc
    v_cmp_lt_u32 vcc, 15, v18
    v_lshlrev_b32 v20, 4, v18
    v_lshl_add_u32 v22, v19, 9, v20
    v_add_u32 v22, 1280, v22
    v_lshl_add_u32 v23, v19, 7, v20
    v_add_u32 v23, 2048, v23
    v_cndmask_b32 v22, v22, v23, vcc
    v_mov_b32 v23, 256
    v_cndmask_b32_e64 v23, v23, 64, vcc
    v_cmp_lt_u32 vcc, 19, v18
    v_add_u32 v23, v22, v23
    v_mov_b32 v20, 0x40000000
    v_cndmask_b32 v22, v22, v21, vcc
    v_cndmask_b32 v23, v23, v21, vcc
    v_cmp_lt_u32 vcc, 20, v18
    s_nop 1
    v_cndmask_b32 v245, v22, v20, vcc
    v_cndmask_b32 v246, v23, v20, vcc
    v_mov_b32 v242, 0xdddd
    v_lshl_add_u32 v26, v19, 30, v27
    v_lshlrev_b32 v1, 4, v17
    v_cmp_gt_u32 s[10:11], 32, v17
    s_mov_b32 s18, 0x10000
    s_mov_b32 s19, 0x20000
    s_mov_b32 s22, 0x2000000
    s_mov_b32 s23, 0x20000
    s_mov_b32 s96, 0xffff0000
    s_getpc_b64 s[30:31]
L_back_pc_2:
    s_lshl2_add_u32 s3, s2, s29
    s_lshl_b32 s3, s3, 7
    s_add_u32 s3, s3, L_wavetab-L_back_pc_2
    s_add_u32 s36, s30, s3
    s_addc_u32 s37, s31, 0
    v_mov_b32 v92, 0
    v_mov_b32 v93, 0
    v_mov_b32 v94, 0
    v_mov_b32 v95, 0
    v_mov_b32 v96, 0
    v_mov_b32 v97, 0
    v_mov_b32 v98, 0
    v_mov_b32 v99, 0
    v_mov_b32 v100, 0
    v_mov_b32 v101, 0
    v_mov_b32 v102, 0
    v_mov_b32 v103, 0
    v_mov_b32 v104, 0
    v_mov_b32 v105, 0
    v_mov_b32 v106, 0
    v_mov_b32 v107, 0
    s_waitcnt lgkmcnt(0)
    s_add_u32 s16, s6, 0x2000000
    s_cselect_b32 s16, 0x2000000, 0
    s_add_u32 s6, s6, s16
    s_addc_u32 s7, s7, 0
    s_mov_b32 s20, s6
    s_mov_b32 s21, s7
    s_add_u32 s16, s6, s41
    s_mov_b32 s17, s7
    buffer_load_dwordx4 v[236:239], v1, s[20:23], s40 offen
    buffer_load_dwordx2 v[240:241], v27, s[20:23], s40 offen offset:1024
    buffer_load_dwordx4 v[156:159], v1, s[20:23], s38 offen offset:0
    buffer_load_dwordx2 v[160:161], v26, s[20:23], s38 offen offset:1024
    buffer_load_dwordx4 v[162:165], v1, s[20:23], s38 offen offset:1280
    buffer_load_dwordx2 v[166:167], v26, s[20:23], s38 offen offset:2304
    buffer_load_dwordx4 v[168:171], v1, s[20:23], s39 offen offset:0
    buffer_load_dwordx2 v[172:173], v26, s[20:23], s39 offen offset:1024
    buffer_load_dwordx4 v[174:177], v1, s[20:23], s39 offen offset:1280
    buffer_load_dwordx2 v[178:179], v26, s[20:23], s39 offen offset:2304
    buffer_load_dwordx4 v[180:183], v1, s[16:19], 0 offen
    buffer_load_dwordx2 v[192:193], v244, s[16:19], 0 offen
    buffer_load_dwordx4 v[184:187], v245, s[16:19], 0 offen
    buffer_load_dwordx4 v[188:191], v246, s[16:19], 0 offen
    s_add_u32 s16, s16, 2688
    s_load_dwordx16 s[48:63], s[36:37], 0
    s_load_dwordx4 s[44:47], s[36:37], 64
    s_load_dwordx4 s[92:95], s[36:37], 80
    v_lshlrev_b32 v243, 4, v0
    v_and_b32 v15, 15, v17
    v_lshlrev_b32 v15, 2, v15
    v_mul_u32_u24 v25, 48, v17
    v_lshlrev_b32 v247, 4, v27
    v_min_u32 v14, 1, v17
    v_lshlrev_b32 v14, 30, v14
    v_mov_b32 v24, 1
    v_mov_b32 v108, 0
    v_mov_b32 v109, 0
    v_mov_b32 v110, 0
    v_mov_b32 v111, 0
    v_mov_b32 v112, 0
    v_mov_b32 v113, 0
    v_mov_b32 v114, 0
    v_mov_b32 v115, 0
    v_mov_b32 v116, 0
    v_mov_b32 v117, 0
    v_mov_b32 v118, 0
    v_mov_b32 v119, 0
    v_mov_b32 v120, 0
    v_mov_b32 v121, 0
    v_mov_b32 v122, 0
    v_mov_b32 v123, 0
    v_mov_b32 v124, 0
    v_mov_b32 v125, 0
    v_mov_b32 v126, 0
    v_mov_b32 v127, 0
    v_mov_b32 v128, 0
    v_mov_b32 v129, 0
    v_mov_b32 v130, 0
    v_mov_b32 v131, 0
    v_mov_b32 v132, 0
    v_mov_b32 v133, 0
    v_mov_b32 v134, 0
    v_mov_b32 v135, 0
    v_mov_b32 v136, 0
    v_mov_b32 v137, 0
    v_mov_b32 v138, 0
    v_mov_b32 v139, 0
    v_mov_b32 v140, 0
    v_mov_b32 v141, 0
    v_mov_b32 v142, 0
    v_mov_b32 v143, 0
    v_mov_b32 v144, 0
    v_mov_b32 v145, 0
    v_mov_b32 v146, 0
    v_mov_b32 v147, 0
    v_mov_b32 v148, 0
    v_mov_b32 v149, 0
    v_mov_b32 v150, 0
    v_mov_b32 v151, 0
    v_mov_b32 v152, 0
    v_mov_b32 v153, 0
    v_mov_b32 v154, 0
    v_mov_b32 v155, 0
    v_add_u32 v26, L_lanetab-L_back_pc_2, v25
    s_mov_b32 s0, 1
    s_cmp_eq_u32 s29, 0
    s_cbranch_scc1 L_back_stub0_0
    s_cmp_eq_u32 s29, 1
    s_cbranch_scc1 L_back_stub0_1
    s_cmp_eq_u32 s29, 2
    s_cbranch_scc1 L_back_stub0_2
    s_branch L_back_stub0_3
L_back_wret0:
    s_mov_b32 s0, 0
    s_mov_b32 s3, 0x42540000
    s_waitcnt vmcnt(10)
    v_mfma_f32_32x32x16_bf16 v[28:43], v[236:239], v[156:159], 0
    buffer_load_dwordx4 v[194:197], v1, s[16:19], 0 offen
    buffer_load_dwordx2 v[206:207], v244, s[16:19], 0 offen
    v_mfma_f32_32x32x8_bf16 v[28:43], v[240:241], v[160:161], v[28:43]
    buffer_load_dwordx4 v[198:201], v245, s[16:19], 0 offen
    buffer_load_dwordx4 v[202:205], v246, s[16:19], 0 offen
    s_add_u32 s16, s16, 2688
    s_waitcnt vmcnt(12)
    v_mfma_f32_32x32x16_bf16 v[44:59], v[236:239], v[162:165], 0
    buffer_load_dwordx4 v[208:211], v1, s[16:19], 0 offen
    buffer_load_dwordx2 v[220:221], v244, s[16:19], 0 offen
    v_mfma_f32_32x32x8_bf16 v[44:59], v[240:241], v[166:167], v[44:59]
    buffer_load_dwordx4 v[212:215], v245, s[16:19], 0 offen
    buffer_load_dwordx4 v[216:219], v246, s[16:19], 0 offen
    s_add_u32 s16, s16, 2688
    s_waitcnt vmcnt(14)
    v_mfma_f32_32x32x16_bf16 v[60:75], v[236:239], v[168:171], 0
    v_max3_f32 v16, v28, v29, v30
    v_max3_f32 v16, v16, v31, v32
    v_max3_f32 v16, v16, v33, v34
    v_max3_f32 v16, v16, v35, v36
    v_max3_f32 v16, v16, v37, v38
    v_mfma_f32_32x32x8_bf16 v[60:75], v[240:241], v[172:173], v[60:75]
    v_max3_f32 v16, v16, v39, v40
    v_max3_f32 v16, v16, v41, v42
    v_max_f32 v16, v16, v43
    v_cvt_pk_bf16_f32 v16, -v16, s3
    v_cndmask_b32 v160, v16, v160, s[10:11]
    s_waitcnt vmcnt(12)
    v_mfma_f32_32x32x16_bf16 v[76:91], v[236:239], v[174:177], 0
    v_max3_f32 v16, v44, v45, v46
    v_max3_f32 v16, v16, v47, v48
    v_max3_f32 v16, v16, v49, v50
    v_max3_f32 v16, v16, v51, v52
    v_max3_f32 v16, v16, v53, v54
    v_mfma_f32_32x32x8_bf16 v[76:91], v[240:241], v[178:179], v[76:91]
    v_max3_f32 v16, v16, v55, v56
    v_max3_f32 v16, v16, v57, v58
    v_max_f32 v16, v16, v59
    v_cvt_pk_bf16_f32 v16, -v16, s3
    v_cndmask_b32 v166, v16, v166, s[10:11]
    s_waitcnt vmcnt(8)
    v_mfma_f32_32x32x16_bf16 v[28:43], v[180:183], v[156:159], 0
    v_max3_f32 v16, v60, v61, v62
    v_max3_f32 v16, v16, v63, v64
    v_max3_f32 v16, v16, v65, v66
    v_max3_f32 v16, v16, v67, v68
    v_max3_f32 v16, v16, v69, v70
    v_mfma_f32_32x32x8_bf16 v[28:43], v[192:193], v[160:161], v[28:43]
    v_max3_f32 v16, v16, v71, v72
    v_max3_f32 v16, v16, v73, v74
    v_max_f32 v16, v16, v75
    v_cvt_pk_bf16_f32 v16, -v16, s3
    v_cndmask_b32 v172, v16, v172, s[10:11]
    v_mfma_f32_32x32x16_bf16 v[44:59], v[180:183], v[162:165], 0
    buffer_load_dwordx4 v[222:225], v1, s[16:19], 0 offen
    buffer_load_dwordx2 v[234:235], v244, s[16:19], 0 offen
    buffer_load_dwordx4 v[226:229], v245, s[16:19], 0 offen
    buffer_load_dwordx4 v[230:233], v246, s[16:19], 0 offen
    s_add_u32 s16, s16, 2688
    v_mfma_f32_32x32x8_bf16 v[44:59], v[192:193], v[166:167], v[44:59]
    v_max3_f32 v16, v76, v77, v78
    v_max3_f32 v16, v16, v79, v80
    v_max3_f32 v16, v16, v81, v82
    v_max3_f32 v16, v16, v83, v84
    v_max3_f32 v16, v16, v85, v86
    v_max3_f32 v16, v16, v87, v88
    v_max3_f32 v16, v16, v89, v90
    v_max_f32 v16, v16, v91
    v_cvt_pk_bf16_f32 v16, -v16, s3
    v_cndmask_b32 v178, v16, v178, s[10:11]
    v_exp_f32 v28, v28
    v_exp_f32 v29, v29
    v_exp_f32 v30, v30
    v_exp_f32 v31, v31
    v_exp_f32 v32, v32
    v_exp_f32 v33, v33
    v_mfma_f32_32x32x8_bf16 v[60:75], v[192:193], v[172:173], 0
    v_exp_f32 v34, v34
    v_exp_f32 v35, v35
    v_exp_f32 v36, v36
    v_exp_f32 v37, v37
    v_smfmac_f32_32x32x32_bf16 v[92:107], v[184:187], v[28:35], v242
    s_mov_b32 s26, 819200
    s_mov_b32 s27, 0x20000
    v_exp_f32 v38, v38
    v_exp_f32 v39, v39
    v_exp_f32 v40, v40
    v_exp_f32 v41, v41
    v_mfma_f32_32x32x16_bf16 v[60:75], v[180:183], v[168:171], v[60:75]
    s_mov_b32 s15, 0x20000
    v_exp_f32 v42, v42
    v_exp_f32 v43, v43
    v_exp_f32 v44, v44
    v_exp_f32 v45, v45
    v_smfmac_f32_32x32x32_bf16 v[92:107], v[188:191], v[36:43], v242
    s_mov_b32 s41, s7
    s_mul_i32 s38, s29, 25600
    v_exp_f32 v46, v46
    v_exp_f32 v47, v47
    v_exp_f32 v48, v48
    v_exp_f32 v49, v49
    v_mfma_f32_32x32x8_bf16 v[76:91], v[192:193], v[178:179], 0
    v_exp_f32 v50, v50
    v_exp_f32 v51, v51
    v_exp_f32 v52, v52
    v_exp_f32 v53, v53
    v_smfmac_f32_32x32x32_bf16 v[108:123], v[184:187], v[44:51], v242
    s_mul_i32 s97, s29, 3072
    s_add_u32 s97, s97, 102400
    v_exp_f32 v54, v54
    v_exp_f32 v55, v55
    v_exp_f32 v56, v56
    v_exp_f32 v57, v57
    v_mfma_f32_32x32x16_bf16 v[76:91], v[180:183], v[174:177], v[76:91]
    s_waitcnt vmcnt(8)
    v_exp_f32 v58, v58
    v_exp_f32 v59, v59
    v_exp_f32 v60, v60
    v_exp_f32 v61, v61
    v_smfmac_f32_32x32x32_bf16 v[108:123], v[188:191], v[52:59], v242
    s_mul_i32 s28, s29, 6144
    s_add_u32 s39, s28, 133120
    v_exp_f32 v62, v62
    v_exp_f32 v63, v63
    v_exp_f32 v64, v64
    v_exp_f32 v65, v65
    v_mfma_f32_32x32x8_bf16 v[28:43], v[206:207], v[160:161], 0
    v_exp_f32 v66, v66
    v_exp_f32 v67, v67
    v_exp_f32 v68, v68
    v_exp_f32 v69, v69
    v_smfmac_f32_32x32x32_bf16 v[124:139], v[184:187], v[60:67], v242
    s_waitcnt lgkmcnt(0)
    s_add_u32 s40, s59, s6
    v_exp_f32 v70, v70
    v_exp_f32 v71, v71
    v_exp_f32 v72, v72
    v_exp_f32 v73, v73
    v_mfma_f32_32x32x16_bf16 v[28:43], v[194:197], v[156:159], v[28:43]
    v_exp_f32 v74, v74
    v_exp_f32 v75, v75
    v_exp_f32 v76, v76
    v_exp_f32 v77, v77
    v_smfmac_f32_32x32x32_bf16 v[124:139], v[188:191], v[68:75], v242
    s_cmp_ge_u32 s62, 1
    s_cselect_b64 s[24:25], s[42:43], s[24:25]
    v_exp_f32 v78, v78
    v_exp_f32 v79, v79
    v_exp_f32 v80, v80
    v_exp_f32 v81, v81
    v_mfma_f32_32x32x8_bf16 v[44:59], v[206:207], v[166:167], 0
    v_exp_f32 v82, v82
    v_exp_f32 v83, v83
    v_exp_f32 v84, v84
    v_exp_f32 v85, v85
    v_smfmac_f32_32x32x32_bf16 v[140:155], v[184:187], v[76:83], v242
    s_cmp_ge_u32 s62, 1
    s_cselect_b32 s26, 1966080, s26
    v_exp_f32 v86, v86
    v_exp_f32 v87, v87
    v_exp_f32 v88, v88
    v_exp_f32 v89, v89
    v_mfma_f32_32x32x16_bf16 v[44:59], v[194:197], v[162:165], v[44:59]
    v_exp_f32 v90, v90
    v_exp_f32 v91, v91
    v_exp_f32 v28, v28
    v_exp_f32 v29, v29
    v_smfmac_f32_32x32x32_bf16 v[140:155], v[188:191], v[84:91], v242
    buffer_load_dwordx4 v[180:183], v1, s[16:19], 0 offen
    buffer_load_dwordx2 v[192:193], v244, s[16:19], 0 offen
    buffer_load_dwordx4 v[184:187], v245, s[16:19], 0 offen
    buffer_load_dwordx4 v[188:191], v246, s[16:19], 0 offen
    v_exp_f32 v30, v30
    v_exp_f32 v31, v31
    v_exp_f32 v32, v32
    v_exp_f32 v33, v33
    v_mfma_f32_32x32x8_bf16 v[60:75], v[206:207], v[172:173], 0
    v_exp_f32 v34, v34
    v_exp_f32 v35, v35
    v_exp_f32 v36, v36
    v_exp_f32 v37, v37
    v_smfmac_f32_32x32x32_bf16 v[92:107], v[198:201], v[28:35], v242
    s_cmp_eq_u32 s62, 2
    s_cselect_b64 s[12:13], s[34:35], s[24:25]
    v_exp_f32 v38, v38
    v_exp_f32 v39, v39
    v_exp_f32 v40, v40
    v_exp_f32 v41, v41
    v_mfma_f32_32x32x16_bf16 v[60:75], v[194:197], v[168:171], v[60:75]
    s_add_u32 s16, s16, 2688
    v_exp_f32 v42, v42
    v_exp_f32 v43, v43
    v_exp_f32 v44, v44
    v_exp_f32 v45, v45
    v_smfmac_f32_32x32x32_bf16 v[92:107], v[202:205], v[36:43], v242
    s_cmp_eq_u32 s62, 2
    s_cselect_b64 s[24:25], s[32:33], s[24:25]
    v_exp_f32 v46, v46
    v_exp_f32 v47, v47
    v_exp_f32 v48, v48
    v_exp_f32 v49, v49
    v_mfma_f32_32x32x8_bf16 v[76:91], v[206:207], v[178:179], 0
    v_exp_f32 v50, v50
    v_exp_f32 v51, v51
    v_exp_f32 v52, v52
    v_exp_f32 v53, v53
    v_smfmac_f32_32x32x32_bf16 v[108:123], v[198:201], v[44:51], v242
    s_mov_b32 s14, s26
    s_add_u32 s34, s58, s6
    v_exp_f32 v54, v54
    v_exp_f32 v55, v55
    v_exp_f32 v56, v56
    v_exp_f32 v57, v57
    v_mfma_f32_32x32x16_bf16 v[76:91], v[194:197], v[174:177], v[76:91]
    s_waitcnt vmcnt(8)
    v_exp_f32 v58, v58
    v_exp_f32 v59, v59
    v_exp_f32 v60, v60
    v_exp_f32 v61, v61
    v_smfmac_f32_32x32x32_bf16 v[108:123], v[202:205], v[52:59], v242
    v_add_u32 v25, s51, v25
    v_exp_f32 v62, v62
    v_exp_f32 v63, v63
    v_exp_f32 v64, v64
    v_exp_f32 v65, v65
    v_mfma_f32_32x32x8_bf16 v[28:43], v[220:221], v[160:161], 0
    v_exp_f32 v66, v66
    v_exp_f32 v67, v67
    v_exp_f32 v68, v68
    v_exp_f32 v69, v69
    v_smfmac_f32_32x32x32_bf16 v[124:139], v[198:201], v[60:67], v242
    global_load_dwordx4 v[248:251], v26, s[30:31] offset:0
    global_load_dwordx4 v[252:255], v26, s[30:31] offset:16
    global_load_dwordx4 v[2:5], v25, s[30:31] offset:0
    global_load_dwordx4 v[6:9], v25, s[30:31] offset:16
    global_load_dwordx4 v[10:13], v25, s[30:31] offset:32
    v_exp_f32 v70, v70
    v_exp_f32 v71, v71
    v_exp_f32 v72, v72
    v_exp_f32 v73, v73
    v_mfma_f32_32x32x16_bf16 v[28:43], v[208:211], v[156:159], v[28:43]
    s_mov_b32 s35, s7
    v_exp_f32 v74, v74
    v_exp_f32 v75, v75
    v_exp_f32 v76, v76
    v_exp_f32 v77, v77
    v_smfmac_f32_32x32x32_bf16 v[124:139], v[202:205], v[68:75], v242
    s_add_u32 s4, s4, s61
    s_addc_u32 s5, s5, 0
    v_exp_f32 v78, v78
    v_exp_f32 v79, v79
    v_exp_f32 v80, v80
    v_exp_f32 v81, v81
    v_mfma_f32_32x32x8_bf16 v[44:59], v[220:221], v[166:167], 0
    v_exp_f32 v82, v82
    v_exp_f32 v83, v83
    v_exp_f32 v84, v84
    v_exp_f32 v85, v85
    v_smfmac_f32_32x32x32_bf16 v[140:155], v[198:201], v[76:83], v242
    s_mov_b32 s58, 10240
    s_mov_b32 s59, 20480
    v_exp_f32 v86, v86
    v_exp_f32 v87, v87
    v_exp_f32 v88, v88
    v_exp_f32 v89, v89
    v_mfma_f32_32x32x16_bf16 v[44:59], v[208:211], v[162:165], v[44:59]
    s_getreg_b32 s1, hwreg(HW_REG_XCC_ID)
    v_exp_f32 v90, v90
    v_exp_f32 v91, v91
    v_exp_f32 v28, v28
    v_exp_f32 v29, v29
    v_smfmac_f32_32x32x32_bf16 v[140:155], v[202:205], v[84:91], v242
    buffer_load_dwordx4 v[194:197], v1, s[16:19], 0 offen
    buffer_load_dwordx2 v[206:207], v244, s[16:19], 0 offen
    buffer_load_dwordx4 v[198:201], v245, s[16:19], 0 offen
    buffer_load_dwordx4 v[202:205], v246, s[16:19], 0 offen
    v_exp_f32 v30, v30
    v_exp_f32 v31, v31
    v_exp_f32 v32, v32
    v_exp_f32 v33, v33
    v_mfma_f32_32x32x8_bf16 v[60:75], v[220:221], v[172:173], 0
    v_exp_f32 v34, v34
    v_exp_f32 v35, v35
    v_exp_f32 v36, v36
    v_exp_f32 v37, v37
    v_smfmac_f32_32x32x32_bf16 v[92:107], v[212:215], v[28:35], v242
    s_add_u32 s1, s1, 1
    v_exp_f32 v38, v38
    v_exp_f32 v39, v39
    v_exp_f32 v40, v40
    v_exp_f32 v41, v41
    v_mfma_f32_32x32x16_bf16 v[60:75], v[208:211], v[168:171], v[60:75]
    s_add_u32 s16, s16, 2688
    v_exp_f32 v42, v42
    v_exp_f32 v43, v43
    v_exp_f32 v44, v44
    v_exp_f32 v45, v45
    v_smfmac_f32_32x32x32_bf16 v[92:107], v[216:219], v[36:43], v242
    v_exp_f32 v46, v46
    v_exp_f32 v47, v47
    v_exp_f32 v48, v48
    v_exp_f32 v49, v49
    v_mfma_f32_32x32x8_bf16 v[76:91], v[220:221], v[178:179], 0
    v_exp_f32 v50, v50
    v_exp_f32 v51, v51
    v_exp_f32 v52, v52
    v_exp_f32 v53, v53
    v_smfmac_f32_32x32x32_bf16 v[108:123], v[212:215], v[44:51], v242
    v_exp_f32 v54, v54
    v_exp_f32 v55, v55
    v_exp_f32 v56, v56
    v_exp_f32 v57, v57
    v_mfma_f32_32x32x16_bf16 v[76:91], v[208:211], v[174:177], v[76:91]
    s_waitcnt vmcnt(13)
    v_exp_f32 v58, v58
    v_exp_f32 v59, v59
    v_exp_f32 v60, v60
    v_exp_f32 v61, v61
    v_smfmac_f32_32x32x32_bf16 v[108:123], v[216:219], v[52:59], v242
    v_exp_f32 v62, v62
    v_exp_f32 v63, v63
    v_exp_f32 v64, v64
    v_exp_f32 v65, v65
    v_mfma_f32_32x32x8_bf16 v[28:43], v[234:235], v[160:161], 0
    v_exp_f32 v66, v66
    v_exp_f32 v67, v67
    v_exp_f32 v68, v68
    v_exp_f32 v69, v69
    v_smfmac_f32_32x32x32_bf16 v[124:139], v[212:215], v[60:67], v242
    global_load_dwordx4 a[48:51], v1, s[40:41] offset:-4096 sc1
    global_load_dwordx4 a[52:55], v1, s[40:41] offset:-3072 sc1
    global_load_dwordx4 a[56:59], v1, s[40:41] offset:-2048 sc1
    global_load_dwordx4 a[60:63], v1, s[40:41] offset:-1024 sc1
    v_exp_f32 v70, v70
    v_exp_f32 v71, v71
    v_exp_f32 v72, v72
    v_exp_f32 v73, v73
    v_mfma_f32_32x32x16_bf16 v[28:43], v[222:225], v[156:159], v[28:43]
    v_exp_f32 v74, v74
    v_exp_f32 v75, v75
    v_exp_f32 v76, v76
    v_exp_f32 v77, v77
    v_smfmac_f32_32x32x32_bf16 v[124:139], v[216:219], v[68:75], v242
    s_mov_b32 m0, s39
    s_waitcnt vmcnt(8)
    v_exp_f32 v78, v78
    v_exp_f32 v79, v79
    v_exp_f32 v80, v80
    v_exp_f32 v81, v81
    v_mfma_f32_32x32x8_bf16 v[44:59], v[234:235], v[166:167], 0
    v_exp_f32 v82, v82
    v_exp_f32 v83, v83
    v_exp_f32 v84, v84
    v_exp_f32 v85, v85
    v_smfmac_f32_32x32x32_bf16 v[140:155], v[212:215], v[76:83], v242
    v_exp_f32 v86, v86
    v_exp_f32 v87, v87
    v_exp_f32 v88, v88
    v_exp_f32 v89, v89
    v_mfma_f32_32x32x16_bf16 v[44:59], v[222:225], v[162:165], v[44:59]
    v_add_u32 v8, s39, v8
    v_add_u32 v9, s39, v9
    v_add_u32 v10, s39, v10
    v_add_u32 v11, s39, v11
    v_add_u32 v12, s39, v12
    v_add_u32 v13, s39, v13
    v_add_u32 v252, s28, v252
    v_mad_u32_u24 v253, v254, s53, v253
    v_add_u32 v251, s55, v251
    v_exp_f32 v90, v90
    v_exp_f32 v91, v91
    v_exp_f32 v28, v28
    v_exp_f32 v29, v29
    v_smfmac_f32_32x32x32_bf16 v[140:155], v[216:219], v[84:91], v242
    buffer_load_dwordx4 v[208:211], v1, s[16:19], 0 offen
    buffer_load_dwordx2 v[220:221], v244, s[16:19], 0 offen
    buffer_load_dwordx4 v[212:215], v245, s[16:19], 0 offen
    buffer_load_dwordx4 v[216:219], v246, s[16:19], 0 offen
    v_exp_f32 v30, v30
    v_exp_f32 v31, v31
    v_exp_f32 v32, v32
    v_exp_f32 v33, v33
    v_mfma_f32_32x32x8_bf16 v[60:75], v[234:235], v[172:173], 0
    v_exp_f32 v34, v34
    v_exp_f32 v35, v35
    v_exp_f32 v36, v36
    v_exp_f32 v37, v37
    v_smfmac_f32_32x32x32_bf16 v[92:107], v[226:229], v[28:35], v242
    buffer_load_dwordx4 v2, s[24:27], s44 offen offset:0 lds
    buffer_load_dwordx4 v3, s[24:27], s44 offen offset:1024 lds
    v_exp_f32 v38, v38
    v_exp_f32 v39, v39
    v_exp_f32 v40, v40
    v_exp_f32 v41, v41
    v_mfma_f32_32x32x16_bf16 v[60:75], v[222:225], v[168:171], v[60:75]
    s_add_u32 s16, s16, 2688
    v_exp_f32 v42, v42
    v_exp_f32 v43, v43
    v_exp_f32 v44, v44
    v_exp_f32 v45, v45
    v_smfmac_f32_32x32x32_bf16 v[92:107], v[230:233], v[36:43], v242
    v_exp_f32 v46, v46
    v_exp_f32 v47, v47
    v_exp_f32 v48, v48
    v_exp_f32 v49, v49
    v_mfma_f32_32x32x8_bf16 v[76:91], v[234:235], v[178:179], 0
    v_exp_f32 v50, v50
    v_exp_f32 v51, v51
    v_exp_f32 v52, v52
    v_exp_f32 v53, v53
    v_smfmac_f32_32x32x32_bf16 v[108:123], v[226:229], v[44:51], v242
    v_exp_f32 v54, v54
    v_exp_f32 v55, v55
    v_exp_f32 v56, v56
    v_exp_f32 v57, v57
    v_mfma_f32_32x32x16_bf16 v[76:91], v[222:225], v[174:177], v[76:91]
    v_exp_f32 v58, v58
    v_exp_f32 v59, v59
    v_exp_f32 v60, v60
    v_exp_f32 v61, v61
    v_smfmac_f32_32x32x32_bf16 v[108:123], v[230:233], v[52:59], v242
    v_exp_f32 v62, v62
    v_exp_f32 v63, v63
    v_exp_f32 v64, v64
    v_exp_f32 v65, v65
    v_mfma_f32_32x32x8_bf16 v[28:43], v[192:193], v[160:161], 0
    v_exp_f32 v66, v66
    v_exp_f32 v67, v67
    v_exp_f32 v68, v68
    v_exp_f32 v69, v69
    v_smfmac_f32_32x32x32_bf16 v[124:139], v[226:229], v[60:67], v242
    v_exp_f32 v70, v70
    v_exp_f32 v71, v71
    v_exp_f32 v72, v72
    v_exp_f32 v73, v73
    v_mfma_f32_32x32x16_bf16 v[28:43], v[180:183], v[156:159], v[28:43]
    v_exp_f32 v74, v74
    v_exp_f32 v75, v75
    v_exp_f32 v76, v76
    v_exp_f32 v77, v77
    v_smfmac_f32_32x32x32_bf16 v[124:139], v[230:233], v[68:75], v242
    v_exp_f32 v78, v78
    v_exp_f32 v79, v79
    v_exp_f32 v80, v80
    v_exp_f32 v81, v81
    v_mfma_f32_32x32x8_bf16 v[44:59], v[192:193], v[166:167], 0
    v_exp_f32 v82, v82
    v_exp_f32 v83, v83
    v_exp_f32 v84, v84
    v_exp_f32 v85, v85
    v_smfmac_f32_32x32x32_bf16 v[140:155], v[226:229], v[76:83], v242
    v_exp_f32 v86, v86
    v_exp_f32 v87, v87
    v_exp_f32 v88, v88
    v_exp_f32 v89, v89
    v_mfma_f32_32x32x16_bf16 v[44:59], v[180:183], v[162:165], v[44:59]
    v_exp_f32 v90, v90
    v_exp_f32 v91, v91
    v_exp_f32 v28, v28
    v_exp_f32 v29, v29
    v_smfmac_f32_32x32x32_bf16 v[140:155], v[230:233], v[84:91], v242
    buffer_load_dwordx4 v[222:225], v1, s[16:19], 0 offen
    buffer_load_dwordx2 v[234:235], v244, s[16:19], 0 offen
    buffer_load_dwordx4 v[226:229], v245, s[16:19], 0 offen
    buffer_load_dwordx4 v[230:233], v246, s[16:19], 0 offen
    v_exp_f32 v30, v30
    v_exp_f32 v31, v31
    v_exp_f32 v32, v32
    v_exp_f32 v33, v33
    v_mfma_f32_32x32x8_bf16 v[60:75], v[192:193], v[172:173], 0
    v_exp_f32 v34, v34
    v_exp_f32 v35, v35
    v_exp_f32 v36, v36
    v_exp_f32 v37, v37
    v_smfmac_f32_32x32x32_bf16 v[92:107], v[184:187], v[28:35], v242
    buffer_load_dwordx4 v4, s[24:27], s44 offen offset:2048 lds
    v_exp_f32 v38, v38
    v_exp_f32 v39, v39
    v_exp_f32 v40, v40
    v_exp_f32 v41, v41
    v_mfma_f32_32x32x16_bf16 v[60:75], v[180:183], v[168:171], v[60:75]
    s_add_u32 s16, s16, 2688
    v_exp_f32 v42, v42
    v_exp_f32 v43, v43
    v_exp_f32 v44, v44
    v_exp_f32 v45, v45
    v_smfmac_f32_32x32x32_bf16 v[92:107], v[188:191], v[36:43], v242
    v_exp_f32 v46, v46
    v_exp_f32 v47, v47
    v_exp_f32 v48, v48
    v_exp_f32 v49, v49
    v_mfma_f32_32x32x8_bf16 v[76:91], v[192:193], v[178:179], 0
    v_exp_f32 v50, v50
    v_exp_f32 v51, v51
    v_exp_f32 v52, v52
    v_exp_f32 v53, v53
    v_smfmac_f32_32x32x32_bf16 v[108:123], v[184:187], v[44:51], v242
    v_exp_f32 v54, v54
    v_exp_f32 v55, v55
    v_exp_f32 v56, v56
    v_exp_f32 v57, v57
    v_mfma_f32_32x32x16_bf16 v[76:91], v[180:183], v[174:177], v[76:91]
    s_waitcnt vmcnt(15)
    v_exp_f32 v58, v58
    v_exp_f32 v59, v59
    v_exp_f32 v60, v60
    v_exp_f32 v61, v61
    v_smfmac_f32_32x32x32_bf16 v[108:123], v[188:191], v[52:59], v242
    v_exp_f32 v62, v62
    v_exp_f32 v63, v63
    v_exp_f32 v64, v64
    v_exp_f32 v65, v65
    v_mfma_f32_32x32x8_bf16 v[28:43], v[206:207], v[160:161], 0
    v_exp_f32 v66, v66
    v_exp_f32 v67, v67
    v_exp_f32 v68, v68
    v_exp_f32 v69, v69
    v_smfmac_f32_32x32x32_bf16 v[124:139], v[184:187], v[60:67], v242
    global_load_dwordx4 a[64:67], v1, s[40:41] offset:0 sc1
    global_load_dwordx4 a[68:71], v1, s[40:41] offset:1024 sc1
    global_load_dwordx4 a[72:75], v1, s[40:41] offset:2048 sc1
    global_load_dwordx4 a[76:79], v1, s[40:41] offset:3072 sc1
    v_exp_f32 v70, v70
    v_exp_f32 v71, v71
    v_exp_f32 v72, v72
    v_exp_f32 v73, v73
    v_mfma_f32_32x32x16_bf16 v[28:43], v[194:197], v[156:159], v[28:43]
    v_exp_f32 v74, v74
    v_exp_f32 v75, v75
    v_exp_f32 v76, v76
    v_exp_f32 v77, v77
    v_smfmac_f32_32x32x32_bf16 v[124:139], v[188:191], v[68:75], v242
    s_add_u32 m0, s39, 3072
    v_exp_f32 v78, v78
    v_exp_f32 v79, v79
    v_exp_f32 v80, v80
    v_exp_f32 v81, v81
    v_mfma_f32_32x32x8_bf16 v[44:59], v[206:207], v[166:167], 0
    v_exp_f32 v82, v82
    v_exp_f32 v83, v83
    v_exp_f32 v84, v84
    v_exp_f32 v85, v85
    v_smfmac_f32_32x32x32_bf16 v[140:155], v[184:187], v[76:83], v242
    v_exp_f32 v86, v86
    v_exp_f32 v87, v87
    v_exp_f32 v88, v88
    v_exp_f32 v89, v89
    v_mfma_f32_32x32x16_bf16 v[44:59], v[194:197], v[162:165], v[44:59]
    v_exp_f32 v90, v90
    v_exp_f32 v91, v91
    v_exp_f32 v28, v28
    v_exp_f32 v29, v29
    v_smfmac_f32_32x32x32_bf16 v[140:155], v[188:191], v[84:91], v242
    buffer_load_dwordx4 v[180:183], v1, s[16:19], 0 offen
    buffer_load_dwordx2 v[192:193], v244, s[16:19], 0 offen
    buffer_load_dwordx4 v[184:187], v245, s[16:19], 0 offen
    buffer_load_dwordx4 v[188:191], v246, s[16:19], 0 offen
    v_exp_f32 v30, v30
    v_exp_f32 v31, v31
    v_exp_f32 v32, v32
    v_exp_f32 v33, v33
    v_mfma_f32_32x32x8_bf16 v[60:75], v[206:207], v[172:173], 0
    v_exp_f32 v34, v34
    v_exp_f32 v35, v35
    v_exp_f32 v36, v36
    v_exp_f32 v37, v37
    v_smfmac_f32_32x32x32_bf16 v[92:107], v[198:201], v[28:35], v242
    buffer_load_dwordx4 v5, s[12:15], s44 offen offset:0 lds
    buffer_load_dwordx4 v6, s[12:15], s44 offen offset:1024 lds
    v_exp_f32 v38, v38
    v_exp_f32 v39, v39
    v_exp_f32 v40, v40
    v_exp_f32 v41, v41
    v_mfma_f32_32x32x16_bf16 v[60:75], v[194:197], v[168:171], v[60:75]
    s_add_u32 s16, s16, 2688
    v_exp_f32 v42, v42
    v_exp_f32 v43, v43
    v_exp_f32 v44, v44
    v_exp_f32 v45, v45
    v_smfmac_f32_32x32x32_bf16 v[92:107], v[202:205], v[36:43], v242
    v_exp_f32 v46, v46
    v_exp_f32 v47, v47
    v_exp_f32 v48, v48
    v_exp_f32 v49, v49
    v_mfma_f32_32x32x8_bf16 v[76:91], v[206:207], v[178:179], 0
    v_exp_f32 v50, v50
    v_exp_f32 v51, v51
    v_exp_f32 v52, v52
    v_exp_f32 v53, v53
    v_smfmac_f32_32x32x32_bf16 v[108:123], v[198:201], v[44:51], v242
    v_exp_f32 v54, v54
    v_exp_f32 v55, v55
    v_exp_f32 v56, v56
    v_exp_f32 v57, v57
    v_mfma_f32_32x32x16_bf16 v[76:91], v[194:197], v[174:177], v[76:91]
    s_waitcnt vmcnt(17)
    v_exp_f32 v58, v58
L_back_stub0_0:
    s_cmp_eq_u32 s0, 1
    s_cbranch_scc1 L_back_wret0
    v_exp_f32 v59, v59
    v_exp_f32 v60, v60
    v_exp_f32 v61, v61
    v_smfmac_f32_32x32x32_bf16 v[108:123], v[202:205], v[52:59], v242
    s_add_u32 s40, s40, 8192
    v_exp_f32 v62, v62
    v_exp_f32 v63, v63
    v_exp_f32 v64, v64
    v_exp_f32 v65, v65
    v_mfma_f32_32x32x8_bf16 v[28:43], v[220:221], v[160:161], 0
    v_exp_f32 v66, v66
    v_exp_f32 v67, v67
    v_exp_f32 v68, v68
    v_exp_f32 v69, v69
    v_smfmac_f32_32x32x32_bf16 v[124:139], v[198:201], v[60:67], v242
    global_load_dwordx4 a[80:83], v1, s[40:41] offset:-4096 sc1
    global_load_dwordx4 a[84:87], v1, s[40:41] offset:-3072 sc1
    global_load_dwordx4 a[88:91], v1, s[40:41] offset:-2048 sc1
    global_load_dwordx4 a[92:95], v1, s[40:41] offset:-1024 sc1
    v_exp_f32 v70, v70
    v_exp_f32 v71, v71
    v_exp_f32 v72, v72
    v_exp_f32 v73, v73
    v_mfma_f32_32x32x16_bf16 v[28:43], v[208:211], v[156:159], v[28:43]
    v_exp_f32 v74, v74
    v_exp_f32 v75, v75
    v_exp_f32 v76, v76
    v_exp_f32 v77, v77
    v_smfmac_f32_32x32x32_bf16 v[124:139], v[202:205], v[68:75], v242
    s_add_u32 s30, s30, 4096
    s_addc_u32 s31, s31, 0
    v_exp_f32 v78, v78
    v_exp_f32 v79, v79
    v_exp_f32 v80, v80
    v_exp_f32 v81, v81
    v_mfma_f32_32x32x8_bf16 v[44:59], v[220:221], v[166:167], 0
    v_exp_f32 v82, v82
    v_exp_f32 v83, v83
    v_exp_f32 v84, v84
    v_exp_f32 v85, v85
    v_smfmac_f32_32x32x32_bf16 v[140:155], v[198:201], v[76:83], v242
    global_load_dword v26, v247, s[30:31]
    v_exp_f32 v86, v86
    v_exp_f32 v87, v87
    v_exp_f32 v88, v88
    v_exp_f32 v89, v89
    v_mfma_f32_32x32x16_bf16 v[44:59], v[208:211], v[162:165], v[44:59]
    v_exp_f32 v90, v90
    v_exp_f32 v91, v91
    v_exp_f32 v28, v28
    v_exp_f32 v29, v29
    v_smfmac_f32_32x32x32_bf16 v[140:155], v[202:205], v[84:91], v242
    buffer_load_dwordx4 v[194:197], v1, s[16:19], 0 offen
    buffer_load_dwordx2 v[206:207], v244, s[16:19], 0 offen
    buffer_load_dwordx4 v[198:201], v245, s[16:19], 0 offen
    buffer_load_dwordx4 v[202:205], v246, s[16:19], 0 offen
    v_exp_f32 v30, v30
    v_exp_f32 v31, v31
    v_exp_f32 v32, v32
    v_exp_f32 v33, v33
    v_mfma_f32_32x32x8_bf16 v[60:75], v[220:221], v[172:173], 0
    v_exp_f32 v34, v34
    v_exp_f32 v35, v35
    v_exp_f32 v36, v36
    v_exp_f32 v37, v37
    v_smfmac_f32_32x32x32_bf16 v[92:107], v[212:215], v[28:35], v242
    buffer_load_dwordx4 v7, s[12:15], s44 offen offset:2048 lds
    v_exp_f32 v38, v38
    v_exp_f32 v39, v39
    v_exp_f32 v40, v40
    v_exp_f32 v41, v41
    v_mfma_f32_32x32x16_bf16 v[60:75], v[208:211], v[168:171], v[60:75]
    s_add_u32 s16, s16, 2688
    v_exp_f32 v42, v42
    v_exp_f32 v43, v43
    v_exp_f32 v44, v44
    v_exp_f32 v45, v45
    v_smfmac_f32_32x32x32_bf16 v[92:107], v[216:219], v[36:43], v242
    v_exp_f32 v46, v46
    v_exp_f32 v47, v47
    v_exp_f32 v48, v48
    v_exp_f32 v49, v49
    v_mfma_f32_32x32x8_bf16 v[76:91], v[220:221], v[178:179], 0
    v_exp_f32 v50, v50
    v_exp_f32 v51, v51
    v_exp_f32 v52, v52
    v_exp_f32 v53, v53
    v_smfmac_f32_32x32x32_bf16 v[108:123], v[212:215], v[44:51], v242
    v_exp_f32 v54, v54
    v_exp_f32 v55, v55
    v_exp_f32 v56, v56
    v_exp_f32 v57, v57
    v_mfma_f32_32x32x16_bf16 v[76:91], v[208:211], v[174:177], v[76:91]
    s_waitcnt vmcnt(21)
    v_exp_f32 v58, v58
    v_exp_f32 v59, v59
    v_exp_f32 v60, v60
    v_exp_f32 v61, v61
    v_smfmac_f32_32x32x32_bf16 v[108:123], v[216:219], v[52:59], v242
    v_exp_f32 v62, v62
    v_exp_f32 v63, v63
    v_exp_f32 v64, v64
    v_exp_f32 v65, v65
    v_mfma_f32_32x32x8_bf16 v[28:43], v[234:235], v[160:161], 0
    v_exp_f32 v66, v66
    v_exp_f32 v67, v67
    v_exp_f32 v68, v68
    v_exp_f32 v69, v69
    v_smfmac_f32_32x32x32_bf16 v[124:139], v[212:215], v[60:67], v242
    v_exp_f32 v70, v70
    v_exp_f32 v71, v71
    v_exp_f32 v72, v72
    v_exp_f32 v73, v73
    v_mfma_f32_32x32x16_bf16 v[28:43], v[222:225], v[156:159], v[28:43]
    v_exp_f32 v74, v74
    v_exp_f32 v75, v75
    v_exp_f32 v76, v76
    v_exp_f32 v77, v77
    v_smfmac_f32_32x32x32_bf16 v[124:139], v[216:219], v[68:75], v242
    v_exp_f32 v78, v78
    v_exp_f32 v79, v79
    v_exp_f32 v80, v80
    v_exp_f32 v81, v81
    v_mfma_f32_32x32x8_bf16 v[44:59], v[234:235], v[166:167], 0
    v_exp_f32 v82, v82
    v_exp_f32 v83, v83
    v_exp_f32 v84, v84
    v_exp_f32 v85, v85
    v_smfmac_f32_32x32x32_bf16 v[140:155], v[212:215], v[76:83], v242
    v_exp_f32 v86, v86
    v_exp_f32 v87, v87
    v_exp_f32 v88, v88
    v_exp_f32 v89, v89
    v_mfma_f32_32x32x16_bf16 v[44:59], v[222:225], v[162:165], v[44:59]
    v_exp_f32 v90, v90
    v_exp_f32 v91, v91
    v_exp_f32 v28, v28
    v_exp_f32 v29, v29
    v_smfmac_f32_32x32x32_bf16 v[140:155], v[216:219], v[84:91], v242
    buffer_load_dwordx4 v[208:211], v1, s[16:19], 0 offen
    buffer_load_dwordx2 v[220:221], v244, s[16:19], 0 offen
    buffer_load_dwordx4 v[212:215], v245, s[16:19], 0 offen
    buffer_load_dwordx4 v[216:219], v246, s[16:19], 0 offen
    v_exp_f32 v30, v30
    v_exp_f32 v31, v31
    v_exp_f32 v32, v32
    v_exp_f32 v33, v33
    v_mfma_f32_32x32x8_bf16 v[60:75], v[234:235], v[172:173], 0
    v_exp_f32 v34, v34
    v_exp_f32 v35, v35
    v_exp_f32 v36, v36
    v_exp_f32 v37, v37
    v_smfmac_f32_32x32x32_bf16 v[92:107], v[226:229], v[28:35], v242
    v_exp_f32 v38, v38
    v_exp_f32 v39, v39
    v_exp_f32 v40, v40
    v_exp_f32 v41, v41
    v_mfma_f32_32x32x16_bf16 v[60:75], v[222:225], v[168:171], v[60:75]
    s_add_u32 s16, s16, 2688
    v_exp_f32 v42, v42
    v_exp_f32 v43, v43
    v_exp_f32 v44, v44
    v_exp_f32 v45, v45
    v_smfmac_f32_32x32x32_bf16 v[92:107], v[230:233], v[36:43], v242
    v_exp_f32 v46, v46
    v_exp_f32 v47, v47
    v_exp_f32 v48, v48
    v_exp_f32 v49, v49
    v_mfma_f32_32x32x8_bf16 v[76:91], v[234:235], v[178:179], 0
    v_exp_f32 v50, v50
    v_exp_f32 v51, v51
    v_exp_f32 v52, v52
    v_exp_f32 v53, v53
    v_smfmac_f32_32x32x32_bf16 v[108:123], v[226:229], v[44:51], v242
    v_exp_f32 v54, v54
    v_exp_f32 v55, v55
    v_exp_f32 v56, v56
    v_exp_f32 v57, v57
    v_mfma_f32_32x32x16_bf16 v[76:91], v[222:225], v[174:177], v[76:91]
    s_waitcnt vmcnt(16)
    v_exp_f32 v58, v58
    v_exp_f32 v59, v59
    v_exp_f32 v60, v60
    v_exp_f32 v61, v61
    v_smfmac_f32_32x32x32_bf16 v[108:123], v[230:233], v[52:59], v242
    v_exp_f32 v62, v62
    v_exp_f32 v63, v63
    v_exp_f32 v64, v64
    v_exp_f32 v65, v65
    v_mfma_f32_32x32x8_bf16 v[28:43], v[192:193], v[160:161], 0
    v_exp_f32 v66, v66
    v_exp_f32 v67, v67
    v_exp_f32 v68, v68
    v_exp_f32 v69, v69
    v_smfmac_f32_32x32x32_bf16 v[124:139], v[226:229], v[60:67], v242
    global_load_dwordx4 a[96:99], v1, s[40:41] offset:0 sc1
    global_load_dwordx4 a[100:103], v1, s[40:41] offset:1024 sc1
    global_load_dwordx4 a[104:107], v1, s[40:41] offset:2048 sc1
    global_load_dwordx4 a[108:111], v1, s[40:41] offset:3072 sc1
    v_exp_f32 v70, v70
    v_exp_f32 v71, v71
    v_exp_f32 v72, v72
    v_exp_f32 v73, v73
    v_mfma_f32_32x32x16_bf16 v[28:43], v[180:183], v[156:159], v[28:43]
    v_exp_f32 v74, v74
    v_exp_f32 v75, v75
    v_exp_f32 v76, v76
    v_exp_f32 v77, v77
    v_smfmac_f32_32x32x32_bf16 v[124:139], v[230:233], v[68:75], v242
    v_exp_f32 v78, v78
    v_exp_f32 v79, v79
    v_exp_f32 v80, v80
    v_exp_f32 v81, v81
    v_mfma_f32_32x32x8_bf16 v[44:59], v[192:193], v[166:167], 0
    v_exp_f32 v82, v82
    v_exp_f32 v83, v83
    v_exp_f32 v84, v84
    v_exp_f32 v85, v85
    v_smfmac_f32_32x32x32_bf16 v[140:155], v[226:229], v[76:83], v242
    v_exp_f32 v86, v86
    v_exp_f32 v87, v87
    v_exp_f32 v88, v88
    v_exp_f32 v89, v89
    v_mfma_f32_32x32x16_bf16 v[44:59], v[180:183], v[162:165], v[44:59]
    v_exp_f32 v90, v90
    v_exp_f32 v91, v91
    v_exp_f32 v28, v28
    v_exp_f32 v29, v29
    v_smfmac_f32_32x32x32_bf16 v[140:155], v[230:233], v[84:91], v242
    buffer_load_dwordx4 v[222:225], v1, s[16:19], 0 offen
    buffer_load_dwordx2 v[234:235], v244, s[16:19], 0 offen
    buffer_load_dwordx4 v[226:229], v245, s[16:19], 0 offen
    buffer_load_dwordx4 v[230:233], v246, s[16:19], 0 offen
    v_exp_f32 v30, v30
    v_exp_f32 v31, v31
    v_exp_f32 v32, v32
    v_exp_f32 v33, v33
    v_mfma_f32_32x32x8_bf16 v[60:75], v[192:193], v[172:173], 0
    v_exp_f32 v34, v34
    v_exp_f32 v35, v35
    v_exp_f32 v36, v36
    v_exp_f32 v37, v37
    v_smfmac_f32_32x32x32_bf16 v[92:107], v[184:187], v[28:35], v242
    v_exp_f32 v38, v38
    v_exp_f32 v39, v39
    v_exp_f32 v40, v40
    v_exp_f32 v41, v41
    v_mfma_f32_32x32x16_bf16 v[60:75], v[180:183], v[168:171], v[60:75]
    s_add_u32 s16, s16, 2688
    v_exp_f32 v42, v42
    v_exp_f32 v43, v43
    v_exp_f32 v44, v44
    v_exp_f32 v45, v45
    v_smfmac_f32_32x32x32_bf16 v[92:107], v[188:191], v[36:43], v242
    v_exp_f32 v46, v46
    v_exp_f32 v47, v47
    v_exp_f32 v48, v48
    v_exp_f32 v49, v49
    v_mfma_f32_32x32x8_bf16 v[76:91], v[192:193], v[178:179], 0
    v_exp_f32 v50, v50
    v_exp_f32 v51, v51
    v_exp_f32 v52, v52
    v_exp_f32 v53, v53
    v_smfmac_f32_32x32x32_bf16 v[108:123], v[184:187], v[44:51], v242
    v_exp_f32 v54, v54
    v_exp_f32 v55, v55
    v_exp_f32 v56, v56
    v_exp_f32 v57, v57
    v_mfma_f32_32x32x16_bf16 v[76:91], v[180:183], v[174:177], v[76:91]
    s_waitcnt vmcnt(13)
    v_exp_f32 v58, v58
    v_exp_f32 v59, v59
    v_exp_f32 v60, v60
    v_exp_f32 v61, v61
    v_smfmac_f32_32x32x32_bf16 v[108:123], v[188:191], v[52:59], v242
    v_exp_f32 v62, v62
    v_exp_f32 v63, v63
    v_exp_f32 v64, v64
    v_exp_f32 v65, v65
    v_mfma_f32_32x32x8_bf16 v[28:43], v[206:207], v[160:161], 0
    v_exp_f32 v66, v66
    v_exp_f32 v67, v67
    v_exp_f32 v68, v68
    v_exp_f32 v69, v69
    v_smfmac_f32_32x32x32_bf16 v[124:139], v[184:187], v[60:67], v242
    v_exp_f32 v70, v70
    v_exp_f32 v71, v71
    v_exp_f32 v72, v72
    v_exp_f32 v73, v73
    v_mfma_f32_32x32x16_bf16 v[28:43], v[194:197], v[156:159], v[28:43]
    v_exp_f32 v74, v74
    v_exp_f32 v75, v75
    v_exp_f32 v76, v76
    v_exp_f32 v77, v77
    v_smfmac_f32_32x32x32_bf16 v[124:139], v[188:191], v[68:75], v242
    v_exp_f32 v78, v78
    v_exp_f32 v79, v79
    v_exp_f32 v80, v80
    v_exp_f32 v81, v81
    v_mfma_f32_32x32x8_bf16 v[44:59], v[206:207], v[166:167], 0
    v_exp_f32 v82, v82
    v_exp_f32 v83, v83
    v_exp_f32 v84, v84
    v_exp_f32 v85, v85
    v_smfmac_f32_32x32x32_bf16 v[140:155], v[184:187], v[76:83], v242
    v_exp_f32 v86, v86
    v_exp_f32 v87, v87
    v_exp_f32 v88, v88
    v_exp_f32 v89, v89
    v_mfma_f32_32x32x16_bf16 v[44:59], v[194:197], v[162:165], v[44:59]
    v_exp_f32 v90, v90
    v_exp_f32 v91, v91
    v_exp_f32 v28, v28
    v_exp_f32 v29, v29
    v_smfmac_f32_32x32x32_bf16 v[140:155], v[188:191], v[84:91], v242
    buffer_load_dwordx4 v[180:183], v1, s[16:19], 0 offen
    buffer_load_dwordx2 v[192:193], v244, s[16:19], 0 offen
    buffer_load_dwordx4 v[184:187], v245, s[16:19], 0 offen
    buffer_load_dwordx4 v[188:191], v246, s[16:19], 0 offen
    v_exp_f32 v30, v30
    v_exp_f32 v31, v31
    v_exp_f32 v32, v32
    v_exp_f32 v33, v33
    v_mfma_f32_32x32x8_bf16 v[60:75], v[206:207], v[172:173], 0
    v_exp_f32 v34, v34
    v_exp_f32 v35, v35
    v_exp_f32 v36, v36
    v_exp_f32 v37, v37
    v_smfmac_f32_32x32x32_bf16 v[92:107], v[198:201], v[28:35], v242
    v_exp_f32 v38, v38
    v_exp_f32 v39, v39
    v_exp_f32 v40, v40
    v_exp_f32 v41, v41
    v_mfma_f32_32x32x16_bf16 v[60:75], v[194:197], v[168:171], v[60:75]
    s_add_u32 s16, s16, 2688
    v_exp_f32 v42, v42
    v_exp_f32 v43, v43
    v_exp_f32 v44, v44
    v_exp_f32 v45, v45
    v_smfmac_f32_32x32x32_bf16 v[92:107], v[202:205], v[36:43], v242
    v_exp_f32 v46, v46
    v_exp_f32 v47, v47
    v_exp_f32 v48, v48
    v_exp_f32 v49, v49
    v_mfma_f32_32x32x8_bf16 v[76:91], v[206:207], v[178:179], 0
    v_exp_f32 v50, v50
    v_exp_f32 v51, v51
    v_exp_f32 v52, v52
    v_exp_f32 v53, v53
    v_smfmac_f32_32x32x32_bf16 v[108:123], v[198:201], v[44:51], v242
    v_exp_f32 v54, v54
    v_exp_f32 v55, v55
    v_exp_f32 v56, v56
    v_exp_f32 v57, v57
    v_mfma_f32_32x32x16_bf16 v[76:91], v[194:197], v[174:177], v[76:91]
    s_waitcnt vmcnt(12)
    v_exp_f32 v58, v58
    v_exp_f32 v59, v59
    v_exp_f32 v60, v60
    v_exp_f32 v61, v61
    v_smfmac_f32_32x32x32_bf16 v[108:123], v[202:205], v[52:59], v242
    s_add_u32 s40, s40, 8192
    v_exp_f32 v62, v62
    v_exp_f32 v63, v63
    v_exp_f32 v64, v64
    v_exp_f32 v65, v65
    v_mfma_f32_32x32x8_bf16 v[28:43], v[220:221], v[160:161], 0
    v_exp_f32 v66, v66
    v_exp_f32 v67, v67
    v_exp_f32 v68, v68
    v_exp_f32 v69, v69
    v_smfmac_f32_32x32x32_bf16 v[124:139], v[198:201], v[60:67], v242
    global_load_dwordx4 a[112:115], v1, s[40:41] offset:-4096 sc1
    global_load_dwordx4 a[116:119], v1, s[40:41] offset:-3072 sc1
    global_load_dwordx4 a[120:123], v1, s[40:41] offset:-2048 sc1
    global_load_dwordx4 a[124:127], v1, s[40:41] offset:-1024 sc1
    v_exp_f32 v70, v70
    v_exp_f32 v71, v71
    v_exp_f32 v72, v72
    v_exp_f32 v73, v73
    v_mfma_f32_32x32x16_bf16 v[28:43], v[208:211], v[156:159], v[28:43]
    v_exp_f32 v74, v74
    v_exp_f32 v75, v75
    v_exp_f32 v76, v76
    v_exp_f32 v77, v77
    v_smfmac_f32_32x32x32_bf16 v[124:139], v[202:205], v[68:75], v242
    v_exp_f32 v78, v78
    v_exp_f32 v79, v79
    v_exp_f32 v80, v80
    v_exp_f32 v81, v81
    v_mfma_f32_32x32x8_bf16 v[44:59], v[220:221], v[166:167], 0
    v_exp_f32 v82, v82
    v_exp_f32 v83, v83
    v_exp_f32 v84, v84
    v_exp_f32 v85, v85
    v_smfmac_f32_32x32x32_bf16 v[140:155], v[198:201], v[76:83], v242
    ds_read_b64_tr_b16 a[240:241], v8
    ds_read_b64_tr_b16 a[244:245], v9
    v_exp_f32 v86, v86
    v_exp_f32 v87, v87
    v_exp_f32 v88, v88
    v_exp_f32 v89, v89
    v_mfma_f32_32x32x16_bf16 v[44:59], v[208:211], v[162:165], v[44:59]
    ds_read_b64_tr_b16 a[248:249], v10
    ds_read_b64_tr_b16 a[252:253], v11
    ds_read_b64_tr_b16 v[236:237], v12
    ds_read_b64_tr_b16 v[16:17], v13
    v_add_u32 v8, s54, v8
    v_add_u32 v9, s54, v9
    v_add_u32 v10, s54, v10
    v_add_u32 v11, s54, v11
    v_add_u32 v12, s54, v12
    v_add_u32 v13, s54, v13
    v_exp_f32 v90, v90
    v_exp_f32 v91, v91
    v_exp_f32 v28, v28
    v_exp_f32 v29, v29
    v_smfmac_f32_32x32x32_bf16 v[140:155], v[202:205], v[84:91], v242
    buffer_load_dwordx4 v[194:197], v1, s[16:19], 0 offen
    buffer_load_dwordx2 v[206:207], v244, s[16:19], 0 offen
    buffer_load_dwordx4 v[198:201], v245, s[16:19], 0 offen
    buffer_load_dwordx4 v[202:205], v246, s[16:19], 0 offen
    v_exp_f32 v30, v30
    v_exp_f32 v31, v31
    v_exp_f32 v32, v32
    v_exp_f32 v33, v33
    v_mfma_f32_32x32x8_bf16 v[60:75], v[220:221], v[172:173], 0
    v_exp_f32 v34, v34
    v_exp_f32 v35, v35
    v_exp_f32 v36, v36
    v_exp_f32 v37, v37
    v_smfmac_f32_32x32x32_bf16 v[92:107], v[212:215], v[28:35], v242
    v_exp_f32 v38, v38
    v_exp_f32 v39, v39
    v_exp_f32 v40, v40
    v_exp_f32 v41, v41
    v_mfma_f32_32x32x16_bf16 v[60:75], v[208:211], v[168:171], v[60:75]
    s_add_u32 s16, s16, 2688
    v_exp_f32 v42, v42
    v_exp_f32 v43, v43
    v_exp_f32 v44, v44
    v_exp_f32 v45, v45
    v_smfmac_f32_32x32x32_bf16 v[92:107], v[216:219], v[36:43], v242
    v_exp_f32 v46, v46
    v_exp_f32 v47, v47
    v_exp_f32 v48, v48
    v_exp_f32 v49, v49
    v_mfma_f32_32x32x8_bf16 v[76:91], v[220:221], v[178:179], 0
    v_exp_f32 v50, v50
    v_exp_f32 v51, v51
    v_exp_f32 v52, v52
    v_exp_f32 v53, v53
    v_smfmac_f32_32x32x32_bf16 v[108:123], v[212:215], v[44:51], v242
    v_exp_f32 v54, v54
    v_exp_f32 v55, v55
    v_exp_f32 v56, v56
    v_exp_f32 v57, v57
    v_mfma_f32_32x32x16_bf16 v[76:91], v[208:211], v[174:177], v[76:91]
    s_waitcnt vmcnt(12)
    v_exp_f32 v58, v58
    v_exp_f32 v59, v59
    v_exp_f32 v60, v60
    v_exp_f32 v61, v61
    v_smfmac_f32_32x32x32_bf16 v[108:123], v[216:219], v[52:59], v242
    v_exp_f32 v62, v62
    v_exp_f32 v63, v63
    v_exp_f32 v64, v64
    v_exp_f32 v65, v65
    v_mfma_f32_32x32x8_bf16 v[28:43], v[234:235], v[160:161], 0
    v_exp_f32 v66, v66
    v_exp_f32 v67, v67
    v_exp_f32 v68, v68
    v_exp_f32 v69, v69
    v_smfmac_f32_32x32x32_bf16 v[124:139], v[212:215], v[60:67], v242
    global_load_dwordx4 a[128:131], v1, s[40:41] offset:0 sc1
    global_load_dwordx4 a[132:135], v1, s[40:41] offset:1024 sc1
    global_load_dwordx4 a[136:139], v1, s[40:41] offset:2048 sc1
    global_load_dwordx4 a[140:143], v1, s[40:41] offset:3072 sc1
    v_exp_f32 v70, v70
    v_exp_f32 v71, v71
    v_exp_f32 v72, v72
    v_exp_f32 v73, v73
    v_mfma_f32_32x32x16_bf16 v[28:43], v[222:225], v[156:159], v[28:43]
    v_exp_f32 v74, v74
    v_exp_f32 v75, v75
    v_exp_f32 v76, v76
    v_exp_f32 v77, v77
    v_smfmac_f32_32x32x32_bf16 v[124:139], v[216:219], v[68:75], v242
    ds_read_b64_tr_b16 a[242:243], v8
    v_exp_f32 v78, v78
    v_exp_f32 v79, v79
    v_exp_f32 v80, v80
    v_exp_f32 v81, v81
    v_mfma_f32_32x32x8_bf16 v[44:59], v[234:235], v[166:167], 0
    v_exp_f32 v82, v82
    v_exp_f32 v83, v83
    v_exp_f32 v84, v84
    v_exp_f32 v85, v85
    v_smfmac_f32_32x32x32_bf16 v[140:155], v[212:215], v[76:83], v242
    ds_read_b64_tr_b16 v[18:19], v13
    v_exp_f32 v86, v86
    v_exp_f32 v87, v87
    v_exp_f32 v88, v88
    v_exp_f32 v89, v89
    v_mfma_f32_32x32x16_bf16 v[44:59], v[222:225], v[162:165], v[44:59]
    ds_read_b64_tr_b16 a[246:247], v9
    ds_read_b64_tr_b16 a[250:251], v10
    ds_read_b64_tr_b16 a[254:255], v11
    ds_read_b64_tr_b16 v[238:239], v12
    v_exp_f32 v90, v90
    v_exp_f32 v91, v91
    v_exp_f32 v28, v28
    v_exp_f32 v29, v29
    v_smfmac_f32_32x32x32_bf16 v[140:155], v[216:219], v[84:91], v242
    buffer_load_dwordx4 v[208:211], v1, s[16:19], 0 offen
    buffer_load_dwordx2 v[220:221], v244, s[16:19], 0 offen
    buffer_load_dwordx4 v[212:215], v245, s[16:19], 0 offen
    buffer_load_dwordx4 v[216:219], v246, s[16:19], 0 offen
    v_exp_f32 v30, v30
    v_exp_f32 v31, v31
    v_exp_f32 v32, v32
    v_exp_f32 v33, v33
    v_mfma_f32_32x32x8_bf16 v[60:75], v[234:235], v[172:173], 0
    v_exp_f32 v34, v34
    v_exp_f32 v35, v35
    v_exp_f32 v36, v36
    v_exp_f32 v37, v37
    v_smfmac_f32_32x32x32_bf16 v[92:107], v[226:229], v[28:35], v242
    v_exp_f32 v38, v38
    v_exp_f32 v39, v39
    v_exp_f32 v40, v40
    v_exp_f32 v41, v41
    v_mfma_f32_32x32x16_bf16 v[60:75], v[222:225], v[168:171], v[60:75]
    s_add_u32 s16, s16, 2688
    v_exp_f32 v42, v42
    v_exp_f32 v43, v43
    v_exp_f32 v44, v44
    v_exp_f32 v45, v45
    v_smfmac_f32_32x32x32_bf16 v[92:107], v[230:233], v[36:43], v242
    v_exp_f32 v46, v46
    v_exp_f32 v47, v47
    v_exp_f32 v48, v48
    v_exp_f32 v49, v49
    v_mfma_f32_32x32x8_bf16 v[76:91], v[234:235], v[178:179], 0
    v_exp_f32 v50, v50
    v_exp_f32 v51, v51
    v_exp_f32 v52, v52
    v_exp_f32 v53, v53
    v_smfmac_f32_32x32x32_bf16 v[108:123], v[226:229], v[44:51], v242
    v_exp_f32 v54, v54
    v_exp_f32 v55, v55
    v_exp_f32 v56, v56
    v_exp_f32 v57, v57
    v_mfma_f32_32x32x16_bf16 v[76:91], v[222:225], v[174:177], v[76:91]
    s_waitcnt vmcnt(16)
    v_exp_f32 v58, v58
    v_exp_f32 v59, v59
    v_exp_f32 v60, v60
    v_exp_f32 v61, v61
    v_smfmac_f32_32x32x32_bf16 v[108:123], v[230:233], v[52:59], v242
    v_exp_f32 v62, v62
    v_exp_f32 v63, v63
    v_exp_f32 v64, v64
    v_exp_f32 v65, v65
    v_mfma_f32_32x32x8_bf16 v[28:43], v[192:193], v[160:161], 0
    v_exp_f32 v66, v66
    v_exp_f32 v67, v67
    v_exp_f32 v68, v68
    v_exp_f32 v69, v69
    v_smfmac_f32_32x32x32_bf16 v[124:139], v[226:229], v[60:67], v242
    v_exp_f32 v70, v70
    v_exp_f32 v71, v71
    v_exp_f32 v72, v72
    v_exp_f32 v73, v73
    v_mfma_f32_32x32x16_bf16 v[28:43], v[180:183], v[156:159], v[28:43]
    v_exp_f32 v74, v74
    v_exp_f32 v75, v75
    v_exp_f32 v76, v76
    v_exp_f32 v77, v77
    v_smfmac_f32_32x32x32_bf16 v[124:139], v[230:233], v[68:75], v242
    s_waitcnt lgkmcnt(0)
    v_exp_f32 v78, v78
    v_exp_f32 v79, v79
    v_exp_f32 v80, v80
    v_exp_f32 v81, v81
    v_mfma_f32_32x32x8_bf16 v[44:59], v[192:193], v[166:167], 0
    v_exp_f32 v82, v82
    v_exp_f32 v83, v83
    v_exp_f32 v84, v84
    v_exp_f32 v85, v85
    v_smfmac_f32_32x32x32_bf16 v[140:155], v[226:229], v[76:83], v242
    buffer_store_dwordx4 a[240:243], v1, s[20:23], s45 offen offset:0 sc1
    buffer_store_dwordx4 a[244:247], v1, s[20:23], s45 offen offset:1024 sc1
    v_exp_f32 v86, v86
    v_exp_f32 v87, v87
    v_exp_f32 v88, v88
    v_exp_f32 v89, v89
    v_mfma_f32_32x32x16_bf16 v[44:59], v[180:183], v[162:165], v[44:59]
    v_exp_f32 v90, v90
    v_exp_f32 v91, v91
    v_exp_f32 v28, v28
    v_exp_f32 v29, v29
    v_smfmac_f32_32x32x32_bf16 v[140:155], v[230:233], v[84:91], v242
    buffer_load_dwordx4 v[222:225], v1, s[16:19], 0 offen
    buffer_load_dwordx2 v[234:235], v244, s[16:19], 0 offen
    buffer_load_dwordx4 v[226:229], v245, s[16:19], 0 offen
    buffer_load_dwordx4 v[230:233], v246, s[16:19], 0 offen
    v_exp_f32 v30, v30
    v_exp_f32 v31, v31
    v_exp_f32 v32, v32
    v_exp_f32 v33, v33
    v_mfma_f32_32x32x8_bf16 v[60:75], v[192:193], v[172:173], 0
    v_exp_f32 v34, v34
    v_exp_f32 v35, v35
    v_exp_f32 v36, v36
    v_exp_f32 v37, v37
    v_smfmac_f32_32x32x32_bf16 v[92:107], v[184:187], v[28:35], v242
    v_exp_f32 v38, v38
    v_exp_f32 v39, v39
    v_exp_f32 v40, v40
    v_exp_f32 v41, v41
    v_mfma_f32_32x32x16_bf16 v[60:75], v[180:183], v[168:171], v[60:75]
    s_add_u32 s16, s16, 2688
    v_exp_f32 v42, v42
    v_exp_f32 v43, v43
    v_exp_f32 v44, v44
    v_exp_f32 v45, v45
    v_smfmac_f32_32x32x32_bf16 v[92:107], v[188:191], v[36:43], v242
    v_exp_f32 v46, v46
    v_exp_f32 v47, v47
    v_exp_f32 v48, v48
    v_exp_f32 v49, v49
    v_mfma_f32_32x32x8_bf16 v[76:91], v[192:193], v[178:179], 0
    v_exp_f32 v50, v50
    v_exp_f32 v51, v51
    v_exp_f32 v52, v52
    v_exp_f32 v53, v53
    v_smfmac_f32_32x32x32_bf16 v[108:123], v[184:187], v[44:51], v242
    v_exp_f32 v54, v54
    v_exp_f32 v55, v55
    v_exp_f32 v56, v56
    v_exp_f32 v57, v57
    v_mfma_f32_32x32x16_bf16 v[76:91], v[180:183], v[174:177], v[76:91]
    s_waitcnt vmcnt(14)
    v_exp_f32 v58, v58
    v_exp_f32 v59, v59
    v_exp_f32 v60, v60
    v_exp_f32 v61, v61
    v_smfmac_f32_32x32x32_bf16 v[108:123], v[188:191], v[52:59], v242
    s_add_u32 s40, s40, 8192
    v_exp_f32 v62, v62
    v_exp_f32 v63, v63
    v_exp_f32 v64, v64
    v_exp_f32 v65, v65
    v_mfma_f32_32x32x8_bf16 v[28:43], v[206:207], v[160:161], 0
    v_exp_f32 v66, v66
    v_exp_f32 v67, v67
    v_exp_f32 v68, v68
    v_exp_f32 v69, v69
    v_smfmac_f32_32x32x32_bf16 v[124:139], v[184:187], v[60:67], v242
    global_load_dwordx4 a[144:147], v1, s[40:41] offset:-4096 sc1
    global_load_dwordx4 a[148:151], v1, s[40:41] offset:-3072 sc1
    global_load_dwordx4 a[152:155], v1, s[40:41] offset:-2048 sc1
    global_load_dwordx4 a[156:159], v1, s[40:41] offset:-1024 sc1
    v_exp_f32 v70, v70
    v_exp_f32 v71, v71
    v_exp_f32 v72, v72
    v_exp_f32 v73, v73
    v_mfma_f32_32x32x16_bf16 v[28:43], v[194:197], v[156:159], v[28:43]
    v_exp_f32 v74, v74
    v_exp_f32 v75, v75
    v_exp_f32 v76, v76
    v_exp_f32 v77, v77
    v_smfmac_f32_32x32x32_bf16 v[124:139], v[188:191], v[68:75], v242
    v_exp_f32 v78, v78
    v_exp_f32 v79, v79
    v_exp_f32 v80, v80
    v_exp_f32 v81, v81
    v_mfma_f32_32x32x8_bf16 v[44:59], v[206:207], v[166:167], 0
    v_exp_f32 v82, v82
    v_exp_f32 v83, v83
    v_exp_f32 v84, v84
    v_exp_f32 v85, v85
    v_smfmac_f32_32x32x32_bf16 v[140:155], v[184:187], v[76:83], v242
    buffer_store_dwordx4 a[248:251], v1, s[20:23], s45 offen offset:2048 sc1
    buffer_store_dwordx4 a[252:255], v1, s[20:23], s46 offen offset:0 sc1
    v_exp_f32 v86, v86
    v_exp_f32 v87, v87
    v_exp_f32 v88, v88
    v_exp_f32 v89, v89
    v_mfma_f32_32x32x16_bf16 v[44:59], v[194:197], v[162:165], v[44:59]
    v_exp_f32 v90, v90
    v_exp_f32 v91, v91
    v_exp_f32 v28, v28
    v_exp_f32 v29, v29
    v_smfmac_f32_32x32x32_bf16 v[140:155], v[188:191], v[84:91], v242
    buffer_load_dwordx4 v[180:183], v1, s[16:19], 0 offen
    buffer_load_dwordx2 v[192:193], v244, s[16:19], 0 offen
    buffer_load_dwordx4 v[184:187], v245, s[16:19], 0 offen
    buffer_load_dwordx4 v[188:191], v246, s[16:19], 0 offen
    v_exp_f32 v30, v30
    v_exp_f32 v31, v31
    v_exp_f32 v32, v32
    v_exp_f32 v33, v33
    v_mfma_f32_32x32x8_bf16 v[60:75], v[206:207], v[172:173], 0
    v_exp_f32 v34, v34
    v_exp_f32 v35, v35
    v_exp_f32 v36, v36
    v_exp_f32 v37, v37
    v_smfmac_f32_32x32x32_bf16 v[92:107], v[198:201], v[28:35], v242
    v_exp_f32 v38, v38
    v_exp_f32 v39, v39
    v_exp_f32 v40, v40
    v_exp_f32 v41, v41
    v_mfma_f32_32x32x16_bf16 v[60:75], v[194:197], v[168:171], v[60:75]
    s_add_u32 s16, s16, 2688
    v_exp_f32 v42, v42
    v_exp_f32 v43, v43
    v_exp_f32 v44, v44
    v_exp_f32 v45, v45
    v_smfmac_f32_32x32x32_bf16 v[92:107], v[202:205], v[36:43], v242
    v_exp_f32 v46, v46
    v_exp_f32 v47, v47
    v_exp_f32 v48, v48
    v_exp_f32 v49, v49
    v_mfma_f32_32x32x8_bf16 v[76:91], v[206:207], v[178:179], 0
    v_exp_f32 v50, v50
    v_exp_f32 v51, v51
    v_exp_f32 v52, v52
    v_exp_f32 v53, v53
    v_smfmac_f32_32x32x32_bf16 v[108:123], v[198:201], v[44:51], v242
    v_exp_f32 v54, v54
    v_exp_f32 v55, v55
    v_exp_f32 v56, v56
    v_exp_f32 v57, v57
    v_mfma_f32_32x32x16_bf16 v[76:91], v[194:197], v[174:177], v[76:91]
    s_waitcnt vmcnt(16)
    v_exp_f32 v58, v58
    v_exp_f32 v59, v59
    v_exp_f32 v60, v60
    v_exp_f32 v61, v61
    v_smfmac_f32_32x32x32_bf16 v[108:123], v[202:205], v[52:59], v242
    v_exp_f32 v62, v62
    v_exp_f32 v63, v63
    v_exp_f32 v64, v64
    v_exp_f32 v65, v65
    v_mfma_f32_32x32x8_bf16 v[28:43], v[220:221], v[160:161], 0
    v_exp_f32 v66, v66
    v_exp_f32 v67, v67
    v_exp_f32 v68, v68
    v_exp_f32 v69, v69
    v_smfmac_f32_32x32x32_bf16 v[124:139], v[198:201], v[60:67], v242
    global_load_dwordx4 a[160:163], v1, s[40:41] offset:0 sc1
    global_load_dwordx4 a[164:167], v1, s[40:41] offset:1024 sc1
    global_load_dwordx4 a[168:171], v1, s[40:41] offset:2048 sc1
    global_load_dwordx4 a[172:175], v1, s[40:41] offset:3072 sc1
    v_exp_f32 v70, v70
    v_exp_f32 v71, v71
    v_exp_f32 v72, v72
    v_exp_f32 v73, v73
    v_mfma_f32_32x32x16_bf16 v[28:43], v[208:211], v[156:159], v[28:43]
    v_exp_f32 v74, v74
    v_exp_f32 v75, v75
    v_exp_f32 v76, v76
    v_exp_f32 v77, v77
    v_smfmac_f32_32x32x32_bf16 v[124:139], v[202:205], v[68:75], v242
    v_exp_f32 v78, v78
    v_exp_f32 v79, v79
    v_exp_f32 v80, v80
    v_exp_f32 v81, v81
    v_mfma_f32_32x32x8_bf16 v[44:59], v[220:221], v[166:167], 0
    v_exp_f32 v82, v82
    v_exp_f32 v83, v83
    v_exp_f32 v84, v84
    v_exp_f32 v85, v85
    v_smfmac_f32_32x32x32_bf16 v[140:155], v[198:201], v[76:83], v242
    buffer_store_dwordx4 v[236:239], v1, s[20:23], s46 offen offset:1024 sc1
    buffer_store_dwordx4 v[16:19], v1, s[20:23], s47 offen offset:2048 sc1
    v_exp_f32 v86, v86
    v_exp_f32 v87, v87
    v_exp_f32 v88, v88
    v_exp_f32 v89, v89
    v_mfma_f32_32x32x16_bf16 v[44:59], v[208:211], v[162:165], v[44:59]
    v_exp_f32 v90, v90
    v_exp_f32 v91, v91
    v_exp_f32 v28, v28
    v_exp_f32 v29, v29
    v_smfmac_f32_32x32x32_bf16 v[140:155], v[202:205], v[84:91], v242
    buffer_load_dwordx4 v[194:197], v1, s[16:19], 0 offen
    buffer_load_dwordx2 v[206:207], v244, s[16:19], 0 offen
    buffer_load_dwordx4 v[198:201], v245, s[16:19], 0 offen
    buffer_load_dwordx4 v[202:205], v246, s[16:19], 0 offen
    v_exp_f32 v30, v30
    v_exp_f32 v31, v31
    v_exp_f32 v32, v32
    v_exp_f32 v33, v33
    v_mfma_f32_32x32x8_bf16 v[60:75], v[220:221], v[172:173], 0
    v_exp_f32 v34, v34
    v_exp_f32 v35, v35
    v_exp_f32 v36, v36
    v_exp_f32 v37, v37
    v_smfmac_f32_32x32x32_bf16 v[92:107], v[212:215], v[28:35], v242
L_back_stub0_1:
    s_cmp_eq_u32 s0, 1
    s_cbranch_scc1 L_back_wret0
    v_exp_f32 v38, v38
    v_exp_f32 v39, v39
    v_exp_f32 v40, v40
    v_exp_f32 v41, v41
    v_mfma_f32_32x32x16_bf16 v[60:75], v[208:211], v[168:171], v[60:75]
    s_add_u32 s16, s16, 2688
    v_exp_f32 v42, v42
    v_exp_f32 v43, v43
    v_exp_f32 v44, v44
    v_exp_f32 v45, v45
    v_smfmac_f32_32x32x32_bf16 v[92:107], v[216:219], v[36:43], v242
    v_exp_f32 v46, v46
    v_exp_f32 v47, v47
    v_exp_f32 v48, v48
    v_exp_f32 v49, v49
    v_mfma_f32_32x32x8_bf16 v[76:91], v[220:221], v[178:179], 0
    v_exp_f32 v50, v50
    v_exp_f32 v51, v51
    v_exp_f32 v52, v52
    v_exp_f32 v53, v53
    v_smfmac_f32_32x32x32_bf16 v[108:123], v[212:215], v[44:51], v242
    v_exp_f32 v54, v54
    v_exp_f32 v55, v55
    v_exp_f32 v56, v56
    v_exp_f32 v57, v57
    v_mfma_f32_32x32x16_bf16 v[76:91], v[208:211], v[174:177], v[76:91]
    s_waitcnt vmcnt(20)
    v_exp_f32 v58, v58
    v_exp_f32 v59, v59
    v_exp_f32 v60, v60
    v_exp_f32 v61, v61
    v_smfmac_f32_32x32x32_bf16 v[108:123], v[216:219], v[52:59], v242
    v_exp_f32 v62, v62
    v_exp_f32 v63, v63
    v_exp_f32 v64, v64
    v_exp_f32 v65, v65
    v_mfma_f32_32x32x8_bf16 v[28:43], v[234:235], v[160:161], 0
    v_exp_f32 v66, v66
    v_exp_f32 v67, v67
    v_exp_f32 v68, v68
    v_exp_f32 v69, v69
    v_smfmac_f32_32x32x32_bf16 v[124:139], v[212:215], v[60:67], v242
    v_exp_f32 v70, v70
    v_exp_f32 v71, v71
    v_exp_f32 v72, v72
    v_exp_f32 v73, v73
    v_mfma_f32_32x32x16_bf16 v[28:43], v[222:225], v[156:159], v[28:43]
    v_exp_f32 v74, v74
    v_exp_f32 v75, v75
    v_exp_f32 v76, v76
    v_exp_f32 v77, v77
    v_smfmac_f32_32x32x32_bf16 v[124:139], v[216:219], v[68:75], v242
    s_add_u32 s30, s30, 4096
    s_addc_u32 s31, s31, 0
    v_exp_f32 v78, v78
    v_exp_f32 v79, v79
    v_exp_f32 v80, v80
    v_exp_f32 v81, v81
    v_mfma_f32_32x32x8_bf16 v[44:59], v[234:235], v[166:167], 0
    v_exp_f32 v82, v82
    v_exp_f32 v83, v83
    v_exp_f32 v84, v84
    v_exp_f32 v85, v85
    v_smfmac_f32_32x32x32_bf16 v[140:155], v[212:215], v[76:83], v242
    global_load_dword v26, v247, s[30:31]
    v_exp_f32 v86, v86
    v_exp_f32 v87, v87
    v_exp_f32 v88, v88
    v_exp_f32 v89, v89
    v_mfma_f32_32x32x16_bf16 v[44:59], v[222:225], v[162:165], v[44:59]
    v_exp_f32 v90, v90
    v_exp_f32 v91, v91
    v_exp_f32 v28, v28
    v_exp_f32 v29, v29
    v_smfmac_f32_32x32x32_bf16 v[140:155], v[216:219], v[84:91], v242
    buffer_load_dwordx4 v[208:211], v1, s[16:19], 0 offen
    buffer_load_dwordx2 v[220:221], v244, s[16:19], 0 offen
    buffer_load_dwordx4 v[212:215], v245, s[16:19], 0 offen
    buffer_load_dwordx4 v[216:219], v246, s[16:19], 0 offen
    v_exp_f32 v30, v30
    v_exp_f32 v31, v31
    v_exp_f32 v32, v32
    v_exp_f32 v33, v33
    v_mfma_f32_32x32x8_bf16 v[60:75], v[234:235], v[172:173], 0
    v_exp_f32 v34, v34
    v_exp_f32 v35, v35
    v_exp_f32 v36, v36
    v_exp_f32 v37, v37
    v_smfmac_f32_32x32x32_bf16 v[92:107], v[226:229], v[28:35], v242
    v_exp_f32 v38, v38
    v_exp_f32 v39, v39
    v_exp_f32 v40, v40
    v_exp_f32 v41, v41
    v_mfma_f32_32x32x16_bf16 v[60:75], v[222:225], v[168:171], v[60:75]
    s_add_u32 s16, s16, 2688
    v_exp_f32 v42, v42
    v_exp_f32 v43, v43
    v_exp_f32 v44, v44
    v_exp_f32 v45, v45
    v_smfmac_f32_32x32x32_bf16 v[92:107], v[230:233], v[36:43], v242
    v_exp_f32 v46, v46
    v_exp_f32 v47, v47
    v_exp_f32 v48, v48
    v_exp_f32 v49, v49
    v_mfma_f32_32x32x8_bf16 v[76:91], v[234:235], v[178:179], 0
    v_exp_f32 v50, v50
    v_exp_f32 v51, v51
    v_exp_f32 v52, v52
    v_exp_f32 v53, v53
    v_smfmac_f32_32x32x32_bf16 v[108:123], v[226:229], v[44:51], v242
    v_exp_f32 v54, v54
    v_exp_f32 v55, v55
    v_exp_f32 v56, v56
    v_exp_f32 v57, v57
    v_mfma_f32_32x32x16_bf16 v[76:91], v[222:225], v[174:177], v[76:91]
    s_waitcnt vmcnt(15)
    v_exp_f32 v58, v58
    v_exp_f32 v59, v59
    v_exp_f32 v60, v60
    v_exp_f32 v61, v61
    v_smfmac_f32_32x32x32_bf16 v[108:123], v[230:233], v[52:59], v242
    s_add_u32 s40, s40, 8192
    v_exp_f32 v62, v62
    v_exp_f32 v63, v63
    v_exp_f32 v64, v64
    v_exp_f32 v65, v65
    v_mfma_f32_32x32x8_bf16 v[28:43], v[192:193], v[160:161], 0
    v_exp_f32 v66, v66
    v_exp_f32 v67, v67
    v_exp_f32 v68, v68
    v_exp_f32 v69, v69
    v_smfmac_f32_32x32x32_bf16 v[124:139], v[226:229], v[60:67], v242
    global_load_dwordx4 a[176:179], v1, s[40:41] offset:-4096 sc1
    global_load_dwordx4 a[180:183], v1, s[40:41] offset:-3072 sc1
    global_load_dwordx4 a[184:187], v1, s[40:41] offset:-2048 sc1
    global_load_dwordx4 a[188:191], v1, s[40:41] offset:-1024 sc1
    v_exp_f32 v70, v70
    v_exp_f32 v71, v71
    v_exp_f32 v72, v72
    v_exp_f32 v73, v73
    v_mfma_f32_32x32x16_bf16 v[28:43], v[180:183], v[156:159], v[28:43]
    v_exp_f32 v74, v74
    v_exp_f32 v75, v75
    v_exp_f32 v76, v76
    v_exp_f32 v77, v77
    v_smfmac_f32_32x32x32_bf16 v[124:139], v[230:233], v[68:75], v242
    v_exp_f32 v78, v78
    v_exp_f32 v79, v79
    v_exp_f32 v80, v80
    v_exp_f32 v81, v81
    v_mfma_f32_32x32x8_bf16 v[44:59], v[192:193], v[166:167], 0
    v_exp_f32 v82, v82
    v_exp_f32 v83, v83
    v_exp_f32 v84, v84
    v_exp_f32 v85, v85
    v_smfmac_f32_32x32x32_bf16 v[140:155], v[226:229], v[76:83], v242
    v_exp_f32 v86, v86
    v_exp_f32 v87, v87
    v_exp_f32 v88, v88
    v_exp_f32 v89, v89
    v_mfma_f32_32x32x16_bf16 v[44:59], v[180:183], v[162:165], v[44:59]
    v_exp_f32 v90, v90
    v_exp_f32 v91, v91
    v_exp_f32 v28, v28
    v_exp_f32 v29, v29
    v_smfmac_f32_32x32x32_bf16 v[140:155], v[230:233], v[84:91], v242
    buffer_load_dwordx4 v[222:225], v1, s[16:19], 0 offen
    buffer_load_dwordx2 v[234:235], v244, s[16:19], 0 offen
    buffer_load_dwordx4 v[226:229], v245, s[16:19], 0 offen
    buffer_load_dwordx4 v[230:233], v246, s[16:19], 0 offen
    v_exp_f32 v30, v30
    v_exp_f32 v31, v31
    v_exp_f32 v32, v32
    v_exp_f32 v33, v33
    v_mfma_f32_32x32x8_bf16 v[60:75], v[192:193], v[172:173], 0
    v_exp_f32 v34, v34
    v_exp_f32 v35, v35
    v_exp_f32 v36, v36
    v_exp_f32 v37, v37
    v_smfmac_f32_32x32x32_bf16 v[92:107], v[184:187], v[28:35], v242
    v_exp_f32 v38, v38
    v_exp_f32 v39, v39
    v_exp_f32 v40, v40
    v_exp_f32 v41, v41
    v_mfma_f32_32x32x16_bf16 v[60:75], v[180:183], v[168:171], v[60:75]
    s_add_u32 s16, s16, 2688
    v_exp_f32 v42, v42
    v_exp_f32 v43, v43
    v_exp_f32 v44, v44
    v_exp_f32 v45, v45
    v_smfmac_f32_32x32x32_bf16 v[92:107], v[188:191], v[36:43], v242
    v_exp_f32 v46, v46
    v_exp_f32 v47, v47
    v_exp_f32 v48, v48
    v_exp_f32 v49, v49
    v_mfma_f32_32x32x8_bf16 v[76:91], v[192:193], v[178:179], 0
    v_exp_f32 v50, v50
    v_exp_f32 v51, v51
    v_exp_f32 v52, v52
    v_exp_f32 v53, v53
    v_smfmac_f32_32x32x32_bf16 v[108:123], v[184:187], v[44:51], v242
    v_exp_f32 v54, v54
    v_exp_f32 v55, v55
    v_exp_f32 v56, v56
    v_exp_f32 v57, v57
    v_mfma_f32_32x32x16_bf16 v[76:91], v[180:183], v[174:177], v[76:91]
    s_waitcnt vmcnt(13)
    v_exp_f32 v58, v58
    v_exp_f32 v59, v59
    v_exp_f32 v60, v60
    v_exp_f32 v61, v61
    v_smfmac_f32_32x32x32_bf16 v[108:123], v[188:191], v[52:59], v242
    v_exp_f32 v62, v62
    v_exp_f32 v63, v63
    v_exp_f32 v64, v64
    v_exp_f32 v65, v65
    v_mfma_f32_32x32x8_bf16 v[28:43], v[206:207], v[160:161], 0
    v_exp_f32 v66, v66
    v_exp_f32 v67, v67
    v_exp_f32 v68, v68
    v_exp_f32 v69, v69
    v_smfmac_f32_32x32x32_bf16 v[124:139], v[184:187], v[60:67], v242
    v_exp_f32 v70, v70
    v_exp_f32 v71, v71
    v_exp_f32 v72, v72
    v_exp_f32 v73, v73
    v_mfma_f32_32x32x16_bf16 v[28:43], v[194:197], v[156:159], v[28:43]
    v_exp_f32 v74, v74
    v_exp_f32 v75, v75
    v_exp_f32 v76, v76
    v_exp_f32 v77, v77
    v_smfmac_f32_32x32x32_bf16 v[124:139], v[188:191], v[68:75], v242
    v_exp_f32 v78, v78
    v_exp_f32 v79, v79
    v_exp_f32 v80, v80
    v_exp_f32 v81, v81
    v_mfma_f32_32x32x8_bf16 v[44:59], v[206:207], v[166:167], 0
    v_exp_f32 v82, v82
    v_exp_f32 v83, v83
    v_exp_f32 v84, v84
    v_exp_f32 v85, v85
    v_smfmac_f32_32x32x32_bf16 v[140:155], v[184:187], v[76:83], v242
    buffer_store_dword v24, v14, s[20:23], s48 offen sc1
    v_exp_f32 v86, v86
    v_exp_f32 v87, v87
    v_exp_f32 v88, v88
    v_exp_f32 v89, v89
    v_mfma_f32_32x32x16_bf16 v[44:59], v[194:197], v[162:165], v[44:59]
    v_exp_f32 v90, v90
    v_exp_f32 v91, v91
    v_exp_f32 v28, v28
    v_exp_f32 v29, v29
    v_smfmac_f32_32x32x32_bf16 v[140:155], v[188:191], v[84:91], v242
    buffer_load_dwordx4 v[180:183], v1, s[16:19], 0 offen
    buffer_load_dwordx2 v[192:193], v244, s[16:19], 0 offen
    buffer_load_dwordx4 v[184:187], v245, s[16:19], 0 offen
    buffer_load_dwordx4 v[188:191], v246, s[16:19], 0 offen
    v_exp_f32 v30, v30
    v_exp_f32 v31, v31
    v_exp_f32 v32, v32
    v_exp_f32 v33, v33
    v_mfma_f32_32x32x8_bf16 v[60:75], v[206:207], v[172:173], 0
    v_exp_f32 v34, v34
    v_exp_f32 v35, v35
    v_exp_f32 v36, v36
    v_exp_f32 v37, v37
    v_smfmac_f32_32x32x32_bf16 v[92:107], v[198:201], v[28:35], v242
    v_exp_f32 v38, v38
    v_exp_f32 v39, v39
    v_exp_f32 v40, v40
    v_exp_f32 v41, v41
    v_mfma_f32_32x32x16_bf16 v[60:75], v[194:197], v[168:171], v[60:75]
    s_add_u32 s16, s16, 2688
    v_exp_f32 v42, v42
    v_exp_f32 v43, v43
    v_exp_f32 v44, v44
    v_exp_f32 v45, v45
    v_smfmac_f32_32x32x32_bf16 v[92:107], v[202:205], v[36:43], v242
    v_exp_f32 v46, v46
    v_exp_f32 v47, v47
    v_exp_f32 v48, v48
    v_exp_f32 v49, v49
    v_mfma_f32_32x32x8_bf16 v[76:91], v[206:207], v[178:179], 0
    v_exp_f32 v50, v50
    v_exp_f32 v51, v51
    v_exp_f32 v52, v52
    v_exp_f32 v53, v53
    v_smfmac_f32_32x32x32_bf16 v[108:123], v[198:201], v[44:51], v242
    v_exp_f32 v54, v54
    v_exp_f32 v55, v55
    v_exp_f32 v56, v56
    v_exp_f32 v57, v57
    v_mfma_f32_32x32x16_bf16 v[76:91], v[194:197], v[174:177], v[76:91]
    s_waitcnt vmcnt(13)
    v_exp_f32 v58, v58
    v_exp_f32 v59, v59
    v_exp_f32 v60, v60
    v_exp_f32 v61, v61
    v_smfmac_f32_32x32x32_bf16 v[108:123], v[202:205], v[52:59], v242
    v_exp_f32 v62, v62
    v_exp_f32 v63, v63
    v_exp_f32 v64, v64
    v_exp_f32 v65, v65
    v_mfma_f32_32x32x8_bf16 v[28:43], v[220:221], v[160:161], 0
    v_exp_f32 v66, v66
    v_exp_f32 v67, v67
    v_exp_f32 v68, v68
    v_exp_f32 v69, v69
    v_smfmac_f32_32x32x32_bf16 v[124:139], v[198:201], v[60:67], v242
    global_load_dwordx4 a[192:195], v1, s[40:41] offset:0 sc1
    global_load_dwordx4 a[196:199], v1, s[40:41] offset:1024 sc1
    global_load_dwordx4 a[200:203], v1, s[40:41] offset:2048 sc1
    global_load_dwordx4 a[204:207], v1, s[40:41] offset:3072 sc1
    v_exp_f32 v70, v70
    v_exp_f32 v71, v71
    v_exp_f32 v72, v72
    v_exp_f32 v73, v73
    v_mfma_f32_32x32x16_bf16 v[28:43], v[208:211], v[156:159], v[28:43]
    v_exp_f32 v74, v74
    v_exp_f32 v75, v75
    v_exp_f32 v76, v76
    v_exp_f32 v77, v77
    v_smfmac_f32_32x32x32_bf16 v[124:139], v[202:205], v[68:75], v242
    s_add_u32 s30, s30, 4096
    s_addc_u32 s31, s31, 0
    v_exp_f32 v78, v78
    v_exp_f32 v79, v79
    v_exp_f32 v80, v80
    v_exp_f32 v81, v81
    v_mfma_f32_32x32x8_bf16 v[44:59], v[220:221], v[166:167], 0
    v_exp_f32 v82, v82
    v_exp_f32 v83, v83
    v_exp_f32 v84, v84
    v_exp_f32 v85, v85
    v_smfmac_f32_32x32x32_bf16 v[140:155], v[198:201], v[76:83], v242
    global_load_dword v26, v247, s[30:31]
    v_exp_f32 v86, v86
    v_exp_f32 v87, v87
    v_exp_f32 v88, v88
    v_exp_f32 v89, v89
    v_mfma_f32_32x32x16_bf16 v[44:59], v[208:211], v[162:165], v[44:59]
    v_exp_f32 v90, v90
    v_exp_f32 v91, v91
    v_exp_f32 v28, v28
    v_exp_f32 v29, v29
    v_smfmac_f32_32x32x32_bf16 v[140:155], v[202:205], v[84:91], v242
    buffer_load_dwordx4 v[194:197], v1, s[16:19], 0 offen
    buffer_load_dwordx2 v[206:207], v244, s[16:19], 0 offen
    buffer_load_dwordx4 v[198:201], v245, s[16:19], 0 offen
    buffer_load_dwordx4 v[202:205], v246, s[16:19], 0 offen
    v_exp_f32 v30, v30
    v_exp_f32 v31, v31
    v_exp_f32 v32, v32
    v_exp_f32 v33, v33
    v_mfma_f32_32x32x8_bf16 v[60:75], v[220:221], v[172:173], 0
    v_exp_f32 v34, v34
    v_exp_f32 v35, v35
    v_exp_f32 v36, v36
    v_exp_f32 v37, v37
    v_smfmac_f32_32x32x32_bf16 v[92:107], v[212:215], v[28:35], v242
    v_exp_f32 v38, v38
    v_exp_f32 v39, v39
    v_exp_f32 v40, v40
    v_exp_f32 v41, v41
    v_mfma_f32_32x32x16_bf16 v[60:75], v[208:211], v[168:171], v[60:75]
    s_add_u32 s16, s16, 2688
    v_exp_f32 v42, v42
    v_exp_f32 v43, v43
    v_exp_f32 v44, v44
    v_exp_f32 v45, v45
    v_smfmac_f32_32x32x32_bf16 v[92:107], v[216:219], v[36:43], v242
    v_exp_f32 v46, v46
    v_exp_f32 v47, v47
    v_exp_f32 v48, v48
    v_exp_f32 v49, v49
    v_mfma_f32_32x32x8_bf16 v[76:91], v[220:221], v[178:179], 0
    v_exp_f32 v50, v50
    v_exp_f32 v51, v51
    v_exp_f32 v52, v52
    v_exp_f32 v53, v53
    v_smfmac_f32_32x32x32_bf16 v[108:123], v[212:215], v[44:51], v242
    v_exp_f32 v54, v54
    v_exp_f32 v55, v55
    v_exp_f32 v56, v56
    v_exp_f32 v57, v57
    v_mfma_f32_32x32x16_bf16 v[76:91], v[208:211], v[174:177], v[76:91]
    s_waitcnt vmcnt(14)
    v_exp_f32 v58, v58
    v_exp_f32 v59, v59
    v_exp_f32 v60, v60
    v_exp_f32 v61, v61
    v_smfmac_f32_32x32x32_bf16 v[108:123], v[216:219], v[52:59], v242
    s_add_u32 s40, s40, 8192
    v_exp_f32 v62, v62
    v_exp_f32 v63, v63
    v_exp_f32 v64, v64
    v_exp_f32 v65, v65
    v_mfma_f32_32x32x8_bf16 v[28:43], v[234:235], v[160:161], 0
    v_exp_f32 v66, v66
    v_exp_f32 v67, v67
    v_exp_f32 v68, v68
    v_exp_f32 v69, v69
    v_smfmac_f32_32x32x32_bf16 v[124:139], v[212:215], v[60:67], v242
    global_load_dwordx4 a[208:211], v1, s[40:41] offset:-4096 sc1
    global_load_dwordx4 a[212:215], v1, s[40:41] offset:-3072 sc1
    global_load_dwordx4 a[216:219], v1, s[40:41] offset:-2048 sc1
    global_load_dwordx4 a[220:223], v1, s[40:41] offset:-1024 sc1
    v_exp_f32 v70, v70
    v_exp_f32 v71, v71
    v_exp_f32 v72, v72
    v_exp_f32 v73, v73
    v_mfma_f32_32x32x16_bf16 v[28:43], v[222:225], v[156:159], v[28:43]
    v_exp_f32 v74, v74
    v_exp_f32 v75, v75
    v_exp_f32 v76, v76
    v_exp_f32 v77, v77
    v_smfmac_f32_32x32x32_bf16 v[124:139], v[216:219], v[68:75], v242
    v_exp_f32 v78, v78
    v_exp_f32 v79, v79
    v_exp_f32 v80, v80
    v_exp_f32 v81, v81
    v_mfma_f32_32x32x8_bf16 v[44:59], v[234:235], v[166:167], 0
    v_exp_f32 v82, v82
    v_exp_f32 v83, v83
    v_exp_f32 v84, v84
    v_exp_f32 v85, v85
    v_smfmac_f32_32x32x32_bf16 v[140:155], v[212:215], v[76:83], v242
    v_exp_f32 v86, v86
    v_exp_f32 v87, v87
    v_exp_f32 v88, v88
    v_exp_f32 v89, v89
    v_mfma_f32_32x32x16_bf16 v[44:59], v[222:225], v[162:165], v[44:59]
    v_exp_f32 v90, v90
    v_exp_f32 v91, v91
    v_exp_f32 v28, v28
    v_exp_f32 v29, v29
    v_smfmac_f32_32x32x32_bf16 v[140:155], v[216:219], v[84:91], v242
    buffer_load_dwordx4 v[208:211], v1, s[16:19], 0 offen
    buffer_load_dwordx2 v[220:221], v244, s[16:19], 0 offen
    buffer_load_dwordx4 v[212:215], v245, s[16:19], 0 offen
    buffer_load_dwordx4 v[216:219], v246, s[16:19], 0 offen
    v_exp_f32 v30, v30
    v_exp_f32 v31, v31
    v_exp_f32 v32, v32
    v_exp_f32 v33, v33
    v_mfma_f32_32x32x8_bf16 v[60:75], v[234:235], v[172:173], 0
    v_exp_f32 v34, v34
    v_exp_f32 v35, v35
    v_exp_f32 v36, v36
    v_exp_f32 v37, v37
    v_smfmac_f32_32x32x32_bf16 v[92:107], v[226:229], v[28:35], v242
    v_exp_f32 v38, v38
    v_exp_f32 v39, v39
    v_exp_f32 v40, v40
    v_exp_f32 v41, v41
    v_mfma_f32_32x32x16_bf16 v[60:75], v[222:225], v[168:171], v[60:75]
    s_add_u32 s16, s16, 2688
    v_exp_f32 v42, v42
    v_exp_f32 v43, v43
    v_exp_f32 v44, v44
    v_exp_f32 v45, v45
    v_smfmac_f32_32x32x32_bf16 v[92:107], v[230:233], v[36:43], v242
    v_exp_f32 v46, v46
    v_exp_f32 v47, v47
    v_exp_f32 v48, v48
    v_exp_f32 v49, v49
    v_mfma_f32_32x32x8_bf16 v[76:91], v[234:235], v[178:179], 0
    v_exp_f32 v50, v50
    v_exp_f32 v51, v51
    v_exp_f32 v52, v52
    v_exp_f32 v53, v53
    v_smfmac_f32_32x32x32_bf16 v[108:123], v[226:229], v[44:51], v242
    v_exp_f32 v54, v54
    v_exp_f32 v55, v55
    v_exp_f32 v56, v56
    v_exp_f32 v57, v57
    v_mfma_f32_32x32x16_bf16 v[76:91], v[222:225], v[174:177], v[76:91]
    s_waitcnt vmcnt(17)
    v_exp_f32 v58, v58
    v_exp_f32 v59, v59
    v_exp_f32 v60, v60
    v_exp_f32 v61, v61
    v_smfmac_f32_32x32x32_bf16 v[108:123], v[230:233], v[52:59], v242
    v_exp_f32 v62, v62
    v_exp_f32 v63, v63
    v_exp_f32 v64, v64
    v_exp_f32 v65, v65
    v_mfma_f32_32x32x8_bf16 v[28:43], v[192:193], v[160:161], 0
    v_exp_f32 v66, v66
    v_exp_f32 v67, v67
    v_exp_f32 v68, v68
    v_exp_f32 v69, v69
    v_smfmac_f32_32x32x32_bf16 v[124:139], v[226:229], v[60:67], v242
    v_exp_f32 v70, v70
    v_exp_f32 v71, v71
    v_exp_f32 v72, v72
    v_exp_f32 v73, v73
    v_mfma_f32_32x32x16_bf16 v[28:43], v[180:183], v[156:159], v[28:43]
    v_exp_f32 v74, v74
    v_exp_f32 v75, v75
    v_exp_f32 v76, v76
    v_exp_f32 v77, v77
    v_smfmac_f32_32x32x32_bf16 v[124:139], v[230:233], v[68:75], v242
    v_exp_f32 v78, v78
    v_exp_f32 v79, v79
    v_exp_f32 v80, v80
    v_exp_f32 v81, v81
    v_mfma_f32_32x32x8_bf16 v[44:59], v[192:193], v[166:167], 0
    v_exp_f32 v82, v82
    v_exp_f32 v83, v83
    v_exp_f32 v84, v84
    v_exp_f32 v85, v85
    v_smfmac_f32_32x32x32_bf16 v[140:155], v[226:229], v[76:83], v242
    buffer_load_dword v25, v253, s[20:23], s52 offen sc1
    v_exp_f32 v86, v86
    v_exp_f32 v87, v87
    v_exp_f32 v88, v88
    v_exp_f32 v89, v89
    v_mfma_f32_32x32x16_bf16 v[44:59], v[180:183], v[162:165], v[44:59]
    v_exp_f32 v90, v90
    v_exp_f32 v91, v91
    v_exp_f32 v28, v28
    v_exp_f32 v29, v29
    v_smfmac_f32_32x32x32_bf16 v[140:155], v[230:233], v[84:91], v242
    buffer_load_dwordx4 v[222:225], v1, s[16:19], 0 offen
    buffer_load_dwordx2 v[234:235], v244, s[16:19], 0 offen
    buffer_load_dwordx4 v[226:229], v245, s[16:19], 0 offen
    buffer_load_dwordx4 v[230:233], v246, s[16:19], 0 offen
    v_exp_f32 v30, v30
    v_exp_f32 v31, v31
    v_exp_f32 v32, v32
    v_exp_f32 v33, v33
    v_mfma_f32_32x32x8_bf16 v[60:75], v[192:193], v[172:173], 0
    v_exp_f32 v34, v34
    v_exp_f32 v35, v35
    v_exp_f32 v36, v36
    v_exp_f32 v37, v37
    v_smfmac_f32_32x32x32_bf16 v[92:107], v[184:187], v[28:35], v242
    v_exp_f32 v38, v38
    v_exp_f32 v39, v39
    v_exp_f32 v40, v40
    v_exp_f32 v41, v41
    v_mfma_f32_32x32x16_bf16 v[60:75], v[180:183], v[168:171], v[60:75]
    s_add_u32 s16, s16, 2688
    v_exp_f32 v42, v42
    v_exp_f32 v43, v43
    v_exp_f32 v44, v44
    v_exp_f32 v45, v45
    v_smfmac_f32_32x32x32_bf16 v[92:107], v[188:191], v[36:43], v242
    v_exp_f32 v46, v46
    v_exp_f32 v47, v47
    v_exp_f32 v48, v48
    v_exp_f32 v49, v49
    v_mfma_f32_32x32x8_bf16 v[76:91], v[192:193], v[178:179], 0
    v_exp_f32 v50, v50
    v_exp_f32 v51, v51
    v_exp_f32 v52, v52
    v_exp_f32 v53, v53
    v_smfmac_f32_32x32x32_bf16 v[108:123], v[184:187], v[44:51], v242
    v_exp_f32 v54, v54
    v_exp_f32 v55, v55
    v_exp_f32 v56, v56
    v_exp_f32 v57, v57
    v_mfma_f32_32x32x16_bf16 v[76:91], v[180:183], v[174:177], v[76:91]
    s_waitcnt vmcnt(13)
    v_exp_f32 v58, v58
    v_exp_f32 v59, v59
    v_exp_f32 v60, v60
    v_exp_f32 v61, v61
    v_smfmac_f32_32x32x32_bf16 v[108:123], v[188:191], v[52:59], v242
    v_exp_f32 v62, v62
    v_exp_f32 v63, v63
    v_exp_f32 v64, v64
    v_exp_f32 v65, v65
    v_mfma_f32_32x32x8_bf16 v[28:43], v[206:207], v[160:161], 0
    v_exp_f32 v66, v66
    v_exp_f32 v67, v67
    v_exp_f32 v68, v68
    v_exp_f32 v69, v69
    v_smfmac_f32_32x32x32_bf16 v[124:139], v[184:187], v[60:67], v242
    global_load_dwordx4 a[224:227], v1, s[40:41] offset:0 sc1
    global_load_dwordx4 a[228:231], v1, s[40:41] offset:1024 sc1
    global_load_dwordx4 a[232:235], v1, s[40:41] offset:2048 sc1
    global_load_dwordx4 a[236:239], v1, s[40:41] offset:3072 sc1
    v_exp_f32 v70, v70
    v_exp_f32 v71, v71
    v_exp_f32 v72, v72
    v_exp_f32 v73, v73
    v_mfma_f32_32x32x16_bf16 v[28:43], v[194:197], v[156:159], v[28:43]
    v_exp_f32 v74, v74
    v_exp_f32 v75, v75
    v_exp_f32 v76, v76
    v_exp_f32 v77, v77
    v_smfmac_f32_32x32x32_bf16 v[124:139], v[188:191], v[68:75], v242
    v_exp_f32 v78, v78
    v_exp_f32 v79, v79
    v_exp_f32 v80, v80
    v_exp_f32 v81, v81
    v_mfma_f32_32x32x8_bf16 v[44:59], v[206:207], v[166:167], 0
    v_exp_f32 v82, v82
    v_exp_f32 v83, v83
    v_exp_f32 v84, v84
    v_exp_f32 v85, v85
    v_smfmac_f32_32x32x32_bf16 v[140:155], v[184:187], v[76:83], v242
    v_exp_f32 v86, v86
    v_exp_f32 v87, v87
    v_exp_f32 v88, v88
    v_exp_f32 v89, v89
    v_mfma_f32_32x32x16_bf16 v[44:59], v[194:197], v[162:165], v[44:59]
    v_exp_f32 v90, v90
    v_exp_f32 v91, v91
    v_exp_f32 v28, v28
    v_exp_f32 v29, v29
    v_smfmac_f32_32x32x32_bf16 v[140:155], v[188:191], v[84:91], v242
    buffer_load_dwordx4 v[180:183], v1, s[16:19], 0 offen
    buffer_load_dwordx2 v[192:193], v244, s[16:19], 0 offen
    buffer_load_dwordx4 v[184:187], v245, s[16:19], 0 offen
    buffer_load_dwordx4 v[188:191], v246, s[16:19], 0 offen
    v_exp_f32 v30, v30
    v_exp_f32 v31, v31
    v_exp_f32 v32, v32
    v_exp_f32 v33, v33
    v_mfma_f32_32x32x8_bf16 v[60:75], v[206:207], v[172:173], 0
    v_exp_f32 v34, v34
    v_exp_f32 v35, v35
    v_exp_f32 v36, v36
    v_exp_f32 v37, v37
    v_smfmac_f32_32x32x32_bf16 v[92:107], v[198:201], v[28:35], v242
    v_exp_f32 v38, v38
    v_exp_f32 v39, v39
    v_exp_f32 v40, v40
    v_exp_f32 v41, v41
    v_mfma_f32_32x32x16_bf16 v[60:75], v[194:197], v[168:171], v[60:75]
    s_add_u32 s16, s16, 2688
    v_exp_f32 v42, v42
    v_exp_f32 v43, v43
    v_exp_f32 v44, v44
    v_exp_f32 v45, v45
    v_smfmac_f32_32x32x32_bf16 v[92:107], v[202:205], v[36:43], v242
    v_exp_f32 v46, v46
    v_exp_f32 v47, v47
    v_exp_f32 v48, v48
    v_exp_f32 v49, v49
    v_mfma_f32_32x32x8_bf16 v[76:91], v[206:207], v[178:179], 0
    v_exp_f32 v50, v50
    v_exp_f32 v51, v51
    v_exp_f32 v52, v52
    v_exp_f32 v53, v53
    v_smfmac_f32_32x32x32_bf16 v[108:123], v[198:201], v[44:51], v242
    v_exp_f32 v54, v54
    v_exp_f32 v55, v55
    v_exp_f32 v56, v56
    v_exp_f32 v57, v57
    v_mfma_f32_32x32x16_bf16 v[76:91], v[194:197], v[174:177], v[76:91]
    s_waitcnt vmcnt(13)
    v_exp_f32 v58, v58
    v_exp_f32 v59, v59
    v_exp_f32 v60, v60
    v_exp_f32 v61, v61
    v_smfmac_f32_32x32x32_bf16 v[108:123], v[202:205], v[52:59], v242
    v_exp_f32 v62, v62
    v_exp_f32 v63, v63
    v_exp_f32 v64, v64
    v_exp_f32 v65, v65
    v_mfma_f32_32x32x8_bf16 v[28:43], v[220:221], v[160:161], 0
    v_exp_f32 v66, v66
    v_exp_f32 v67, v67
    v_exp_f32 v68, v68
    v_exp_f32 v69, v69
    v_smfmac_f32_32x32x32_bf16 v[124:139], v[198:201], v[60:67], v242
    v_exp_f32 v70, v70
    v_exp_f32 v71, v71
    v_exp_f32 v72, v72
    v_exp_f32 v73, v73
    v_mfma_f32_32x32x16_bf16 v[28:43], v[208:211], v[156:159], v[28:43]
    v_exp_f32 v74, v74
    v_exp_f32 v75, v75
    v_exp_f32 v76, v76
    v_exp_f32 v77, v77
    v_smfmac_f32_32x32x32_bf16 v[124:139], v[202:205], v[68:75], v242
    s_waitcnt vmcnt(12)
    v_exp_f32 v78, v78
    v_exp_f32 v79, v79
    v_exp_f32 v80, v80
    v_exp_f32 v81, v81
    v_mfma_f32_32x32x8_bf16 v[44:59], v[220:221], v[166:167], 0
    v_exp_f32 v82, v82
    v_exp_f32 v83, v83
    v_exp_f32 v84, v84
    v_exp_f32 v85, v85
    v_smfmac_f32_32x32x32_bf16 v[140:155], v[198:201], v[76:83], v242
    v_cmp_eq_u32 vcc, 0, v25
    s_cbranch_vccnz L_back_poll_3
L_back_ok_4:
    v_exp_f32 v86, v86
    v_exp_f32 v87, v87
    v_exp_f32 v88, v88
    v_exp_f32 v89, v89
    v_mfma_f32_32x32x16_bf16 v[44:59], v[208:211], v[162:165], v[44:59]
    v_exp_f32 v90, v90
    v_exp_f32 v91, v91
    v_exp_f32 v28, v28
    v_exp_f32 v29, v29
    v_smfmac_f32_32x32x32_bf16 v[140:155], v[202:205], v[84:91], v242
    buffer_load_dwordx4 v[194:197], v1, s[16:19], 0 offen
    buffer_load_dwordx2 v[206:207], v244, s[16:19], 0 offen
    buffer_load_dwordx4 v[198:201], v245, s[16:19], 0 offen
    buffer_load_dwordx4 v[202:205], v246, s[16:19], 0 offen
    v_exp_f32 v30, v30
    v_exp_f32 v31, v31
    v_exp_f32 v32, v32
    v_exp_f32 v33, v33
    v_mfma_f32_32x32x8_bf16 v[60:75], v[220:221], v[172:173], 0
    v_exp_f32 v34, v34
    v_exp_f32 v35, v35
    v_exp_f32 v36, v36
    v_exp_f32 v37, v37
    v_smfmac_f32_32x32x32_bf16 v[92:107], v[212:215], v[28:35], v242
    v_exp_f32 v38, v38
    v_exp_f32 v39, v39
    v_exp_f32 v40, v40
    v_exp_f32 v41, v41
    v_mfma_f32_32x32x16_bf16 v[60:75], v[208:211], v[168:171], v[60:75]
    s_add_u32 s16, s16, 2688
    v_exp_f32 v42, v42
    v_exp_f32 v43, v43
    v_exp_f32 v44, v44
    v_exp_f32 v45, v45
    v_smfmac_f32_32x32x32_bf16 v[92:107], v[216:219], v[36:43], v242
    s_sub_u32 s40, s40, 53248
    v_exp_f32 v46, v46
    v_exp_f32 v47, v47
    v_exp_f32 v48, v48
    v_exp_f32 v49, v49
    v_mfma_f32_32x32x8_bf16 v[76:91], v[220:221], v[178:179], 0
    v_exp_f32 v50, v50
    v_exp_f32 v51, v51
    v_exp_f32 v52, v52
    v_exp_f32 v53, v53
    v_smfmac_f32_32x32x32_bf16 v[108:123], v[212:215], v[44:51], v242
    global_load_dwordx4 a[0:3], v1, s[40:41] offset:-4096 sc1
    global_load_dwordx4 a[4:7], v1, s[40:41] offset:-3072 sc1
    global_load_dwordx4 a[8:11], v1, s[40:41] offset:-2048 sc1
    global_load_dwordx4 a[12:15], v1, s[40:41] offset:-1024 sc1
    v_exp_f32 v54, v54
    v_exp_f32 v55, v55
    v_exp_f32 v56, v56
    v_exp_f32 v57, v57
    v_mfma_f32_32x32x16_bf16 v[76:91], v[208:211], v[174:177], v[76:91]
    s_waitcnt vmcnt(16)
    v_exp_f32 v58, v58
    v_exp_f32 v59, v59
    v_exp_f32 v60, v60
    v_exp_f32 v61, v61
    v_smfmac_f32_32x32x32_bf16 v[108:123], v[216:219], v[52:59], v242
    v_exp_f32 v62, v62
    v_exp_f32 v63, v63
    v_exp_f32 v64, v64
    v_exp_f32 v65, v65
    v_mfma_f32_32x32x8_bf16 v[28:43], v[234:235], v[160:161], 0
    v_exp_f32 v66, v66
    v_exp_f32 v67, v67
    v_exp_f32 v68, v68
    v_exp_f32 v69, v69
    v_smfmac_f32_32x32x32_bf16 v[124:139], v[212:215], v[60:67], v242
    global_load_dwordx4 a[16:19], v1, s[40:41] offset:0 sc1
    global_load_dwordx4 a[20:23], v1, s[40:41] offset:1024 sc1
    global_load_dwordx4 a[24:27], v1, s[40:41] offset:2048 sc1
    global_load_dwordx4 a[28:31], v1, s[40:41] offset:3072 sc1
    v_exp_f32 v70, v70
    v_exp_f32 v71, v71
    v_exp_f32 v72, v72
    v_exp_f32 v73, v73
    v_mfma_f32_32x32x16_bf16 v[28:43], v[222:225], v[156:159], v[28:43]
    v_exp_f32 v74, v74
    v_exp_f32 v75, v75
    v_exp_f32 v76, v76
    v_exp_f32 v77, v77
    v_smfmac_f32_32x32x32_bf16 v[124:139], v[216:219], v[68:75], v242
    v_exp_f32 v78, v78
    v_exp_f32 v79, v79
    v_exp_f32 v80, v80
    v_exp_f32 v81, v81
    v_mfma_f32_32x32x8_bf16 v[44:59], v[234:235], v[166:167], 0
    v_exp_f32 v82, v82
    v_exp_f32 v83, v83
    v_exp_f32 v84, v84
    v_exp_f32 v85, v85
    v_smfmac_f32_32x32x32_bf16 v[140:155], v[212:215], v[76:83], v242
    v_exp_f32 v86, v86
    v_exp_f32 v87, v87
    v_exp_f32 v88, v88
    v_exp_f32 v89, v89
    v_mfma_f32_32x32x16_bf16 v[44:59], v[222:225], v[162:165], v[44:59]
    v_exp_f32 v90, v90
    v_exp_f32 v91, v91
    v_exp_f32 v28, v28
L_back_stub0_2:
    s_cmp_eq_u32 s0, 1
    s_cbranch_scc1 L_back_wret0
    v_exp_f32 v29, v29
    v_smfmac_f32_32x32x32_bf16 v[140:155], v[216:219], v[84:91], v242
    buffer_load_dwordx4 v[208:211], v1, s[16:19], 0 offen
    buffer_load_dwordx2 v[220:221], v244, s[16:19], 0 offen
    buffer_load_dwordx4 v[212:215], v245, s[16:19], 0 offen
    buffer_load_dwordx4 v[216:219], v246, s[16:19], 0 offen
    v_exp_f32 v30, v30
    v_exp_f32 v31, v31
    v_exp_f32 v32, v32
    v_exp_f32 v33, v33
    v_mfma_f32_32x32x8_bf16 v[60:75], v[234:235], v[172:173], 0
    v_exp_f32 v34, v34
    v_exp_f32 v35, v35
    v_exp_f32 v36, v36
    v_exp_f32 v37, v37
    v_smfmac_f32_32x32x32_bf16 v[92:107], v[226:229], v[28:35], v242
    v_exp_f32 v38, v38
    v_exp_f32 v39, v39
    v_exp_f32 v40, v40
    v_exp_f32 v41, v41
    v_mfma_f32_32x32x16_bf16 v[60:75], v[222:225], v[168:171], v[60:75]
    s_add_u32 s16, s16, 2688
    v_exp_f32 v42, v42
    v_exp_f32 v43, v43
    v_exp_f32 v44, v44
    v_exp_f32 v45, v45
    v_smfmac_f32_32x32x32_bf16 v[92:107], v[230:233], v[36:43], v242
    v_exp_f32 v46, v46
    v_exp_f32 v47, v47
    v_exp_f32 v48, v48
    v_exp_f32 v49, v49
    v_mfma_f32_32x32x8_bf16 v[76:91], v[234:235], v[178:179], 0
    v_exp_f32 v50, v50
    v_exp_f32 v51, v51
    v_exp_f32 v52, v52
    v_exp_f32 v53, v53
    v_smfmac_f32_32x32x32_bf16 v[108:123], v[226:229], v[44:51], v242
    v_exp_f32 v54, v54
    v_exp_f32 v55, v55
    v_exp_f32 v56, v56
    v_exp_f32 v57, v57
    v_mfma_f32_32x32x16_bf16 v[76:91], v[222:225], v[174:177], v[76:91]
    s_waitcnt vmcnt(16)
    v_exp_f32 v58, v58
    v_exp_f32 v59, v59
    v_exp_f32 v60, v60
    v_exp_f32 v61, v61
    v_smfmac_f32_32x32x32_bf16 v[108:123], v[230:233], v[52:59], v242
    s_add_u32 s40, s40, 8192
    v_exp_f32 v62, v62
    v_exp_f32 v63, v63
    v_exp_f32 v64, v64
    v_exp_f32 v65, v65
    v_mfma_f32_32x32x8_bf16 v[28:43], v[192:193], v[160:161], 0
    v_exp_f32 v66, v66
    v_exp_f32 v67, v67
    v_exp_f32 v68, v68
    v_exp_f32 v69, v69
    v_smfmac_f32_32x32x32_bf16 v[124:139], v[226:229], v[60:67], v242
    global_load_dwordx4 a[32:35], v1, s[40:41] offset:-4096 sc1
    global_load_dwordx4 a[36:39], v1, s[40:41] offset:-3072 sc1
    global_load_dwordx4 a[40:43], v1, s[40:41] offset:-2048 sc1
    global_load_dwordx4 a[44:47], v1, s[40:41] offset:-1024 sc1
    v_exp_f32 v70, v70
    v_exp_f32 v71, v71
    v_exp_f32 v72, v72
    v_exp_f32 v73, v73
    v_mfma_f32_32x32x16_bf16 v[28:43], v[180:183], v[156:159], v[28:43]
    v_exp_f32 v74, v74
    v_exp_f32 v75, v75
    v_exp_f32 v76, v76
    v_exp_f32 v77, v77
    v_smfmac_f32_32x32x32_bf16 v[124:139], v[230:233], v[68:75], v242
    v_exp_f32 v78, v78
    v_exp_f32 v79, v79
    v_exp_f32 v80, v80
    v_exp_f32 v81, v81
    v_mfma_f32_32x32x8_bf16 v[44:59], v[192:193], v[166:167], 0
    v_exp_f32 v82, v82
    v_exp_f32 v83, v83
    v_exp_f32 v84, v84
    v_exp_f32 v85, v85
    v_smfmac_f32_32x32x32_bf16 v[140:155], v[226:229], v[76:83], v242
    v_exp_f32 v86, v86
    v_exp_f32 v87, v87
    v_exp_f32 v88, v88
    v_exp_f32 v89, v89
    v_mfma_f32_32x32x16_bf16 v[44:59], v[180:183], v[162:165], v[44:59]
    v_exp_f32 v90, v90
    v_exp_f32 v91, v91
    v_exp_f32 v28, v28
    v_exp_f32 v29, v29
    v_smfmac_f32_32x32x32_bf16 v[140:155], v[230:233], v[84:91], v242
    buffer_load_dwordx4 v[222:225], v1, s[16:19], 0 offen
    buffer_load_dwordx2 v[234:235], v244, s[16:19], 0 offen
    buffer_load_dwordx4 v[226:229], v245, s[16:19], 0 offen
    buffer_load_dwordx4 v[230:233], v246, s[16:19], 0 offen
    v_exp_f32 v30, v30
    v_exp_f32 v31, v31
    v_exp_f32 v32, v32
    v_exp_f32 v33, v33
    v_mfma_f32_32x32x8_bf16 v[60:75], v[192:193], v[172:173], 0
    v_exp_f32 v34, v34
    v_exp_f32 v35, v35
    v_exp_f32 v36, v36
    v_exp_f32 v37, v37
    v_smfmac_f32_32x32x32_bf16 v[92:107], v[184:187], v[28:35], v242
    v_exp_f32 v38, v38
    v_exp_f32 v39, v39
    v_exp_f32 v40, v40
    v_exp_f32 v41, v41
    v_mfma_f32_32x32x16_bf16 v[60:75], v[180:183], v[168:171], v[60:75]
    s_add_u32 s16, s16, 2688
    v_exp_f32 v42, v42
    v_exp_f32 v43, v43
    v_exp_f32 v44, v44
    v_exp_f32 v45, v45
    v_smfmac_f32_32x32x32_bf16 v[92:107], v[188:191], v[36:43], v242
    v_exp_f32 v46, v46
    v_exp_f32 v47, v47
    v_exp_f32 v48, v48
    v_exp_f32 v49, v49
    v_mfma_f32_32x32x8_bf16 v[76:91], v[192:193], v[178:179], 0
    v_exp_f32 v50, v50
    v_exp_f32 v51, v51
    v_exp_f32 v52, v52
    v_exp_f32 v53, v53
    v_smfmac_f32_32x32x32_bf16 v[108:123], v[184:187], v[44:51], v242
    v_exp_f32 v54, v54
    v_exp_f32 v55, v55
    v_exp_f32 v56, v56
    v_exp_f32 v57, v57
    v_mfma_f32_32x32x16_bf16 v[76:91], v[180:183], v[174:177], v[76:91]
    s_waitcnt vmcnt(20)
    v_exp_f32 v58, v58
    v_exp_f32 v59, v59
    v_exp_f32 v60, v60
    v_exp_f32 v61, v61
    v_smfmac_f32_32x32x32_bf16 v[108:123], v[188:191], v[52:59], v242
    s_add_u32 m0, s38, 0
    v_exp_f32 v62, v62
    v_exp_f32 v63, v63
    v_exp_f32 v64, v64
    v_exp_f32 v65, v65
    v_mfma_f32_32x32x8_bf16 v[28:43], v[206:207], v[160:161], 0
    v_exp_f32 v66, v66
    v_exp_f32 v67, v67
    v_exp_f32 v68, v68
    v_exp_f32 v69, v69
    v_smfmac_f32_32x32x32_bf16 v[124:139], v[184:187], v[60:67], v242
    global_load_lds_dwordx4 v1, s[34:35] offset:0 sc1
    global_load_lds_dwordx4 v1, s[34:35] offset:1024 sc1
    global_load_lds_dwordx4 v1, s[34:35] offset:2048 sc1
    global_load_lds_dwordx4 v1, s[34:35] offset:3072 sc1
    v_exp_f32 v70, v70
    v_exp_f32 v71, v71
    v_exp_f32 v72, v72
    v_exp_f32 v73, v73
    v_mfma_f32_32x32x16_bf16 v[28:43], v[194:197], v[156:159], v[28:43]
    v_exp_f32 v74, v74
    v_exp_f32 v75, v75
    v_exp_f32 v76, v76
    v_exp_f32 v77, v77
    v_smfmac_f32_32x32x32_bf16 v[124:139], v[188:191], v[68:75], v242
    s_add_u32 m0, s97, 0
    v_exp_f32 v78, v78
    v_exp_f32 v79, v79
    v_exp_f32 v80, v80
    v_exp_f32 v81, v81
    v_mfma_f32_32x32x8_bf16 v[44:59], v[206:207], v[166:167], 0
    v_exp_f32 v82, v82
    v_exp_f32 v83, v83
    v_exp_f32 v84, v84
    v_exp_f32 v85, v85
    v_smfmac_f32_32x32x32_bf16 v[140:155], v[184:187], v[76:83], v242
    global_load_lds_dwordx4 v248, s[4:5]
    v_exp_f32 v86, v86
    v_exp_f32 v87, v87
    v_exp_f32 v88, v88
    v_exp_f32 v89, v89
    v_mfma_f32_32x32x16_bf16 v[44:59], v[194:197], v[162:165], v[44:59]
    v_exp_f32 v90, v90
    v_exp_f32 v91, v91
    v_exp_f32 v28, v28
    v_exp_f32 v29, v29
    v_smfmac_f32_32x32x32_bf16 v[140:155], v[188:191], v[84:91], v242
    buffer_load_dwordx4 v[180:183], v1, s[16:19], 0 offen
    buffer_load_dwordx2 v[192:193], v244, s[16:19], 0 offen
    buffer_load_dwordx4 v[184:187], v245, s[16:19], 0 offen
    buffer_load_dwordx4 v[188:191], v246, s[16:19], 0 offen
    v_exp_f32 v30, v30
    v_exp_f32 v31, v31
    v_exp_f32 v32, v32
    v_exp_f32 v33, v33
    v_mfma_f32_32x32x8_bf16 v[60:75], v[206:207], v[172:173], 0
    v_exp_f32 v34, v34
    v_exp_f32 v35, v35
    v_exp_f32 v36, v36
    v_exp_f32 v37, v37
    v_smfmac_f32_32x32x32_bf16 v[92:107], v[198:201], v[28:35], v242
    v_exp_f32 v38, v38
    v_exp_f32 v39, v39
    v_exp_f32 v40, v40
    v_exp_f32 v41, v41
    v_mfma_f32_32x32x16_bf16 v[60:75], v[194:197], v[168:171], v[60:75]
    s_add_u32 s16, s16, 2688
    v_exp_f32 v42, v42
    v_exp_f32 v43, v43
    v_exp_f32 v44, v44
    v_exp_f32 v45, v45
    v_smfmac_f32_32x32x32_bf16 v[92:107], v[202:205], v[36:43], v242
    v_exp_f32 v46, v46
    v_exp_f32 v47, v47
    v_exp_f32 v48, v48
    v_exp_f32 v49, v49
    v_mfma_f32_32x32x8_bf16 v[76:91], v[206:207], v[178:179], 0
    v_exp_f32 v50, v50
    v_exp_f32 v51, v51
    v_exp_f32 v52, v52
    v_exp_f32 v53, v53
    v_smfmac_f32_32x32x32_bf16 v[108:123], v[198:201], v[44:51], v242
    v_exp_f32 v54, v54
    v_exp_f32 v55, v55
    v_exp_f32 v56, v56
    v_exp_f32 v57, v57
    v_mfma_f32_32x32x16_bf16 v[76:91], v[194:197], v[174:177], v[76:91]
    s_waitcnt vmcnt(17)
    v_exp_f32 v58, v58
    v_exp_f32 v59, v59
    v_exp_f32 v60, v60
    v_exp_f32 v61, v61
    v_smfmac_f32_32x32x32_bf16 v[108:123], v[202:205], v[52:59], v242
    s_add_u32 m0, s38, 4096
    s_add_u32 s34, s34, 4096
    v_exp_f32 v62, v62
    v_exp_f32 v63, v63
    v_exp_f32 v64, v64
    v_exp_f32 v65, v65
    v_mfma_f32_32x32x8_bf16 v[28:43], v[220:221], v[160:161], 0
    v_exp_f32 v66, v66
    v_exp_f32 v67, v67
    v_exp_f32 v68, v68
    v_exp_f32 v69, v69
    v_smfmac_f32_32x32x32_bf16 v[124:139], v[198:201], v[60:67], v242
    global_load_lds_dwordx4 v1, s[34:35] offset:0 sc1
    global_load_lds_dwordx4 v1, s[34:35] offset:1024 sc1
    global_load_lds_dwordx4 v1, s[34:35] offset:2048 sc1
    global_load_lds_dwordx4 v1, s[34:35] offset:3072 sc1
    v_exp_f32 v70, v70
    v_exp_f32 v71, v71
    v_exp_f32 v72, v72
    v_exp_f32 v73, v73
    v_mfma_f32_32x32x16_bf16 v[28:43], v[208:211], v[156:159], v[28:43]
    v_exp_f32 v74, v74
    v_exp_f32 v75, v75
    v_exp_f32 v76, v76
    v_exp_f32 v77, v77
    v_smfmac_f32_32x32x32_bf16 v[124:139], v[202:205], v[68:75], v242
    s_add_u32 m0, s97, 1024
    v_exp_f32 v78, v78
    v_exp_f32 v79, v79
    v_exp_f32 v80, v80
    v_exp_f32 v81, v81
    v_mfma_f32_32x32x8_bf16 v[44:59], v[220:221], v[166:167], 0
    v_exp_f32 v82, v82
    v_exp_f32 v83, v83
    v_exp_f32 v84, v84
    v_exp_f32 v85, v85
    v_smfmac_f32_32x32x32_bf16 v[140:155], v[198:201], v[76:83], v242
    global_load_lds_dwordx4 v249, s[4:5]
    v_exp_f32 v86, v86
    v_exp_f32 v87, v87
    v_exp_f32 v88, v88
    v_exp_f32 v89, v89
    v_mfma_f32_32x32x16_bf16 v[44:59], v[208:211], v[162:165], v[44:59]
    v_exp_f32 v90, v90
    v_exp_f32 v91, v91
    v_exp_f32 v28, v28
    v_exp_f32 v29, v29
    v_smfmac_f32_32x32x32_bf16 v[140:155], v[202:205], v[84:91], v242
    buffer_load_dwordx4 v[194:197], v1, s[16:19], 0 offen
    buffer_load_dwordx2 v[206:207], v244, s[16:19], 0 offen
    buffer_load_dwordx4 v[198:201], v245, s[16:19], 0 offen
    buffer_load_dwordx4 v[202:205], v246, s[16:19], 0 offen
    v_exp_f32 v30, v30
    v_exp_f32 v31, v31
    v_exp_f32 v32, v32
    v_exp_f32 v33, v33
    v_mfma_f32_32x32x8_bf16 v[60:75], v[220:221], v[172:173], 0
    v_exp_f32 v34, v34
    v_exp_f32 v35, v35
    v_exp_f32 v36, v36
    v_exp_f32 v37, v37
    v_smfmac_f32_32x32x32_bf16 v[92:107], v[212:215], v[28:35], v242
    v_exp_f32 v38, v38
    v_exp_f32 v39, v39
    v_exp_f32 v40, v40
    v_exp_f32 v41, v41
    v_mfma_f32_32x32x16_bf16 v[60:75], v[208:211], v[168:171], v[60:75]
    s_add_u32 s16, s16, 2688
    v_exp_f32 v42, v42
    v_exp_f32 v43, v43
    v_exp_f32 v44, v44
    v_exp_f32 v45, v45
    v_smfmac_f32_32x32x32_bf16 v[92:107], v[216:219], v[36:43], v242
    v_exp_f32 v46, v46
    v_exp_f32 v47, v47
    v_exp_f32 v48, v48
    v_exp_f32 v49, v49
    v_mfma_f32_32x32x8_bf16 v[76:91], v[220:221], v[178:179], 0
    v_exp_f32 v50, v50
    v_exp_f32 v51, v51
    v_exp_f32 v52, v52
    v_exp_f32 v53, v53
    v_smfmac_f32_32x32x32_bf16 v[108:123], v[212:215], v[44:51], v242
    v_exp_f32 v54, v54
    v_exp_f32 v55, v55
    v_exp_f32 v56, v56
    v_exp_f32 v57, v57
    v_mfma_f32_32x32x16_bf16 v[76:91], v[208:211], v[174:177], v[76:91]
    s_waitcnt vmcnt(18)
    v_exp_f32 v58, v58
    v_exp_f32 v59, v59
    v_exp_f32 v60, v60
    v_exp_f32 v61, v61
    v_smfmac_f32_32x32x32_bf16 v[108:123], v[216:219], v[52:59], v242
    s_add_u32 m0, s38, 8192
    s_add_u32 s34, s34, 4096
    v_exp_f32 v62, v62
    v_exp_f32 v63, v63
    v_exp_f32 v64, v64
    v_exp_f32 v65, v65
    v_mfma_f32_32x32x8_bf16 v[28:43], v[234:235], v[160:161], 0
    v_exp_f32 v66, v66
    v_exp_f32 v67, v67
    v_exp_f32 v68, v68
    v_exp_f32 v69, v69
    v_smfmac_f32_32x32x32_bf16 v[124:139], v[212:215], v[60:67], v242
    global_load_lds_dwordx4 v1, s[34:35] offset:0 sc1
    global_load_lds_dwordx4 v1, s[34:35] offset:1024 sc1
    global_load_lds_dwordx4 v1, s[34:35] offset:2048 sc1
    global_load_lds_dwordx4 v1, s[34:35] offset:3072 sc1
    v_exp_f32 v70, v70
    v_exp_f32 v71, v71
    v_exp_f32 v72, v72
    v_exp_f32 v73, v73
    v_mfma_f32_32x32x16_bf16 v[28:43], v[222:225], v[156:159], v[28:43]
    v_exp_f32 v74, v74
    v_exp_f32 v75, v75
    v_exp_f32 v76, v76
    v_exp_f32 v77, v77
    v_smfmac_f32_32x32x32_bf16 v[124:139], v[216:219], v[68:75], v242
    s_add_u32 m0, s97, 2048
    v_exp_f32 v78, v78
    v_exp_f32 v79, v79
    v_exp_f32 v80, v80
    v_exp_f32 v81, v81
    v_mfma_f32_32x32x8_bf16 v[44:59], v[234:235], v[166:167], 0
    v_exp_f32 v82, v82
    v_exp_f32 v83, v83
    v_exp_f32 v84, v84
    v_exp_f32 v85, v85
    v_smfmac_f32_32x32x32_bf16 v[140:155], v[212:215], v[76:83], v242
    global_load_lds_dwordx4 v250, s[4:5]
    v_exp_f32 v86, v86
    v_exp_f32 v87, v87
    v_exp_f32 v88, v88
    v_exp_f32 v89, v89
    v_mfma_f32_32x32x16_bf16 v[44:59], v[222:225], v[162:165], v[44:59]
    v_exp_f32 v90, v90
    v_exp_f32 v91, v91
    v_exp_f32 v28, v28
    v_exp_f32 v29, v29
    v_smfmac_f32_32x32x32_bf16 v[140:155], v[216:219], v[84:91], v242
    buffer_load_dwordx4 v[208:211], v1, s[16:19], 0 offen
    buffer_load_dwordx2 v[220:221], v244, s[16:19], 0 offen
    buffer_load_dwordx4 v[212:215], v245, s[16:19], 0 offen
    buffer_load_dwordx4 v[216:219], v246, s[16:19], 0 offen
    v_exp_f32 v30, v30
    v_exp_f32 v31, v31
    v_exp_f32 v32, v32
    v_exp_f32 v33, v33
    v_mfma_f32_32x32x8_bf16 v[60:75], v[234:235], v[172:173], 0
    v_exp_f32 v34, v34
    v_exp_f32 v35, v35
    v_exp_f32 v36, v36
    v_exp_f32 v37, v37
    v_smfmac_f32_32x32x32_bf16 v[92:107], v[226:229], v[28:35], v242
    v_exp_f32 v38, v38
    v_exp_f32 v39, v39
    v_exp_f32 v40, v40
    v_exp_f32 v41, v41
    v_mfma_f32_32x32x16_bf16 v[60:75], v[222:225], v[168:171], v[60:75]
    s_add_u32 s16, s16, 2688
    v_exp_f32 v42, v42
    v_exp_f32 v43, v43
    v_exp_f32 v44, v44
    v_exp_f32 v45, v45
    v_smfmac_f32_32x32x32_bf16 v[92:107], v[230:233], v[36:43], v242
    v_exp_f32 v46, v46
    v_exp_f32 v47, v47
    v_exp_f32 v48, v48
    v_exp_f32 v49, v49
    v_mfma_f32_32x32x8_bf16 v[76:91], v[234:235], v[178:179], 0
    v_exp_f32 v50, v50
    v_exp_f32 v51, v51
    v_exp_f32 v52, v52
    v_exp_f32 v53, v53
    v_smfmac_f32_32x32x32_bf16 v[108:123], v[226:229], v[44:51], v242
    v_exp_f32 v54, v54
    v_exp_f32 v55, v55
    v_exp_f32 v56, v56
    v_exp_f32 v57, v57
    v_mfma_f32_32x32x16_bf16 v[76:91], v[222:225], v[174:177], v[76:91]
    s_waitcnt vmcnt(18)
    v_exp_f32 v58, v58
    v_exp_f32 v59, v59
    v_exp_f32 v60, v60
    v_exp_f32 v61, v61
    v_smfmac_f32_32x32x32_bf16 v[108:123], v[230:233], v[52:59], v242
    s_add_u32 m0, s38, 12288
    s_add_u32 s34, s34, 4096
    v_exp_f32 v62, v62
    v_exp_f32 v63, v63
    v_exp_f32 v64, v64
    v_exp_f32 v65, v65
    v_mfma_f32_32x32x8_bf16 v[28:43], v[192:193], v[160:161], 0
    v_exp_f32 v66, v66
    v_exp_f32 v67, v67
    v_exp_f32 v68, v68
    v_exp_f32 v69, v69
    v_smfmac_f32_32x32x32_bf16 v[124:139], v[226:229], v[60:67], v242
    global_load_lds_dwordx4 v1, s[34:35] offset:0 sc1
    global_load_lds_dwordx4 v1, s[34:35] offset:1024 sc1
    global_load_lds_dwordx4 v1, s[34:35] offset:2048 sc1
    global_load_lds_dwordx4 v1, s[34:35] offset:3072 sc1
    v_exp_f32 v70, v70
    v_exp_f32 v71, v71
    v_exp_f32 v72, v72
    v_exp_f32 v73, v73
    v_mfma_f32_32x32x16_bf16 v[28:43], v[180:183], v[156:159], v[28:43]
    v_exp_f32 v74, v74
    v_exp_f32 v75, v75
    v_exp_f32 v76, v76
    v_exp_f32 v77, v77
    v_smfmac_f32_32x32x32_bf16 v[124:139], v[230:233], v[68:75], v242
    s_add_u32 s30, s30, 4096
    s_addc_u32 s31, s31, 0
    v_exp_f32 v78, v78
    v_exp_f32 v79, v79
    v_exp_f32 v80, v80
    v_exp_f32 v81, v81
    v_mfma_f32_32x32x8_bf16 v[44:59], v[192:193], v[166:167], 0
    v_exp_f32 v82, v82
    v_exp_f32 v83, v83
    v_exp_f32 v84, v84
    v_exp_f32 v85, v85
    v_smfmac_f32_32x32x32_bf16 v[140:155], v[226:229], v[76:83], v242
    global_load_dword v26, v252, s[30:31]
    buffer_load_dword v26, v15, s[20:23], s50 offen offset:128 sc1
    v_exp_f32 v86, v86
    v_exp_f32 v87, v87
    v_exp_f32 v88, v88
    v_exp_f32 v89, v89
    v_mfma_f32_32x32x16_bf16 v[44:59], v[180:183], v[162:165], v[44:59]
    v_exp_f32 v90, v90
    v_exp_f32 v91, v91
    v_exp_f32 v28, v28
    v_exp_f32 v29, v29
    v_smfmac_f32_32x32x32_bf16 v[140:155], v[230:233], v[84:91], v242
    buffer_load_dwordx4 v[222:225], v1, s[16:19], 0 offen
    buffer_load_dwordx2 v[234:235], v244, s[16:19], 0 offen
    buffer_load_dwordx4 v[226:229], v245, s[16:19], 0 offen
    buffer_load_dwordx4 v[230:233], v246, s[16:19], 0 offen
    v_exp_f32 v30, v30
    v_exp_f32 v31, v31
    v_exp_f32 v32, v32
    v_exp_f32 v33, v33
    v_mfma_f32_32x32x8_bf16 v[60:75], v[192:193], v[172:173], 0
    v_exp_f32 v34, v34
    v_exp_f32 v35, v35
    v_exp_f32 v36, v36
    v_exp_f32 v37, v37
    v_smfmac_f32_32x32x32_bf16 v[92:107], v[184:187], v[28:35], v242
    v_exp_f32 v38, v38
    v_exp_f32 v39, v39
    v_exp_f32 v40, v40
    v_exp_f32 v41, v41
    v_mfma_f32_32x32x16_bf16 v[60:75], v[180:183], v[168:171], v[60:75]
    s_add_u32 s16, s16, 2688
    v_exp_f32 v42, v42
    v_exp_f32 v43, v43
    v_exp_f32 v44, v44
    v_exp_f32 v45, v45
    v_smfmac_f32_32x32x32_bf16 v[92:107], v[188:191], v[36:43], v242
    v_exp_f32 v46, v46
    v_exp_f32 v47, v47
    v_exp_f32 v48, v48
    v_exp_f32 v49, v49
    v_mfma_f32_32x32x8_bf16 v[76:91], v[192:193], v[178:179], 0
    v_exp_f32 v50, v50
    v_exp_f32 v51, v51
    v_exp_f32 v52, v52
    v_exp_f32 v53, v53
    v_smfmac_f32_32x32x32_bf16 v[108:123], v[184:187], v[44:51], v242
    v_exp_f32 v54, v54
    v_exp_f32 v55, v55
    v_exp_f32 v56, v56
    v_exp_f32 v57, v57
    v_mfma_f32_32x32x16_bf16 v[76:91], v[180:183], v[174:177], v[76:91]
    s_waitcnt vmcnt(19)
    v_exp_f32 v58, v58
    v_exp_f32 v59, v59
    v_exp_f32 v60, v60
    v_exp_f32 v61, v61
    v_smfmac_f32_32x32x32_bf16 v[108:123], v[188:191], v[52:59], v242
    s_add_u32 m0, s38, 16384
    s_add_u32 s34, s34, 4096
    v_exp_f32 v62, v62
    v_exp_f32 v63, v63
    v_exp_f32 v64, v64
    v_exp_f32 v65, v65
    v_mfma_f32_32x32x8_bf16 v[28:43], v[206:207], v[160:161], 0
    v_exp_f32 v66, v66
    v_exp_f32 v67, v67
    v_exp_f32 v68, v68
    v_exp_f32 v69, v69
    v_smfmac_f32_32x32x32_bf16 v[124:139], v[184:187], v[60:67], v242
    global_load_lds_dwordx4 v1, s[34:35] offset:0 sc1
    global_load_lds_dwordx4 v1, s[34:35] offset:1024 sc1
    global_load_lds_dwordx4 v1, s[34:35] offset:2048 sc1
    global_load_lds_dwordx4 v1, s[34:35] offset:3072 sc1
    v_exp_f32 v70, v70
    v_exp_f32 v71, v71
    v_exp_f32 v72, v72
    v_exp_f32 v73, v73
    v_mfma_f32_32x32x16_bf16 v[28:43], v[194:197], v[156:159], v[28:43]
    v_exp_f32 v74, v74
    v_exp_f32 v75, v75
    v_exp_f32 v76, v76
    v_exp_f32 v77, v77
    v_smfmac_f32_32x32x32_bf16 v[124:139], v[188:191], v[68:75], v242
    v_exp_f32 v78, v78
    v_exp_f32 v79, v79
    v_exp_f32 v80, v80
    v_exp_f32 v81, v81
    v_mfma_f32_32x32x8_bf16 v[44:59], v[206:207], v[166:167], 0
    v_exp_f32 v82, v82
    v_exp_f32 v83, v83
    v_exp_f32 v84, v84
    v_exp_f32 v85, v85
    v_smfmac_f32_32x32x32_bf16 v[140:155], v[184:187], v[76:83], v242
    v_exp_f32 v86, v86
    v_exp_f32 v87, v87
    v_exp_f32 v88, v88
    v_exp_f32 v89, v89
    v_mfma_f32_32x32x16_bf16 v[44:59], v[194:197], v[162:165], v[44:59]
    v_exp_f32 v90, v90
    v_exp_f32 v91, v91
    v_exp_f32 v28, v28
    v_exp_f32 v29, v29
    v_smfmac_f32_32x32x32_bf16 v[140:155], v[188:191], v[84:91], v242
    v_exp_f32 v30, v30
    v_exp_f32 v31, v31
    v_exp_f32 v32, v32
    v_exp_f32 v33, v33
    v_mfma_f32_32x32x8_bf16 v[60:75], v[206:207], v[172:173], 0
    v_exp_f32 v34, v34
    v_exp_f32 v35, v35
    v_exp_f32 v36, v36
    v_exp_f32 v37, v37
    v_smfmac_f32_32x32x32_bf16 v[92:107], v[198:201], v[28:35], v242
    v_exp_f32 v38, v38
    v_exp_f32 v39, v39
    v_exp_f32 v40, v40
    v_exp_f32 v41, v41
    v_mfma_f32_32x32x16_bf16 v[60:75], v[194:197], v[168:171], v[60:75]
    v_exp_f32 v42, v42
    v_exp_f32 v43, v43
    v_exp_f32 v44, v44
    v_exp_f32 v45, v45
    v_smfmac_f32_32x32x32_bf16 v[92:107], v[202:205], v[36:43], v242
    v_exp_f32 v46, v46
    v_exp_f32 v47, v47
    v_exp_f32 v48, v48
    v_exp_f32 v49, v49
    v_mfma_f32_32x32x8_bf16 v[76:91], v[206:207], v[178:179], 0
    v_exp_f32 v50, v50
    v_exp_f32 v51, v51
    v_exp_f32 v52, v52
    v_exp_f32 v53, v53
    v_smfmac_f32_32x32x32_bf16 v[108:123], v[198:201], v[44:51], v242
    v_exp_f32 v54, v54
    v_exp_f32 v55, v55
    v_exp_f32 v56, v56
    v_exp_f32 v57, v57
    v_mfma_f32_32x32x16_bf16 v[76:91], v[194:197], v[174:177], v[76:91]
    s_waitcnt vmcnt(14)
    v_exp_f32 v58, v58
    v_exp_f32 v59, v59
    v_exp_f32 v60, v60
    v_exp_f32 v61, v61
    v_smfmac_f32_32x32x32_bf16 v[108:123], v[202:205], v[52:59], v242
    s_add_u32 m0, s38, 20480
    s_add_u32 s34, s34, 4096
    v_exp_f32 v62, v62
    v_exp_f32 v63, v63
    v_exp_f32 v64, v64
    v_exp_f32 v65, v65
    v_mfma_f32_32x32x8_bf16 v[28:43], v[220:221], v[160:161], 0
    v_exp_f32 v66, v66
    v_exp_f32 v67, v67
    v_exp_f32 v68, v68
    v_exp_f32 v69, v69
    v_smfmac_f32_32x32x32_bf16 v[124:139], v[198:201], v[60:67], v242
    global_load_lds_dwordx4 v1, s[34:35] offset:0 sc1
    global_load_lds_dwordx4 v1, s[34:35] offset:1024 sc1
    global_load_lds_dwordx4 v1, s[34:35] offset:2048 sc1
    global_load_lds_dwordx4 v1, s[34:35] offset:3072 sc1
    v_exp_f32 v70, v70
    v_exp_f32 v71, v71
    v_exp_f32 v72, v72
    v_exp_f32 v73, v73
    v_mfma_f32_32x32x16_bf16 v[28:43], v[208:211], v[156:159], v[28:43]
    v_exp_f32 v74, v74
    v_exp_f32 v75, v75
    v_exp_f32 v76, v76
    v_exp_f32 v77, v77
    v_smfmac_f32_32x32x32_bf16 v[124:139], v[202:205], v[68:75], v242
    v_exp_f32 v78, v78
    v_exp_f32 v79, v79
    v_exp_f32 v80, v80
    v_exp_f32 v81, v81
    v_mfma_f32_32x32x8_bf16 v[44:59], v[220:221], v[166:167], 0
    v_exp_f32 v82, v82
    v_exp_f32 v83, v83
    v_exp_f32 v84, v84
    v_exp_f32 v85, v85
    v_smfmac_f32_32x32x32_bf16 v[140:155], v[198:201], v[76:83], v242
    v_exp_f32 v86, v86
    v_exp_f32 v87, v87
    v_exp_f32 v88, v88
    v_exp_f32 v89, v89
    v_mfma_f32_32x32x16_bf16 v[44:59], v[208:211], v[162:165], v[44:59]
    v_exp_f32 v90, v90
    v_exp_f32 v91, v91
    v_exp_f32 v28, v28
    v_exp_f32 v29, v29
    v_smfmac_f32_32x32x32_bf16 v[140:155], v[202:205], v[84:91], v242
    buffer_load_dwordx4 v[194:197], v243, s[20:23], 0 offen offset:2560
    buffer_load_dwordx4 v[198:201], v243, s[20:23], s58 offen offset:2560
    buffer_load_dwordx4 v[202:205], v243, s[20:23], s59 offen offset:2560
    v_exp_f32 v30, v30
    v_exp_f32 v31, v31
    v_exp_f32 v32, v32
    v_exp_f32 v33, v33
    v_mfma_f32_32x32x8_bf16 v[60:75], v[220:221], v[172:173], 0
    v_exp_f32 v34, v34
    v_exp_f32 v35, v35
    v_exp_f32 v36, v36
    v_exp_f32 v37, v37
    v_smfmac_f32_32x32x32_bf16 v[92:107], v[212:215], v[28:35], v242
    v_exp_f32 v38, v38
    v_exp_f32 v39, v39
    v_exp_f32 v40, v40
    v_exp_f32 v41, v41
    v_mfma_f32_32x32x16_bf16 v[60:75], v[208:211], v[168:171], v[60:75]
    v_exp_f32 v42, v42
    v_exp_f32 v43, v43
    v_exp_f32 v44, v44
    v_exp_f32 v45, v45
    v_smfmac_f32_32x32x32_bf16 v[92:107], v[216:219], v[36:43], v242
    s_xor_b32 s36, s29, 2
    s_mul_i32 s36, s36, 6144
    v_exp_f32 v46, v46
    v_exp_f32 v47, v47
    v_exp_f32 v48, v48
    v_exp_f32 v49, v49
    v_mfma_f32_32x32x8_bf16 v[76:91], v[220:221], v[178:179], 0
    v_exp_f32 v50, v50
    v_exp_f32 v51, v51
    v_exp_f32 v52, v52
    v_exp_f32 v53, v53
    v_smfmac_f32_32x32x32_bf16 v[108:123], v[212:215], v[44:51], v242
    s_add_u32 s36, s36, 133120
    v_exp_f32 v54, v54
    v_exp_f32 v55, v55
    v_exp_f32 v56, v56
    v_exp_f32 v57, v57
    v_mfma_f32_32x32x16_bf16 v[76:91], v[208:211], v[174:177], v[76:91]
    s_waitcnt vmcnt(11)
    v_exp_f32 v58, v58
    v_exp_f32 v59, v59
    v_exp_f32 v60, v60
    v_exp_f32 v61, v61
    v_smfmac_f32_32x32x32_bf16 v[108:123], v[216:219], v[52:59], v242
    s_add_u32 m0, s38, 24576
    s_add_u32 s34, s34, 4096
    v_exp_f32 v62, v62
    v_exp_f32 v63, v63
    v_exp_f32 v64, v64
    v_exp_f32 v65, v65
    v_mfma_f32_32x32x8_bf16 v[28:43], v[234:235], v[160:161], 0
    v_exp_f32 v66, v66
    v_exp_f32 v67, v67
    v_exp_f32 v68, v68
    v_exp_f32 v69, v69
    v_smfmac_f32_32x32x32_bf16 v[124:139], v[212:215], v[60:67], v242
    global_load_lds_dwordx4 v1, s[34:35] offset:0 sc1
    v_exp_f32 v70, v70
    v_exp_f32 v71, v71
    v_exp_f32 v72, v72
    v_exp_f32 v73, v73
    v_mfma_f32_32x32x16_bf16 v[28:43], v[222:225], v[156:159], v[28:43]
    v_add_u32 v16, s39, v1
    v_add_u32 v17, s36, v1
    v_exp_f32 v74, v74
    v_exp_f32 v75, v75
    v_exp_f32 v76, v76
    v_exp_f32 v77, v77
    v_smfmac_f32_32x32x32_bf16 v[124:139], v[216:219], v[68:75], v242
    s_cmp_eq_u32 s29, 0
    s_cselect_b64 vcc, -1, 0
    v_exp_f32 v78, v78
    v_exp_f32 v79, v79
    v_exp_f32 v80, v80
    v_exp_f32 v81, v81
    v_mfma_f32_32x32x8_bf16 v[44:59], v[234:235], v[166:167], 0
    v_exp_f32 v82, v82
    v_exp_f32 v83, v83
    v_exp_f32 v84, v84
    v_exp_f32 v85, v85
    v_smfmac_f32_32x32x32_bf16 v[140:155], v[212:215], v[76:83], v242
    v_exp_f32 v86, v86
    v_exp_f32 v87, v87
    v_exp_f32 v88, v88
    v_exp_f32 v89, v89
    v_mfma_f32_32x32x16_bf16 v[44:59], v[222:225], v[162:165], v[44:59]
    v_add_u32 v25, 6656, v1
    v_cndmask_b32 v251, v251, v25, vcc
    v_exp_f32 v90, v90
    v_exp_f32 v91, v91
    v_exp_f32 v28, v28
    v_exp_f32 v29, v29
    v_smfmac_f32_32x32x32_bf16 v[140:155], v[216:219], v[84:91], v242
    buffer_load_dwordx4 v[208:211], v251, s[20:23], 0 offen offset:0
    buffer_load_dwordx4 v[212:215], v251, s[20:23], s58 offen offset:0
    buffer_load_dwordx4 v[216:219], v251, s[20:23], s59 offen offset:0
    v_exp_f32 v30, v30
    v_exp_f32 v31, v31
    v_exp_f32 v32, v32
    v_exp_f32 v33, v33
    v_mfma_f32_32x32x8_bf16 v[60:75], v[234:235], v[172:173], 0
    v_exp_f32 v34, v34
    v_exp_f32 v35, v35
    v_exp_f32 v36, v36
    v_exp_f32 v37, v37
    v_smfmac_f32_32x32x32_bf16 v[92:107], v[226:229], v[28:35], v242
    v_exp_f32 v38, v38
    v_exp_f32 v39, v39
    v_exp_f32 v40, v40
    v_exp_f32 v41, v41
    v_mfma_f32_32x32x16_bf16 v[60:75], v[222:225], v[168:171], v[60:75]
    v_exp_f32 v42, v42
    v_exp_f32 v43, v43
    v_exp_f32 v44, v44
    v_exp_f32 v45, v45
    v_smfmac_f32_32x32x32_bf16 v[92:107], v[230:233], v[36:43], v242
    v_exp_f32 v46, v46
    v_exp_f32 v47, v47
    v_exp_f32 v48, v48
    v_exp_f32 v49, v49
    v_mfma_f32_32x32x8_bf16 v[76:91], v[234:235], v[178:179], 0
    v_exp_f32 v50, v50
    v_exp_f32 v51, v51
    v_exp_f32 v52, v52
    v_exp_f32 v53, v53
    v_smfmac_f32_32x32x32_bf16 v[108:123], v[226:229], v[44:51], v242
    v_exp_f32 v54, v54
    v_exp_f32 v55, v55
    v_exp_f32 v56, v56
    v_exp_f32 v57, v57
    v_mfma_f32_32x32x16_bf16 v[76:91], v[222:225], v[174:177], v[76:91]
    v_exp_f32 v58, v58
    v_exp_f32 v59, v59
    v_exp_f32 v60, v60
    v_exp_f32 v61, v61
    v_smfmac_f32_32x32x32_bf16 v[108:123], v[230:233], v[52:59], v242
    ds_write_b128 v16, v[92:95] offset:0
    ds_write_b128 v16, v[96:99] offset:1024
    ds_write_b128 v16, v[100:103] offset:2048
    v_exp_f32 v62, v62
    v_exp_f32 v63, v63
    v_exp_f32 v64, v64
    v_exp_f32 v65, v65
    v_exp_f32 v66, v66
    v_exp_f32 v67, v67
    v_exp_f32 v68, v68
    v_exp_f32 v69, v69
    v_smfmac_f32_32x32x32_bf16 v[124:139], v[226:229], v[60:67], v242
L_back_stub0_3:
    s_cmp_eq_u32 s0, 1
    s_cbranch_scc1 L_back_wret0
    v_exp_f32 v70, v70
    v_exp_f32 v71, v71
    v_exp_f32 v72, v72
    v_exp_f32 v73, v73
    v_exp_f32 v74, v74
    v_exp_f32 v75, v75
    v_exp_f32 v76, v76
    v_exp_f32 v77, v77
    v_smfmac_f32_32x32x32_bf16 v[124:139], v[230:233], v[68:75], v242
    ds_write_b128 v16, v[108:111] offset:3072
    ds_write_b128 v16, v[112:115] offset:4096
    ds_write_b128 v16, v[116:119] offset:5120
    v_exp_f32 v78, v78
    v_exp_f32 v79, v79
    v_exp_f32 v80, v80
    v_exp_f32 v81, v81
    v_exp_f32 v82, v82
    v_exp_f32 v83, v83
    v_exp_f32 v84, v84
    v_exp_f32 v85, v85
    v_smfmac_f32_32x32x32_bf16 v[140:155], v[226:229], v[76:83], v242
    v_exp_f32 v86, v86
    v_exp_f32 v87, v87
    v_exp_f32 v88, v88
    v_exp_f32 v89, v89
    v_exp_f32 v90, v90
    v_exp_f32 v91, v91
    s_waitcnt lgkmcnt(0)
    s_barrier
    v_smfmac_f32_32x32x32_bf16 v[140:155], v[230:233], v[84:91], v242
    ds_read_b128 v[92:95], v17 offset:0
    ds_read_b128 v[96:99], v17 offset:1024
    ds_read_b128 v[100:103], v17 offset:2048
    ds_read_b128 v[104:107], v17 offset:3072
    ds_read_b128 v[108:111], v17 offset:4096
    ds_read_b128 v[112:115], v17 offset:5120
    v_lshrrev_b32 v26, 9, v1
    v_mul_u32_u24 v26, 40960, v26
    v_add_u32 v26, v26, v27
    s_add_u32 s28, s63, 40960
    s_waitcnt lgkmcnt(3)
    v_add_f32 v18, v132, v100
    v_add_f32 v19, v132, v100
    v_pk_add_f32 v[28:29], v[124:125], v[92:93]
    v_pk_add_f32 v[30:31], v[126:127], v[94:95]
    v_permlane32_swap_b32 v18, v19
    v_pk_add_f32 v[32:33], v[128:129], v[96:97]
    v_pk_add_f32 v[34:35], v[130:131], v[98:99]
    v_pk_add_f32 v[36:37], v[132:133], v[100:101]
    v_pk_add_f32 v[38:39], v[134:135], v[102:103]
    s_waitcnt lgkmcnt(0)
    v_add_f32 v20, v148, v112
    v_add_f32 v21, v148, v112
    v_pk_add_f32 v[44:45], v[140:141], v[104:105]
    v_pk_add_f32 v[46:47], v[142:143], v[106:107]
    v_permlane32_swap_b32 v20, v21
    v_pk_add_f32 v[48:49], v[144:145], v[108:109]
    v_pk_add_f32 v[50:51], v[146:147], v[110:111]
    v_pk_add_f32 v[52:53], v[148:149], v[112:113]
    v_pk_add_f32 v[54:55], v[150:151], v[114:115]
    v_rcp_f32 v18, v19
    v_rcp_f32 v20, v21
    v_pk_mul_f32 v[92:93], v[28:29], v[18:19] op_sel_hi:[1,0]
    v_pk_mul_f32 v[94:95], v[30:31], v[18:19] op_sel_hi:[1,0]
    v_pk_mul_f32 v[96:97], v[32:33], v[18:19] op_sel_hi:[1,0]
    v_pk_mul_f32 v[98:99], v[34:35], v[18:19] op_sel_hi:[1,0]
    v_pk_mul_f32 v[100:101], v[36:37], v[18:19] op_sel_hi:[1,0]
    v_pk_mul_f32 v[102:103], v[38:39], v[18:19] op_sel_hi:[1,0]
    v_cvt_pk_bf16_f32 v64, v100, v101
    v_cvt_pk_bf16_f32 v65, v102, v103
    v_cvt_pk_bf16_f32 v60, v92, v93
    v_cvt_pk_bf16_f32 v61, v94, v95
    v_cvt_pk_bf16_f32 v62, v96, v97
    v_cvt_pk_bf16_f32 v63, v98, v99
    buffer_store_dwordx4 v[60:63], v1, s[20:23], s63 offen sc1
    v_pk_mul_f32 v[104:105], v[44:45], v[20:21] op_sel_hi:[1,0]
    v_pk_mul_f32 v[106:107], v[46:47], v[20:21] op_sel_hi:[1,0]
    v_pk_mul_f32 v[108:109], v[48:49], v[20:21] op_sel_hi:[1,0]
    v_pk_mul_f32 v[110:111], v[50:51], v[20:21] op_sel_hi:[1,0]
    v_pk_mul_f32 v[112:113], v[52:53], v[20:21] op_sel_hi:[1,0]
    v_pk_mul_f32 v[114:115], v[54:55], v[20:21] op_sel_hi:[1,0]
    v_cvt_pk_bf16_f32 v70, v112, v113
    v_cvt_pk_bf16_f32 v71, v114, v115
    v_cvt_pk_bf16_f32 v66, v104, v105
    v_cvt_pk_bf16_f32 v67, v106, v107
    v_cvt_pk_bf16_f32 v68, v108, v109
    v_cvt_pk_bf16_f32 v69, v110, v111
    buffer_store_dwordx4 v[66:69], v1, s[20:23], s28 offen sc1
    v_permlane32_swap_b32 v64, v70
    v_permlane32_swap_b32 v65, v71
    buffer_store_dwordx2 v[64:65], v26, s[20:23], s49 offen sc1
    v_pk_mul_f32 v[22:23], v[28:29], 0 op_sel_hi:[1,0]
    v_pk_fma_f32 v[22:23], v[30:31], 0, v[22:23] op_sel_hi:[1,0,1]
    v_pk_fma_f32 v[22:23], v[32:33], 0, v[22:23] op_sel_hi:[1,0,1]
    v_pk_fma_f32 v[22:23], v[34:35], 0, v[22:23] op_sel_hi:[1,0,1]
    v_pk_fma_f32 v[22:23], v[36:37], 0, v[22:23] op_sel_hi:[1,0,1]
    v_pk_fma_f32 v[22:23], v[38:39], 0, v[22:23] op_sel_hi:[1,0,1]
    v_add_f32 v22, v22, v23
    v_add_f32 v22, v22, v19
    v_cmp_ngt_f32 vcc, 0x7b800000, v22
    s_cbranch_vccnz L_back_fb0_5
L_back_rt0_7:
    v_pk_mul_f32 v[22:23], v[44:45], 0 op_sel_hi:[1,0]
    v_pk_fma_f32 v[22:23], v[46:47], 0, v[22:23] op_sel_hi:[1,0,1]
    v_pk_fma_f32 v[22:23], v[48:49], 0, v[22:23] op_sel_hi:[1,0,1]
    v_pk_fma_f32 v[22:23], v[50:51], 0, v[22:23] op_sel_hi:[1,0,1]
    v_pk_fma_f32 v[22:23], v[52:53], 0, v[22:23] op_sel_hi:[1,0,1]
    v_pk_fma_f32 v[22:23], v[54:55], 0, v[22:23] op_sel_hi:[1,0,1]
    v_add_f32 v22, v22, v23
    v_add_f32 v22, v22, v21
    v_cmp_ngt_f32 vcc, 0x7b800000, v22
    s_cbranch_vccnz L_back_fb1_6
L_back_rt1_8:
    v_cmp_lt_u32 vcc, 159, v0
    v_subrev_u32 v31, 320, v1
    v_lshrrev_b32 v33, 1, v243
    v_cndmask_b32_e64 v32, 0, 1.0, vcc
    v_cmp_gt_u32 vcc, 320, v31
    s_cmp_eq_u32 s29, 0
    s_cselect_b64 vcc, -1, vcc
    s_cselect_b32 s36, 10240, 0
    s_cselect_b32 s3, 0, 11264
    v_cndmask_b32_e64 v34, 0, 1.0, vcc
    v_add_u32 v33, 122880, v33
    v_lshrrev_b32 v35, 1, v1
    v_add_u32 v35, s36, v35
    v_add_u32 v35, 114688, v35
    v_add_u32 v31, s3, v1
    v_add_u32 v31, 114688, v31
    s_waitcnt vmcnt(3)
    v_pk_add_f32 v[194:195], v[194:195], v[198:199]
    v_pk_add_f32 v[196:197], v[196:197], v[200:201]
    v_pk_add_f32 v[194:195], v[194:195], v[202:203]
    v_pk_add_f32 v[196:197], v[196:197], v[204:205]
    v_cvt_pk_bf16_f32 v198, v194, v195
    v_cvt_pk_bf16_f32 v199, v196, v197
    v_lshlrev_b32 v194, 16, v198
    v_and_b32 v195, s96, v198
    v_lshlrev_b32 v196, 16, v199
    v_and_b32 v197, s96, v199
    v_pk_add_f32 v[194:195], v[194:195], v[32:33] op_sel_hi:[1,0]
    v_pk_add_f32 v[196:197], v[196:197], v[32:33] op_sel_hi:[1,0]
    v_cvt_pk_bf16_f32 v198, v194, v195
    v_cvt_pk_bf16_f32 v199, v196, v197
    ds_write_b64 v33, v[198:199]
    v_pk_add_f32 v[208:209], v[208:209], v[212:213]
    v_pk_add_f32 v[210:211], v[210:211], v[214:215]
    v_pk_add_f32 v[208:209], v[208:209], v[216:217]
    v_pk_add_f32 v[210:211], v[210:211], v[218:219]
    v_cvt_pk_bf16_f32 v212, v208, v209
    v_cvt_pk_bf16_f32 v213, v210, v211
    v_lshlrev_b32 v208, 16, v212
    v_and_b32 v209, s96, v212
    v_lshlrev_b32 v210, 16, v213
    v_and_b32 v211, s96, v213
    v_pk_add_f32 v[208:209], v[208:209], v[34:35] op_sel_hi:[1,0]
    v_pk_add_f32 v[210:211], v[210:211], v[34:35] op_sel_hi:[1,0]
    v_cvt_pk_bf16_f32 v212, v208, v209
    v_cvt_pk_bf16_f32 v213, v210, v211
    v_lshlrev_b32 v208, 16, v212
    v_and_b32 v209, s96, v212
    v_lshlrev_b32 v210, 16, v213
    v_and_b32 v211, s96, v213
    ds_write_b64 v35, v[212:213]
    ds_write_b128 v31, v[208:211]
    s_and_b32 s12, s2, 7
    s_lshr_b32 s13, s2, 7
    s_lshl1_add_u32 s12, s12, s13
    s_bfe_u32 s13, s2, 0x10006
    s_bfe_u32 s14, s2, 0x30003
    s_bfe_u32 s15, s2, 0x40003
    s_lshl_b32 s28, s12, 2
    s_add_u32 s30, s28, s29
    s_lshl2_add_u32 s39, s15, s29
    v_lshrrev_b32 v18, 8, v1
    v_lshlrev_b32 v10, 4, v18
    v_add_u32 v10, 125952, v10
    v_lshlrev_b32 v9, 5, v18
    v_add_u32 v9, 125952, v9
    v_cmp_eq_u32 vcc, 0, v0
    s_lshl_b32 s44, s2, 8
    s_add_u32 s44, s44, 262144
    v_mov_b32 v19, 0x40000000
    v_cndmask_b32_e64 v5, v19, 0, vcc
    s_lshl2_add_u32 s55, s15, s50
    s_lshl2_add_u32 s42, s14, s29
    s_mul_i32 s42, s42, 61440
    s_add_u32 s42, s42, 26247168
    s_add_u32 s42, s42, s6
    s_mov_b32 s43, s7
    s_mul_i32 s52, s29, 6144
    s_add_u32 s52, s52, 133120
    v_bfe_u32 v30, v1, 6, 1
    v_mul_u32_u24 v30, 1280, v30
    v_sub_u32 v30, v10, v30
    v_subrev_u32 v30, 1792, v30
    v_mul_u32_u24 v186, 40, v15
    v_add_u32 v186, s97, v186
    v_lshl_add_u32 v187, v18, 3, v186
    v_lshl_add_u32 v186, v18, 4, v186
    ds_read_b128 v[176:179], v186 offset:0
    ds_read_b128 v[180:183], v186 offset:64
    ds_read_b64 v[184:185], v187 offset:128
    s_waitcnt vmcnt(0) lgkmcnt(0)
    v_mov_b32 v34, 1
    s_barrier
    buffer_store_dword v34, v5, s[20:23], s44 offen sc1
    ds_read_b128 v[36:39], v30 offset:0
    ds_read_b128 v[40:43], v30 offset:64
    ds_read_b128 v[44:47], v30 offset:128
    s_waitcnt lgkmcnt(2)
    v_mfma_f32_16x16x32_bf16 v[52:55], v[36:39], a[0:3], 0
    ds_read_b128 v[48:51], v30 offset:192
    v_lshrrev_b32 v19, 2, v15
    v_mfma_f32_16x16x32_bf16 v[56:59], v[36:39], a[4:7], 0
    s_lshl_b32 s31, s13, 8
    v_lshlrev_b32 v20, 4, v19
    v_lshl_add_u32 v3, v18, 9, v20
    v_mfma_f32_16x16x32_bf16 v[60:63], v[36:39], a[8:11], 0
    s_waitcnt lgkmcnt(2)
    v_add_u32 v2, s31, v3
    v_add_u32 v4, 40960, v3
    v_mfma_f32_16x16x32_bf16 v[52:55], v[40:43], a[12:15], v[52:55]
    global_load_dwordx4 a[240:243], v1, s[42:43] offset:0 sc1
    v_add_u32 v6, 51200, v1
    v_mfma_f32_16x16x32_bf16 v[56:59], v[40:43], a[16:19], v[56:59]
    ds_read_b128 v[36:39], v30 offset:256
    global_load_dwordx4 a[244:247], v1, s[42:43] offset:1024 sc1
    v_lshrrev_b32 v22, 1, v18
    v_mfma_f32_16x16x32_bf16 v[60:63], v[40:43], a[20:23], v[60:63]
    s_waitcnt lgkmcnt(2)
    v_and_b32 v23, 1, v18
    v_lshlrev_b32 v23, 30, v23
    v_mfma_f32_16x16x32_bf16 v[52:55], v[44:47], a[24:27], v[52:55]
    global_load_dwordx4 a[248:251], v1, s[42:43] offset:2048 sc1
    v_lshl_add_u32 v11, v19, 3, v23
    v_mfma_f32_16x16x32_bf16 v[56:59], v[44:47], a[28:31], v[56:59]
    ds_read_b128 v[40:43], v30 offset:320
    v_lshl_add_u32 v11, v22, 2, v11
    v_mfma_f32_16x16x32_bf16 v[60:63], v[44:47], a[32:35], v[60:63]
    global_load_dwordx4 a[252:255], v1, s[42:43] offset:3072 sc1
    s_waitcnt lgkmcnt(2)
    s_add_u32 s42, s42, 4096
    v_mfma_f32_16x16x32_bf16 v[52:55], v[48:51], a[36:39], v[52:55]
    ds_read_b128 v[44:47], v30 offset:384
    s_add_u32 m0, s52, 0
    v_lshl_add_u32 v24, v22, 8, v20
    v_mfma_f32_16x16x32_bf16 v[56:59], v[48:51], a[40:43], v[56:59]
    global_load_lds_dwordx4 v1, s[42:43] offset:0 sc1
    v_add_u32 v12, v24, v23
    v_mfma_f32_16x16x32_bf16 v[60:63], v[48:51], a[44:47], v[60:63]
    global_load_lds_dwordx4 v1, s[42:43] offset:1024 sc1
    s_waitcnt lgkmcnt(2)
    v_mfma_f32_16x16x32_bf16 v[52:55], v[36:39], a[48:51], v[52:55]
    ds_read_b128 v[48:51], v30 offset:448
    v_add_u32 v13, 126976, v20
    v_mfma_f32_16x16x32_bf16 v[56:59], v[36:39], a[52:55], v[56:59]
    global_load_lds_dwordx4 v1, s[42:43] offset:2048 sc1
    v_lshlrev_b32 v24, 5, v19
    v_mfma_f32_16x16x32_bf16 v[60:63], v[36:39], a[56:59], v[60:63]
    global_load_lds_dwordx4 v1, s[42:43] offset:3072 sc1
    s_waitcnt lgkmcnt(2)
    s_add_u32 s42, s42, 4096
    v_mfma_f32_16x16x32_bf16 v[52:55], v[40:43], a[60:63], v[52:55]
    ds_read_b128 v[36:39], v30 offset:512
    v_lshl_add_u32 v24, v18, 3, v24
    v_mfma_f32_16x16x32_bf16 v[56:59], v[40:43], a[64:67], v[56:59]
    s_add_u32 m0, s52, 4096
    v_add_u32 v14, 129024, v24
    v_and_b32 v24, 0x1ff, v2
    v_mfma_f32_16x16x32_bf16 v[60:63], v[40:43], a[68:71], v[60:63]
    global_load_lds_dwordx4 v1, s[42:43] offset:0 sc1
    s_waitcnt lgkmcnt(2)
    v_mfma_f32_16x16x32_bf16 v[52:55], v[44:47], a[72:75], v[52:55]
    global_load_lds_dwordx4 v1, s[42:43] offset:1024 sc1
    v_lshrrev_b32 v24, 1, v24
    v_mfma_f32_16x16x32_bf16 v[56:59], v[44:47], a[76:79], v[56:59]
    ds_read_b128 v[40:43], v30 offset:576
    v_lshl_add_u32 v254, v18, 9, v24
    v_mfma_f32_16x16x32_bf16 v[60:63], v[44:47], a[80:83], v[60:63]
    ds_read_b128 v[188:191], v9 offset:0
    s_waitcnt lgkmcnt(3)
    v_mfma_f32_16x16x32_bf16 v[52:55], v[48:51], a[84:87], v[52:55]
    ds_read_b128 v[192:195], v9 offset:16
    s_mul_i32 s46, s30, 40960
    v_mfma_f32_16x16x32_bf16 v[56:59], v[48:51], a[88:91], v[56:59]
    ds_read_b128 v[44:47], v30 offset:640
    s_add_u32 s32, s46, 11276288
    v_mfma_f32_16x16x32_bf16 v[60:63], v[48:51], a[92:95], v[60:63]
    ds_read_b128 v[196:199], v9 offset:128
    s_waitcnt lgkmcnt(5)
    v_mfma_f32_16x16x32_bf16 v[52:55], v[36:39], a[96:99], v[52:55]
    ds_read_b128 v[48:51], v30 offset:704
    s_add_u32 s32, s32, s6
    v_mfma_f32_16x16x32_bf16 v[56:59], v[36:39], a[100:103], v[56:59]
    ds_read_b128 v[200:203], v9 offset:144
    s_mov_b32 s33, s7
    v_mfma_f32_16x16x32_bf16 v[60:63], v[36:39], a[104:107], v[60:63]
    ds_read_b128 v[204:207], v10 offset:256
    s_waitcnt lgkmcnt(7)
    v_mfma_f32_16x16x32_bf16 v[52:55], v[40:43], a[108:111], v[52:55]
    ds_read_b128 v[36:39], v30 offset:768
    s_mul_i32 s36, s14, 5120
    v_mfma_f32_16x16x32_bf16 v[56:59], v[40:43], a[112:115], v[56:59]
    ds_read_b128 v[208:211], v9 offset:320
    s_add_u32 s46, s46, s36
    v_mfma_f32_16x16x32_bf16 v[60:63], v[40:43], a[116:119], v[60:63]
    ds_read_b128 v[212:215], v9 offset:336
    s_waitcnt lgkmcnt(7)
    v_mfma_f32_16x16x32_bf16 v[52:55], v[44:47], a[120:123], v[52:55]
    ds_read_b128 v[40:43], v30 offset:832
    s_add_u32 s46, s46, 16515072
    v_mfma_f32_16x16x32_bf16 v[56:59], v[44:47], a[124:127], v[56:59]
    ds_read_b128 v[216:219], v9 offset:448
    s_add_u32 s47, s46, s31
    v_mfma_f32_16x16x32_bf16 v[60:63], v[44:47], a[128:131], v[60:63]
    ds_read_b128 v[220:223], v9 offset:464
    s_waitcnt lgkmcnt(8)
    v_mfma_f32_16x16x32_bf16 v[52:55], v[48:51], a[132:135], v[52:55]
    ds_read_b128 v[44:47], v30 offset:896
    s_add_u32 s47, s47, 4096
    v_mfma_f32_16x16x32_bf16 v[56:59], v[48:51], a[136:139], v[56:59]
    ds_read_b128 v[224:227], v10 offset:576
    s_lshl1_add_u32 s48, s30, s13
    v_mfma_f32_16x16x32_bf16 v[60:63], v[48:51], a[140:143], v[60:63]
    s_lshl3_add_u32 s48, s48, s14
    s_lshl_b32 s48, s48, 7
    s_add_u32 s48, s48, 65536
    buffer_load_dword v0, v255, s[20:23], s60 offen sc1
    s_waitcnt lgkmcnt(7)
    v_mfma_f32_16x16x32_bf16 v[52:55], v[36:39], a[144:147], v[52:55]
    ds_read_b128 v[48:51], v30 offset:960
    v_lshlrev_b32 v228, 16, v176
    v_mfma_f32_16x16x32_bf16 v[56:59], v[36:39], a[148:151], v[56:59]
    v_and_b32 v229, s96, v176
    v_lshlrev_b32 v230, 16, v177
    v_mfma_f32_16x16x32_bf16 v[60:63], v[36:39], a[152:155], v[60:63]
    s_waitcnt lgkmcnt(5)
    v_and_b32 v231, s96, v177
    v_lshlrev_b32 v232, 16, v178
    v_mfma_f32_16x16x32_bf16 v[52:55], v[40:43], a[156:159], v[52:55]
    ds_read_b128 v[36:39], v30 offset:1024
    v_and_b32 v233, s96, v178
    v_mfma_f32_16x16x32_bf16 v[56:59], v[40:43], a[160:163], v[56:59]
    v_lshlrev_b32 v234, 16, v179
    v_and_b32 v235, s96, v179
    v_mfma_f32_16x16x32_bf16 v[60:63], v[40:43], a[164:167], v[60:63]
    s_waitcnt lgkmcnt(3)
    v_lshlrev_b32 v236, 16, v180
    v_and_b32 v237, s96, v180
    v_mfma_f32_16x16x32_bf16 v[52:55], v[44:47], a[168:171], v[52:55]
    ds_read_b128 v[40:43], v30 offset:1088
    v_lshlrev_b32 v238, 16, v181
    v_mfma_f32_16x16x32_bf16 v[56:59], v[44:47], a[172:175], v[56:59]
    v_and_b32 v239, s96, v181
    v_lshlrev_b32 v240, 16, v182
    v_mfma_f32_16x16x32_bf16 v[60:63], v[44:47], a[176:179], v[60:63]
    s_waitcnt lgkmcnt(2)
    v_and_b32 v241, s96, v182
    v_lshlrev_b32 v242, 16, v183
    v_mfma_f32_16x16x32_bf16 v[52:55], v[48:51], a[180:183], v[52:55]
    ds_read_b128 v[44:47], v30 offset:1152
    v_and_b32 v243, s96, v183
    v_mfma_f32_16x16x32_bf16 v[56:59], v[48:51], a[184:187], v[56:59]
    v_lshlrev_b32 v244, 16, v184
    v_and_b32 v245, s96, v184
    v_mfma_f32_16x16x32_bf16 v[60:63], v[48:51], a[188:191], v[60:63]
    s_waitcnt lgkmcnt(2)
    v_lshlrev_b32 v246, 16, v185
    v_and_b32 v247, s96, v185
    v_mfma_f32_16x16x32_bf16 v[52:55], v[36:39], a[192:195], v[52:55]
    ds_read_b128 v[48:51], v30 offset:1216
    v_mfma_f32_16x16x32_bf16 v[56:59], v[36:39], a[196:199], v[56:59]
    v_mfma_f32_16x16x32_bf16 v[60:63], v[36:39], a[200:203], v[60:63]
    s_waitcnt lgkmcnt(2)
    v_mfma_f32_16x16x32_bf16 v[52:55], v[40:43], a[204:207], v[52:55]
    v_mfma_f32_16x16x32_bf16 v[56:59], v[40:43], a[208:211], v[56:59]
    v_mfma_f32_16x16x32_bf16 v[60:63], v[40:43], a[212:215], v[60:63]
    s_waitcnt lgkmcnt(1)
    v_mfma_f32_16x16x32_bf16 v[52:55], v[44:47], a[216:219], v[52:55]
    v_mfma_f32_16x16x32_bf16 v[56:59], v[44:47], a[220:223], v[56:59]
    v_mfma_f32_16x16x32_bf16 v[60:63], v[44:47], a[224:227], v[60:63]
    s_waitcnt lgkmcnt(0)
    v_mfma_f32_16x16x32_bf16 v[52:55], v[48:51], a[228:231], v[52:55]
    v_mfma_f32_16x16x32_bf16 v[56:59], v[48:51], a[232:235], v[56:59]
    v_mfma_f32_16x16x32_bf16 v[60:63], v[48:51], a[236:239], v[60:63]
    ds_read_b128 v[116:119], v1 offset:0
    ds_read_b128 v[120:123], v1 offset:1024
    ds_read_b128 v[124:127], v1 offset:2048
    ds_read_b128 v[128:131], v1 offset:3072
    ds_read_b128 v[132:135], v1 offset:4096
    ds_read_b128 v[136:139], v1 offset:5120
    ds_read_b128 v[140:143], v1 offset:6144
    ds_read_b128 v[144:147], v1 offset:7168
    ds_read_b128 v[148:151], v1 offset:8192
    ds_read_b128 v[152:155], v1 offset:9216
    ds_read_b128 v[156:159], v1 offset:10240
    ds_read_b128 v[160:163], v1 offset:11264
    ds_read_b128 v[164:167], v1 offset:12288
    ds_read_b128 v[168:171], v1 offset:13312
    ds_read_b128 v[172:175], v1 offset:14336
    v_cndmask_b32 v36, 0, v52, s[10:11]
    v_cndmask_b32 v37, 0, v56, s[10:11]
    v_cndmask_b32 v38, 0, v60, s[10:11]
    v_cvt_pk_bf16_f32 v248, v36, v36
    v_cvt_pk_bf16_f32 v250, v37, v37
    v_cvt_pk_bf16_f32 v252, v38, v38
    v_and_b32 v40, s96, v248
    v_and_b32 v41, s96, v250
    v_and_b32 v42, s96, v252
    v_sub_f32 v36, v36, v40
    v_sub_f32 v37, v37, v41
    v_sub_f32 v38, v38, v42
    v_cvt_pk_bf16_f32 v249, v36, v36
    v_cvt_pk_bf16_f32 v251, v37, v37
    v_cvt_pk_bf16_f32 v253, v38, v38
    s_waitcnt vmcnt(0)
    v_cmp_gt_u32 vcc, 1, v0
    s_cbranch_vccnz L_back_poll_9
L_back_ok_10:
    global_load_dwordx4 v[36:39], v2, s[32:33] offset:-4096 sc1
    global_load_dwordx4 v[40:43], v2, s[32:33] offset:-2048 sc1
    global_load_dwordx4 v[44:47], v2, s[32:33] offset:0 sc1
    global_load_dwordx4 v[48:51], v2, s[32:33] offset:2048 sc1
    s_add_u32 s32, s32, 8192
    global_load_dwordx2 v[52:53], v254, s[32:33] offset:-4096 sc1
    global_load_dwordx2 v[54:55], v254, s[32:33] offset:-3840 sc1
    global_load_dwordx4 v[56:59], v2, s[32:33] offset:-2048 sc1
    global_load_dwordx4 v[60:63], v2, s[32:33] offset:0 sc1
    global_load_dwordx4 v[64:67], v2, s[32:33] offset:2048 sc1
    s_add_u32 s32, s32, 8192
    global_load_dwordx4 v[68:71], v2, s[32:33] offset:-4096 sc1
    global_load_dwordx2 v[72:73], v254, s[32:33] offset:-2048 sc1
    global_load_dwordx2 v[74:75], v254, s[32:33] offset:-1792 sc1
    global_load_dwordx4 v[76:79], v2, s[32:33] offset:0 sc1
    global_load_dwordx4 v[80:83], v2, s[32:33] offset:2048 sc1
    s_add_u32 s32, s32, 8192
    s_mov_b32 s0, 1
    s_cmp_eq_u32 s29, 0
    s_cbranch_scc1 L_back_stub1_0
    s_cmp_eq_u32 s29, 1
    s_cbranch_scc1 L_back_stub1_1
    s_cmp_eq_u32 s29, 2
    s_cbranch_scc1 L_back_stub1_2
    s_branch L_back_stub1_3
L_back_wret1:
    s_mov_b32 s0, 0
    s_waitcnt vmcnt(13) lgkmcnt(10)
    v_mfma_f32_16x16x32_bf16 v[16:19], v[116:119], v[36:39], 0
    global_load_dwordx4 v[84:87], v2, s[32:33] offset:-4096 sc1
    v_mfma_f32_16x16x32_bf16 v[20:23], v[120:123], v[36:39], 0
    ds_read_b128 v[116:119], v1 offset:15360
    v_mfma_f32_16x16x32_bf16 v[24:27], v[124:127], v[36:39], 0
    ds_read_b128 v[120:123], v1 offset:16384
    v_mfma_f32_16x16x32_bf16 v[28:31], v[128:131], v[36:39], 0
    ds_read_b128 v[124:127], v1 offset:17408
    v_mfma_f32_16x16x32_bf16 v[32:35], v[132:135], v[36:39], 0
    ds_read_b128 v[128:131], v1 offset:18432
    s_waitcnt vmcnt(13) lgkmcnt(9)
    v_mfma_f32_16x16x32_bf16 v[16:19], v[136:139], v[40:43], v[16:19]
    global_load_dwordx4 v[88:91], v2, s[32:33] offset:-2048 sc1
    v_mfma_f32_16x16x32_bf16 v[20:23], v[140:143], v[40:43], v[20:23]
    ds_read_b128 v[132:135], v1 offset:19456
    v_mfma_f32_16x16x32_bf16 v[24:27], v[144:147], v[40:43], v[24:27]
    ds_read_b128 v[136:139], v1 offset:20480
    v_mfma_f32_16x16x32_bf16 v[28:31], v[148:151], v[40:43], v[28:31]
    ds_read_b128 v[140:143], v1 offset:21504
    v_mfma_f32_16x16x32_bf16 v[32:35], v[152:155], v[40:43], v[32:35]
    ds_read_b128 v[144:147], v1 offset:22528
    s_waitcnt vmcnt(13) lgkmcnt(8)
    v_mfma_f32_16x16x32_bf16 v[16:19], v[156:159], v[44:47], v[16:19]
    ds_read_b128 v[148:151], v1 offset:23552
    v_mfma_f32_16x16x32_bf16 v[20:23], v[160:163], v[44:47], v[20:23]
    global_load_dwordx2 v[92:93], v254, s[32:33] offset:0 sc1
    v_mfma_f32_16x16x32_bf16 v[24:27], v[164:167], v[44:47], v[24:27]
    global_load_dwordx2 v[94:95], v254, s[32:33] offset:256 sc1
    v_mfma_f32_16x16x32_bf16 v[28:31], v[168:171], v[44:47], v[28:31]
    ds_read_b128 v[152:155], v1 offset:24576
    v_mfma_f32_16x16x32_bf16 v[32:35], v[172:175], v[44:47], v[32:35]
    ds_read_b128 v[156:159], v1 offset:25600
    s_waitcnt vmcnt(14) lgkmcnt(6)
    v_mfma_f32_16x16x32_bf16 v[16:19], v[116:119], v[48:51], v[16:19]
    ds_read_b128 v[160:163], v1 offset:26624
    v_mfma_f32_16x16x32_bf16 v[20:23], v[120:123], v[48:51], v[20:23]
    ds_read_b128 v[164:167], v1 offset:27648
    v_mfma_f32_16x16x32_bf16 v[24:27], v[124:127], v[48:51], v[24:27]
    ds_read_b128 v[168:171], v1 offset:28672
    global_load_dwordx4 v[96:99], v2, s[32:33] offset:2048 sc1
    s_add_u32 s32, s32, 8192
    v_mfma_f32_16x16x32_bf16 v[28:31], v[128:131], v[48:51], v[28:31]
    ds_read_b128 v[172:175], v1 offset:29696
    v_mfma_f32_16x16x32_bf16 v[32:35], v[132:135], v[48:51], v[32:35]
    ds_read_b128 v[116:119], v1 offset:30720
    s_waitcnt vmcnt(13) lgkmcnt(6)
    v_mfma_f32_16x16x32_bf16 v[16:19], v[136:139], v[52:55], v[16:19]
    ds_read_b128 v[120:123], v1 offset:31744
    v_mfma_f32_16x16x32_bf16 v[20:23], v[140:143], v[52:55], v[20:23]
    ds_read_b128 v[124:127], v1 offset:32768
    v_mfma_f32_16x16x32_bf16 v[24:27], v[144:147], v[52:55], v[24:27]
    ds_read_b128 v[128:131], v1 offset:33792
    global_load_dwordx4 v[100:103], v2, s[32:33] offset:-4096 sc1
    v_mfma_f32_16x16x32_bf16 v[28:31], v[148:151], v[52:55], v[28:31]
    ds_read_b128 v[132:135], v1 offset:34816
    v_mfma_f32_16x16x32_bf16 v[32:35], v[152:155], v[52:55], v[32:35]
    ds_read_b128 v[136:139], v1 offset:35840
    s_waitcnt vmcnt(13) lgkmcnt(6)
    v_mfma_f32_16x16x32_bf16 v[16:19], v[156:159], v[56:59], v[16:19]
    ds_read_b128 v[140:143], v1 offset:36864
    v_mfma_f32_16x16x32_bf16 v[20:23], v[160:163], v[56:59], v[20:23]
    ds_read_b128 v[144:147], v1 offset:37888
    v_mfma_f32_16x16x32_bf16 v[24:27], v[164:167], v[56:59], v[24:27]
    ds_read_b128 v[148:151], v1 offset:38912
    global_load_dwordx4 v[104:107], v2, s[32:33] offset:-2048 sc1
    v_mfma_f32_16x16x32_bf16 v[28:31], v[168:171], v[56:59], v[28:31]
    ds_read_b128 v[152:155], v1 offset:39936
    v_mfma_f32_16x16x32_bf16 v[32:35], v[172:175], v[56:59], v[32:35]
    ds_read_b128 v[156:159], v1 offset:40960
    s_waitcnt vmcnt(13) lgkmcnt(6)
    v_mfma_f32_16x16x32_bf16 v[16:19], v[116:119], v[60:63], v[16:19]
    ds_read_b128 v[160:163], v1 offset:41984
    v_mfma_f32_16x16x32_bf16 v[20:23], v[120:123], v[60:63], v[20:23]
    ds_read_b128 v[164:167], v1 offset:43008
    v_mfma_f32_16x16x32_bf16 v[24:27], v[124:127], v[60:63], v[24:27]
    ds_read_b128 v[168:171], v1 offset:44032
    global_load_dwordx4 v[108:111], v2, s[32:33] offset:0 sc1
    v_mfma_f32_16x16x32_bf16 v[28:31], v[128:131], v[60:63], v[28:31]
    ds_read_b128 v[172:175], v1 offset:45056
    v_mfma_f32_16x16x32_bf16 v[32:35], v[132:135], v[60:63], v[32:35]
    ds_read_b128 v[116:119], v1 offset:46080
    s_waitcnt vmcnt(13) lgkmcnt(6)
    v_mfma_f32_16x16x32_bf16 v[16:19], v[136:139], v[64:67], v[16:19]
    ds_read_b128 v[120:123], v1 offset:47104
    v_mfma_f32_16x16x32_bf16 v[20:23], v[140:143], v[64:67], v[20:23]
    ds_read_b128 v[124:127], v1 offset:48128
    v_mfma_f32_16x16x32_bf16 v[24:27], v[144:147], v[64:67], v[24:27]
    ds_read_b128 v[128:131], v1 offset:49152
    global_load_dwordx2 v[112:113], v254, s[32:33] offset:2048 sc1
    global_load_dwordx2 v[114:115], v254, s[32:33] offset:2304 sc1
    s_add_u32 s32, s32, 8192
    v_mfma_f32_16x16x32_bf16 v[28:31], v[148:151], v[64:67], v[28:31]
    ds_read_b128 v[132:135], v1 offset:50176
    v_mfma_f32_16x16x32_bf16 v[32:35], v[152:155], v[64:67], v[32:35]
    ds_read_b128 v[136:139], v6 offset:0
    s_waitcnt vmcnt(14) lgkmcnt(6)
    v_mfma_f32_16x16x32_bf16 v[16:19], v[156:159], v[68:71], v[16:19]
    ds_read_b128 v[140:143], v6 offset:1024
    v_mfma_f32_16x16x32_bf16 v[20:23], v[160:163], v[68:71], v[20:23]
    ds_read_b128 v[144:147], v6 offset:2048
    v_mfma_f32_16x16x32_bf16 v[24:27], v[164:167], v[68:71], v[24:27]
    ds_read_b128 v[148:151], v6 offset:3072
    v_mfma_f32_16x16x32_bf16 v[28:31], v[168:171], v[68:71], v[28:31]
    ds_read_b128 v[152:155], v6 offset:4096
    v_mfma_f32_16x16x32_bf16 v[32:35], v[172:175], v[68:71], v[32:35]
    ds_read_b128 v[156:159], v6 offset:5120
    s_waitcnt vmcnt(12) lgkmcnt(6)
    v_mfma_f32_16x16x32_bf16 v[16:19], v[116:119], v[72:75], v[16:19]
    ds_read_b128 v[160:163], v6 offset:6144
    v_mfma_f32_16x16x32_bf16 v[20:23], v[120:123], v[72:75], v[20:23]
    ds_read_b128 v[164:167], v6 offset:7168
    v_mfma_f32_16x16x32_bf16 v[24:27], v[124:127], v[72:75], v[24:27]
    ds_read_b128 v[168:171], v6 offset:8192
    v_mfma_f32_16x16x32_bf16 v[28:31], v[128:131], v[72:75], v[28:31]
    ds_read_b128 v[172:175], v6 offset:9216
    v_mfma_f32_16x16x32_bf16 v[32:35], v[132:135], v[72:75], v[32:35]
    ds_read_b128 v[116:119], v6 offset:10240
    s_waitcnt vmcnt(11) lgkmcnt(6)
    v_mfma_f32_16x16x32_bf16 v[16:19], v[136:139], v[76:79], v[16:19]
    ds_read_b128 v[120:123], v6 offset:11264
    v_mfma_f32_16x16x32_bf16 v[20:23], v[140:143], v[76:79], v[20:23]
    ds_read_b128 v[124:127], v6 offset:12288
    v_mfma_f32_16x16x32_bf16 v[24:27], v[144:147], v[76:79], v[24:27]
    ds_read_b128 v[128:131], v6 offset:13312
    v_mfma_f32_16x16x32_bf16 v[28:31], v[148:151], v[76:79], v[28:31]
    ds_read_b128 v[132:135], v6 offset:14336
    v_mfma_f32_16x16x32_bf16 v[32:35], v[152:155], v[76:79], v[32:35]
    ds_read_b128 v[136:139], v6 offset:15360
    s_waitcnt vmcnt(10) lgkmcnt(6)
    v_mfma_f32_16x16x32_bf16 v[16:19], v[156:159], v[80:83], v[16:19]
    ds_read_b128 v[140:143], v6 offset:16384
    v_mfma_f32_16x16x32_bf16 v[20:23], v[160:163], v[80:83], v[20:23]
    ds_read_b128 v[144:147], v6 offset:17408
    v_mfma_f32_16x16x32_bf16 v[24:27], v[164:167], v[80:83], v[24:27]
    ds_read_b128 v[148:151], v6 offset:18432
    v_mfma_f32_16x16x32_bf16 v[28:31], v[168:171], v[80:83], v[28:31]
    ds_read_b128 v[152:155], v6 offset:19456
    v_mfma_f32_16x16x32_bf16 v[32:35], v[172:175], v[80:83], v[32:35]
    ds_read_b128 v[156:159], v6 offset:20480
    s_waitcnt vmcnt(9) lgkmcnt(6)
    v_mfma_f32_16x16x32_bf16 v[16:19], v[116:119], v[84:87], v[16:19]
    ds_read_b128 v[160:163], v6 offset:21504
    v_mfma_f32_16x16x32_bf16 v[20:23], v[120:123], v[84:87], v[20:23]
    ds_read_b128 v[164:167], v6 offset:22528
    v_mfma_f32_16x16x32_bf16 v[24:27], v[124:127], v[84:87], v[24:27]
    ds_read_b128 v[168:171], v6 offset:23552
    v_mfma_f32_16x16x32_bf16 v[28:31], v[128:131], v[84:87], v[28:31]
    ds_read_b128 v[172:175], v6 offset:24576
    v_mfma_f32_16x16x32_bf16 v[32:35], v[132:135], v[84:87], v[32:35]
    ds_read_b128 v[116:119], v6 offset:25600
L_back_stub1_0:
    s_cmp_eq_u32 s0, 1
    s_cbranch_scc1 L_back_wret1
    s_waitcnt vmcnt(8) lgkmcnt(6)
    v_mfma_f32_16x16x32_bf16 v[16:19], v[136:139], v[88:91], v[16:19]
    ds_read_b128 v[120:123], v6 offset:26624
    v_mfma_f32_16x16x32_bf16 v[20:23], v[140:143], v[88:91], v[20:23]
    ds_read_b128 v[124:127], v6 offset:27648
    v_mfma_f32_16x16x32_bf16 v[24:27], v[144:147], v[88:91], v[24:27]
    ds_read_b128 v[128:131], v6 offset:28672
    v_mfma_f32_16x16x32_bf16 v[28:31], v[148:151], v[88:91], v[28:31]
    ds_read_b128 v[132:135], v6 offset:29696
    v_mfma_f32_16x16x32_bf16 v[32:35], v[152:155], v[88:91], v[32:35]
    ds_read_b128 v[136:139], v6 offset:30720
    s_waitcnt vmcnt(6) lgkmcnt(6)
    v_mfma_f32_16x16x32_bf16 v[16:19], v[156:159], v[92:95], v[16:19]
    ds_read_b128 v[140:143], v6 offset:31744
    v_mfma_f32_16x16x32_bf16 v[20:23], v[160:163], v[92:95], v[20:23]
    ds_read_b128 v[144:147], v6 offset:32768
    v_mfma_f32_16x16x32_bf16 v[24:27], v[164:167], v[92:95], v[24:27]
    ds_read_b128 v[148:151], v6 offset:33792
    v_mfma_f32_16x16x32_bf16 v[28:31], v[168:171], v[92:95], v[28:31]
    ds_read_b128 v[152:155], v6 offset:34816
    v_mfma_f32_16x16x32_bf16 v[32:35], v[172:175], v[92:95], v[32:35]
    ds_read_b128 v[156:159], v6 offset:35840
    s_waitcnt vmcnt(5) lgkmcnt(6)
    v_mfma_f32_16x16x32_bf16 v[16:19], v[116:119], v[96:99], v[16:19]
    ds_read_b128 v[160:163], v6 offset:36864
    v_mfma_f32_16x16x32_bf16 v[20:23], v[120:123], v[96:99], v[20:23]
    ds_read_b128 v[164:167], v6 offset:37888
    v_mfma_f32_16x16x32_bf16 v[24:27], v[124:127], v[96:99], v[24:27]
    ds_read_b128 v[168:171], v6 offset:38912
    v_mfma_f32_16x16x32_bf16 v[28:31], v[128:131], v[96:99], v[28:31]
    ds_read_b128 v[172:175], v6 offset:39936
    v_mfma_f32_16x16x32_bf16 v[32:35], v[132:135], v[96:99], v[32:35]
    ds_read_b128 v[116:119], v6 offset:40960
    s_waitcnt vmcnt(4) lgkmcnt(6)
    v_mfma_f32_16x16x32_bf16 v[16:19], v[136:139], v[100:103], v[16:19]
    ds_read_b128 v[120:123], v6 offset:41984
    v_mfma_f32_16x16x32_bf16 v[20:23], v[140:143], v[100:103], v[20:23]
    ds_read_b128 v[124:127], v6 offset:43008
    v_mfma_f32_16x16x32_bf16 v[24:27], v[144:147], v[100:103], v[24:27]
    ds_read_b128 v[128:131], v6 offset:44032
    v_mfma_f32_16x16x32_bf16 v[28:31], v[148:151], v[100:103], v[28:31]
    ds_read_b128 v[132:135], v6 offset:45056
    v_mfma_f32_16x16x32_bf16 v[32:35], v[152:155], v[100:103], v[32:35]
    ds_read_b128 v[136:139], v6 offset:46080
    s_waitcnt vmcnt(3) lgkmcnt(6)
    v_mfma_f32_16x16x32_bf16 v[16:19], v[156:159], v[104:107], v[16:19]
    ds_read_b128 v[140:143], v6 offset:47104
    v_mfma_f32_16x16x32_bf16 v[20:23], v[160:163], v[104:107], v[20:23]
    ds_read_b128 v[144:147], v6 offset:48128
    v_mfma_f32_16x16x32_bf16 v[24:27], v[164:167], v[104:107], v[24:27]
    ds_read_b128 v[148:151], v6 offset:49152
    v_mfma_f32_16x16x32_bf16 v[28:31], v[168:171], v[104:107], v[28:31]
    ds_read_b128 v[152:155], v6 offset:50176
    v_mfma_f32_16x16x32_bf16 v[32:35], v[172:175], v[104:107], v[32:35]
    s_waitcnt vmcnt(2) lgkmcnt(5)
    v_mfma_f32_16x16x32_bf16 v[16:19], v[116:119], v[108:111], v[16:19]
    v_mfma_f32_16x16x32_bf16 v[20:23], v[120:123], v[108:111], v[20:23]
    v_mfma_f32_16x16x32_bf16 v[24:27], v[124:127], v[108:111], v[24:27]
    v_mfma_f32_16x16x32_bf16 v[28:31], v[128:131], v[108:111], v[28:31]
    v_mfma_f32_16x16x32_bf16 v[32:35], v[132:135], v[108:111], v[32:35]
    s_waitcnt vmcnt(0) lgkmcnt(0)
    v_mfma_f32_16x16x32_bf16 v[16:19], v[136:139], v[112:115], v[16:19]
    v_mfma_f32_16x16x32_bf16 v[20:23], v[140:143], v[112:115], v[20:23]
    v_mfma_f32_16x16x32_bf16 v[24:27], v[144:147], v[112:115], v[24:27]
    v_mfma_f32_16x16x32_bf16 v[28:31], v[148:151], v[112:115], v[28:31]
    v_mfma_f32_16x16x32_bf16 v[32:35], v[152:155], v[112:115], v[32:35]
    v_mov_b32 v108, v248
    v_mov_b32 v109, v249
    v_mov_b32 v110, v250
    v_mov_b32 v111, v251
    v_mov_b32 v112, v252
    v_mov_b32 v113, v253
    v_pk_fma_f32 v[16:17], v[16:17], v[188:189], v[228:229]
    v_pk_fma_f32 v[18:19], v[18:19], v[190:191], v[230:231]
    v_pk_fma_f32 v[20:21], v[20:21], v[192:193], v[232:233]
    v_pk_fma_f32 v[22:23], v[22:23], v[194:195], v[234:235]
    v_pk_fma_f32 v[24:25], v[24:25], v[196:197], v[236:237]
    v_pk_fma_f32 v[26:27], v[26:27], v[198:199], v[238:239]
    v_pk_fma_f32 v[28:29], v[28:29], v[200:201], v[240:241]
    v_pk_fma_f32 v[30:31], v[30:31], v[202:203], v[242:243]
    v_pk_fma_f32 v[32:33], v[32:33], v[204:205], v[244:245]
    v_pk_fma_f32 v[34:35], v[34:35], v[206:207], v[246:247]
    v_pk_mul_f32 v[228:229], v[16:17], v[208:209]
    v_pk_mul_f32 v[230:231], v[18:19], v[210:211]
    v_pk_mul_f32 v[232:233], v[20:21], v[212:213]
    v_pk_mul_f32 v[234:235], v[22:23], v[214:215]
    v_pk_mul_f32 v[236:237], v[24:25], v[216:217]
    v_pk_mul_f32 v[238:239], v[26:27], v[218:219]
    v_pk_mul_f32 v[240:241], v[28:29], v[220:221]
    v_pk_mul_f32 v[242:243], v[30:31], v[222:223]
    v_pk_mul_f32 v[244:245], v[32:33], v[224:225]
    v_pk_mul_f32 v[246:247], v[34:35], v[226:227]
    v_cvt_pk_bf16_f32 v196, v244, v245
    v_cvt_pk_bf16_f32 v198, v244, v245
    v_cvt_pk_bf16_f32 v197, v246, v247
    v_cvt_pk_bf16_f32 v199, v246, v247
    v_cvt_pk_bf16_f32 v188, v228, v229
    v_cvt_pk_bf16_f32 v189, v230, v231
    v_cvt_pk_bf16_f32 v190, v232, v233
    v_cvt_pk_bf16_f32 v191, v234, v235
    buffer_store_dwordx4 v[188:191], v2, s[20:23], s46 offen offset:0 sc1
    v_cvt_pk_bf16_f32 v192, v236, v237
    v_cvt_pk_bf16_f32 v193, v238, v239
    v_cvt_pk_bf16_f32 v194, v240, v241
    v_cvt_pk_bf16_f32 v195, v242, v243
    buffer_store_dwordx4 v[192:195], v2, s[20:23], s46 offen offset:2048 sc1
    v_permlane16_swap_b32 v196, v198
    v_permlane16_swap_b32 v197, v199
    v_and_b32 v228, 0x100, v12
    v_add_u32 v228, v228, v12
    buffer_store_dwordx4 v[196:199], v228, s[20:23], s47 offen sc1
    v_pk_add_f32 v[176:177], v[16:17], v[18:19]
    v_pk_mul_f32 v[178:179], v[16:17], v[16:17]
    v_pk_fma_f32 v[178:179], v[18:19], v[18:19], v[178:179]
    v_pk_add_f32 v[176:177], v[176:177], v[20:21]
    v_pk_fma_f32 v[178:179], v[20:21], v[20:21], v[178:179]
    v_pk_add_f32 v[176:177], v[176:177], v[22:23]
    v_pk_fma_f32 v[178:179], v[22:23], v[22:23], v[178:179]
    v_pk_add_f32 v[176:177], v[176:177], v[24:25]
    v_pk_fma_f32 v[178:179], v[24:25], v[24:25], v[178:179]
    v_pk_add_f32 v[176:177], v[176:177], v[26:27]
    v_pk_fma_f32 v[178:179], v[26:27], v[26:27], v[178:179]
    v_pk_add_f32 v[176:177], v[176:177], v[28:29]
    v_pk_fma_f32 v[178:179], v[28:29], v[28:29], v[178:179]
    v_pk_add_f32 v[176:177], v[176:177], v[30:31]
    v_pk_fma_f32 v[178:179], v[30:31], v[30:31], v[178:179]
    v_pk_add_f32 v[176:177], v[176:177], v[32:33]
    v_pk_fma_f32 v[178:179], v[32:33], v[32:33], v[178:179]
    v_pk_add_f32 v[176:177], v[176:177], v[34:35]
    v_pk_fma_f32 v[178:179], v[34:35], v[34:35], v[178:179]
    v_add_f32 v176, v176, v177
    v_add_f32 v177, v178, v179
    s_nop 1
    v_permlane32_swap_b32 v176, v177
    v_add_f32 v178, v176, v177
    v_add_f32 v179, v176, v177
    s_nop 1
    v_permlane16_swap_b32 v178, v179
    v_add_f32 v178, v178, v179
    buffer_store_dword v178, v11, s[20:23], s48 offen sc1
    s_waitcnt vmcnt(0)
    v_mov_b32 v153, 2
    s_barrier
    buffer_store_dword v153, v5, s[20:23], s55 offen offset:128
    buffer_store_dword v153, v5, s[20:23], s44 offen sc1
    s_mul_i32 s40, s28, 40960
    s_add_u32 s40, s40, 16515072
    s_add_u32 s40, s40, s6
    s_lshl_b32 s51, s29, 11
    s_add_u32 s34, s40, s51
    s_mul_i32 s53, s29, 10240
    s_add_u32 s40, s40, s53
    s_add_u32 s40, s40, 8192
    s_mov_b32 s18, 0x10000
    s_lshl_b32 s54, s30, 11
    s_add_u32 s54, s54, 65536
    s_mul_i32 s16, s28, 98304
    s_add_u32 s16, s16, 19136512
    s_add_u32 s16, s16, s6
    s_mul_i32 s58, s29, 24576
    s_add_u32 s58, s58, s16
    s_add_u32 s58, s58, 4096
    s_mov_b32 s59, s7
    s_mul_i32 s36, s39, 1536
    s_add_u32 s16, s16, s36
    s_mov_b32 s24, s8
    s_mov_b32 s25, s9
    s_mov_b32 s26, 2621440
    s_mov_b32 s27, 0x20000
    v_add_u32 v152, s50, v15
    v_add_u32 v154, s52, v1
    s_add_u32 s36, s53, 40960
    v_add_u32 v155, s36, v1
    v_add_u32 v119, 81920, v3
    v_and_b32 v118, 0x1ff, v12
    v_add_u32 v118, 126976, v118
    v_bfe_u32 v132, v1, 8, 1
    v_lshlrev_b32 v132, 10, v132
    v_lshl_add_u32 v132, v15, 1, v132
    v_and_b32 v133, 0x200, v1
    v_add_u32 v132, v132, v133
    v_lshrrev_b32 v133, 4, v1
    v_cmp_lt_u32 vcc, 39, v133
    v_min_u32 v133, 39, v133
    v_mul_u32_u24 v134, 13, v133
    v_lshrrev_b32 v134, 7, v134
    v_mul_u32_u24 v135, 10, v134
    v_sub_u32 v133, v133, v135
    v_lshl_add_u32 v134, s29, 2, v134
    s_mul_i32 s36, s29, 40960
    s_sub_u32 s61, s61, s36
    v_mul_u32_u24 v7, 1280, v134
    v_lshl_add_u32 v7, v133, 4, v7
    v_mov_b32 v135, 0x40000000
    v_cndmask_b32 v7, v7, v135, vcc
    v_lshlrev_b32 v9, 5, v133
    v_add_u32 v9, 126592, v9
    v_lshrrev_b32 v135, 3, v133
    v_and_b32 v136, 3, v133
    v_lshlrev_b32 v136, v135, v136
    v_lshrrev_b32 v137, 2, v133
    v_lshlrev_b32 v137, 7, v137
    v_lshl_add_u32 v138, v136, 2, v134
    v_and_b32 v138, 15, v138
    v_lshl_add_u32 v138, v136, 4, v138
    v_add_lshl_u32 v11, v138, v137, 4
    v_add_u32 v136, v136, v135
    v_xor_b32 v135, 1, v135
    v_lshl_add_u32 v137, v135, 6, v137
    v_lshl_add_u32 v138, v136, 2, v134
    v_and_b32 v138, 15, v138
    v_lshl_add_u32 v138, v136, 4, v138
    v_add_lshl_u32 v8, v138, v137, 4
    v_lshrrev_b32 v133, 2, v1
    v_and_b32 v133, 0xc0, v133
    v_add_u32 v133, v133, v1
    v_and_b32 v133, 0xf0, v133
    v_and_b32 v6, 0x300, v1
    v_add_u32 v6, v6, v133
    s_mul_i32 s36, s29, 5120
    v_add_u32 v6, s36, v6
    v_mov_b32 v153, 3
    buffer_load_dword v0, v152, s[20:23], 0 offen offset:128 sc1
    s_waitcnt vmcnt(0)
    v_cmp_gt_u32 vcc, 2, v0
    s_cbranch_vccnz L_back_poll_11
L_back_ok_12:
    s_add_u32 m0, s51, 0
    s_nop 0
    global_load_lds_dwordx4 v1, s[34:35] offset:0 sc1
    global_load_lds_dwordx4 v1, s[34:35] offset:1024 sc1
    s_add_u32 m0, s51, 8192
    s_add_u32 s34, s34, 8192
    global_load_lds_dwordx4 v1, s[34:35] offset:0 sc1
    global_load_lds_dwordx4 v1, s[34:35] offset:1024 sc1
    buffer_load_dwordx2 v[144:145], v132, s[20:23], s54 offen offset:0 sc1
    buffer_load_dwordx2 v[146:147], v132, s[20:23], s54 offen offset:128 sc1
    buffer_load_dwordx2 v[148:149], v132, s[20:23], s54 offen offset:256 sc1
    buffer_load_dwordx2 v[150:151], v132, s[20:23], s54 offen offset:384 sc1
    s_add_u32 m0, s51, 16384
    s_add_u32 s34, s34, 8192
    global_load_lds_dwordx4 v1, s[34:35] offset:0 sc1
    global_load_lds_dwordx4 v1, s[34:35] offset:1024 sc1
    s_add_u32 m0, s51, 24576
    s_add_u32 s34, s34, 8192
    global_load_lds_dwordx4 v1, s[34:35] offset:0 sc1
    global_load_lds_dwordx4 v1, s[34:35] offset:1024 sc1
    s_add_u32 m0, s51, 32768
    s_add_u32 s34, s34, 8192
    global_load_lds_dwordx4 v1, s[34:35] offset:0 sc1
    global_load_lds_dwordx4 v1, s[34:35] offset:1024 sc1
    s_waitcnt vmcnt(12)
    s_barrier
    ds_read_b128 v[84:87], v3 offset:0
    ds_read_b128 v[88:91], v3 offset:256
    ds_read_b128 v[92:95], v3 offset:2048
    ds_read_b128 v[96:99], v3 offset:2304
    s_waitcnt lgkmcnt(2)
    v_mfma_f32_16x16x32_bf16 v[36:39], a[0:3], v[84:87], 0
    ds_read_b128 v[100:103], v3 offset:4096
    v_mfma_f32_16x16x32_bf16 v[40:43], a[4:7], v[84:87], 0
    ds_read_b128 v[104:107], v3 offset:4352
    v_mfma_f32_16x16x32_bf16 v[44:47], a[8:11], v[84:87], 0
    v_mfma_f32_16x16x32_bf16 v[48:51], a[0:3], v[88:91], 0
    v_mfma_f32_16x16x32_bf16 v[52:55], a[4:7], v[88:91], 0
    v_mfma_f32_16x16x32_bf16 v[56:59], a[8:11], v[88:91], 0
    s_waitcnt lgkmcnt(2)
    v_mfma_f32_16x16x32_bf16 v[36:39], a[12:15], v[92:95], v[36:39]
    ds_read_b128 v[84:87], v3 offset:6144
    v_mfma_f32_16x16x32_bf16 v[40:43], a[16:19], v[92:95], v[40:43]
    ds_read_b128 v[88:91], v3 offset:6400
    v_mfma_f32_16x16x32_bf16 v[44:47], a[20:23], v[92:95], v[44:47]
    v_mfma_f32_16x16x32_bf16 v[48:51], a[12:15], v[96:99], v[48:51]
    v_mfma_f32_16x16x32_bf16 v[52:55], a[16:19], v[96:99], v[52:55]
    s_waitcnt vmcnt(10)
    s_barrier
    v_mfma_f32_16x16x32_bf16 v[56:59], a[20:23], v[96:99], v[56:59]
    s_waitcnt lgkmcnt(2)
    v_mfma_f32_16x16x32_bf16 v[36:39], a[24:27], v[100:103], v[36:39]
    ds_read_b128 v[92:95], v3 offset:8192
    v_mfma_f32_16x16x32_bf16 v[40:43], a[28:31], v[100:103], v[40:43]
    ds_read_b128 v[96:99], v3 offset:8448
    v_mfma_f32_16x16x32_bf16 v[44:47], a[32:35], v[100:103], v[44:47]
    v_mfma_f32_16x16x32_bf16 v[48:51], a[24:27], v[104:107], v[48:51]
    v_mfma_f32_16x16x32_bf16 v[52:55], a[28:31], v[104:107], v[52:55]
    v_mfma_f32_16x16x32_bf16 v[56:59], a[32:35], v[104:107], v[56:59]
    s_waitcnt lgkmcnt(2)
    v_mfma_f32_16x16x32_bf16 v[36:39], a[36:39], v[84:87], v[36:39]
    ds_read_b128 v[100:103], v3 offset:10240
    v_mfma_f32_16x16x32_bf16 v[40:43], a[40:43], v[84:87], v[40:43]
    ds_read_b128 v[104:107], v3 offset:10496
    v_mfma_f32_16x16x32_bf16 v[44:47], a[44:47], v[84:87], v[44:47]
    s_waitcnt vmcnt(6)
    v_mfma_f32_16x16x32_bf16 v[48:51], a[36:39], v[88:91], v[48:51]
    s_add_u32 m0, s53, 40960
    v_add_f32 v144, v144, v146
    v_add_f32 v145, v145, v147
    v_mfma_f32_16x16x32_bf16 v[52:55], a[40:43], v[88:91], v[52:55]
    s_add_u32 s40, s40, 32768
    v_add_f32 v144, v144, v148
    v_add_f32 v145, v145, v149
    v_mfma_f32_16x16x32_bf16 v[56:59], a[44:47], v[88:91], v[56:59]
    s_waitcnt lgkmcnt(2)
    v_add_f32 v144, v144, v150
    v_add_f32 v145, v145, v151
    v_mfma_f32_16x16x32_bf16 v[36:39], a[48:51], v[92:95], v[36:39]
    s_lshl_b32 s36, s29, 9
    v_mov_b32 v146, v144
    v_mov_b32 v147, v145
    v_mfma_f32_16x16x32_bf16 v[40:43], a[52:55], v[92:95], v[40:43]
    s_add_u32 s36, s36, 65536
    v_permlane32_swap_b32 v144, v146
    v_mfma_f32_16x16x32_bf16 v[44:47], a[56:59], v[92:95], v[44:47]
    ds_read_b128 v[84:87], v3 offset:12288
    v_and_b32 v140, 0x1f0, v1
    v_mfma_f32_16x16x32_bf16 v[48:51], a[48:51], v[96:99], v[48:51]
    global_load_lds_dwordx4 v1, s[40:41] offset:0 sc1
    v_add_f32 v144, v144, v146
    v_mfma_f32_16x16x32_bf16 v[52:55], a[52:55], v[96:99], v[52:55]
    ds_read_b128 v[88:91], v3 offset:12544
    v_mul_f32 v144, 0xbacccccd, v144
    v_mfma_f32_16x16x32_bf16 v[56:59], a[56:59], v[96:99], v[56:59]
    s_waitcnt lgkmcnt(2)
    v_permlane32_swap_b32 v145, v147
    v_mfma_f32_16x16x32_bf16 v[36:39], a[60:63], v[100:103], v[36:39]
    global_load_lds_dwordx4 v1, s[40:41] offset:1024 sc1
    v_add_f32 v145, v145, v147
    v_mfma_f32_16x16x32_bf16 v[40:43], a[64:67], v[100:103], v[40:43]
    ds_read_b128 v[92:95], v3 offset:14336
    v_mul_f32 v145, 0x3acccccd, v145
    v_mfma_f32_16x16x32_bf16 v[44:47], a[68:71], v[100:103], v[44:47]
    ds_read_b128 v[96:99], v3 offset:14592
    v_fma_f32 v145, -v144, v144, v145
    v_mfma_f32_16x16x32_bf16 v[48:51], a[60:63], v[104:107], v[48:51]
    global_load_lds_dwordx4 v1, s[40:41] offset:2048 sc1
    v_max_f32 v145, 0, v145
    v_mfma_f32_16x16x32_bf16 v[52:55], a[64:67], v[104:107], v[52:55]
    s_waitcnt vmcnt(7)
    s_barrier
    v_add_f32 v134, 0x3727c5ac, v145
    v_add_u32 v140, s36, v140
    v_mfma_f32_16x16x32_bf16 v[56:59], a[68:71], v[104:107], v[56:59]
    s_waitcnt lgkmcnt(2)
    v_rsq_f32 v146, v134
    v_mfma_f32_16x16x32_bf16 v[36:39], a[72:75], v[84:87], v[36:39]
    global_load_lds_dwordx4 v1, s[40:41] offset:3072 sc1
    v_mul_f32 v145, v134, v146
    v_mfma_f32_16x16x32_bf16 v[40:43], a[76:79], v[84:87], v[40:43]
    ds_read_b128 v[100:103], v3 offset:16384
    v_mul_f32 v132, 0xc0135761, v146
    v_mfma_f32_16x16x32_bf16 v[44:47], a[80:83], v[84:87], v[44:47]
    s_add_u32 m0, s53, 45056
    v_mul_f32 v147, v146, v146
    v_mul_f32 v147, 0x3d372713, v147
    v_mfma_f32_16x16x32_bf16 v[48:51], a[72:75], v[88:91], v[48:51]
    ds_read_b128 v[104:107], v3 offset:16640
    v_mul_f32 v133, v147, v132
    v_mfma_f32_16x16x32_bf16 v[52:55], a[76:79], v[88:91], v[52:55]
    s_add_u32 s40, s40, 4096
    v_cvt_pk_bf16_f32 v146, v144, v145
    v_lshlrev_b32 v148, 16, v146
    v_mfma_f32_16x16x32_bf16 v[56:59], a[80:83], v[88:91], v[56:59]
    s_waitcnt lgkmcnt(2)
    v_and_b32 v149, s96, v146
    v_sub_f32 v150, v144, v148
    v_mfma_f32_16x16x32_bf16 v[36:39], a[84:87], v[92:95], v[36:39]
    ds_write_b128 v140, v[132:135] offset:61440
    v_sub_f32 v151, v145, v149
    v_mfma_f32_16x16x32_bf16 v[40:43], a[88:91], v[92:95], v[40:43]
    global_load_lds_dwordx4 v1, s[40:41] offset:0 sc1
    v_cvt_pk_bf16_f32 v136, v148, v150
    v_mfma_f32_16x16x32_bf16 v[44:47], a[92:95], v[92:95], v[44:47]
    ds_read_b128 v[84:87], v3 offset:18432
    v_cvt_pk_bf16_f32 v138, v149, v151
    v_mfma_f32_16x16x32_bf16 v[48:51], a[84:87], v[96:99], v[48:51]
    ds_read_b128 v[88:91], v3 offset:18688
    v_cndmask_b32 v136, 0, v136, s[10:11]
    v_mfma_f32_16x16x32_bf16 v[52:55], a[88:91], v[96:99], v[52:55]
    global_load_lds_dwordx4 v1, s[40:41] offset:1024 sc1
    v_cndmask_b32 v138, 0, v138, s[10:11]
    v_mfma_f32_16x16x32_bf16 v[56:59], a[92:95], v[96:99], v[56:59]
    s_waitcnt lgkmcnt(3)
    v_lshrrev_b32 v141, 5, v1
    v_and_b32 v141, 16, v141
    v_mfma_f32_16x16x32_bf16 v[36:39], a[96:99], v[100:103], v[36:39]
    ds_read_b128 v[92:95], v3 offset:20480
    v_mov_b32 v137, v136
    v_mfma_f32_16x16x32_bf16 v[40:43], a[100:103], v[100:103], v[40:43]
    global_load_lds_dwordx4 v1, s[40:41] offset:2048 sc1
    v_mov_b32 v139, v138
    v_mfma_f32_16x16x32_bf16 v[44:47], a[104:107], v[100:103], v[44:47]
    ds_read_b128 v[96:99], v3 offset:20736
    v_lshl_add_u32 v141, v140, 1, v141
    v_mfma_f32_16x16x32_bf16 v[48:51], a[96:99], v[104:107], v[48:51]
    v_subrev_u32 v141, 65536, v141
    v_mfma_f32_16x16x32_bf16 v[52:55], a[100:103], v[104:107], v[52:55]
    ds_write_b128 v141, v[136:139] offset:63488
    v_mfma_f32_16x16x32_bf16 v[56:59], a[104:107], v[104:107], v[56:59]
    global_load_lds_dwordx4 v1, s[40:41] offset:3072 sc1
    s_waitcnt lgkmcnt(3)
    v_mfma_f32_16x16x32_bf16 v[36:39], a[108:111], v[84:87], v[36:39]
    ds_read_b128 v[100:103], v3 offset:22528
    v_mfma_f32_16x16x32_bf16 v[40:43], a[112:115], v[84:87], v[40:43]
    ds_read_b128 v[104:107], v3 offset:22784
    s_add_u32 m0, s53, 49152
    v_mfma_f32_16x16x32_bf16 v[44:47], a[116:119], v[84:87], v[44:47]
    s_add_u32 s40, s40, 4096
    v_mfma_f32_16x16x32_bf16 v[48:51], a[108:111], v[88:91], v[48:51]
    v_mfma_f32_16x16x32_bf16 v[52:55], a[112:115], v[88:91], v[52:55]
    s_waitcnt vmcnt(10)
    s_barrier
    v_mfma_f32_16x16x32_bf16 v[56:59], a[116:119], v[88:91], v[56:59]
    global_load_lds_dwordx4 v1, s[40:41] offset:0 sc1
    s_waitcnt lgkmcnt(3)
    v_mfma_f32_16x16x32_bf16 v[36:39], a[120:123], v[92:95], v[36:39]
    ds_read_b128 v[84:87], v3 offset:24576
    v_mfma_f32_16x16x32_bf16 v[40:43], a[124:127], v[92:95], v[40:43]
    ds_read_b128 v[88:91], v3 offset:24832
    v_mfma_f32_16x16x32_bf16 v[44:47], a[128:131], v[92:95], v[44:47]
    global_load_lds_dwordx4 v1, s[40:41] offset:1024 sc1
    v_mfma_f32_16x16x32_bf16 v[48:51], a[120:123], v[96:99], v[48:51]
    v_mfma_f32_16x16x32_bf16 v[52:55], a[124:127], v[96:99], v[52:55]
    v_mfma_f32_16x16x32_bf16 v[56:59], a[128:131], v[96:99], v[56:59]
    s_waitcnt lgkmcnt(2)
    v_mfma_f32_16x16x32_bf16 v[36:39], a[132:135], v[100:103], v[36:39]
    ds_read_b128 v[92:95], v3 offset:26624
    v_mfma_f32_16x16x32_bf16 v[40:43], a[136:139], v[100:103], v[40:43]
    ds_read_b128 v[96:99], v3 offset:26880
    v_mfma_f32_16x16x32_bf16 v[44:47], a[140:143], v[100:103], v[44:47]
    v_mfma_f32_16x16x32_bf16 v[48:51], a[132:135], v[104:107], v[48:51]
    v_mfma_f32_16x16x32_bf16 v[52:55], a[136:139], v[104:107], v[52:55]
    v_mfma_f32_16x16x32_bf16 v[56:59], a[140:143], v[104:107], v[56:59]
    s_waitcnt lgkmcnt(2)
    v_mfma_f32_16x16x32_bf16 v[36:39], a[144:147], v[84:87], v[36:39]
    ds_read_b128 v[100:103], v3 offset:28672
    v_mfma_f32_16x16x32_bf16 v[40:43], a[148:151], v[84:87], v[40:43]
    ds_read_b128 v[104:107], v3 offset:28928
    v_mfma_f32_16x16x32_bf16 v[44:47], a[152:155], v[84:87], v[44:47]
    v_mfma_f32_16x16x32_bf16 v[48:51], a[144:147], v[88:91], v[48:51]
    v_mfma_f32_16x16x32_bf16 v[52:55], a[148:151], v[88:91], v[52:55]
    v_mfma_f32_16x16x32_bf16 v[56:59], a[152:155], v[88:91], v[56:59]
    s_waitcnt lgkmcnt(2)
    v_mfma_f32_16x16x32_bf16 v[36:39], a[156:159], v[92:95], v[36:39]
    ds_read_b128 v[84:87], v3 offset:30720
    v_mfma_f32_16x16x32_bf16 v[40:43], a[160:163], v[92:95], v[40:43]
    ds_read_b128 v[88:91], v3 offset:30976
    v_mfma_f32_16x16x32_bf16 v[44:47], a[164:167], v[92:95], v[44:47]
    v_mfma_f32_16x16x32_bf16 v[48:51], a[156:159], v[96:99], v[48:51]
    v_mfma_f32_16x16x32_bf16 v[52:55], a[160:163], v[96:99], v[52:55]
    s_waitcnt vmcnt(10)
    s_barrier
    v_mfma_f32_16x16x32_bf16 v[56:59], a[164:167], v[96:99], v[56:59]
    s_waitcnt lgkmcnt(2)
    v_mfma_f32_16x16x32_bf16 v[36:39], a[168:171], v[100:103], v[36:39]
    ds_read_b128 v[92:95], v3 offset:32768
    v_mfma_f32_16x16x32_bf16 v[40:43], a[172:175], v[100:103], v[40:43]
    ds_read_b128 v[96:99], v3 offset:33024
    v_mfma_f32_16x16x32_bf16 v[44:47], a[176:179], v[100:103], v[44:47]
    global_load_dwordx4 v[156:159], v1, s[42:43] offset:2048 sc1
    v_mfma_f32_16x16x32_bf16 v[48:51], a[168:171], v[104:107], v[48:51]
    v_mfma_f32_16x16x32_bf16 v[52:55], a[172:175], v[104:107], v[52:55]
    v_mfma_f32_16x16x32_bf16 v[56:59], a[176:179], v[104:107], v[56:59]
    global_load_dwordx4 v[160:163], v1, s[42:43] offset:3072 sc1
    s_waitcnt lgkmcnt(2)
    v_mfma_f32_16x16x32_bf16 v[36:39], a[180:183], v[84:87], v[36:39]
    ds_read_b128 v[100:103], v3 offset:34816
    s_add_u32 s42, s42, 4096
    v_mfma_f32_16x16x32_bf16 v[40:43], a[184:187], v[84:87], v[40:43]
    ds_read_b128 v[104:107], v3 offset:35072
    v_mfma_f32_16x16x32_bf16 v[44:47], a[188:191], v[84:87], v[44:47]
    v_mfma_f32_16x16x32_bf16 v[48:51], a[180:183], v[88:91], v[48:51]
    global_load_dwordx4 v[164:167], v1, s[42:43] offset:0 sc1
    v_mfma_f32_16x16x32_bf16 v[52:55], a[184:187], v[88:91], v[52:55]
    v_mfma_f32_16x16x32_bf16 v[56:59], a[188:191], v[88:91], v[56:59]
    s_waitcnt lgkmcnt(2)
    v_mfma_f32_16x16x32_bf16 v[36:39], a[192:195], v[92:95], v[36:39]
    ds_read_b128 v[84:87], v3 offset:36864
    v_mfma_f32_16x16x32_bf16 v[40:43], a[196:199], v[92:95], v[40:43]
    ds_read_b128 v[88:91], v3 offset:37120
    v_mfma_f32_16x16x32_bf16 v[44:47], a[200:203], v[92:95], v[44:47]
    global_load_dwordx4 v[168:171], v1, s[42:43] offset:1024 sc1
    v_mfma_f32_16x16x32_bf16 v[48:51], a[192:195], v[96:99], v[48:51]
    v_mfma_f32_16x16x32_bf16 v[52:55], a[196:199], v[96:99], v[52:55]
    v_mfma_f32_16x16x32_bf16 v[56:59], a[200:203], v[96:99], v[56:59]
    global_load_dwordx4 v[172:175], v1, s[42:43] offset:2048 sc1
    s_waitcnt lgkmcnt(2)
    v_mfma_f32_16x16x32_bf16 v[36:39], a[204:207], v[100:103], v[36:39]
    ds_read_b128 v[92:95], v3 offset:38912
    v_mfma_f32_16x16x32_bf16 v[40:43], a[208:211], v[100:103], v[40:43]
    ds_read_b128 v[96:99], v3 offset:39168
    v_mfma_f32_16x16x32_bf16 v[44:47], a[212:215], v[100:103], v[44:47]
    v_mfma_f32_16x16x32_bf16 v[48:51], a[204:207], v[104:107], v[48:51]
    global_load_dwordx4 v[176:179], v1, s[42:43] offset:3072 sc1
    s_add_u32 s42, s42, 4096
    v_mfma_f32_16x16x32_bf16 v[52:55], a[208:211], v[104:107], v[52:55]
    s_waitcnt vmcnt(6)
    s_barrier
    v_mfma_f32_16x16x32_bf16 v[56:59], a[212:215], v[104:107], v[56:59]
    s_waitcnt lgkmcnt(2)
    v_mfma_f32_16x16x32_bf16 v[36:39], a[216:219], v[84:87], v[36:39]
    ds_read_b64 v[114:115], v14 offset:0
    v_mfma_f32_16x16x32_bf16 v[40:43], a[220:223], v[84:87], v[40:43]
    ds_read_b64 v[116:117], v14 offset:512
    v_mfma_f32_16x16x32_bf16 v[44:47], a[224:227], v[84:87], v[44:47]
    ds_read_b128 v[100:103], v4 offset:0
    v_mfma_f32_16x16x32_bf16 v[48:51], a[216:219], v[88:91], v[48:51]
    ds_read_b128 v[104:107], v4 offset:256
    v_mfma_f32_16x16x32_bf16 v[52:55], a[220:223], v[88:91], v[52:55]
    global_load_dwordx4 v[180:183], v1, s[42:43] offset:0 sc1
    v_mfma_f32_16x16x32_bf16 v[56:59], a[224:227], v[88:91], v[56:59]
    global_load_dwordx4 v[184:187], v1, s[42:43] offset:1024 sc1
    s_waitcnt lgkmcnt(4)
    v_mfma_f32_16x16x32_bf16 v[36:39], a[228:231], v[92:95], v[36:39]
    ds_read_b128 v[84:87], v4 offset:2048
    v_mfma_f32_16x16x32_bf16 v[40:43], a[232:235], v[92:95], v[40:43]
    ds_read_b128 v[88:91], v4 offset:2304
    v_mfma_f32_16x16x32_bf16 v[44:47], a[236:239], v[92:95], v[44:47]
    ds_read_b128 v[120:123], v13 offset:0
    v_mfma_f32_16x16x32_bf16 v[48:51], a[228:231], v[96:99], v[48:51]
    ds_read_b128 v[124:127], v13 offset:256
    v_mfma_f32_16x16x32_bf16 v[52:55], a[232:235], v[96:99], v[52:55]
    ds_read_b128 v[128:131], v118 offset:0
    v_mfma_f32_16x16x32_bf16 v[56:59], a[236:239], v[96:99], v[56:59]
    global_load_dwordx4 v[188:191], v1, s[42:43] offset:2048 sc1
    s_waitcnt lgkmcnt(7)
    v_mfma_f32_16x16x16_bf16 v[36:39], v[108:109], v[114:115], v[36:39]
    v_mfma_f32_16x16x16_bf16 v[40:43], v[110:111], v[114:115], v[40:43]
    global_load_dwordx4 v[192:195], v1, s[42:43] offset:3072 sc1
    s_add_u32 s42, s42, 4096
    v_mfma_f32_16x16x16_bf16 v[44:47], v[112:113], v[114:115], v[44:47]
    v_mfma_f32_16x16x16_bf16 v[48:51], v[108:109], v[116:117], v[48:51]
    v_mfma_f32_16x16x16_bf16 v[52:55], v[110:111], v[116:117], v[52:55]
    v_mfma_f32_16x16x16_bf16 v[56:59], v[112:113], v[116:117], v[56:59]
    s_waitcnt lgkmcnt(5)
    v_mfma_f32_16x16x32_bf16 v[60:63], a[0:3], v[100:103], 0
    ds_read_b128 v[92:95], v4 offset:4096
    s_add_u32 m0, s53, 81920
    v_mfma_f32_16x16x32_bf16 v[64:67], a[4:7], v[100:103], 0
    ds_read_b128 v[96:99], v4 offset:4352
    s_add_u32 s40, s40, 32768
    v_mfma_f32_16x16x32_bf16 v[68:71], a[8:11], v[100:103], 0
    s_waitcnt lgkmcnt(2)
    v_mul_f32 v132, v36, v36
    v_mul_f32 v133, v37, v37
    v_mfma_f32_16x16x32_bf16 v[72:75], a[0:3], v[104:107], 0
    v_mul_f32 v134, v38, v38
    v_mul_f32 v135, v39, v39
    v_mfma_f32_16x16x32_bf16 v[76:79], a[4:7], v[104:107], 0
    global_load_lds_dwordx4 v1, s[40:41] offset:0 sc1
    v_fma_f32 v132, v132, v121, v120
    v_mfma_f32_16x16x32_bf16 v[80:83], a[8:11], v[104:107], 0
    v_fma_f32 v133, v133, v121, v120
    v_fma_f32 v134, v134, v121, v120
    v_mfma_f32_16x16x32_bf16 v[60:63], a[12:15], v[84:87], v[60:63]
    ds_read_b128 v[100:103], v4 offset:6144
    v_fma_f32 v135, v135, v121, v120
    v_mfma_f32_16x16x32_bf16 v[64:67], a[16:19], v[84:87], v[64:67]
    ds_read_b128 v[104:107], v4 offset:6400
    v_mul_f32 v132, v132, v36
    v_mfma_f32_16x16x32_bf16 v[68:71], a[20:23], v[84:87], v[68:71]
    v_exp_f32 v132, v132
    v_mfma_f32_16x16x32_bf16 v[72:75], a[12:15], v[88:91], v[72:75]
    global_load_lds_dwordx4 v1, s[40:41] offset:1024 sc1
    v_mul_f32 v133, v133, v37
    v_mfma_f32_16x16x32_bf16 v[76:79], a[16:19], v[88:91], v[76:79]
    v_exp_f32 v133, v133
    v_mfma_f32_16x16x32_bf16 v[80:83], a[20:23], v[88:91], v[80:83]
    s_waitcnt lgkmcnt(2)
    v_mul_f32 v134, v134, v38
    v_mul_f32 v135, v135, v39
    v_mfma_f32_16x16x32_bf16 v[60:63], a[24:27], v[92:95], v[60:63]
    v_exp_f32 v134, v134
    v_mfma_f32_16x16x32_bf16 v[64:67], a[28:31], v[92:95], v[64:67]
    v_exp_f32 v135, v135
    v_mfma_f32_16x16x32_bf16 v[68:71], a[32:35], v[92:95], v[68:71]
    ds_read_b128 v[84:87], v4 offset:8192
    v_mul_f32 v40, v40, v36
    v_mfma_f32_16x16x32_bf16 v[72:75], a[24:27], v[96:99], v[72:75]
    global_load_lds_dwordx4 v1, s[40:41] offset:2048 sc1
    v_mul_f32 v41, v41, v37
    v_mfma_f32_16x16x32_bf16 v[76:79], a[28:31], v[96:99], v[76:79]
    ds_read_b128 v[88:91], v4 offset:8448
    v_mul_f32 v42, v42, v38
    v_mfma_f32_16x16x32_bf16 v[80:83], a[32:35], v[96:99], v[80:83]
    s_waitcnt lgkmcnt(2)
    v_mul_f32 v43, v43, v39
    v_fma_f32 v132, v132, v122, v122
    v_mfma_f32_16x16x32_bf16 v[60:63], a[36:39], v[100:103], v[60:63]
    global_load_lds_dwordx4 v1, s[40:41] offset:3072 sc1
    v_fma_f32 v133, v133, v122, v122
    v_mfma_f32_16x16x32_bf16 v[64:67], a[40:43], v[100:103], v[64:67]
L_back_stub1_1:
    s_cmp_eq_u32 s0, 1
    s_cbranch_scc1 L_back_wret1
    v_rcp_f32 v132, v132
    v_mfma_f32_16x16x32_bf16 v[68:71], a[44:47], v[100:103], v[68:71]
    ds_read_b128 v[92:95], v4 offset:10240
    v_fma_f32 v134, v134, v122, v122
    v_mfma_f32_16x16x32_bf16 v[72:75], a[36:39], v[104:107], v[72:75]
    ds_read_b128 v[96:99], v4 offset:10496
    v_fma_f32 v135, v135, v122, v122
    v_mfma_f32_16x16x32_bf16 v[76:79], a[40:43], v[104:107], v[76:79]
    s_add_u32 m0, s53, 86016
    v_rcp_f32 v133, v133
    v_mfma_f32_16x16x32_bf16 v[80:83], a[44:47], v[104:107], v[80:83]
    s_waitcnt lgkmcnt(2)
    v_rcp_f32 v134, v134
    v_mfma_f32_16x16x32_bf16 v[60:63], a[48:51], v[84:87], v[60:63]
    s_add_u32 s40, s40, 4096
    v_rcp_f32 v135, v135
    v_mfma_f32_16x16x32_bf16 v[64:67], a[52:55], v[84:87], v[64:67]
    ds_read_b128 v[100:103], v4 offset:12288
    v_mul_f32 v40, v40, v132
    v_mfma_f32_16x16x32_bf16 v[68:71], a[56:59], v[84:87], v[68:71]
    ds_read_b128 v[104:107], v4 offset:12544
    v_mul_f32 v41, v41, v133
    v_mfma_f32_16x16x32_bf16 v[72:75], a[48:51], v[88:91], v[72:75]
    global_load_lds_dwordx4 v1, s[40:41] offset:0 sc1
    v_mul_f32 v42, v42, v134
    v_mfma_f32_16x16x32_bf16 v[76:79], a[52:55], v[88:91], v[76:79]
    v_mul_f32 v43, v43, v135
    v_cvt_pk_bf16_f32 v144, v40, v41
    v_mfma_f32_16x16x32_bf16 v[80:83], a[56:59], v[88:91], v[80:83]
    s_waitcnt lgkmcnt(2)
    v_cvt_pk_bf16_f32 v145, v42, v43
    v_mul_f32 v136, v48, v48
    v_mfma_f32_16x16x32_bf16 v[60:63], a[60:63], v[92:95], v[60:63]
    global_load_lds_dwordx4 v1, s[40:41] offset:1024 sc1
    v_mul_f32 v137, v49, v49
    v_mfma_f32_16x16x32_bf16 v[64:67], a[64:67], v[92:95], v[64:67]
    ds_read_b128 v[84:87], v4 offset:14336
    v_mul_f32 v138, v50, v50
    v_mfma_f32_16x16x32_bf16 v[68:71], a[68:71], v[92:95], v[68:71]
    ds_read_b128 v[88:91], v4 offset:14592
    v_mul_f32 v139, v51, v51
    v_mfma_f32_16x16x32_bf16 v[72:75], a[60:63], v[96:99], v[72:75]
    global_load_lds_dwordx4 v1, s[40:41] offset:2048 sc1
    v_fma_f32 v136, v136, v125, v124
    v_mfma_f32_16x16x32_bf16 v[76:79], a[64:67], v[96:99], v[76:79]
    v_fma_f32 v137, v137, v125, v124
    v_fma_f32 v138, v138, v125, v124
    v_mfma_f32_16x16x32_bf16 v[80:83], a[68:71], v[96:99], v[80:83]
    s_waitcnt lgkmcnt(2)
    v_fma_f32 v139, v139, v125, v124
    v_mul_f32 v136, v136, v48
    v_mfma_f32_16x16x32_bf16 v[60:63], a[72:75], v[100:103], v[60:63]
    v_exp_f32 v136, v136
    v_mfma_f32_16x16x32_bf16 v[64:67], a[76:79], v[100:103], v[64:67]
    ds_read_b128 v[92:95], v4 offset:16384
    v_mul_f32 v137, v137, v49
    v_mfma_f32_16x16x32_bf16 v[68:71], a[80:83], v[100:103], v[68:71]
    v_exp_f32 v137, v137
    v_mfma_f32_16x16x32_bf16 v[72:75], a[72:75], v[104:107], v[72:75]
    ds_read_b128 v[96:99], v4 offset:16640
    v_mul_f32 v138, v138, v50
    v_mfma_f32_16x16x32_bf16 v[76:79], a[76:79], v[104:107], v[76:79]
    global_load_lds_dwordx4 v1, s[40:41] offset:3072 sc1
    v_mul_f32 v139, v139, v51
    v_mfma_f32_16x16x32_bf16 v[80:83], a[80:83], v[104:107], v[80:83]
    s_waitcnt lgkmcnt(2)
    v_exp_f32 v138, v138
    v_mfma_f32_16x16x32_bf16 v[60:63], a[84:87], v[84:87], v[60:63]
    s_add_u32 m0, s53, 90112
    v_exp_f32 v139, v139
    v_mfma_f32_16x16x32_bf16 v[64:67], a[88:91], v[84:87], v[64:67]
    s_add_u32 s40, s40, 4096
    v_mul_f32 v52, v52, v48
    v_mul_f32 v53, v53, v49
    v_mfma_f32_16x16x32_bf16 v[68:71], a[92:95], v[84:87], v[68:71]
    ds_read_b128 v[100:103], v4 offset:18432
    v_mul_f32 v54, v54, v50
    v_mfma_f32_16x16x32_bf16 v[72:75], a[84:87], v[88:91], v[72:75]
    ds_read_b128 v[104:107], v4 offset:18688
    v_mul_f32 v55, v55, v51
    v_mfma_f32_16x16x32_bf16 v[76:79], a[88:91], v[88:91], v[76:79]
    global_load_lds_dwordx4 v1, s[40:41] offset:0 sc1
    v_fma_f32 v136, v136, v126, v126
    v_mfma_f32_16x16x32_bf16 v[80:83], a[92:95], v[88:91], v[80:83]
    s_waitcnt lgkmcnt(2)
    v_rcp_f32 v136, v136
    v_mfma_f32_16x16x32_bf16 v[60:63], a[96:99], v[92:95], v[60:63]
    v_permlane32_swap_b32 v44, v56
    v_mfma_f32_16x16x32_bf16 v[64:67], a[100:103], v[92:95], v[64:67]
    v_permlane32_swap_b32 v45, v57
    v_mfma_f32_16x16x32_bf16 v[68:71], a[104:107], v[92:95], v[68:71]
    ds_read_b128 v[84:87], v4 offset:20480
    v_fma_f32 v137, v137, v126, v126
    v_mfma_f32_16x16x32_bf16 v[72:75], a[96:99], v[96:99], v[72:75]
    ds_read_b128 v[88:91], v4 offset:20736
    v_fma_f32 v138, v138, v126, v126
    v_mfma_f32_16x16x32_bf16 v[76:79], a[100:103], v[96:99], v[76:79]
    global_load_lds_dwordx4 v1, s[40:41] offset:1024 sc1
    v_fma_f32 v139, v139, v126, v126
    v_mfma_f32_16x16x32_bf16 v[80:83], a[104:107], v[96:99], v[80:83]
    s_waitcnt lgkmcnt(2)
    v_rcp_f32 v137, v137
    v_mfma_f32_16x16x32_bf16 v[60:63], a[108:111], v[100:103], v[60:63]
    v_rcp_f32 v138, v138
    v_mfma_f32_16x16x32_bf16 v[64:67], a[112:115], v[100:103], v[64:67]
    v_rcp_f32 v139, v139
    v_mfma_f32_16x16x32_bf16 v[68:71], a[116:119], v[100:103], v[68:71]
    ds_read_b128 v[92:95], v4 offset:22528
    v_mul_f32 v52, v52, v136
    v_mfma_f32_16x16x32_bf16 v[72:75], a[108:111], v[104:107], v[72:75]
    ds_read_b128 v[96:99], v4 offset:22784
    v_mul_f32 v53, v53, v137
    v_mfma_f32_16x16x32_bf16 v[76:79], a[112:115], v[104:107], v[76:79]
    v_permlane32_swap_b32 v46, v58
    v_mfma_f32_16x16x32_bf16 v[80:83], a[116:119], v[104:107], v[80:83]
    s_waitcnt lgkmcnt(2)
    v_permlane32_swap_b32 v47, v59
    v_mfma_f32_16x16x32_bf16 v[60:63], a[120:123], v[84:87], v[60:63]
    ds_read_b128 v[100:103], v4 offset:24576
    v_mul_f32 v54, v54, v138
    v_mfma_f32_16x16x32_bf16 v[64:67], a[124:127], v[84:87], v[64:67]
    global_load_dwordx4 v[196:199], v1, s[42:43] offset:0 sc1
    v_mul_f32 v55, v55, v139
    v_mfma_f32_16x16x32_bf16 v[68:71], a[128:131], v[84:87], v[68:71]
    ds_read_b128 v[104:107], v4 offset:24832
    v_cvt_pk_bf16_f32 v146, v52, v53
    v_mfma_f32_16x16x32_bf16 v[72:75], a[120:123], v[88:91], v[72:75]
    v_cvt_pk_bf16_f32 v147, v54, v55
    v_mul_f32 v140, v44, v44
    v_mfma_f32_16x16x32_bf16 v[76:79], a[124:127], v[88:91], v[76:79]
    global_load_dwordx4 v[200:203], v1, s[42:43] offset:1024 sc1
    v_mul_f32 v141, v45, v45
    v_mfma_f32_16x16x32_bf16 v[80:83], a[128:131], v[88:91], v[80:83]
    s_waitcnt lgkmcnt(2)
    v_mul_f32 v142, v46, v46
    v_mul_f32 v143, v47, v47
    v_mfma_f32_16x16x32_bf16 v[60:63], a[132:135], v[92:95], v[60:63]
    ds_read_b128 v[84:87], v4 offset:26624
    v_fma_f32 v140, v140, v129, v128
    v_mfma_f32_16x16x32_bf16 v[64:67], a[136:139], v[92:95], v[64:67]
    ds_read_b128 v[88:91], v4 offset:26880
    v_fma_f32 v141, v141, v129, v128
    v_mfma_f32_16x16x32_bf16 v[68:71], a[140:143], v[92:95], v[68:71]
    global_load_dwordx4 v[204:207], v1, s[42:43] offset:2048 sc1
    v_fma_f32 v142, v142, v129, v128
    v_mfma_f32_16x16x32_bf16 v[72:75], a[132:135], v[96:99], v[72:75]
    v_fma_f32 v143, v143, v129, v128
    v_mul_f32 v140, v140, v44
    v_mfma_f32_16x16x32_bf16 v[76:79], a[136:139], v[96:99], v[76:79]
    v_exp_f32 v140, v140
    v_mfma_f32_16x16x32_bf16 v[80:83], a[140:143], v[96:99], v[80:83]
    s_waitcnt lgkmcnt(2)
    v_mul_f32 v141, v141, v45
    v_mul_f32 v142, v142, v46
    v_mfma_f32_16x16x32_bf16 v[60:63], a[144:147], v[100:103], v[60:63]
    v_exp_f32 v141, v141
    v_mfma_f32_16x16x32_bf16 v[64:67], a[148:151], v[100:103], v[64:67]
    v_exp_f32 v142, v142
    v_mfma_f32_16x16x32_bf16 v[68:71], a[152:155], v[100:103], v[68:71]
    ds_read_b128 v[92:95], v4 offset:28672
    v_mul_f32 v143, v143, v47
    v_mfma_f32_16x16x32_bf16 v[72:75], a[144:147], v[104:107], v[72:75]
    global_load_dwordx4 v[208:211], v1, s[42:43] offset:3072 sc1
    s_add_u32 s42, s42, 4096
    v_mul_f32 v56, v56, v44
    v_mfma_f32_16x16x32_bf16 v[76:79], a[148:151], v[104:107], v[76:79]
    ds_read_b128 v[96:99], v4 offset:28928
    v_mul_f32 v57, v57, v45
    v_mfma_f32_16x16x32_bf16 v[80:83], a[152:155], v[104:107], v[80:83]
    s_waitcnt lgkmcnt(2)
    v_exp_f32 v143, v143
    v_mfma_f32_16x16x32_bf16 v[60:63], a[156:159], v[84:87], v[60:63]
    global_load_dwordx4 v[212:215], v1, s[42:43] offset:0 sc1
    v_mul_f32 v58, v58, v46
    v_mfma_f32_16x16x32_bf16 v[64:67], a[160:163], v[84:87], v[64:67]
    ds_read_b128 v[100:103], v4 offset:30720
    v_mul_f32 v59, v59, v47
    v_mfma_f32_16x16x32_bf16 v[68:71], a[164:167], v[84:87], v[68:71]
    ds_read_b128 v[104:107], v4 offset:30976
    v_fma_f32 v140, v140, v130, v130
    v_mfma_f32_16x16x32_bf16 v[72:75], a[156:159], v[88:91], v[72:75]
    v_rcp_f32 v140, v140
    v_mfma_f32_16x16x32_bf16 v[76:79], a[160:163], v[88:91], v[76:79]
    global_load_dwordx4 v[216:219], v1, s[42:43] offset:1024 sc1
    v_fma_f32 v141, v141, v130, v130
    v_mfma_f32_16x16x32_bf16 v[80:83], a[164:167], v[88:91], v[80:83]
    s_waitcnt lgkmcnt(2)
    v_rcp_f32 v141, v141
    v_mfma_f32_16x16x32_bf16 v[60:63], a[168:171], v[92:95], v[60:63]
    v_permlane16_swap_b32 v144, v146
    v_mfma_f32_16x16x32_bf16 v[64:67], a[172:175], v[92:95], v[64:67]
    v_permlane16_swap_b32 v145, v147
    v_mfma_f32_16x16x32_bf16 v[68:71], a[176:179], v[92:95], v[68:71]
    buffer_store_dwordx4 v[144:147], v1, s[16:19], 0 offen sc1
    v_fma_f32 v142, v142, v130, v130
    v_mfma_f32_16x16x32_bf16 v[72:75], a[168:171], v[96:99], v[72:75]
    ds_read_b128 v[84:87], v4 offset:32768
    v_fma_f32 v143, v143, v130, v130
    v_mfma_f32_16x16x32_bf16 v[76:79], a[172:175], v[96:99], v[76:79]
    ds_read_b128 v[88:91], v4 offset:33024
    global_load_dwordx4 v[220:223], v1, s[42:43] offset:2048 sc1
    v_mul_f32 v56, v56, v140
    v_mfma_f32_16x16x32_bf16 v[80:83], a[176:179], v[96:99], v[80:83]
    s_waitcnt lgkmcnt(2)
    v_rcp_f32 v142, v142
    v_mfma_f32_16x16x32_bf16 v[60:63], a[180:183], v[100:103], v[60:63]
    v_rcp_f32 v143, v143
    v_mfma_f32_16x16x32_bf16 v[64:67], a[184:187], v[100:103], v[64:67]
    global_load_dwordx4 v[224:227], v1, s[42:43] offset:3072 sc1
    v_mul_f32 v57, v57, v141
    v_mfma_f32_16x16x32_bf16 v[68:71], a[188:191], v[100:103], v[68:71]
    ds_read_b128 v[92:95], v4 offset:34816
    s_add_u32 s42, s42, 4096
    v_mul_f32 v58, v58, v142
    v_mfma_f32_16x16x32_bf16 v[72:75], a[180:183], v[104:107], v[72:75]
    ds_read_b128 v[96:99], v4 offset:35072
    v_mul_f32 v59, v59, v143
    v_mfma_f32_16x16x32_bf16 v[76:79], a[184:187], v[104:107], v[76:79]
    global_load_dwordx4 v[228:231], v1, s[42:43] offset:0 sc1
    v_cvt_pk_bf16_f32 v148, v56, v57
    v_mfma_f32_16x16x32_bf16 v[80:83], a[188:191], v[104:107], v[80:83]
    s_waitcnt lgkmcnt(2)
    v_cvt_pk_bf16_f32 v149, v58, v59
    v_cvt_pk_bf16_f32 v150, v56, v57
    v_mfma_f32_16x16x32_bf16 v[60:63], a[192:195], v[84:87], v[60:63]
    ds_read_b128 v[100:103], v4 offset:36864
    v_cvt_pk_bf16_f32 v151, v58, v59
    v_mfma_f32_16x16x32_bf16 v[64:67], a[196:199], v[84:87], v[64:67]
    v_permlane16_swap_b32 v148, v150
    v_mfma_f32_16x16x32_bf16 v[68:71], a[200:203], v[84:87], v[68:71]
    v_permlane16_swap_b32 v149, v151
    v_mfma_f32_16x16x32_bf16 v[72:75], a[192:195], v[88:91], v[72:75]
    buffer_store_dwordx4 v[148:151], v12, s[16:19], 0 offen offset:1024 sc1
    s_add_u32 s16, s16, 98304
    v_mfma_f32_16x16x32_bf16 v[76:79], a[196:199], v[88:91], v[76:79]
    ds_read_b128 v[104:107], v4 offset:37120
    v_mfma_f32_16x16x32_bf16 v[80:83], a[200:203], v[88:91], v[80:83]
    global_load_dwordx4 v[232:235], v1, s[42:43] offset:1024 sc1
    s_waitcnt lgkmcnt(2)
    v_mfma_f32_16x16x32_bf16 v[60:63], a[204:207], v[92:95], v[60:63]
    ds_read_b128 v[120:123], v13 offset:512
    v_mfma_f32_16x16x32_bf16 v[64:67], a[208:211], v[92:95], v[64:67]
    ds_read_b128 v[124:127], v13 offset:768
    v_mfma_f32_16x16x32_bf16 v[68:71], a[212:215], v[92:95], v[68:71]
    ds_read_b128 v[128:131], v118 offset:512
    v_mfma_f32_16x16x32_bf16 v[72:75], a[204:207], v[96:99], v[72:75]
    ds_read_b128 v[84:87], v4 offset:38912
    global_load_dwordx4 v[236:239], v1, s[42:43] offset:2048 sc1
    v_mfma_f32_16x16x32_bf16 v[76:79], a[208:211], v[96:99], v[76:79]
    s_waitcnt vmcnt(13)
    s_barrier
    ds_read_b128 v[88:91], v4 offset:39168
    v_mfma_f32_16x16x32_bf16 v[80:83], a[212:215], v[96:99], v[80:83]
    global_load_dwordx4 v[240:243], v1, s[42:43] offset:3072 sc1
    s_waitcnt lgkmcnt(5)
    v_mfma_f32_16x16x32_bf16 v[60:63], a[216:219], v[100:103], v[60:63]
    ds_read_b64 v[114:115], v14 offset:1024
    s_add_u32 s42, s42, 4096
    v_mfma_f32_16x16x32_bf16 v[64:67], a[220:223], v[100:103], v[64:67]
    ds_read_b64 v[116:117], v14 offset:1536
    v_mfma_f32_16x16x32_bf16 v[68:71], a[224:227], v[100:103], v[68:71]
    ds_read_b128 v[92:95], v119 offset:0
    v_mfma_f32_16x16x32_bf16 v[72:75], a[216:219], v[104:107], v[72:75]
    ds_read_b128 v[96:99], v119 offset:256
    v_mfma_f32_16x16x32_bf16 v[76:79], a[220:223], v[104:107], v[76:79]
    global_load_dwordx4 v[244:247], v1, s[42:43] offset:0 sc1
    v_mfma_f32_16x16x32_bf16 v[80:83], a[224:227], v[104:107], v[80:83]
    s_waitcnt lgkmcnt(4)
    v_mfma_f32_16x16x32_bf16 v[60:63], a[228:231], v[84:87], v[60:63]
    ds_read_b128 v[100:103], v119 offset:2048
    v_mfma_f32_16x16x32_bf16 v[64:67], a[232:235], v[84:87], v[64:67]
    ds_read_b128 v[104:107], v119 offset:2304
    v_mfma_f32_16x16x32_bf16 v[68:71], a[236:239], v[84:87], v[68:71]
    global_load_dwordx4 v[248:251], v1, s[42:43] offset:1024 sc1
    v_mfma_f32_16x16x32_bf16 v[72:75], a[228:231], v[88:91], v[72:75]
    v_mfma_f32_16x16x32_bf16 v[76:79], a[232:235], v[88:91], v[76:79]
    v_mfma_f32_16x16x32_bf16 v[80:83], a[236:239], v[88:91], v[80:83]
    global_load_dwordx4 v[252:255], v1, s[42:43] offset:2048 sc1
    s_waitcnt lgkmcnt(4)
    v_mfma_f32_16x16x16_bf16 v[60:63], v[108:109], v[114:115], v[60:63]
    v_mfma_f32_16x16x16_bf16 v[64:67], v[110:111], v[114:115], v[64:67]
    v_mfma_f32_16x16x16_bf16 v[68:71], v[112:113], v[114:115], v[68:71]
    v_mfma_f32_16x16x16_bf16 v[72:75], v[108:109], v[116:117], v[72:75]
    v_mfma_f32_16x16x16_bf16 v[76:79], v[110:111], v[116:117], v[76:79]
    v_mfma_f32_16x16x16_bf16 v[80:83], v[112:113], v[116:117], v[80:83]
    s_waitcnt lgkmcnt(2)
    v_mfma_f32_16x16x32_bf16 v[36:39], a[0:3], v[92:95], 0
    ds_read_b128 v[84:87], v119 offset:4096
    s_add_u32 m0, s53, 0
    v_mfma_f32_16x16x32_bf16 v[40:43], a[4:7], v[92:95], 0
    ds_read_b128 v[88:91], v119 offset:4352
    s_add_u32 s40, s40, 32768
    v_mfma_f32_16x16x32_bf16 v[44:47], a[8:11], v[92:95], 0
    v_mul_f32 v132, v60, v60
    v_mul_f32 v133, v61, v61
    v_mfma_f32_16x16x32_bf16 v[48:51], a[0:3], v[96:99], 0
    v_mul_f32 v134, v62, v62
    v_mul_f32 v135, v63, v63
    v_mfma_f32_16x16x32_bf16 v[52:55], a[4:7], v[96:99], 0
    global_load_lds_dwordx4 v1, s[40:41] offset:0 sc1
    v_fma_f32 v132, v132, v121, v120
    v_mfma_f32_16x16x32_bf16 v[56:59], a[8:11], v[96:99], 0
    s_waitcnt lgkmcnt(2)
    v_fma_f32 v133, v133, v121, v120
    v_fma_f32 v134, v134, v121, v120
    v_mfma_f32_16x16x32_bf16 v[36:39], a[12:15], v[100:103], v[36:39]
    ds_read_b128 v[92:95], v119 offset:6144
    v_fma_f32 v135, v135, v121, v120
    v_mfma_f32_16x16x32_bf16 v[40:43], a[16:19], v[100:103], v[40:43]
    ds_read_b128 v[96:99], v119 offset:6400
    v_mul_f32 v132, v132, v60
    v_mfma_f32_16x16x32_bf16 v[44:47], a[20:23], v[100:103], v[44:47]
    v_exp_f32 v132, v132
    v_mfma_f32_16x16x32_bf16 v[48:51], a[12:15], v[104:107], v[48:51]
    global_load_lds_dwordx4 v1, s[40:41] offset:1024 sc1
    v_mul_f32 v133, v133, v61
    v_mfma_f32_16x16x32_bf16 v[52:55], a[16:19], v[104:107], v[52:55]
    v_exp_f32 v133, v133
    v_mfma_f32_16x16x32_bf16 v[56:59], a[20:23], v[104:107], v[56:59]
    s_waitcnt lgkmcnt(2)
    v_mul_f32 v134, v134, v62
    v_mul_f32 v135, v135, v63
    v_mfma_f32_16x16x32_bf16 v[36:39], a[24:27], v[84:87], v[36:39]
    v_exp_f32 v134, v134
    v_mfma_f32_16x16x32_bf16 v[40:43], a[28:31], v[84:87], v[40:43]
    v_exp_f32 v135, v135
    v_mfma_f32_16x16x32_bf16 v[44:47], a[32:35], v[84:87], v[44:47]
    ds_read_b128 v[100:103], v119 offset:8192
    v_mul_f32 v64, v64, v60
    v_mfma_f32_16x16x32_bf16 v[48:51], a[24:27], v[88:91], v[48:51]
    global_load_lds_dwordx4 v1, s[40:41] offset:2048 sc1
    v_mul_f32 v65, v65, v61
    v_mfma_f32_16x16x32_bf16 v[52:55], a[28:31], v[88:91], v[52:55]
    ds_read_b128 v[104:107], v119 offset:8448
    v_mul_f32 v66, v66, v62
    v_mfma_f32_16x16x32_bf16 v[56:59], a[32:35], v[88:91], v[56:59]
    s_waitcnt lgkmcnt(2)
    v_mul_f32 v67, v67, v63
    v_fma_f32 v132, v132, v122, v122
    v_mfma_f32_16x16x32_bf16 v[36:39], a[36:39], v[92:95], v[36:39]
    global_load_lds_dwordx4 v1, s[40:41] offset:3072 sc1
    v_fma_f32 v133, v133, v122, v122
    v_mfma_f32_16x16x32_bf16 v[40:43], a[40:43], v[92:95], v[40:43]
    v_rcp_f32 v132, v132
    v_mfma_f32_16x16x32_bf16 v[44:47], a[44:47], v[92:95], v[44:47]
    ds_read_b128 v[84:87], v119 offset:10240
    v_fma_f32 v134, v134, v122, v122
    v_mfma_f32_16x16x32_bf16 v[48:51], a[36:39], v[96:99], v[48:51]
    ds_read_b128 v[88:91], v119 offset:10496
    v_fma_f32 v135, v135, v122, v122
    v_mfma_f32_16x16x32_bf16 v[52:55], a[40:43], v[96:99], v[52:55]
    s_add_u32 m0, s53, 4096
    v_rcp_f32 v133, v133
    v_mfma_f32_16x16x32_bf16 v[56:59], a[44:47], v[96:99], v[56:59]
    s_waitcnt lgkmcnt(2)
    v_rcp_f32 v134, v134
    v_mfma_f32_16x16x32_bf16 v[36:39], a[48:51], v[100:103], v[36:39]
    s_add_u32 s40, s40, 4096
    v_rcp_f32 v135, v135
    v_mfma_f32_16x16x32_bf16 v[40:43], a[52:55], v[100:103], v[40:43]
    ds_read_b128 v[92:95], v119 offset:12288
    v_mul_f32 v64, v64, v132
    v_mfma_f32_16x16x32_bf16 v[44:47], a[56:59], v[100:103], v[44:47]
    ds_read_b128 v[96:99], v119 offset:12544
    v_mul_f32 v65, v65, v133
    v_mfma_f32_16x16x32_bf16 v[48:51], a[48:51], v[104:107], v[48:51]
    global_load_lds_dwordx4 v1, s[40:41] offset:0 sc1
    v_mul_f32 v66, v66, v134
    v_mfma_f32_16x16x32_bf16 v[52:55], a[52:55], v[104:107], v[52:55]
    v_mul_f32 v67, v67, v135
    v_cvt_pk_bf16_f32 v144, v64, v65
    v_mfma_f32_16x16x32_bf16 v[56:59], a[56:59], v[104:107], v[56:59]
    s_waitcnt lgkmcnt(2)
    v_cvt_pk_bf16_f32 v145, v66, v67
    v_mul_f32 v136, v72, v72
    v_mfma_f32_16x16x32_bf16 v[36:39], a[60:63], v[84:87], v[36:39]
    global_load_lds_dwordx4 v1, s[40:41] offset:1024 sc1
    v_mul_f32 v137, v73, v73
    v_mfma_f32_16x16x32_bf16 v[40:43], a[64:67], v[84:87], v[40:43]
    ds_read_b128 v[100:103], v119 offset:14336
    v_mul_f32 v138, v74, v74
    v_mfma_f32_16x16x32_bf16 v[44:47], a[68:71], v[84:87], v[44:47]
    ds_read_b128 v[104:107], v119 offset:14592
    v_mul_f32 v139, v75, v75
    v_mfma_f32_16x16x32_bf16 v[48:51], a[60:63], v[88:91], v[48:51]
    global_load_lds_dwordx4 v1, s[40:41] offset:2048 sc1
    v_fma_f32 v136, v136, v125, v124
    v_mfma_f32_16x16x32_bf16 v[52:55], a[64:67], v[88:91], v[52:55]
    v_fma_f32 v137, v137, v125, v124
    v_fma_f32 v138, v138, v125, v124
    v_mfma_f32_16x16x32_bf16 v[56:59], a[68:71], v[88:91], v[56:59]
    s_waitcnt lgkmcnt(2)
    v_fma_f32 v139, v139, v125, v124
    v_mul_f32 v136, v136, v72
    v_mfma_f32_16x16x32_bf16 v[36:39], a[72:75], v[92:95], v[36:39]
    v_exp_f32 v136, v136
    v_mfma_f32_16x16x32_bf16 v[40:43], a[76:79], v[92:95], v[40:43]
    ds_read_b128 v[84:87], v119 offset:16384
    v_mul_f32 v137, v137, v73
    v_mfma_f32_16x16x32_bf16 v[44:47], a[80:83], v[92:95], v[44:47]
    v_exp_f32 v137, v137
    v_mfma_f32_16x16x32_bf16 v[48:51], a[72:75], v[96:99], v[48:51]
    ds_read_b128 v[88:91], v119 offset:16640
    v_mul_f32 v138, v138, v74
    v_mfma_f32_16x16x32_bf16 v[52:55], a[76:79], v[96:99], v[52:55]
    global_load_lds_dwordx4 v1, s[40:41] offset:3072 sc1
    v_mul_f32 v139, v139, v75
    v_mfma_f32_16x16x32_bf16 v[56:59], a[80:83], v[96:99], v[56:59]
    s_waitcnt lgkmcnt(2)
    v_exp_f32 v138, v138
    v_mfma_f32_16x16x32_bf16 v[36:39], a[84:87], v[100:103], v[36:39]
    s_add_u32 m0, s53, 8192
    v_exp_f32 v139, v139
    v_mfma_f32_16x16x32_bf16 v[40:43], a[88:91], v[100:103], v[40:43]
    s_add_u32 s40, s40, 4096
    v_mul_f32 v76, v76, v72
    v_mul_f32 v77, v77, v73
    v_mfma_f32_16x16x32_bf16 v[44:47], a[92:95], v[100:103], v[44:47]
    ds_read_b128 v[92:95], v119 offset:18432
    v_mul_f32 v78, v78, v74
    v_mfma_f32_16x16x32_bf16 v[48:51], a[84:87], v[104:107], v[48:51]
    ds_read_b128 v[96:99], v119 offset:18688
    v_mul_f32 v79, v79, v75
    v_mfma_f32_16x16x32_bf16 v[52:55], a[88:91], v[104:107], v[52:55]
    global_load_lds_dwordx4 v1, s[40:41] offset:0 sc1
    v_fma_f32 v136, v136, v126, v126
    v_mfma_f32_16x16x32_bf16 v[56:59], a[92:95], v[104:107], v[56:59]
    s_waitcnt lgkmcnt(2)
    v_rcp_f32 v136, v136
    v_mfma_f32_16x16x32_bf16 v[36:39], a[96:99], v[84:87], v[36:39]
    v_permlane32_swap_b32 v68, v80
    v_mfma_f32_16x16x32_bf16 v[40:43], a[100:103], v[84:87], v[40:43]
    v_permlane32_swap_b32 v69, v81
    v_mfma_f32_16x16x32_bf16 v[44:47], a[104:107], v[84:87], v[44:47]
    ds_read_b128 v[100:103], v119 offset:20480
    v_fma_f32 v137, v137, v126, v126
    v_mfma_f32_16x16x32_bf16 v[48:51], a[96:99], v[88:91], v[48:51]
    ds_read_b128 v[104:107], v119 offset:20736
    v_fma_f32 v138, v138, v126, v126
    v_mfma_f32_16x16x32_bf16 v[52:55], a[100:103], v[88:91], v[52:55]
    global_load_lds_dwordx4 v1, s[40:41] offset:1024 sc1
    v_fma_f32 v139, v139, v126, v126
    v_mfma_f32_16x16x32_bf16 v[56:59], a[104:107], v[88:91], v[56:59]
    s_waitcnt lgkmcnt(2)
    v_rcp_f32 v137, v137
    v_mfma_f32_16x16x32_bf16 v[36:39], a[108:111], v[92:95], v[36:39]
    v_rcp_f32 v138, v138
    v_mfma_f32_16x16x32_bf16 v[40:43], a[112:115], v[92:95], v[40:43]
    v_rcp_f32 v139, v139
    v_mfma_f32_16x16x32_bf16 v[44:47], a[116:119], v[92:95], v[44:47]
    ds_read_b128 v[84:87], v119 offset:22528
    v_mul_f32 v76, v76, v136
    v_mfma_f32_16x16x32_bf16 v[48:51], a[108:111], v[96:99], v[48:51]
    ds_read_b128 v[88:91], v119 offset:22784
    v_mul_f32 v77, v77, v137
    v_mfma_f32_16x16x32_bf16 v[52:55], a[112:115], v[96:99], v[52:55]
    s_waitcnt vmcnt(16)
    s_barrier
    v_permlane32_swap_b32 v70, v82
    v_mfma_f32_16x16x32_bf16 v[56:59], a[116:119], v[96:99], v[56:59]
    buffer_store_dword v153, v5, s[20:23], s55 offen offset:128
    s_waitcnt lgkmcnt(2)
    v_mfma_f32_16x16x32_bf16 v[36:39], a[120:123], v[100:103], v[36:39]
    s_add_u32 m0, s53, 37888
    v_permlane32_swap_b32 v71, v83
    v_mfma_f32_16x16x32_bf16 v[40:43], a[124:127], v[100:103], v[40:43]
    buffer_store_dword v153, v5, s[20:23], s44 offen sc1
    v_mul_f32 v78, v78, v138
    v_mfma_f32_16x16x32_bf16 v[44:47], a[128:131], v[100:103], v[44:47]
    ds_read_b128 v[92:95], v119 offset:24576
    v_mul_f32 v79, v79, v139
    v_mfma_f32_16x16x32_bf16 v[48:51], a[120:123], v[104:107], v[48:51]
    global_load_lds_dwordx4 v1, s[42:43] offset:3072 sc1
    s_add_u32 s42, s42, 4096
    v_cvt_pk_bf16_f32 v146, v76, v77
    v_mfma_f32_16x16x32_bf16 v[52:55], a[124:127], v[104:107], v[52:55]
    ds_read_b128 v[96:99], v119 offset:24832
    v_cvt_pk_bf16_f32 v147, v78, v79
    v_mfma_f32_16x16x32_bf16 v[56:59], a[128:131], v[104:107], v[56:59]
    s_waitcnt lgkmcnt(2)
    v_mul_f32 v140, v68, v68
    v_mul_f32 v141, v69, v69
    v_mfma_f32_16x16x32_bf16 v[36:39], a[132:135], v[84:87], v[36:39]
    v_mov_b32 v153, 4
    v_mul_f32 v142, v70, v70
    v_mul_f32 v143, v71, v71
    v_mfma_f32_16x16x32_bf16 v[40:43], a[136:139], v[84:87], v[40:43]
    s_add_u32 m0, s53, 41984
    v_fma_f32 v140, v140, v129, v128
    v_fma_f32 v141, v141, v129, v128
    v_mfma_f32_16x16x32_bf16 v[44:47], a[140:143], v[84:87], v[44:47]
    ds_read_b128 v[100:103], v119 offset:26624
    v_fma_f32 v142, v142, v129, v128
    v_mfma_f32_16x16x32_bf16 v[48:51], a[132:135], v[88:91], v[48:51]
    global_load_lds_dwordx4 v1, s[42:43] offset:0 sc1
    v_fma_f32 v143, v143, v129, v128
    v_mfma_f32_16x16x32_bf16 v[52:55], a[136:139], v[88:91], v[52:55]
    ds_read_b128 v[104:107], v119 offset:26880
    v_mul_f32 v140, v140, v68
    v_mfma_f32_16x16x32_bf16 v[56:59], a[140:143], v[88:91], v[56:59]
    s_waitcnt lgkmcnt(2)
    v_exp_f32 v140, v140
    v_mfma_f32_16x16x32_bf16 v[36:39], a[144:147], v[92:95], v[36:39]
    ds_read_b128 v[84:87], v119 offset:28672
    v_mul_f32 v141, v141, v69
    v_mfma_f32_16x16x32_bf16 v[40:43], a[148:151], v[92:95], v[40:43]
    v_exp_f32 v141, v141
    v_mfma_f32_16x16x32_bf16 v[44:47], a[152:155], v[92:95], v[44:47]
    global_load_lds_dwordx4 v1, s[42:43] offset:1024 sc1
    v_mul_f32 v142, v142, v70
    v_mfma_f32_16x16x32_bf16 v[48:51], a[144:147], v[96:99], v[48:51]
    ds_read_b128 v[88:91], v119 offset:28928
    v_mul_f32 v143, v143, v71
    v_mfma_f32_16x16x32_bf16 v[52:55], a[148:151], v[96:99], v[52:55]
    v_exp_f32 v142, v142
    v_mfma_f32_16x16x32_bf16 v[56:59], a[152:155], v[96:99], v[56:59]
    s_waitcnt lgkmcnt(2)
    v_exp_f32 v143, v143
    v_mfma_f32_16x16x32_bf16 v[36:39], a[156:159], v[100:103], v[36:39]
    ds_read_b128 v[92:95], v119 offset:30720
    v_mul_f32 v80, v80, v68
    v_mfma_f32_16x16x32_bf16 v[40:43], a[160:163], v[100:103], v[40:43]
    ds_read_b128 v[96:99], v119 offset:30976
    v_mul_f32 v81, v81, v69
    v_mfma_f32_16x16x32_bf16 v[44:47], a[164:167], v[100:103], v[44:47]
    global_load_lds_dwordx4 v1, s[42:43] offset:2048 sc1
    v_mul_f32 v82, v82, v70
    v_mfma_f32_16x16x32_bf16 v[48:51], a[156:159], v[104:107], v[48:51]
    v_mul_f32 v83, v83, v71
    v_fma_f32 v140, v140, v130, v130
    v_mfma_f32_16x16x32_bf16 v[52:55], a[160:163], v[104:107], v[52:55]
    v_rcp_f32 v140, v140
    v_mfma_f32_16x16x32_bf16 v[56:59], a[164:167], v[104:107], v[56:59]
    s_waitcnt lgkmcnt(2)
    v_fma_f32 v141, v141, v130, v130
    v_fma_f32 v142, v142, v130, v130
    v_mfma_f32_16x16x32_bf16 v[36:39], a[168:171], v[84:87], v[36:39]
    v_rcp_f32 v141, v141
    v_mfma_f32_16x16x32_bf16 v[40:43], a[172:175], v[84:87], v[40:43]
    v_rcp_f32 v142, v142
    v_mfma_f32_16x16x32_bf16 v[44:47], a[176:179], v[84:87], v[44:47]
    ds_read_b128 v[100:103], v119 offset:32768
    v_fma_f32 v143, v143, v130, v130
    v_mfma_f32_16x16x32_bf16 v[48:51], a[168:171], v[88:91], v[48:51]
    ds_read_b128 v[104:107], v119 offset:33024
    v_mul_f32 v80, v80, v140
    v_mfma_f32_16x16x32_bf16 v[52:55], a[172:175], v[88:91], v[52:55]
    global_load_lds_dwordx4 v1, s[42:43] offset:3072 sc1
    s_add_u32 s42, s42, 4096
    v_mul_f32 v81, v81, v141
    v_mfma_f32_16x16x32_bf16 v[56:59], a[176:179], v[88:91], v[56:59]
    s_waitcnt lgkmcnt(2)
    v_rcp_f32 v143, v143
    v_mfma_f32_16x16x32_bf16 v[36:39], a[180:183], v[92:95], v[36:39]
    v_permlane16_swap_b32 v144, v146
    v_mfma_f32_16x16x32_bf16 v[40:43], a[184:187], v[92:95], v[40:43]
    v_permlane16_swap_b32 v145, v147
    v_mfma_f32_16x16x32_bf16 v[44:47], a[188:191], v[92:95], v[44:47]
    buffer_store_dwordx4 v[144:147], v1, s[16:19], 0 offen sc1
    v_mul_f32 v82, v82, v142
    v_mfma_f32_16x16x32_bf16 v[48:51], a[180:183], v[96:99], v[48:51]
    ds_read_b128 v[84:87], v119 offset:34816
    v_mul_f32 v83, v83, v143
    v_mfma_f32_16x16x32_bf16 v[52:55], a[184:187], v[96:99], v[52:55]
    ds_read_b128 v[88:91], v119 offset:35072
    v_cvt_pk_bf16_f32 v148, v80, v81
    v_mfma_f32_16x16x32_bf16 v[56:59], a[188:191], v[96:99], v[56:59]
    s_waitcnt lgkmcnt(2)
    s_add_u32 m0, s53, 46080
    v_cvt_pk_bf16_f32 v149, v82, v83
    v_cvt_pk_bf16_f32 v150, v80, v81
    v_mfma_f32_16x16x32_bf16 v[36:39], a[192:195], v[100:103], v[36:39]
    global_load_lds_dwordx4 v1, s[42:43] offset:0 sc1
    v_cvt_pk_bf16_f32 v151, v82, v83
    v_mfma_f32_16x16x32_bf16 v[40:43], a[196:199], v[100:103], v[40:43]
    v_permlane16_swap_b32 v148, v150
    v_mfma_f32_16x16x32_bf16 v[44:47], a[200:203], v[100:103], v[44:47]
    ds_read_b128 v[92:95], v119 offset:36864
    v_mfma_f32_16x16x32_bf16 v[48:51], a[192:195], v[104:107], v[48:51]
    ds_read_b128 v[96:99], v119 offset:37120
    v_mfma_f32_16x16x32_bf16 v[52:55], a[196:199], v[104:107], v[52:55]
    global_load_lds_dwordx4 v1, s[42:43] offset:1024 sc1
    v_mfma_f32_16x16x32_bf16 v[56:59], a[200:203], v[104:107], v[56:59]
    s_waitcnt lgkmcnt(2)
    v_permlane16_swap_b32 v149, v151
    v_mfma_f32_16x16x32_bf16 v[36:39], a[204:207], v[84:87], v[36:39]
    buffer_store_dwordx4 v[148:151], v12, s[16:19], 0 offen offset:1024 sc1
    s_add_u32 s16, s16, 98304
    v_mfma_f32_16x16x32_bf16 v[40:43], a[208:211], v[84:87], v[40:43]
    ds_read_b128 v[120:123], v13 offset:1024
    v_mfma_f32_16x16x32_bf16 v[44:47], a[212:215], v[84:87], v[44:47]
    ds_read_b128 v[124:127], v13 offset:1280
    v_mfma_f32_16x16x32_bf16 v[48:51], a[204:207], v[88:91], v[48:51]
    ds_read_b128 v[100:103], v119 offset:38912
    v_mfma_f32_16x16x32_bf16 v[52:55], a[208:211], v[88:91], v[52:55]
    s_waitcnt vmcnt(11)
    s_barrier
    ds_read_b128 v[104:107], v119 offset:39168
    v_mfma_f32_16x16x32_bf16 v[56:59], a[212:215], v[88:91], v[56:59]
    global_load_lds_dwordx4 v1, s[42:43] offset:2048 sc1
    s_waitcnt lgkmcnt(4)
    v_mfma_f32_16x16x32_bf16 v[36:39], a[216:219], v[92:95], v[36:39]
    ds_read_b128 v[128:131], v118 offset:1024
    v_mfma_f32_16x16x32_bf16 v[40:43], a[220:223], v[92:95], v[40:43]
L_back_stub1_2:
    s_cmp_eq_u32 s0, 1
    s_cbranch_scc1 L_back_wret1
    ds_read_b64 v[114:115], v14 offset:2048
    v_mfma_f32_16x16x32_bf16 v[44:47], a[224:227], v[92:95], v[44:47]
    ds_read_b64 v[116:117], v14 offset:2560
    v_mfma_f32_16x16x32_bf16 v[48:51], a[216:219], v[96:99], v[48:51]
    ds_read_b128 v[84:87], v3 offset:0
    v_mfma_f32_16x16x32_bf16 v[52:55], a[220:223], v[96:99], v[52:55]
    ds_read_b128 v[88:91], v3 offset:256
    v_mfma_f32_16x16x32_bf16 v[56:59], a[224:227], v[96:99], v[56:59]
    global_load_lds_dwordx4 v1, s[42:43] offset:3072 sc1
    s_waitcnt lgkmcnt(5)
    v_mfma_f32_16x16x32_bf16 v[36:39], a[228:231], v[100:103], v[36:39]
    ds_read_b128 v[92:95], v3 offset:2048
    s_add_u32 s42, s42, 4096
    v_mfma_f32_16x16x32_bf16 v[40:43], a[232:235], v[100:103], v[40:43]
    ds_read_b128 v[96:99], v3 offset:2304
    v_mfma_f32_16x16x32_bf16 v[44:47], a[236:239], v[100:103], v[44:47]
    v_mfma_f32_16x16x32_bf16 v[48:51], a[228:231], v[104:107], v[48:51]
    s_add_u32 m0, s53, 50176
    v_mfma_f32_16x16x32_bf16 v[52:55], a[232:235], v[104:107], v[52:55]
    global_load_lds_dwordx4 v1, s[42:43] offset:0 sc1
    v_mfma_f32_16x16x32_bf16 v[56:59], a[236:239], v[104:107], v[56:59]
    s_waitcnt lgkmcnt(4)
    v_mfma_f32_16x16x16_bf16 v[36:39], v[108:109], v[114:115], v[36:39]
    v_mfma_f32_16x16x16_bf16 v[40:43], v[110:111], v[114:115], v[40:43]
    v_mfma_f32_16x16x16_bf16 v[44:47], v[112:113], v[114:115], v[44:47]
    v_mfma_f32_16x16x16_bf16 v[48:51], v[108:109], v[116:117], v[48:51]
    v_mfma_f32_16x16x16_bf16 v[52:55], v[110:111], v[116:117], v[52:55]
    v_mfma_f32_16x16x16_bf16 v[56:59], v[112:113], v[116:117], v[56:59]
    s_waitcnt lgkmcnt(2)
    v_mfma_f32_16x16x32_bf16 v[60:63], a[0:3], v[84:87], 0
    ds_read_b128 v[100:103], v3 offset:4096
    v_mfma_f32_16x16x32_bf16 v[64:67], a[4:7], v[84:87], 0
    ds_read_b128 v[104:107], v3 offset:4352
    v_mul_f32 v132, v36, v36
    v_mfma_f32_16x16x32_bf16 v[68:71], a[8:11], v[84:87], 0
    v_mul_f32 v133, v37, v37
    v_mul_f32 v134, v38, v38
    v_mfma_f32_16x16x32_bf16 v[72:75], a[0:3], v[88:91], 0
    v_mul_f32 v135, v39, v39
    v_fma_f32 v132, v132, v121, v120
    v_mfma_f32_16x16x32_bf16 v[76:79], a[4:7], v[88:91], 0
    v_fma_f32 v133, v133, v121, v120
    v_fma_f32 v134, v134, v121, v120
    v_mfma_f32_16x16x32_bf16 v[80:83], a[8:11], v[88:91], 0
    s_waitcnt lgkmcnt(2)
    v_fma_f32 v135, v135, v121, v120
    v_mul_f32 v132, v132, v36
    v_mfma_f32_16x16x32_bf16 v[60:63], a[12:15], v[92:95], v[60:63]
    v_exp_f32 v132, v132
    v_mfma_f32_16x16x32_bf16 v[64:67], a[16:19], v[92:95], v[64:67]
    ds_read_b128 v[84:87], v3 offset:6144
    v_mul_f32 v133, v133, v37
    v_mfma_f32_16x16x32_bf16 v[68:71], a[20:23], v[92:95], v[68:71]
    global_load_dwordx4 a[0:3], v1, s[42:43] offset:1024 sc1
    v_mul_f32 v134, v134, v38
    v_mfma_f32_16x16x32_bf16 v[72:75], a[12:15], v[96:99], v[72:75]
    ds_read_b128 v[88:91], v3 offset:6400
    v_mul_f32 v135, v135, v39
    v_mfma_f32_16x16x32_bf16 v[76:79], a[16:19], v[96:99], v[76:79]
    v_exp_f32 v133, v133
    v_mfma_f32_16x16x32_bf16 v[80:83], a[20:23], v[96:99], v[80:83]
    s_waitcnt lgkmcnt(2)
    v_exp_f32 v134, v134
    v_mfma_f32_16x16x32_bf16 v[60:63], a[24:27], v[100:103], v[60:63]
    global_load_dwordx4 a[4:7], v1, s[42:43] offset:2048 sc1
    v_mul_f32 v40, v40, v36
    v_mfma_f32_16x16x32_bf16 v[64:67], a[28:31], v[100:103], v[64:67]
    v_exp_f32 v135, v135
    v_mfma_f32_16x16x32_bf16 v[68:71], a[32:35], v[100:103], v[68:71]
    ds_read_b128 v[92:95], v3 offset:8192
    v_mul_f32 v41, v41, v37
    v_mfma_f32_16x16x32_bf16 v[72:75], a[24:27], v[104:107], v[72:75]
    ds_read_b128 v[96:99], v3 offset:8448
    v_mul_f32 v42, v42, v38
    v_mfma_f32_16x16x32_bf16 v[76:79], a[28:31], v[104:107], v[76:79]
    global_load_dwordx4 a[8:11], v1, s[42:43] offset:3072 sc1
    s_add_u32 s42, s42, 4096
    v_mul_f32 v43, v43, v39
    v_mfma_f32_16x16x32_bf16 v[80:83], a[32:35], v[104:107], v[80:83]
    s_waitcnt lgkmcnt(2)
    v_fma_f32 v132, v132, v122, v122
    v_fma_f32 v133, v133, v122, v122
    v_mfma_f32_16x16x32_bf16 v[60:63], a[36:39], v[84:87], v[60:63]
    global_load_dwordx4 a[12:15], v1, s[42:43] offset:0 sc1
    v_fma_f32 v134, v134, v122, v122
    v_mfma_f32_16x16x32_bf16 v[64:67], a[40:43], v[84:87], v[64:67]
    v_rcp_f32 v132, v132
    v_mfma_f32_16x16x32_bf16 v[68:71], a[44:47], v[84:87], v[68:71]
    ds_read_b128 v[100:103], v3 offset:10240
    v_fma_f32 v135, v135, v122, v122
    v_mfma_f32_16x16x32_bf16 v[72:75], a[36:39], v[88:91], v[72:75]
    buffer_load_dword v0, v152, s[20:23], 0 offen offset:128 sc1
    v_mul_f32 v40, v40, v132
    v_mfma_f32_16x16x32_bf16 v[76:79], a[40:43], v[88:91], v[76:79]
    ds_read_b128 v[104:107], v3 offset:10496
    v_mul_f32 v136, v48, v48
    v_mfma_f32_16x16x32_bf16 v[80:83], a[44:47], v[88:91], v[80:83]
    global_load_dwordx4 a[16:19], v1, s[42:43] offset:1024 sc1
    s_waitcnt lgkmcnt(2)
    v_mfma_f32_16x16x32_bf16 v[60:63], a[48:51], v[92:95], v[60:63]
    v_rcp_f32 v133, v133
    v_mfma_f32_16x16x32_bf16 v[64:67], a[52:55], v[92:95], v[64:67]
    v_rcp_f32 v134, v134
    v_mfma_f32_16x16x32_bf16 v[68:71], a[56:59], v[92:95], v[68:71]
    ds_read_b128 v[84:87], v3 offset:12288
    v_mul_f32 v41, v41, v133
    v_mfma_f32_16x16x32_bf16 v[72:75], a[48:51], v[96:99], v[72:75]
    global_load_dwordx4 a[20:23], v1, s[42:43] offset:2048 sc1
    v_mul_f32 v42, v42, v134
    v_mfma_f32_16x16x32_bf16 v[76:79], a[52:55], v[96:99], v[76:79]
    ds_read_b128 v[88:91], v3 offset:12544
    v_cvt_pk_bf16_f32 v144, v40, v41
    v_mfma_f32_16x16x32_bf16 v[80:83], a[56:59], v[96:99], v[80:83]
    s_waitcnt lgkmcnt(2)
    v_rcp_f32 v135, v135
    v_mfma_f32_16x16x32_bf16 v[60:63], a[60:63], v[100:103], v[60:63]
    global_load_dwordx4 a[24:27], v1, s[42:43] offset:3072 sc1
    s_add_u32 s42, s42, 4096
    v_mul_f32 v43, v43, v135
    v_mfma_f32_16x16x32_bf16 v[64:67], a[64:67], v[100:103], v[64:67]
    ds_read_b128 v[92:95], v3 offset:14336
    v_cvt_pk_bf16_f32 v145, v42, v43
    v_mfma_f32_16x16x32_bf16 v[68:71], a[68:71], v[100:103], v[68:71]
    ds_read_b128 v[96:99], v3 offset:14592
    v_mul_f32 v137, v49, v49
    v_mfma_f32_16x16x32_bf16 v[72:75], a[60:63], v[104:107], v[72:75]
    global_load_dwordx4 a[28:31], v1, s[42:43] offset:0 sc1
    v_mul_f32 v138, v50, v50
    v_mfma_f32_16x16x32_bf16 v[76:79], a[64:67], v[104:107], v[76:79]
    global_load_dwordx4 a[32:35], v1, s[42:43] offset:1024 sc1
    v_mul_f32 v139, v51, v51
    v_mfma_f32_16x16x32_bf16 v[80:83], a[68:71], v[104:107], v[80:83]
    s_waitcnt lgkmcnt(2)
    v_fma_f32 v136, v136, v125, v124
    v_fma_f32 v137, v137, v125, v124
    v_mfma_f32_16x16x32_bf16 v[60:63], a[72:75], v[84:87], v[60:63]
    ds_read_b128 v[100:103], v3 offset:16384
    v_fma_f32 v138, v138, v125, v124
    v_mfma_f32_16x16x32_bf16 v[64:67], a[76:79], v[84:87], v[64:67]
    ds_read_b128 v[104:107], v3 offset:16640
    v_fma_f32 v139, v139, v125, v124
    v_mfma_f32_16x16x32_bf16 v[68:71], a[80:83], v[84:87], v[68:71]
    global_load_dwordx4 a[36:39], v1, s[42:43] offset:2048 sc1
    v_mul_f32 v136, v136, v48
    v_mfma_f32_16x16x32_bf16 v[72:75], a[72:75], v[88:91], v[72:75]
    v_exp_f32 v136, v136
    v_mfma_f32_16x16x32_bf16 v[76:79], a[76:79], v[88:91], v[76:79]
    v_mul_f32 v137, v137, v49
    v_mul_f32 v138, v138, v50
    v_mfma_f32_16x16x32_bf16 v[80:83], a[80:83], v[88:91], v[80:83]
    s_waitcnt lgkmcnt(2)
    v_exp_f32 v137, v137
    v_mfma_f32_16x16x32_bf16 v[60:63], a[84:87], v[92:95], v[60:63]
    v_exp_f32 v138, v138
    v_mfma_f32_16x16x32_bf16 v[64:67], a[88:91], v[92:95], v[64:67]
    ds_read_b128 v[84:87], v3 offset:18432
    v_mul_f32 v139, v139, v51
    v_mfma_f32_16x16x32_bf16 v[68:71], a[92:95], v[92:95], v[68:71]
    global_load_dwordx4 a[40:43], v1, s[42:43] offset:3072 sc1
    v_mul_f32 v52, v52, v48
    v_mfma_f32_16x16x32_bf16 v[72:75], a[84:87], v[96:99], v[72:75]
    ds_read_b128 v[88:91], v3 offset:18688
    s_add_u32 s42, s42, 4096
    v_mul_f32 v53, v53, v49
    v_mfma_f32_16x16x32_bf16 v[76:79], a[88:91], v[96:99], v[76:79]
    v_exp_f32 v139, v139
    v_mfma_f32_16x16x32_bf16 v[80:83], a[92:95], v[96:99], v[80:83]
    s_waitcnt lgkmcnt(2)
    v_mul_f32 v54, v54, v50
    v_mul_f32 v55, v55, v51
    v_mfma_f32_16x16x32_bf16 v[60:63], a[96:99], v[100:103], v[60:63]
    global_load_dwordx4 a[44:47], v1, s[42:43] offset:0 sc1
    v_fma_f32 v136, v136, v126, v126
    v_mfma_f32_16x16x32_bf16 v[64:67], a[100:103], v[100:103], v[64:67]
    v_rcp_f32 v136, v136
    v_mfma_f32_16x16x32_bf16 v[68:71], a[104:107], v[100:103], v[68:71]
    ds_read_b128 v[92:95], v3 offset:20480
    v_fma_f32 v137, v137, v126, v126
    v_mfma_f32_16x16x32_bf16 v[72:75], a[96:99], v[104:107], v[72:75]
    ds_read_b128 v[96:99], v3 offset:20736
    v_fma_f32 v138, v138, v126, v126
    v_mfma_f32_16x16x32_bf16 v[76:79], a[100:103], v[104:107], v[76:79]
    global_load_dwordx4 a[48:51], v1, s[42:43] offset:1024 sc1
    v_fma_f32 v139, v139, v126, v126
    v_mfma_f32_16x16x32_bf16 v[80:83], a[104:107], v[104:107], v[80:83]
    s_waitcnt lgkmcnt(2)
    v_rcp_f32 v137, v137
    v_mfma_f32_16x16x32_bf16 v[60:63], a[108:111], v[84:87], v[60:63]
    global_load_dwordx4 a[52:55], v1, s[42:43] offset:2048 sc1
    v_mul_f32 v52, v52, v136
    v_mfma_f32_16x16x32_bf16 v[64:67], a[112:115], v[84:87], v[64:67]
    v_rcp_f32 v138, v138
    v_mfma_f32_16x16x32_bf16 v[68:71], a[116:119], v[84:87], v[68:71]
    ds_read_b128 v[100:103], v3 offset:22528
    v_mul_f32 v53, v53, v137
    v_mfma_f32_16x16x32_bf16 v[72:75], a[108:111], v[88:91], v[72:75]
    ds_read_b128 v[104:107], v3 offset:22784
    v_mul_f32 v54, v54, v138
    v_mfma_f32_16x16x32_bf16 v[76:79], a[112:115], v[88:91], v[76:79]
    s_waitcnt vmcnt(18)
    s_barrier
    s_waitcnt vmcnt(10)
    v_cmp_gt_u32 vcc, 3, v0
    s_cbranch_vccnz L_back_poll_13
L_back_ok_14:
    v_rcp_f32 v139, v139
    v_mfma_f32_16x16x32_bf16 v[80:83], a[116:119], v[88:91], v[80:83]
    buffer_store_dword v153, v5, s[20:23], s55 offen offset:128
    s_waitcnt lgkmcnt(2)
    global_load_dwordx4 a[56:59], v1, s[42:43] offset:3072 sc1
    s_add_u32 s42, s42, 4096
    v_mfma_f32_16x16x32_bf16 v[60:63], a[120:123], v[92:95], v[60:63]
    v_permlane32_swap_b32 v44, v56
    v_mfma_f32_16x16x32_bf16 v[64:67], a[124:127], v[92:95], v[64:67]
    buffer_store_dword v153, v5, s[20:23], s44 offen sc1
    v_mul_f32 v55, v55, v139
    v_mfma_f32_16x16x32_bf16 v[68:71], a[128:131], v[92:95], v[68:71]
    ds_read_b128 v[84:87], v3 offset:24576
    v_cvt_pk_bf16_f32 v146, v52, v53
    v_mfma_f32_16x16x32_bf16 v[72:75], a[120:123], v[96:99], v[72:75]
    global_load_dwordx4 a[60:63], v2, s[58:59] offset:-4096 sc1
    v_cvt_pk_bf16_f32 v147, v54, v55
    v_mfma_f32_16x16x32_bf16 v[76:79], a[124:127], v[96:99], v[76:79]
    ds_read_b128 v[88:91], v3 offset:24832
    v_mul_f32 v140, v44, v44
    v_mfma_f32_16x16x32_bf16 v[80:83], a[128:131], v[96:99], v[80:83]
    s_waitcnt lgkmcnt(2)
    v_permlane32_swap_b32 v45, v57
    v_mfma_f32_16x16x32_bf16 v[60:63], a[132:135], v[100:103], v[60:63]
    global_load_dwordx4 a[64:67], v2, s[58:59] offset:-2048 sc1
    v_mov_b32 v153, 5
    v_mul_f32 v141, v45, v45
    v_mfma_f32_16x16x32_bf16 v[64:67], a[136:139], v[100:103], v[64:67]
    v_permlane32_swap_b32 v46, v58
    v_mfma_f32_16x16x32_bf16 v[68:71], a[140:143], v[100:103], v[68:71]
    ds_read_b128 v[92:95], v3 offset:26624
    v_mul_f32 v142, v46, v46
    v_mfma_f32_16x16x32_bf16 v[72:75], a[132:135], v[104:107], v[72:75]
    ds_read_b128 v[96:99], v3 offset:26880
    v_fma_f32 v140, v140, v129, v128
    v_mfma_f32_16x16x32_bf16 v[76:79], a[136:139], v[104:107], v[76:79]
    v_permlane32_swap_b32 v47, v59
    v_mfma_f32_16x16x32_bf16 v[80:83], a[140:143], v[104:107], v[80:83]
    s_waitcnt lgkmcnt(2)
    v_mul_f32 v143, v47, v47
    v_fma_f32 v141, v141, v129, v128
    v_mfma_f32_16x16x32_bf16 v[60:63], a[144:147], v[84:87], v[60:63]
    global_load_dwordx4 a[68:71], v2, s[58:59] offset:0 sc1
    v_fma_f32 v142, v142, v129, v128
    v_mfma_f32_16x16x32_bf16 v[64:67], a[148:151], v[84:87], v[64:67]
    ds_read_b128 v[100:103], v3 offset:28672
    v_fma_f32 v143, v143, v129, v128
    v_mfma_f32_16x16x32_bf16 v[68:71], a[152:155], v[84:87], v[68:71]
    ds_read_b128 v[104:107], v3 offset:28928
    v_mul_f32 v140, v140, v44
    v_mfma_f32_16x16x32_bf16 v[72:75], a[144:147], v[88:91], v[72:75]
    global_load_dwordx4 a[72:75], v2, s[58:59] offset:2048 sc1
    v_mul_f32 v141, v141, v45
    v_mfma_f32_16x16x32_bf16 v[76:79], a[148:151], v[88:91], v[76:79]
    s_add_u32 s58, s58, 8192
    v_exp_f32 v140, v140
    v_mfma_f32_16x16x32_bf16 v[80:83], a[152:155], v[88:91], v[80:83]
    s_waitcnt lgkmcnt(2)
    v_exp_f32 v141, v141
    v_mfma_f32_16x16x32_bf16 v[60:63], a[156:159], v[92:95], v[60:63]
    ds_read_b128 v[84:87], v3 offset:30720
    v_mul_f32 v142, v142, v46
    v_mfma_f32_16x16x32_bf16 v[64:67], a[160:163], v[92:95], v[64:67]
    v_exp_f32 v142, v142
    v_mfma_f32_16x16x32_bf16 v[68:71], a[164:167], v[92:95], v[68:71]
    global_load_dwordx4 a[76:79], v2, s[58:59] offset:-4096 sc1
    v_mul_f32 v143, v143, v47
    v_mfma_f32_16x16x32_bf16 v[72:75], a[156:159], v[96:99], v[72:75]
    ds_read_b128 v[88:91], v3 offset:30976
    v_mul_f32 v56, v56, v44
    v_mfma_f32_16x16x32_bf16 v[76:79], a[160:163], v[96:99], v[76:79]
    v_exp_f32 v143, v143
    v_mfma_f32_16x16x32_bf16 v[80:83], a[164:167], v[96:99], v[80:83]
    s_waitcnt lgkmcnt(2)
    v_mul_f32 v57, v57, v45
    v_mul_f32 v58, v58, v46
    v_mfma_f32_16x16x32_bf16 v[60:63], a[168:171], v[100:103], v[60:63]
    global_load_dwordx4 a[80:83], v2, s[58:59] offset:-2048 sc1
    v_mul_f32 v59, v59, v47
    v_mfma_f32_16x16x32_bf16 v[64:67], a[172:175], v[100:103], v[64:67]
    v_fma_f32 v140, v140, v130, v130
    v_fma_f32 v141, v141, v130, v130
    v_mfma_f32_16x16x32_bf16 v[68:71], a[176:179], v[100:103], v[68:71]
    ds_read_b128 v[92:95], v3 offset:32768
    v_fma_f32 v142, v142, v130, v130
    v_mfma_f32_16x16x32_bf16 v[72:75], a[168:171], v[104:107], v[72:75]
    ds_read_b128 v[96:99], v3 offset:33024
    v_fma_f32 v143, v143, v130, v130
    v_mfma_f32_16x16x32_bf16 v[76:79], a[172:175], v[104:107], v[76:79]
    v_rcp_f32 v140, v140
    v_mfma_f32_16x16x32_bf16 v[80:83], a[176:179], v[104:107], v[80:83]
    s_waitcnt lgkmcnt(2)
    v_rcp_f32 v141, v141
    v_mfma_f32_16x16x32_bf16 v[60:63], a[180:183], v[84:87], v[60:63]
    global_load_dwordx4 a[84:87], v2, s[58:59] offset:0 sc1
    v_mul_f32 v56, v56, v140
    v_mfma_f32_16x16x32_bf16 v[64:67], a[184:187], v[84:87], v[64:67]
    v_rcp_f32 v142, v142
    v_mfma_f32_16x16x32_bf16 v[68:71], a[188:191], v[84:87], v[68:71]
    ds_read_b128 v[100:103], v3 offset:34816
    v_mul_f32 v57, v57, v141
    v_mfma_f32_16x16x32_bf16 v[72:75], a[180:183], v[88:91], v[72:75]
    ds_read_b128 v[104:107], v3 offset:35072
    v_mul_f32 v58, v58, v142
    v_mfma_f32_16x16x32_bf16 v[76:79], a[184:187], v[88:91], v[76:79]
    global_load_dwordx4 a[88:91], v2, s[58:59] offset:2048 sc1
    s_add_u32 s58, s58, 8192
    v_cvt_pk_bf16_f32 v148, v56, v57
    v_mfma_f32_16x16x32_bf16 v[80:83], a[188:191], v[88:91], v[80:83]
    s_waitcnt lgkmcnt(2)
    v_rcp_f32 v143, v143
    v_mfma_f32_16x16x32_bf16 v[60:63], a[192:195], v[92:95], v[60:63]
    v_permlane16_swap_b32 v144, v146
    v_mfma_f32_16x16x32_bf16 v[64:67], a[196:199], v[92:95], v[64:67]
    v_permlane16_swap_b32 v145, v147
    v_mfma_f32_16x16x32_bf16 v[68:71], a[200:203], v[92:95], v[68:71]
    buffer_store_dwordx4 v[144:147], v1, s[16:19], 0 offen sc1
    v_mul_f32 v59, v59, v143
    v_mfma_f32_16x16x32_bf16 v[72:75], a[192:195], v[96:99], v[72:75]
    ds_read_b128 v[84:87], v3 offset:36864
    global_load_dwordx4 a[92:95], v2, s[58:59] offset:-4096 sc1
    v_cvt_pk_bf16_f32 v149, v58, v59
    v_mfma_f32_16x16x32_bf16 v[76:79], a[196:199], v[96:99], v[76:79]
    ds_read_b128 v[88:91], v3 offset:37120
    v_cvt_pk_bf16_f32 v150, v56, v57
    v_mfma_f32_16x16x32_bf16 v[80:83], a[200:203], v[96:99], v[80:83]
    s_waitcnt lgkmcnt(2)
    v_permlane16_swap_b32 v148, v150
    v_mfma_f32_16x16x32_bf16 v[60:63], a[204:207], v[100:103], v[60:63]
    global_load_dwordx4 a[96:99], v2, s[58:59] offset:-2048 sc1
    v_cvt_pk_bf16_f32 v151, v58, v59
    v_mfma_f32_16x16x32_bf16 v[64:67], a[208:211], v[100:103], v[64:67]
    ds_read_b128 v[92:95], v3 offset:38912
    v_mfma_f32_16x16x32_bf16 v[68:71], a[212:215], v[100:103], v[68:71]
    v_permlane16_swap_b32 v149, v151
    v_mfma_f32_16x16x32_bf16 v[72:75], a[204:207], v[104:107], v[72:75]
    buffer_store_dwordx4 v[148:151], v12, s[16:19], 0 offen offset:1024 sc1
    s_add_u32 s16, s16, 98304
    v_mfma_f32_16x16x32_bf16 v[76:79], a[208:211], v[104:107], v[76:79]
    ds_read_b128 v[96:99], v3 offset:39168
    v_mfma_f32_16x16x32_bf16 v[80:83], a[212:215], v[104:107], v[80:83]
    ds_read_b128 v[120:123], v13 offset:1536
    s_waitcnt lgkmcnt(3)
    v_mfma_f32_16x16x32_bf16 v[60:63], a[216:219], v[84:87], v[60:63]
    global_load_dwordx4 a[100:103], v2, s[58:59] offset:0 sc1
    v_mfma_f32_16x16x32_bf16 v[64:67], a[220:223], v[84:87], v[64:67]
    ds_read_b128 v[124:127], v13 offset:1792
    v_mfma_f32_16x16x32_bf16 v[68:71], a[224:227], v[84:87], v[68:71]
    ds_read_b64 v[114:115], v14 offset:3072
    v_mfma_f32_16x16x32_bf16 v[72:75], a[216:219], v[88:91], v[72:75]
    ds_read_b64 v[116:117], v14 offset:3584
    v_mfma_f32_16x16x32_bf16 v[76:79], a[220:223], v[88:91], v[76:79]
    global_load_dwordx4 a[104:107], v2, s[58:59] offset:2048 sc1
    s_add_u32 s58, s58, 81920
    v_mfma_f32_16x16x32_bf16 v[80:83], a[224:227], v[88:91], v[80:83]
    ds_read_b128 v[128:131], v118 offset:1536
    s_waitcnt lgkmcnt(5)
    v_mfma_f32_16x16x32_bf16 v[60:63], a[228:231], v[92:95], v[60:63]
    ds_read_b128 a[108:111], v154 offset:0
    v_mfma_f32_16x16x32_bf16 v[64:67], a[232:235], v[92:95], v[64:67]
    ds_read_b128 a[112:115], v154 offset:1024
    v_mfma_f32_16x16x32_bf16 v[68:71], a[236:239], v[92:95], v[68:71]
    ds_read_b128 a[116:119], v154 offset:2048
    v_mfma_f32_16x16x32_bf16 v[72:75], a[228:231], v[96:99], v[72:75]
    ds_read_b128 a[120:123], v154 offset:3072
    v_mfma_f32_16x16x32_bf16 v[76:79], a[232:235], v[96:99], v[76:79]
    ds_read_b128 a[124:127], v154 offset:4096
    v_mfma_f32_16x16x32_bf16 v[80:83], a[236:239], v[96:99], v[80:83]
    ds_read_b128 a[128:131], v154 offset:5120
    s_waitcnt lgkmcnt(7)
    v_mfma_f32_16x16x16_bf16 v[60:63], v[108:109], v[114:115], v[60:63]
    ds_read_b128 a[132:135], v155 offset:0
    v_mfma_f32_16x16x16_bf16 v[64:67], v[110:111], v[114:115], v[64:67]
    ds_read_b128 a[136:139], v155 offset:1024
    v_mfma_f32_16x16x16_bf16 v[68:71], v[112:113], v[114:115], v[68:71]
    ds_read_b128 a[140:143], v155 offset:2048
    v_mfma_f32_16x16x16_bf16 v[72:75], v[108:109], v[116:117], v[72:75]
    ds_read_b128 a[144:147], v155 offset:3072
    v_mfma_f32_16x16x16_bf16 v[76:79], v[110:111], v[116:117], v[76:79]
    ds_read_b128 a[148:151], v155 offset:4096
    v_mfma_f32_16x16x16_bf16 v[80:83], v[112:113], v[116:117], v[80:83]
    ds_read_b128 a[152:155], v155 offset:5120
    ds_read_b128 a[156:159], v155 offset:6144
    ds_read_b128 a[160:163], v155 offset:7168
    ds_read_b128 a[164:167], v155 offset:8192
    ds_read_b128 a[168:171], v155 offset:9216
    v_add_u32 v13, 40960, v11
    v_add_u32 v10, 40960, v8
    v_add_u32 v14, 40960, v6
    s_waitcnt lgkmcnt(15)
    buffer_load_dword v0, v152, s[20:23], 0 offen offset:128 sc1
    v_permlane32_swap_b32 v68, v80
    v_permlane32_swap_b32 v69, v81
    v_permlane32_swap_b32 v70, v82
    v_permlane32_swap_b32 v71, v83
    v_pk_mul_f32 v[132:133], v[60:61], v[60:61]
    v_pk_mul_f32 v[134:135], v[62:63], v[62:63]
    v_pk_mul_f32 v[136:137], v[72:73], v[72:73]
    v_pk_mul_f32 v[138:139], v[74:75], v[74:75]
    v_pk_mul_f32 v[140:141], v[68:69], v[68:69]
    v_pk_mul_f32 v[142:143], v[70:71], v[70:71]
    v_pk_fma_f32 v[132:133], v[132:133], v[120:121], v[120:121] op_sel:[0,1,0] op_sel_hi:[1,1,0]
    v_pk_fma_f32 v[134:135], v[134:135], v[120:121], v[120:121] op_sel:[0,1,0] op_sel_hi:[1,1,0]
    v_pk_fma_f32 v[136:137], v[136:137], v[124:125], v[124:125] op_sel:[0,1,0] op_sel_hi:[1,1,0]
    v_pk_fma_f32 v[138:139], v[138:139], v[124:125], v[124:125] op_sel:[0,1,0] op_sel_hi:[1,1,0]
    v_pk_fma_f32 v[140:141], v[140:141], v[128:129], v[128:129] op_sel:[0,1,0] op_sel_hi:[1,1,0]
    v_pk_fma_f32 v[142:143], v[142:143], v[128:129], v[128:129] op_sel:[0,1,0] op_sel_hi:[1,1,0]
    v_pk_mul_f32 v[132:133], v[132:133], v[60:61]
    v_pk_mul_f32 v[134:135], v[134:135], v[62:63]
    v_pk_mul_f32 v[136:137], v[136:137], v[72:73]
    v_pk_mul_f32 v[138:139], v[138:139], v[74:75]
    v_pk_mul_f32 v[140:141], v[140:141], v[68:69]
    v_pk_mul_f32 v[142:143], v[142:143], v[70:71]
    v_exp_f32 v132, v132
    v_exp_f32 v133, v133
    v_exp_f32 v134, v134
    v_exp_f32 v135, v135
    v_exp_f32 v136, v136
    v_exp_f32 v137, v137
    v_exp_f32 v138, v138
    v_exp_f32 v139, v139
    v_exp_f32 v140, v140
    v_exp_f32 v141, v141
    v_exp_f32 v142, v142
    v_exp_f32 v143, v143
    v_pk_fma_f32 v[132:133], v[132:133], v[122:123], v[122:123] op_sel_hi:[1,0,0]
    v_pk_fma_f32 v[134:135], v[134:135], v[122:123], v[122:123] op_sel_hi:[1,0,0]
    v_pk_fma_f32 v[136:137], v[136:137], v[126:127], v[126:127] op_sel_hi:[1,0,0]
    v_pk_fma_f32 v[138:139], v[138:139], v[126:127], v[126:127] op_sel_hi:[1,0,0]
    v_pk_fma_f32 v[140:141], v[140:141], v[130:131], v[130:131] op_sel_hi:[1,0,0]
    v_pk_fma_f32 v[142:143], v[142:143], v[130:131], v[130:131] op_sel_hi:[1,0,0]
    v_rcp_f32 v132, v132
    v_rcp_f32 v133, v133
    v_rcp_f32 v134, v134
    v_rcp_f32 v135, v135
    v_rcp_f32 v136, v136
    v_rcp_f32 v137, v137
    v_rcp_f32 v138, v138
    v_rcp_f32 v139, v139
    v_rcp_f32 v140, v140
    v_rcp_f32 v141, v141
    v_rcp_f32 v142, v142
    v_rcp_f32 v143, v143
    v_pk_mul_f32 v[64:65], v[64:65], v[60:61]
    v_pk_mul_f32 v[66:67], v[66:67], v[62:63]
    v_pk_mul_f32 v[76:77], v[76:77], v[72:73]
    v_pk_mul_f32 v[78:79], v[78:79], v[74:75]
    v_pk_mul_f32 v[80:81], v[80:81], v[68:69]
    v_pk_mul_f32 v[82:83], v[82:83], v[70:71]
    v_pk_mul_f32 v[64:65], v[64:65], v[132:133]
    v_pk_mul_f32 v[66:67], v[66:67], v[134:135]
    v_pk_mul_f32 v[76:77], v[76:77], v[136:137]
    v_pk_mul_f32 v[78:79], v[78:79], v[138:139]
    v_pk_mul_f32 v[80:81], v[80:81], v[140:141]
    v_pk_mul_f32 v[82:83], v[82:83], v[142:143]
    v_cvt_pk_bf16_f32 v144, v64, v65
    v_cvt_pk_bf16_f32 v145, v66, v67
    v_cvt_pk_bf16_f32 v146, v76, v77
    v_cvt_pk_bf16_f32 v147, v78, v79
    v_cvt_pk_bf16_f32 v148, v80, v81
    v_cvt_pk_bf16_f32 v149, v82, v83
    v_cvt_pk_bf16_f32 v150, v80, v81
    v_cvt_pk_bf16_f32 v151, v82, v83
    v_permlane16_swap_b32 v144, v146
    v_permlane16_swap_b32 v145, v147
    buffer_store_dwordx4 v[144:147], v1, s[16:19], 0 offen sc1
    v_permlane16_swap_b32 v148, v150
    v_permlane16_swap_b32 v149, v151
    buffer_store_dwordx4 v[148:151], v12, s[16:19], 0 offen offset:1024 sc1
    s_add_u32 s16, s16, 98304
    s_waitcnt vmcnt(2)
    v_cmp_gt_u32 vcc, 4, v0
    s_cbranch_vccnz L_back_poll_15
L_back_ok_16:
    s_waitcnt lgkmcnt(0)
    v_mfma_f32_16x16x32_bf16 v[36:39], a[240:243], a[60:63], 0
    global_load_dwordx4 a[172:175], v2, s[58:59] offset:-4096 sc1
    v_mfma_f32_16x16x32_bf16 v[40:43], a[244:247], a[60:63], 0
    v_mfma_f32_16x16x32_bf16 v[44:47], a[248:251], a[60:63], 0
    v_mfma_f32_16x16x32_bf16 v[48:51], a[252:255], a[60:63], 0
    v_mfma_f32_16x16x32_bf16 v[52:55], a[108:111], a[60:63], 0
    global_load_dwordx4 a[176:179], v2, s[58:59] offset:-2048 sc1
    v_mfma_f32_16x16x32_bf16 v[36:39], a[112:115], a[64:67], v[36:39]
    v_mfma_f32_16x16x32_bf16 v[40:43], a[116:119], a[64:67], v[40:43]
    v_mfma_f32_16x16x32_bf16 v[44:47], a[120:123], a[64:67], v[44:47]
    v_mfma_f32_16x16x32_bf16 v[48:51], a[124:127], a[64:67], v[48:51]
    global_load_dwordx4 a[180:183], v2, s[58:59] offset:0 sc1
    v_mfma_f32_16x16x32_bf16 v[52:55], a[128:131], a[64:67], v[52:55]
    v_mfma_f32_16x16x32_bf16 v[36:39], v[156:159], a[68:71], v[36:39]
    v_mfma_f32_16x16x32_bf16 v[40:43], v[160:163], a[68:71], v[40:43]
    v_mfma_f32_16x16x32_bf16 v[44:47], v[164:167], a[68:71], v[44:47]
    global_load_dwordx4 a[184:187], v2, s[58:59] offset:2048 sc1
    s_add_u32 s58, s58, 8192
    v_mfma_f32_16x16x32_bf16 v[48:51], v[168:171], a[68:71], v[48:51]
    v_mfma_f32_16x16x32_bf16 v[52:55], v[172:175], a[68:71], v[52:55]
    v_mfma_f32_16x16x32_bf16 v[36:39], v[176:179], a[72:75], v[36:39]
    v_mfma_f32_16x16x32_bf16 v[40:43], v[180:183], a[72:75], v[40:43]
    global_load_dwordx4 a[188:191], v2, s[58:59] offset:-4096 sc1
    v_mfma_f32_16x16x32_bf16 v[44:47], v[184:187], a[72:75], v[44:47]
    v_mfma_f32_16x16x32_bf16 v[48:51], v[188:191], a[72:75], v[48:51]
    s_barrier
    v_mfma_f32_16x16x32_bf16 v[52:55], v[192:195], a[72:75], v[52:55]
    buffer_store_dword v153, v5, s[20:23], s55 offen offset:128
    v_mfma_f32_16x16x32_bf16 v[36:39], v[196:199], a[76:79], v[36:39]
    buffer_store_dword v153, v5, s[20:23], s44 offen sc1
    v_mfma_f32_16x16x32_bf16 v[40:43], v[200:203], a[76:79], v[40:43]
    global_load_dwordx4 a[192:195], v2, s[58:59] offset:-2048 sc1
    v_mfma_f32_16x16x32_bf16 v[44:47], v[204:207], a[76:79], v[44:47]
    v_mfma_f32_16x16x32_bf16 v[48:51], v[208:211], a[76:79], v[48:51]
    v_mfma_f32_16x16x32_bf16 v[52:55], v[212:215], a[76:79], v[52:55]
    global_load_dwordx4 a[196:199], v2, s[58:59] offset:0 sc1
    v_mfma_f32_16x16x32_bf16 v[36:39], v[216:219], a[80:83], v[36:39]
    v_mov_b32 v153, 6
    v_mfma_f32_16x16x32_bf16 v[40:43], v[220:223], a[80:83], v[40:43]
    v_mfma_f32_16x16x32_bf16 v[44:47], v[224:227], a[80:83], v[44:47]
    v_mfma_f32_16x16x32_bf16 v[48:51], v[228:231], a[80:83], v[48:51]
    global_load_dwordx4 a[200:203], v2, s[58:59] offset:2048 sc1
    s_add_u32 s58, s58, 8192
    v_mfma_f32_16x16x32_bf16 v[52:55], v[232:235], a[80:83], v[52:55]
    v_mfma_f32_16x16x32_bf16 v[36:39], v[236:239], a[84:87], v[36:39]
    ds_write_b128 v14, v[16:19] offset:40960
    v_mfma_f32_16x16x32_bf16 v[40:43], v[240:243], a[84:87], v[40:43]
    ds_write_b128 v14, v[20:23] offset:41984
    v_mfma_f32_16x16x32_bf16 v[44:47], v[244:247], a[84:87], v[44:47]
    global_load_dwordx4 a[204:207], v2, s[58:59] offset:-4096 sc1
    v_mfma_f32_16x16x32_bf16 v[48:51], v[248:251], a[84:87], v[48:51]
    ds_write_b128 v14, v[24:27] offset:43008
    v_mfma_f32_16x16x32_bf16 v[52:55], v[252:255], a[84:87], v[52:55]
    ds_write_b128 v14, v[28:31] offset:44032
    v_mfma_f32_16x16x32_bf16 v[36:39], a[132:135], a[88:91], v[36:39]
    ds_write_b128 v14, v[32:35] offset:45056
    v_mfma_f32_16x16x32_bf16 v[40:43], a[136:139], a[88:91], v[40:43]
    global_load_dwordx4 a[208:211], v2, s[58:59] offset:-2048 sc1
    v_mfma_f32_16x16x32_bf16 v[44:47], a[140:143], a[88:91], v[44:47]
    v_mfma_f32_16x16x32_bf16 v[48:51], a[144:147], a[88:91], v[48:51]
    v_mfma_f32_16x16x32_bf16 v[52:55], a[148:151], a[88:91], v[52:55]
    v_mfma_f32_16x16x32_bf16 v[36:39], a[152:155], a[92:95], v[36:39]
    global_load_dwordx4 a[212:215], v2, s[58:59] offset:0 sc1
    v_mfma_f32_16x16x32_bf16 v[40:43], a[156:159], a[92:95], v[40:43]
    ds_read_b128 v[120:123], v9 offset:0
    v_mfma_f32_16x16x32_bf16 v[44:47], a[160:163], a[92:95], v[44:47]
    ds_read_b128 v[124:127], v9 offset:16
    v_mfma_f32_16x16x32_bf16 v[48:51], a[164:167], a[92:95], v[48:51]
    v_mfma_f32_16x16x32_bf16 v[52:55], a[168:171], a[92:95], v[52:55]
    global_load_dwordx4 a[216:219], v2, s[58:59] offset:2048 sc1
    v_mfma_f32_16x16x32_bf16 v[36:39], a[0:3], a[96:99], v[36:39]
    buffer_load_dword v0, v152, s[20:23], 0 offen offset:128 sc1
    s_add_u32 s58, s58, 81920
    v_mfma_f32_16x16x32_bf16 v[40:43], a[4:7], a[96:99], v[40:43]
    v_mfma_f32_16x16x32_bf16 v[44:47], a[8:11], a[96:99], v[44:47]
    v_mfma_f32_16x16x32_bf16 v[48:51], a[12:15], a[96:99], v[48:51]
    s_waitcnt vmcnt(15)
    s_barrier
    v_mfma_f32_16x16x32_bf16 v[52:55], a[16:19], a[96:99], v[52:55]
    buffer_store_dword v153, v5, s[20:23], s55 offen offset:128
    v_mfma_f32_16x16x32_bf16 v[36:39], a[20:23], a[100:103], v[36:39]
    buffer_store_dword v153, v5, s[20:23], s44 offen sc1
    v_mfma_f32_16x16x32_bf16 v[40:43], a[24:27], a[100:103], v[40:43]
    v_mfma_f32_16x16x32_bf16 v[44:47], a[28:31], a[100:103], v[44:47]
    v_mfma_f32_16x16x32_bf16 v[48:51], a[32:35], a[100:103], v[48:51]
    v_mfma_f32_16x16x32_bf16 v[52:55], a[36:39], a[100:103], v[52:55]
    v_mov_b32 v153, 7
    v_mfma_f32_16x16x32_bf16 v[36:39], a[40:43], a[104:107], v[36:39]
    v_mfma_f32_16x16x32_bf16 v[40:43], a[44:47], a[104:107], v[40:43]
    v_mfma_f32_16x16x32_bf16 v[44:47], a[48:51], a[104:107], v[44:47]
    v_mfma_f32_16x16x32_bf16 v[48:51], a[52:55], a[104:107], v[48:51]
    v_mfma_f32_16x16x32_bf16 v[52:55], a[56:59], a[104:107], v[52:55]
    s_waitcnt vmcnt(16)
    v_mfma_f32_16x16x32_bf16 v[56:59], a[240:243], a[172:175], 0
    v_mfma_f32_16x16x32_bf16 v[60:63], a[244:247], a[172:175], 0
    v_mfma_f32_16x16x32_bf16 v[64:67], a[248:251], a[172:175], 0
    v_mfma_f32_16x16x32_bf16 v[68:71], a[252:255], a[172:175], 0
    v_mfma_f32_16x16x32_bf16 v[72:75], a[108:111], a[172:175], 0
    ds_write_b128 v6, v[36:39] offset:0
    s_waitcnt vmcnt(15)
    v_mfma_f32_16x16x32_bf16 v[56:59], a[112:115], a[176:179], v[56:59]
    ds_write_b128 v6, v[40:43] offset:1024
    v_mfma_f32_16x16x32_bf16 v[60:63], a[116:119], a[176:179], v[60:63]
    ds_write_b128 v6, v[44:47] offset:2048
    v_mfma_f32_16x16x32_bf16 v[64:67], a[120:123], a[176:179], v[64:67]
    ds_write_b128 v6, v[48:51] offset:3072
    ds_write_b128 v6, v[52:55] offset:4096
    v_mfma_f32_16x16x32_bf16 v[68:71], a[124:127], a[176:179], v[68:71]
    v_mfma_f32_16x16x32_bf16 v[72:75], a[128:131], a[176:179], v[72:75]
    s_waitcnt vmcnt(14)
    v_mfma_f32_16x16x32_bf16 v[56:59], v[156:159], a[180:183], v[56:59]
L_back_stub1_3:
    s_cmp_eq_u32 s0, 1
    s_cbranch_scc1 L_back_wret1
    v_mfma_f32_16x16x32_bf16 v[60:63], v[160:163], a[180:183], v[60:63]
    v_mfma_f32_16x16x32_bf16 v[64:67], v[164:167], a[180:183], v[64:67]
    v_mfma_f32_16x16x32_bf16 v[68:71], v[168:171], a[180:183], v[68:71]
    s_waitcnt vmcnt(2)
    v_cmp_gt_u32 vcc, 5, v0
    s_cbranch_vccnz L_back_poll_17
L_back_ok_18:
    s_waitcnt lgkmcnt(0)
    s_barrier
    v_mfma_f32_16x16x32_bf16 v[72:75], v[172:175], a[180:183], v[72:75]
    v_mfma_f32_16x16x32_bf16 v[56:59], v[176:179], a[184:187], v[56:59]
    global_load_dwordx4 a[60:63], v2, s[58:59] offset:-4096 sc1
    v_mfma_f32_16x16x32_bf16 v[60:63], v[180:183], a[184:187], v[60:63]
    ds_read_b128 v[16:19], v13 offset:40960
    v_mfma_f32_16x16x32_bf16 v[64:67], v[184:187], a[184:187], v[64:67]
    ds_read_b128 v[20:23], v10 offset:40960
    v_mfma_f32_16x16x32_bf16 v[68:71], v[188:191], a[184:187], v[68:71]
    ds_read_b128 v[24:27], v11 offset:0
    v_mfma_f32_16x16x32_bf16 v[72:75], v[192:195], a[184:187], v[72:75]
    global_load_dwordx4 a[64:67], v2, s[58:59] offset:-2048 sc1
    v_mfma_f32_16x16x32_bf16 v[56:59], v[196:199], a[188:191], v[56:59]
    buffer_load_dword v0, v152, s[20:23], 0 offen offset:128 sc1
    v_mfma_f32_16x16x32_bf16 v[60:63], v[200:203], a[188:191], v[60:63]
    ds_read_b128 v[28:31], v8 offset:0
    v_mfma_f32_16x16x32_bf16 v[64:67], v[204:207], a[188:191], v[64:67]
    ds_read_b128 v[128:131], v11 offset:5120
    v_mfma_f32_16x16x32_bf16 v[68:71], v[208:211], a[188:191], v[68:71]
    global_load_dwordx4 a[68:71], v2, s[58:59] offset:0 sc1
    v_mfma_f32_16x16x32_bf16 v[72:75], v[212:215], a[188:191], v[72:75]
    ds_read_b128 v[132:135], v8 offset:5120
    v_mfma_f32_16x16x32_bf16 v[56:59], v[216:219], a[192:195], v[56:59]
    ds_read_b128 v[136:139], v11 offset:10240
    v_mfma_f32_16x16x32_bf16 v[60:63], v[220:223], a[192:195], v[60:63]
    ds_read_b128 v[140:143], v8 offset:10240
    v_mfma_f32_16x16x32_bf16 v[64:67], v[224:227], a[192:195], v[64:67]
    global_load_dwordx4 a[72:75], v2, s[58:59] offset:2048 sc1
    s_add_u32 s58, s58, 8192
    v_mfma_f32_16x16x32_bf16 v[68:71], v[228:231], a[192:195], v[68:71]
    ds_read_b128 v[144:147], v11 offset:15360
    v_mfma_f32_16x16x32_bf16 v[72:75], v[232:235], a[192:195], v[72:75]
    ds_read_b128 v[148:151], v8 offset:15360
    v_mfma_f32_16x16x32_bf16 v[56:59], v[236:239], a[196:199], v[56:59]
    v_mfma_f32_16x16x32_bf16 v[60:63], v[240:243], a[196:199], v[60:63]
    global_load_dwordx4 a[76:79], v2, s[58:59] offset:-4096 sc1
    v_mfma_f32_16x16x32_bf16 v[64:67], v[244:247], a[196:199], v[64:67]
    v_mfma_f32_16x16x32_bf16 v[68:71], v[248:251], a[196:199], v[68:71]
    s_waitcnt lgkmcnt(0)
    v_fmac_f32 v16, v24, v120
    v_fmac_f32 v17, v25, v121
    v_mfma_f32_16x16x32_bf16 v[72:75], v[252:255], a[196:199], v[72:75]
    v_fmac_f32 v18, v26, v122
    v_fmac_f32 v19, v27, v123
    v_mfma_f32_16x16x32_bf16 v[56:59], a[132:135], a[200:203], v[56:59]
    global_load_dwordx4 a[80:83], v2, s[58:59] offset:-2048 sc1
    v_fmac_f32 v20, v28, v124
    v_mfma_f32_16x16x32_bf16 v[60:63], a[136:139], a[200:203], v[60:63]
    v_fmac_f32 v21, v29, v125
    v_fmac_f32 v22, v30, v126
    v_mfma_f32_16x16x32_bf16 v[64:67], a[140:143], a[200:203], v[64:67]
    v_fmac_f32 v23, v31, v127
    v_fmac_f32 v16, v128, v120
    v_mfma_f32_16x16x32_bf16 v[68:71], a[144:147], a[200:203], v[68:71]
    v_fmac_f32 v17, v129, v121
    v_fmac_f32 v18, v130, v122
    v_mfma_f32_16x16x32_bf16 v[72:75], a[148:151], a[200:203], v[72:75]
    v_fmac_f32 v19, v131, v123
    v_fmac_f32 v20, v132, v124
    v_mfma_f32_16x16x32_bf16 v[56:59], a[152:155], a[204:207], v[56:59]
    global_load_dwordx4 a[84:87], v2, s[58:59] offset:0 sc1
    v_fmac_f32 v21, v133, v125
    v_mfma_f32_16x16x32_bf16 v[60:63], a[156:159], a[204:207], v[60:63]
    v_fmac_f32 v22, v134, v126
    v_fmac_f32 v23, v135, v127
    v_mfma_f32_16x16x32_bf16 v[64:67], a[160:163], a[204:207], v[64:67]
    v_fmac_f32 v16, v136, v120
    v_fmac_f32 v17, v137, v121
    v_mfma_f32_16x16x32_bf16 v[68:71], a[164:167], a[204:207], v[68:71]
    global_load_dwordx4 a[88:91], v2, s[58:59] offset:2048 sc1
    v_fmac_f32 v18, v138, v122
    v_mfma_f32_16x16x32_bf16 v[72:75], a[168:171], a[204:207], v[72:75]
    v_fmac_f32 v19, v139, v123
    v_fmac_f32 v20, v140, v124
    v_mfma_f32_16x16x32_bf16 v[56:59], a[0:3], a[208:211], v[56:59]
    s_add_u32 s58, s58, 8192
    v_fmac_f32 v21, v141, v125
    v_fmac_f32 v22, v142, v126
    v_mfma_f32_16x16x32_bf16 v[60:63], a[4:7], a[208:211], v[60:63]
    v_fmac_f32 v23, v143, v127
    v_fmac_f32 v16, v144, v120
    v_mfma_f32_16x16x32_bf16 v[64:67], a[8:11], a[208:211], v[64:67]
    global_load_dwordx4 a[92:95], v2, s[58:59] offset:-4096 sc1
    v_fmac_f32 v17, v145, v121
    v_mfma_f32_16x16x32_bf16 v[68:71], a[12:15], a[208:211], v[68:71]
    v_fmac_f32 v18, v146, v122
    v_fmac_f32 v19, v147, v123
    v_mfma_f32_16x16x32_bf16 v[72:75], a[16:19], a[208:211], v[72:75]
    v_fmac_f32 v20, v148, v124
    v_fmac_f32 v21, v149, v125
    v_mfma_f32_16x16x32_bf16 v[56:59], a[20:23], a[212:215], v[56:59]
    v_fmac_f32 v22, v150, v126
    v_fmac_f32 v23, v151, v127
    v_mfma_f32_16x16x32_bf16 v[60:63], a[24:27], a[212:215], v[60:63]
    global_load_dwordx4 a[96:99], v2, s[58:59] offset:-2048 sc1
    v_cvt_pk_bf16_f32 v32, v16, v17
    v_mfma_f32_16x16x32_bf16 v[64:67], a[28:31], a[212:215], v[64:67]
    v_cvt_pk_bf16_f32 v33, v18, v19
    v_cvt_pk_bf16_f32 v34, v20, v21
    v_mfma_f32_16x16x32_bf16 v[68:71], a[32:35], a[212:215], v[68:71]
    v_cvt_pk_bf16_f32 v35, v22, v23
    v_mfma_f32_16x16x32_bf16 v[72:75], a[36:39], a[212:215], v[72:75]
    buffer_store_dwordx4 v[32:35], v7, s[24:27], s61 offen sc1
    v_mfma_f32_16x16x32_bf16 v[56:59], a[40:43], a[216:219], v[56:59]
    ds_read_b128 v[16:19], v13 offset:46080
    s_add_u32 s61, s61, 40960
    v_mfma_f32_16x16x32_bf16 v[60:63], a[44:47], a[216:219], v[60:63]
    ds_read_b128 v[20:23], v10 offset:46080
    v_mfma_f32_16x16x32_bf16 v[64:67], a[48:51], a[216:219], v[64:67]
    global_load_dwordx4 a[100:103], v2, s[58:59] offset:0 sc1
    v_mfma_f32_16x16x32_bf16 v[68:71], a[52:55], a[216:219], v[68:71]
    s_waitcnt vmcnt(10)
    v_cmp_gt_u32 vcc, 6, v0
    s_cbranch_vccnz L_back_poll_19
L_back_ok_20:
    v_mfma_f32_16x16x32_bf16 v[72:75], a[56:59], a[216:219], v[72:75]
    global_load_dwordx4 a[104:107], v2, s[58:59] offset:2048 sc1
    v_mfma_f32_16x16x32_bf16 v[76:79], a[240:243], a[60:63], 0
    s_add_u32 s58, s58, 81920
    v_mfma_f32_16x16x32_bf16 v[80:83], a[244:247], a[60:63], 0
    global_load_dwordx4 a[172:175], v2, s[58:59] offset:-4096 sc1
    v_mfma_f32_16x16x32_bf16 v[84:87], a[248:251], a[60:63], 0
    v_mfma_f32_16x16x32_bf16 v[88:91], a[252:255], a[60:63], 0
    v_mfma_f32_16x16x32_bf16 v[92:95], a[108:111], a[60:63], 0
    ds_write_b128 v6, v[56:59] offset:20480
    v_mfma_f32_16x16x32_bf16 v[76:79], a[112:115], a[64:67], v[76:79]
    ds_write_b128 v6, v[60:63] offset:21504
    v_mfma_f32_16x16x32_bf16 v[80:83], a[116:119], a[64:67], v[80:83]
    ds_write_b128 v6, v[64:67] offset:22528
    v_mfma_f32_16x16x32_bf16 v[84:87], a[120:123], a[64:67], v[84:87]
    ds_write_b128 v6, v[68:71] offset:23552
    ds_write_b128 v6, v[72:75] offset:24576
    v_mfma_f32_16x16x32_bf16 v[88:91], a[124:127], a[64:67], v[88:91]
    global_load_dwordx4 a[176:179], v2, s[58:59] offset:-2048 sc1
    v_mfma_f32_16x16x32_bf16 v[92:95], a[128:131], a[64:67], v[92:95]
    global_load_dwordx4 a[180:183], v2, s[58:59] offset:0 sc1
    s_waitcnt vmcnt(13)
    v_mfma_f32_16x16x32_bf16 v[76:79], v[156:159], a[68:71], v[76:79]
    v_mfma_f32_16x16x32_bf16 v[80:83], v[160:163], a[68:71], v[80:83]
    v_mfma_f32_16x16x32_bf16 v[84:87], v[164:167], a[68:71], v[84:87]
    global_load_dwordx4 a[184:187], v2, s[58:59] offset:2048 sc1
    s_add_u32 s58, s58, 8192
    v_mfma_f32_16x16x32_bf16 v[88:91], v[168:171], a[68:71], v[88:91]
    s_waitcnt lgkmcnt(0)
    s_barrier
    v_mfma_f32_16x16x32_bf16 v[92:95], v[172:175], a[68:71], v[92:95]
    s_waitcnt vmcnt(13)
    v_mfma_f32_16x16x32_bf16 v[76:79], v[176:179], a[72:75], v[76:79]
    ds_read_b128 v[24:27], v11 offset:20480
    v_mfma_f32_16x16x32_bf16 v[80:83], v[180:183], a[72:75], v[80:83]
    global_load_dwordx4 a[188:191], v2, s[58:59] offset:-4096 sc1
    v_mfma_f32_16x16x32_bf16 v[84:87], v[184:187], a[72:75], v[84:87]
    ds_read_b128 v[28:31], v8 offset:20480
    v_mfma_f32_16x16x32_bf16 v[88:91], v[188:191], a[72:75], v[88:91]
    ds_read_b128 v[128:131], v11 offset:25600
    v_mfma_f32_16x16x32_bf16 v[92:95], v[192:195], a[72:75], v[92:95]
    ds_read_b128 v[132:135], v8 offset:25600
    s_waitcnt vmcnt(13)
    v_mfma_f32_16x16x32_bf16 v[76:79], v[196:199], a[76:79], v[76:79]
    global_load_dwordx4 a[192:195], v2, s[58:59] offset:-2048 sc1
    v_mfma_f32_16x16x32_bf16 v[80:83], v[200:203], a[76:79], v[80:83]
    ds_read_b128 v[136:139], v11 offset:30720
    v_mfma_f32_16x16x32_bf16 v[84:87], v[204:207], a[76:79], v[84:87]
    ds_read_b128 v[140:143], v8 offset:30720
    v_mfma_f32_16x16x32_bf16 v[88:91], v[208:211], a[76:79], v[88:91]
    ds_read_b128 v[144:147], v11 offset:35840
    v_mfma_f32_16x16x32_bf16 v[92:95], v[212:215], a[76:79], v[92:95]
    global_load_dwordx4 a[196:199], v2, s[58:59] offset:0 sc1
    s_waitcnt vmcnt(14)
    v_mfma_f32_16x16x32_bf16 v[76:79], v[216:219], a[80:83], v[76:79]
    ds_read_b128 v[148:151], v8 offset:35840
    v_mfma_f32_16x16x32_bf16 v[80:83], v[220:223], a[80:83], v[80:83]
    v_mfma_f32_16x16x32_bf16 v[84:87], v[224:227], a[80:83], v[84:87]
    v_mfma_f32_16x16x32_bf16 v[88:91], v[228:231], a[80:83], v[88:91]
    global_load_dwordx4 a[200:203], v2, s[58:59] offset:2048 sc1
    s_add_u32 s58, s58, 8192
    v_mfma_f32_16x16x32_bf16 v[92:95], v[232:235], a[80:83], v[92:95]
    s_waitcnt vmcnt(14)
    v_mfma_f32_16x16x32_bf16 v[76:79], v[236:239], a[84:87], v[76:79]
    v_mfma_f32_16x16x32_bf16 v[80:83], v[240:243], a[84:87], v[80:83]
    v_mfma_f32_16x16x32_bf16 v[84:87], v[244:247], a[84:87], v[84:87]
    global_load_dwordx4 a[204:207], v2, s[58:59] offset:-4096 sc1
    v_mfma_f32_16x16x32_bf16 v[88:91], v[248:251], a[84:87], v[88:91]
    s_waitcnt lgkmcnt(0)
    v_fmac_f32 v16, v24, v120
    v_fmac_f32 v17, v25, v121
    v_mfma_f32_16x16x32_bf16 v[92:95], v[252:255], a[84:87], v[92:95]
    s_waitcnt vmcnt(14)
    v_fmac_f32 v18, v26, v122
    v_fmac_f32 v19, v27, v123
    v_mfma_f32_16x16x32_bf16 v[76:79], a[132:135], a[88:91], v[76:79]
    v_fmac_f32 v20, v28, v124
    v_fmac_f32 v21, v29, v125
    v_mfma_f32_16x16x32_bf16 v[80:83], a[136:139], a[88:91], v[80:83]
    global_load_dwordx4 a[208:211], v2, s[58:59] offset:-2048 sc1
    v_fmac_f32 v22, v30, v126
    v_mfma_f32_16x16x32_bf16 v[84:87], a[140:143], a[88:91], v[84:87]
    v_fmac_f32 v23, v31, v127
    v_fmac_f32 v16, v128, v120
    v_mfma_f32_16x16x32_bf16 v[88:91], a[144:147], a[88:91], v[88:91]
    v_fmac_f32 v17, v129, v121
    v_fmac_f32 v18, v130, v122
    v_mfma_f32_16x16x32_bf16 v[92:95], a[148:151], a[88:91], v[92:95]
    s_waitcnt vmcnt(14)
    v_fmac_f32 v19, v131, v123
    v_fmac_f32 v20, v132, v124
    v_mfma_f32_16x16x32_bf16 v[76:79], a[152:155], a[92:95], v[76:79]
    global_load_dwordx4 a[212:215], v2, s[58:59] offset:0 sc1
    v_fmac_f32 v21, v133, v125
    v_mfma_f32_16x16x32_bf16 v[80:83], a[156:159], a[92:95], v[80:83]
    v_fmac_f32 v22, v134, v126
    v_fmac_f32 v23, v135, v127
    v_mfma_f32_16x16x32_bf16 v[84:87], a[160:163], a[92:95], v[84:87]
    v_fmac_f32 v16, v136, v120
    v_fmac_f32 v17, v137, v121
    v_mfma_f32_16x16x32_bf16 v[88:91], a[164:167], a[92:95], v[88:91]
    v_fmac_f32 v18, v138, v122
    v_fmac_f32 v19, v139, v123
    v_mfma_f32_16x16x32_bf16 v[92:95], a[168:171], a[92:95], v[92:95]
    s_waitcnt vmcnt(14)
    v_fmac_f32 v20, v140, v124
    v_fmac_f32 v21, v141, v125
    v_mfma_f32_16x16x32_bf16 v[76:79], a[0:3], a[96:99], v[76:79]
    global_load_dwordx4 a[216:219], v2, s[58:59] offset:2048 sc1
    v_fmac_f32 v22, v142, v126
    v_mfma_f32_16x16x32_bf16 v[80:83], a[4:7], a[96:99], v[80:83]
    s_add_u32 s58, s58, 81920
    v_fmac_f32 v23, v143, v127
    v_fmac_f32 v16, v144, v120
    v_mfma_f32_16x16x32_bf16 v[84:87], a[8:11], a[96:99], v[84:87]
    v_fmac_f32 v17, v145, v121
    v_fmac_f32 v18, v146, v122
    v_mfma_f32_16x16x32_bf16 v[88:91], a[12:15], a[96:99], v[88:91]
    v_fmac_f32 v19, v147, v123
    v_fmac_f32 v20, v148, v124
    v_mfma_f32_16x16x32_bf16 v[92:95], a[16:19], a[96:99], v[92:95]
    s_waitcnt vmcnt(13)
    v_fmac_f32 v21, v149, v125
    v_fmac_f32 v22, v150, v126
    v_mfma_f32_16x16x32_bf16 v[76:79], a[20:23], a[100:103], v[76:79]
    v_fmac_f32 v23, v151, v127
    v_cvt_pk_bf16_f32 v32, v16, v17
    v_mfma_f32_16x16x32_bf16 v[80:83], a[24:27], a[100:103], v[80:83]
    v_cvt_pk_bf16_f32 v33, v18, v19
    v_cvt_pk_bf16_f32 v34, v20, v21
    v_mfma_f32_16x16x32_bf16 v[84:87], a[28:31], a[100:103], v[84:87]
    v_cvt_pk_bf16_f32 v35, v22, v23
    v_mfma_f32_16x16x32_bf16 v[88:91], a[32:35], a[100:103], v[88:91]
    buffer_store_dwordx4 v[32:35], v7, s[24:27], s61 offen sc1
    s_add_u32 s61, s61, 40960
    v_mfma_f32_16x16x32_bf16 v[92:95], a[36:39], a[100:103], v[92:95]
    ds_read_b128 v[16:19], v13 offset:51200
    s_waitcnt vmcnt(13)
    v_mfma_f32_16x16x32_bf16 v[76:79], a[40:43], a[104:107], v[76:79]
    ds_read_b128 v[20:23], v10 offset:51200
    v_mfma_f32_16x16x32_bf16 v[80:83], a[44:47], a[104:107], v[80:83]
    v_mfma_f32_16x16x32_bf16 v[84:87], a[48:51], a[104:107], v[84:87]
    v_mfma_f32_16x16x32_bf16 v[88:91], a[52:55], a[104:107], v[88:91]
    v_mfma_f32_16x16x32_bf16 v[92:95], a[56:59], a[104:107], v[92:95]
    s_waitcnt vmcnt(12)
    v_mfma_f32_16x16x32_bf16 v[96:99], a[240:243], a[172:175], 0
    v_mfma_f32_16x16x32_bf16 v[100:103], a[244:247], a[172:175], 0
    v_mfma_f32_16x16x32_bf16 v[104:107], a[248:251], a[172:175], 0
    v_mfma_f32_16x16x32_bf16 v[108:111], a[252:255], a[172:175], 0
    v_mfma_f32_16x16x32_bf16 v[112:115], a[108:111], a[172:175], 0
    ds_write_b128 v14, v[76:79] offset:0
    s_waitcnt vmcnt(11)
    v_mfma_f32_16x16x32_bf16 v[96:99], a[112:115], a[176:179], v[96:99]
    ds_write_b128 v14, v[80:83] offset:1024
    v_mfma_f32_16x16x32_bf16 v[100:103], a[116:119], a[176:179], v[100:103]
    ds_write_b128 v14, v[84:87] offset:2048
    v_mfma_f32_16x16x32_bf16 v[104:107], a[120:123], a[176:179], v[104:107]
    ds_write_b128 v14, v[88:91] offset:3072
    ds_write_b128 v14, v[92:95] offset:4096
    v_mfma_f32_16x16x32_bf16 v[108:111], a[124:127], a[176:179], v[108:111]
    v_mfma_f32_16x16x32_bf16 v[112:115], a[128:131], a[176:179], v[112:115]
    s_waitcnt vmcnt(10)
    v_mfma_f32_16x16x32_bf16 v[96:99], v[156:159], a[180:183], v[96:99]
    v_mfma_f32_16x16x32_bf16 v[100:103], v[160:163], a[180:183], v[100:103]
    v_mfma_f32_16x16x32_bf16 v[104:107], v[164:167], a[180:183], v[104:107]
    v_mfma_f32_16x16x32_bf16 v[108:111], v[168:171], a[180:183], v[108:111]
    s_waitcnt lgkmcnt(0)
    s_barrier
    v_mfma_f32_16x16x32_bf16 v[112:115], v[172:175], a[180:183], v[112:115]
    s_waitcnt vmcnt(9)
    v_mfma_f32_16x16x32_bf16 v[96:99], v[176:179], a[184:187], v[96:99]
    ds_read_b128 v[24:27], v13 offset:0
    v_mfma_f32_16x16x32_bf16 v[100:103], v[180:183], a[184:187], v[100:103]
    ds_read_b128 v[28:31], v10 offset:0
    v_mfma_f32_16x16x32_bf16 v[104:107], v[184:187], a[184:187], v[104:107]
    ds_read_b128 v[128:131], v13 offset:5120
    v_mfma_f32_16x16x32_bf16 v[108:111], v[188:191], a[184:187], v[108:111]
    ds_read_b128 v[132:135], v10 offset:5120
    v_mfma_f32_16x16x32_bf16 v[112:115], v[192:195], a[184:187], v[112:115]
    ds_read_b128 v[136:139], v13 offset:10240
    s_waitcnt vmcnt(8)
    v_mfma_f32_16x16x32_bf16 v[96:99], v[196:199], a[188:191], v[96:99]
    ds_read_b128 v[140:143], v10 offset:10240
    v_mfma_f32_16x16x32_bf16 v[100:103], v[200:203], a[188:191], v[100:103]
    ds_read_b128 v[144:147], v13 offset:15360
    v_mfma_f32_16x16x32_bf16 v[104:107], v[204:207], a[188:191], v[104:107]
    ds_read_b128 v[148:151], v10 offset:15360
    v_mfma_f32_16x16x32_bf16 v[108:111], v[208:211], a[188:191], v[108:111]
    v_mfma_f32_16x16x32_bf16 v[112:115], v[212:215], a[188:191], v[112:115]
    s_waitcnt vmcnt(7)
    v_mfma_f32_16x16x32_bf16 v[96:99], v[216:219], a[192:195], v[96:99]
    v_mfma_f32_16x16x32_bf16 v[100:103], v[220:223], a[192:195], v[100:103]
    v_mfma_f32_16x16x32_bf16 v[104:107], v[224:227], a[192:195], v[104:107]
    v_mfma_f32_16x16x32_bf16 v[108:111], v[228:231], a[192:195], v[108:111]
    v_mfma_f32_16x16x32_bf16 v[112:115], v[232:235], a[192:195], v[112:115]
    s_waitcnt vmcnt(6)
    v_mfma_f32_16x16x32_bf16 v[96:99], v[236:239], a[196:199], v[96:99]
    v_mfma_f32_16x16x32_bf16 v[100:103], v[240:243], a[196:199], v[100:103]
    v_mfma_f32_16x16x32_bf16 v[104:107], v[244:247], a[196:199], v[104:107]
    v_mfma_f32_16x16x32_bf16 v[108:111], v[248:251], a[196:199], v[108:111]
    s_waitcnt lgkmcnt(0)
    v_fmac_f32 v16, v24, v120
    v_fmac_f32 v17, v25, v121
    v_mfma_f32_16x16x32_bf16 v[112:115], v[252:255], a[196:199], v[112:115]
    s_waitcnt vmcnt(5)
    v_fmac_f32 v18, v26, v122
    v_fmac_f32 v19, v27, v123
    v_mfma_f32_16x16x32_bf16 v[96:99], a[132:135], a[200:203], v[96:99]
    v_fmac_f32 v20, v28, v124
    v_fmac_f32 v21, v29, v125
    v_mfma_f32_16x16x32_bf16 v[100:103], a[136:139], a[200:203], v[100:103]
    v_fmac_f32 v22, v30, v126
    v_fmac_f32 v23, v31, v127
    v_mfma_f32_16x16x32_bf16 v[104:107], a[140:143], a[200:203], v[104:107]
    v_fmac_f32 v16, v128, v120
    v_fmac_f32 v17, v129, v121
    v_mfma_f32_16x16x32_bf16 v[108:111], a[144:147], a[200:203], v[108:111]
    v_fmac_f32 v18, v130, v122
    v_fmac_f32 v19, v131, v123
    v_mfma_f32_16x16x32_bf16 v[112:115], a[148:151], a[200:203], v[112:115]
    s_waitcnt vmcnt(4)
    v_fmac_f32 v20, v132, v124
    v_fmac_f32 v21, v133, v125
    v_mfma_f32_16x16x32_bf16 v[96:99], a[152:155], a[204:207], v[96:99]
    v_fmac_f32 v22, v134, v126
    v_fmac_f32 v23, v135, v127
    v_mfma_f32_16x16x32_bf16 v[100:103], a[156:159], a[204:207], v[100:103]
    v_fmac_f32 v16, v136, v120
    v_fmac_f32 v17, v137, v121
    v_mfma_f32_16x16x32_bf16 v[104:107], a[160:163], a[204:207], v[104:107]
    v_fmac_f32 v18, v138, v122
    v_fmac_f32 v19, v139, v123
    v_mfma_f32_16x16x32_bf16 v[108:111], a[164:167], a[204:207], v[108:111]
    v_fmac_f32 v20, v140, v124
    v_fmac_f32 v21, v141, v125
    v_mfma_f32_16x16x32_bf16 v[112:115], a[168:171], a[204:207], v[112:115]
    s_waitcnt vmcnt(3)
    v_fmac_f32 v22, v142, v126
    v_fmac_f32 v23, v143, v127
    v_mfma_f32_16x16x32_bf16 v[96:99], a[0:3], a[208:211], v[96:99]
    v_fmac_f32 v16, v144, v120
    v_fmac_f32 v17, v145, v121
    v_mfma_f32_16x16x32_bf16 v[100:103], a[4:7], a[208:211], v[100:103]
    v_fmac_f32 v18, v146, v122
    v_fmac_f32 v19, v147, v123
    v_mfma_f32_16x16x32_bf16 v[104:107], a[8:11], a[208:211], v[104:107]
    v_fmac_f32 v20, v148, v124
    v_fmac_f32 v21, v149, v125
    v_mfma_f32_16x16x32_bf16 v[108:111], a[12:15], a[208:211], v[108:111]
    v_fmac_f32 v22, v150, v126
    v_fmac_f32 v23, v151, v127
    v_mfma_f32_16x16x32_bf16 v[112:115], a[16:19], a[208:211], v[112:115]
    s_waitcnt vmcnt(2)
    v_cvt_pk_bf16_f32 v32, v16, v17
    v_cvt_pk_bf16_f32 v33, v18, v19
    v_mfma_f32_16x16x32_bf16 v[96:99], a[20:23], a[212:215], v[96:99]
    v_cvt_pk_bf16_f32 v34, v20, v21
    v_cvt_pk_bf16_f32 v35, v22, v23
    v_mfma_f32_16x16x32_bf16 v[100:103], a[24:27], a[212:215], v[100:103]
    buffer_store_dwordx4 v[32:35], v7, s[24:27], s61 offen sc1
    s_add_u32 s61, s61, 40960
    v_mfma_f32_16x16x32_bf16 v[104:107], a[28:31], a[212:215], v[104:107]
    ds_read_b128 v[16:19], v13 offset:56320
    v_mfma_f32_16x16x32_bf16 v[108:111], a[32:35], a[212:215], v[108:111]
    ds_read_b128 v[20:23], v10 offset:56320
    v_mfma_f32_16x16x32_bf16 v[112:115], a[36:39], a[212:215], v[112:115]
    s_waitcnt vmcnt(2)
    v_mfma_f32_16x16x32_bf16 v[96:99], a[40:43], a[216:219], v[96:99]
    v_mfma_f32_16x16x32_bf16 v[100:103], a[44:47], a[216:219], v[100:103]
    v_mfma_f32_16x16x32_bf16 v[104:107], a[48:51], a[216:219], v[104:107]
    v_mfma_f32_16x16x32_bf16 v[108:111], a[52:55], a[216:219], v[108:111]
    v_mfma_f32_16x16x32_bf16 v[112:115], a[56:59], a[216:219], v[112:115]
    s_nop 0
    s_nop 0
    s_nop 0
    s_nop 0
    ds_write_b128 v14, v[96:99] offset:20480
    ds_write_b128 v14, v[100:103] offset:21504
    ds_write_b128 v14, v[104:107] offset:22528
    ds_write_b128 v14, v[108:111] offset:23552
    ds_write_b128 v14, v[112:115] offset:24576
    s_waitcnt lgkmcnt(0)
    s_barrier
    ds_read_b128 v[24:27], v13 offset:20480
    ds_read_b128 v[28:31], v10 offset:20480
    ds_read_b128 v[128:131], v13 offset:25600
    ds_read_b128 v[132:135], v10 offset:25600
    ds_read_b128 v[136:139], v13 offset:30720
    ds_read_b128 v[140:143], v10 offset:30720
    ds_read_b128 v[144:147], v13 offset:35840
    ds_read_b128 v[148:151], v10 offset:35840
    s_waitcnt lgkmcnt(6)
    v_pk_fma_f32 v[16:17], v[24:25], v[120:121], v[16:17]
    v_pk_fma_f32 v[18:19], v[26:27], v[122:123], v[18:19]
    v_pk_fma_f32 v[20:21], v[28:29], v[124:125], v[20:21]
    v_pk_fma_f32 v[22:23], v[30:31], v[126:127], v[22:23]
    s_waitcnt lgkmcnt(4)
    v_pk_fma_f32 v[16:17], v[128:129], v[120:121], v[16:17]
    v_pk_fma_f32 v[18:19], v[130:131], v[122:123], v[18:19]
    v_pk_fma_f32 v[20:21], v[132:133], v[124:125], v[20:21]
    v_pk_fma_f32 v[22:23], v[134:135], v[126:127], v[22:23]
    s_waitcnt lgkmcnt(2)
    v_pk_fma_f32 v[16:17], v[136:137], v[120:121], v[16:17]
    v_pk_fma_f32 v[18:19], v[138:139], v[122:123], v[18:19]
    v_pk_fma_f32 v[20:21], v[140:141], v[124:125], v[20:21]
    v_pk_fma_f32 v[22:23], v[142:143], v[126:127], v[22:23]
    s_waitcnt lgkmcnt(0)
    v_pk_fma_f32 v[16:17], v[144:145], v[120:121], v[16:17]
    v_pk_fma_f32 v[18:19], v[146:147], v[122:123], v[18:19]
    v_pk_fma_f32 v[20:21], v[148:149], v[124:125], v[20:21]
    v_pk_fma_f32 v[22:23], v[150:151], v[126:127], v[22:23]
    v_cvt_pk_bf16_f32 v32, v16, v17
    v_cvt_pk_bf16_f32 v33, v18, v19
    v_cvt_pk_bf16_f32 v34, v20, v21
    v_cvt_pk_bf16_f32 v35, v22, v23
    buffer_store_dwordx4 v[32:35], v7, s[24:27], s61 offen
L_back_end_1:
    s_endpgm
L_back_poll_3:
    s_mov_b32 s3, 0
L_back_poll_3b:
    s_add_u32 s3, s3, 1
    buffer_load_dword v25, v253, s[20:23], s52 offen sc1
    s_waitcnt vmcnt(0)
    v_cmp_eq_u32 vcc, 0, v25
    s_cbranch_vccz L_back_ok_4
    s_cmp_lt_u32 s3, 0x40000
    s_cbranch_scc1 L_back_poll_3b
    s_branch L_back_ok_4
L_back_poll_9:
    s_mov_b32 s49, 0
L_back_poll_9b:
    s_add_u32 s49, s49, 1
    buffer_load_dword v0, v255, s[20:23], s60 offen sc1
    s_waitcnt vmcnt(0)
    v_cmp_gt_u32 vcc, 1, v0
    s_cbranch_vccz L_back_ok_10
    s_cmp_lt_u32 s49, 0x40000
    s_cbranch_scc1 L_back_poll_9b
    s_branch L_back_ok_10
L_back_poll_11:
    s_mov_b32 s49, 0
L_back_poll_11b:
    s_add_u32 s49, s49, 1
    s_and_b32 s36, s49, 3
    s_cselect_b32 s36, 0, 9
    s_cselect_b32 s3, 128, 0
    s_add_u32 s3, s3, s50
    v_lshlrev_b32 v0, s36, v15
    buffer_load_dword v0, v0, s[20:23], s3 offen sc1
    s_waitcnt vmcnt(0)
    v_cmp_gt_u32 vcc, 2, v0
    s_cbranch_vccz L_back_ok_12
    s_cmp_lt_u32 s49, 0x40000
    s_cbranch_scc1 L_back_poll_11b
    s_branch L_back_ok_12
L_back_poll_13:
    s_mov_b32 s49, 0
L_back_poll_13b:
    s_add_u32 s49, s49, 1
    s_and_b32 s36, s49, 3
    s_cselect_b32 s36, 0, 9
    s_cselect_b32 s3, 128, 0
    s_add_u32 s3, s3, s50
    v_lshlrev_b32 v0, s36, v15
    buffer_load_dword v0, v0, s[20:23], s3 offen sc1
    s_waitcnt vmcnt(0)
    v_cmp_gt_u32 vcc, 3, v0
    s_cbranch_vccz L_back_ok_14
    s_cmp_lt_u32 s49, 0x40000
    s_cbranch_scc1 L_back_poll_13b
    s_branch L_back_ok_14
L_back_poll_15:
    s_mov_b32 s49, 0
L_back_poll_15b:
    s_add_u32 s49, s49, 1
    s_and_b32 s36, s49, 3
    s_cselect_b32 s36, 0, 9
    s_cselect_b32 s3, 128, 0
    s_add_u32 s3, s3, s50
    v_lshlrev_b32 v0, s36, v15
    buffer_load_dword v0, v0, s[20:23], s3 offen sc1
    s_waitcnt vmcnt(0)
    v_cmp_gt_u32 vcc, 4, v0
    s_cbranch_vccz L_back_ok_16
    s_cmp_lt_u32 s49, 0x40000
    s_cbranch_scc1 L_back_poll_15b
    s_branch L_back_ok_16
L_back_poll_17:
    s_mov_b32 s49, 0
L_back_poll_17b:
    s_add_u32 s49, s49, 1
    s_and_b32 s36, s49, 3
    s_cselect_b32 s36, 0, 9
    s_cselect_b32 s3, 128, 0
    s_add_u32 s3, s3, s50
    v_lshlrev_b32 v0, s36, v15
    buffer_load_dword v0, v0, s[20:23], s3 offen sc1
    s_waitcnt vmcnt(0)
    v_cmp_gt_u32 vcc, 5, v0
    s_cbranch_vccz L_back_ok_18
    s_cmp_lt_u32 s49, 0x40000
    s_cbranch_scc1 L_back_poll_17b
    s_branch L_back_ok_18
L_back_poll_19:
    s_mov_b32 s49, 0
L_back_poll_19b:
    s_add_u32 s49, s49, 1
    s_and_b32 s36, s49, 3
    s_cselect_b32 s36, 0, 9
    s_cselect_b32 s3, 128, 0
    s_add_u32 s3, s3, s50
    v_lshlrev_b32 v0, s36, v15
    buffer_load_dword v0, v0, s[20:23], s3 offen sc1
    s_waitcnt vmcnt(0)
    v_cmp_gt_u32 vcc, 6, v0
    s_cbranch_vccz L_back_ok_20
    s_cmp_lt_u32 s49, 0x40000
    s_cbranch_scc1 L_back_poll_19b
    s_branch L_back_ok_20
L_back_fb0_5:
    s_lshr_b32 s36, s29, 1
    s_mul_i32 s36, s36, 2560
    s_add_u32 s36, s36, s56
    buffer_load_dwordx4 v[156:159], v1, s[20:23], s36 offen offset:0
    buffer_load_dwordx2 v[160:161], v27, s[20:23], s36 offen offset:1024
    v_mov_b32 v22, 0xff800000
    s_add_u32 s16, s6, s57
    s_add_u32 s36, s16, 172032
    s_waitcnt vmcnt(0)
    v_cndmask_b32 v160, 0, v160, s[10:11]
    v_cndmask_b32 v161, 0, v161, s[10:11]
L_back_p1_21:
    buffer_load_dwordx4 v[180:183], v1, s[16:19], 0 offen
    buffer_load_dwordx2 v[192:193], v244, s[16:19], 0 offen
    s_waitcnt vmcnt(0)
    v_mfma_f32_32x32x16_bf16 v[76:91], v[180:183], v[156:159], 0
    v_mfma_f32_32x32x8_bf16 v[76:91], v[192:193], v[160:161], v[76:91]
    s_nop 11
    v_max3_f32 v22, v22, v76, v77
    v_max3_f32 v22, v22, v78, v79
    v_max3_f32 v22, v22, v80, v81
    v_max3_f32 v22, v22, v82, v83
    v_max3_f32 v22, v22, v84, v85
    v_max3_f32 v22, v22, v86, v87
    v_max3_f32 v22, v22, v88, v89
    v_max3_f32 v22, v22, v90, v91
    s_add_u32 s16, s16, 2688
    s_cmp_lt_u32 s16, s36
    s_cbranch_scc1 L_back_p1_21
    v_mov_b32 v23, v22
    s_nop 1
    v_permlane32_swap_b32 v23, v22
    v_max_f32 v22, v23, v22
    v_sub_f32 v23, 0, v22
    v_and_b32 v24, s96, v23
    v_sub_f32 v23, v23, v24
    v_and_b32 v25, s96, v23
    v_sub_f32 v23, v23, v25
    v_lshrrev_b32 v24, 16, v24
    v_or_b32 v24, v24, v25
    v_lshrrev_b32 v23, 16, v23
    v_cndmask_b32 v160, v24, v160, s[10:11]
    v_cndmask_b32 v161, v23, v161, s[10:11]
    v_mov_b32 v28, 0
    v_mov_b32 v29, 0
    v_mov_b32 v30, 0
    v_mov_b32 v31, 0
    v_mov_b32 v32, 0
    v_mov_b32 v33, 0
    v_mov_b32 v34, 0
    v_mov_b32 v35, 0
    v_mov_b32 v36, 0
    v_mov_b32 v37, 0
    v_mov_b32 v38, 0
    v_mov_b32 v39, 0
    v_mov_b32 v40, 0
    v_mov_b32 v41, 0
    v_mov_b32 v42, 0
    v_mov_b32 v43, 0
    s_add_u32 s16, s6, s57
L_back_p2_22:
    buffer_load_dwordx4 v[180:183], v1, s[16:19], 0 offen
    buffer_load_dwordx2 v[192:193], v244, s[16:19], 0 offen
    buffer_load_dwordx4 v[184:187], v245, s[16:19], 0 offen
    buffer_load_dwordx4 v[188:191], v246, s[16:19], 0 offen
    s_waitcnt vmcnt(0)
    v_mfma_f32_32x32x16_bf16 v[76:91], v[180:183], v[156:159], 0
    v_mfma_f32_32x32x8_bf16 v[76:91], v[192:193], v[160:161], v[76:91]
    s_nop 11
    v_exp_f32 v76, v76
    v_exp_f32 v77, v77
    v_exp_f32 v78, v78
    v_exp_f32 v79, v79
    v_exp_f32 v80, v80
    v_exp_f32 v81, v81
    v_exp_f32 v82, v82
    v_exp_f32 v83, v83
    v_exp_f32 v84, v84
    v_exp_f32 v85, v85
    v_exp_f32 v86, v86
    v_exp_f32 v87, v87
    v_exp_f32 v88, v88
    v_exp_f32 v89, v89
    v_exp_f32 v90, v90
    v_exp_f32 v91, v91
    s_nop 1
    v_smfmac_f32_32x32x32_bf16 v[28:43], v[184:187], v[76:83], v242
    v_smfmac_f32_32x32x32_bf16 v[28:43], v[188:191], v[84:91], v242
    s_add_u32 s16, s16, 2688
    s_cmp_lt_u32 s16, s36
    s_cbranch_scc1 L_back_p2_22
    s_nop 11
    v_mov_b32 v18, v36
    v_mov_b32 v19, v36
    s_nop 1
    v_permlane32_swap_b32 v18, v19
    v_rcp_f32 v18, v19
    v_rcp_f32 v20, v21
    v_pk_mul_f32 v[92:93], v[28:29], v[18:19] op_sel_hi:[1,0]
    v_pk_mul_f32 v[94:95], v[30:31], v[18:19] op_sel_hi:[1,0]
    v_pk_mul_f32 v[96:97], v[32:33], v[18:19] op_sel_hi:[1,0]
    v_pk_mul_f32 v[98:99], v[34:35], v[18:19] op_sel_hi:[1,0]
    v_pk_mul_f32 v[100:101], v[36:37], v[18:19] op_sel_hi:[1,0]
    v_pk_mul_f32 v[102:103], v[38:39], v[18:19] op_sel_hi:[1,0]
    v_cvt_pk_bf16_f32 v64, v100, v101
    v_cvt_pk_bf16_f32 v65, v102, v103
    v_cvt_pk_bf16_f32 v60, v92, v93
    v_cvt_pk_bf16_f32 v61, v94, v95
    v_cvt_pk_bf16_f32 v62, v96, v97
    v_cvt_pk_bf16_f32 v63, v98, v99
    buffer_store_dwordx4 v[60:63], v1, s[20:23], s63 offen sc1
    v_pk_mul_f32 v[104:105], v[44:45], v[20:21] op_sel_hi:[1,0]
    v_pk_mul_f32 v[106:107], v[46:47], v[20:21] op_sel_hi:[1,0]
    v_pk_mul_f32 v[108:109], v[48:49], v[20:21] op_sel_hi:[1,0]
    v_pk_mul_f32 v[110:111], v[50:51], v[20:21] op_sel_hi:[1,0]
    v_pk_mul_f32 v[112:113], v[52:53], v[20:21] op_sel_hi:[1,0]
    v_pk_mul_f32 v[114:115], v[54:55], v[20:21] op_sel_hi:[1,0]
    v_cvt_pk_bf16_f32 v70, v112, v113
    v_cvt_pk_bf16_f32 v71, v114, v115
    v_cvt_pk_bf16_f32 v66, v104, v105
    v_cvt_pk_bf16_f32 v67, v106, v107
    v_cvt_pk_bf16_f32 v68, v108, v109
    v_cvt_pk_bf16_f32 v69, v110, v111
    buffer_store_dwordx4 v[66:69], v1, s[20:23], s28 offen sc1
    v_permlane32_swap_b32 v64, v70
    v_permlane32_swap_b32 v65, v71
    buffer_store_dwordx2 v[64:65], v26, s[20:23], s49 offen sc1
    s_waitcnt vmcnt(0)
    s_branch L_back_rt0_7
L_back_fb1_6:
    s_lshr_b32 s36, s29, 1
    s_mul_i32 s36, s36, 2560
    s_add_u32 s36, s36, s56
    buffer_load_dwordx4 v[156:159], v1, s[20:23], s36 offen offset:1280
    buffer_load_dwordx2 v[160:161], v27, s[20:23], s36 offen offset:2304
    v_mov_b32 v22, 0xff800000
    s_add_u32 s16, s6, s57
    s_add_u32 s36, s16, 172032
    s_waitcnt vmcnt(0)
    v_cndmask_b32 v160, 0, v160, s[10:11]
    v_cndmask_b32 v161, 0, v161, s[10:11]
L_back_p1_23:
    buffer_load_dwordx4 v[180:183], v1, s[16:19], 0 offen
    buffer_load_dwordx2 v[192:193], v244, s[16:19], 0 offen
    s_waitcnt vmcnt(0)
    v_mfma_f32_32x32x16_bf16 v[76:91], v[180:183], v[156:159], 0
    v_mfma_f32_32x32x8_bf16 v[76:91], v[192:193], v[160:161], v[76:91]
    s_nop 11
    v_max3_f32 v22, v22, v76, v77
    v_max3_f32 v22, v22, v78, v79
    v_max3_f32 v22, v22, v80, v81
    v_max3_f32 v22, v22, v82, v83
    v_max3_f32 v22, v22, v84, v85
    v_max3_f32 v22, v22, v86, v87
    v_max3_f32 v22, v22, v88, v89
    v_max3_f32 v22, v22, v90, v91
    s_add_u32 s16, s16, 2688
    s_cmp_lt_u32 s16, s36
    s_cbranch_scc1 L_back_p1_23
    v_mov_b32 v23, v22
    s_nop 1
    v_permlane32_swap_b32 v23, v22
    v_max_f32 v22, v23, v22
    v_sub_f32 v23, 0, v22
    v_and_b32 v24, s96, v23
    v_sub_f32 v23, v23, v24
    v_and_b32 v25, s96, v23
    v_sub_f32 v23, v23, v25
    v_lshrrev_b32 v24, 16, v24
    v_or_b32 v24, v24, v25
    v_lshrrev_b32 v23, 16, v23
    v_cndmask_b32 v160, v24, v160, s[10:11]
    v_cndmask_b32 v161, v23, v161, s[10:11]
    v_mov_b32 v44, 0
    v_mov_b32 v45, 0
    v_mov_b32 v46, 0
    v_mov_b32 v47, 0
    v_mov_b32 v48, 0
    v_mov_b32 v49, 0
    v_mov_b32 v50, 0
    v_mov_b32 v51, 0
    v_mov_b32 v52, 0
    v_mov_b32 v53, 0
    v_mov_b32 v54, 0
    v_mov_b32 v55, 0
    v_mov_b32 v56, 0
    v_mov_b32 v57, 0
    v_mov_b32 v58, 0
    v_mov_b32 v59, 0
    s_add_u32 s16, s6, s57
L_back_p2_24:
    buffer_load_dwordx4 v[180:183], v1, s[16:19], 0 offen
    buffer_load_dwordx2 v[192:193], v244, s[16:19], 0 offen
    buffer_load_dwordx4 v[184:187], v245, s[16:19], 0 offen
    buffer_load_dwordx4 v[188:191], v246, s[16:19], 0 offen
    s_waitcnt vmcnt(0)
    v_mfma_f32_32x32x16_bf16 v[76:91], v[180:183], v[156:159], 0
    v_mfma_f32_32x32x8_bf16 v[76:91], v[192:193], v[160:161], v[76:91]
    s_nop 11
    v_exp_f32 v76, v76
    v_exp_f32 v77, v77
    v_exp_f32 v78, v78
    v_exp_f32 v79, v79
    v_exp_f32 v80, v80
    v_exp_f32 v81, v81
    v_exp_f32 v82, v82
    v_exp_f32 v83, v83
    v_exp_f32 v84, v84
    v_exp_f32 v85, v85
    v_exp_f32 v86, v86
    v_exp_f32 v87, v87
    v_exp_f32 v88, v88
    v_exp_f32 v89, v89
    v_exp_f32 v90, v90
    v_exp_f32 v91, v91
    s_nop 1
    v_smfmac_f32_32x32x32_bf16 v[44:59], v[184:187], v[76:83], v242
    v_smfmac_f32_32x32x32_bf16 v[44:59], v[188:191], v[84:91], v242
    s_add_u32 s16, s16, 2688
    s_cmp_lt_u32 s16, s36
    s_cbranch_scc1 L_back_p2_24
    s_nop 11
    v_mov_b32 v20, v52
    v_mov_b32 v21, v52
    s_nop 1
    v_permlane32_swap_b32 v20, v21
    v_rcp_f32 v18, v19
    v_rcp_f32 v20, v21
    v_pk_mul_f32 v[92:93], v[28:29], v[18:19] op_sel_hi:[1,0]
    v_pk_mul_f32 v[94:95], v[30:31], v[18:19] op_sel_hi:[1,0]
    v_pk_mul_f32 v[96:97], v[32:33], v[18:19] op_sel_hi:[1,0]
    v_pk_mul_f32 v[98:99], v[34:35], v[18:19] op_sel_hi:[1,0]
    v_pk_mul_f32 v[100:101], v[36:37], v[18:19] op_sel_hi:[1,0]
    v_pk_mul_f32 v[102:103], v[38:39], v[18:19] op_sel_hi:[1,0]
    v_cvt_pk_bf16_f32 v64, v100, v101
    v_cvt_pk_bf16_f32 v65, v102, v103
    v_cvt_pk_bf16_f32 v60, v92, v93
    v_cvt_pk_bf16_f32 v61, v94, v95
    v_cvt_pk_bf16_f32 v62, v96, v97
    v_cvt_pk_bf16_f32 v63, v98, v99
    buffer_store_dwordx4 v[60:63], v1, s[20:23], s63 offen sc1
    v_pk_mul_f32 v[104:105], v[44:45], v[20:21] op_sel_hi:[1,0]
    v_pk_mul_f32 v[106:107], v[46:47], v[20:21] op_sel_hi:[1,0]
    v_pk_mul_f32 v[108:109], v[48:49], v[20:21] op_sel_hi:[1,0]
    v_pk_mul_f32 v[110:111], v[50:51], v[20:21] op_sel_hi:[1,0]
    v_pk_mul_f32 v[112:113], v[52:53], v[20:21] op_sel_hi:[1,0]
    v_pk_mul_f32 v[114:115], v[54:55], v[20:21] op_sel_hi:[1,0]
    v_cvt_pk_bf16_f32 v70, v112, v113
    v_cvt_pk_bf16_f32 v71, v114, v115
    v_cvt_pk_bf16_f32 v66, v104, v105
    v_cvt_pk_bf16_f32 v67, v106, v107
    v_cvt_pk_bf16_f32 v68, v108, v109
    v_cvt_pk_bf16_f32 v69, v110, v111
    buffer_store_dwordx4 v[66:69], v1, s[20:23], s28 offen sc1
    v_permlane32_swap_b32 v64, v70
    v_permlane32_swap_b32 v65, v71
    buffer_store_dwordx2 v[64:65], v26, s[20:23], s49 offen sc1
    s_waitcnt vmcnt(0)
    s_branch L_back_rt1_8
L_code_end:
.p2align 7
.type L_lanetab,@object
L_lanetab:
.long 0, 7744, 15488, 0, 0, 0, 0, 0, 0, 0, 0, 0
.long 16, 7760, 15504, 16, 128, 4, 0, 256, 0, 0, 0, 0
.long 32, 7776, 16640, 32, 256, 8, 0, 512, 0, 0, 0, 0
.long 48, 7792, 16656, 48, 384, 12, 0, 768, 0, 0, 0, 0
.long 64, 7808, 16672, 64, 512, 16, 0, 1024, 0, 0, 0, 0
.long 80, 7824, 16688, 80, 640, 20, 0, 1280, 0, 0, 0, 0
.long 96, 8960, 16704, 96, 768, 24, 0, 1536, 0, 0, 0, 0
.long 112, 8976, 16720, 112, 896, 28, 0, 1792, 0, 0, 0, 0
.long 128, 8992, 16736, 128, 1024, 32, 0, 2048, 0, 0, 0, 0
.long 144, 9008, 16752, 144, 1152, 36, 0, 2304, 0, 0, 0, 0
.long 1280, 9024, 16768, 160, 1280, 40, 0, 2560, 0, 0, 0, 0
.long 1296, 9040, 16784, 176, 1408, 44, 0, 2816, 0, 0, 0, 0
.long 1312, 9056, 17920, 192, 1536, 48, 0, 3072, 0, 0, 0, 0
.long 1328, 9072, 17936, 208, 1664, 52, 0, 3328, 0, 0, 0, 0
.long 1344, 9088, 17952, 224, 1792, 56, 0, 3584, 0, 0, 0, 0
.long 1360, 9104, 17968, 240, 1920, 60, 0, 3840, 0, 0, 0, 0
.long 1376, 10240, 17984, 256, 2048, 64, 0, 4096, 0, 0, 0, 0
.long 1392, 10256, 18000, 272, 2176, 0, 1, 4352, 0, 0, 0, 0
.long 1408, 10272, 18016, 288, 2304, 4, 1, 4608, 0, 0, 0, 0
.long 1424, 10288, 18032, 304, 2432, 8, 1, 4864, 0, 0, 0, 0
.long 2560, 10304, 18048, 5120, 2560, 12, 1, 5120, 0, 0, 0, 0
.long 2576, 10320, 18064, 5136, 2688, 12, 1, 5376, 0, 0, 0, 0
.long 2592, 10336, 19200, 5152, 2816, 12, 1, 5632, 0, 0, 0, 0
.long 2608, 10352, 19216, 5168, 2944, 12, 1, 5888, 0, 0, 0, 0
.long 2624, 10368, 19232, 5184, 3072, 12, 1, 6144, 0, 0, 0, 0
.long 2640, 10384, 19248, 5200, 3200, 12, 1, 6400, 0, 0, 0, 0
.long 2656, 11520, 19264, 5216, 3328, 12, 1, 6656, 0, 0, 0, 0
.long 2672, 11536, 19280, 5232, 3456, 12, 1, 6912, 0, 0, 0, 0
.long 2688, 11552, 19296, 5248, 3584, 12, 1, 7168, 0, 0, 0, 0
.long 2704, 11568, 19312, 5264, 3712, 12, 1, 7424, 0, 0, 0, 0
.long 3840, 11584, 19328, 5280, 3840, 12, 1, 7680, 0, 0, 0, 0
.long 3856, 11600, 19344, 5296, 3968, 12, 1, 7936, 0, 0, 0, 0
.long 3872, 11616, 19344, 5312, 4096, 12, 1, 0, 0, 0, 0, 0
.long 3888, 11632, 19344, 5328, 4224, 12, 1, 256, 0, 0, 0, 0
.long 3904, 11648, 19344, 5344, 4352, 12, 1, 512, 0, 0, 0, 0
.long 3920, 11664, 19344, 5360, 4480, 12, 1, 768, 0, 0, 0, 0
.long 3936, 12800, 19344, 5376, 4608, 12, 1, 1024, 0, 0, 0, 0
.long 3952, 12816, 19344, 5392, 4736, 12, 1, 1280, 0, 0, 0, 0
.long 3968, 12832, 19344, 5408, 4864, 12, 1, 1536, 0, 0, 0, 0
.long 3984, 12848, 19344, 5424, 4992, 12, 1, 1792, 0, 0, 0, 0
.long 5120, 12864, 19344, 7680, 5120, 12, 1, 2048, 0, 0, 0, 0
.long 5136, 12880, 19344, 7696, 5248, 12, 1, 2304, 0, 0, 0, 0
.long 5152, 12896, 19344, 7712, 5376, 12, 1, 2560, 0, 0, 0, 0
.long 5168, 12912, 19344, 7728, 5504, 12, 1, 2816, 0, 0, 0, 0
.long 5184, 12928, 19344, 7744, 5632, 12, 1, 3072, 0, 0, 0, 0
.long 5200, 12944, 19344, 7760, 5760, 12, 1, 3328, 0, 0, 0, 0
.long 5216, 14080, 19344, 7776, 5888, 12, 1, 3584, 0, 0, 0, 0
.long 5232, 14096, 19344, 7792, 6016, 12, 1, 3840, 0, 0, 0, 0
.long 5248, 14112, 19344, 7808, 6016, 12, 1, 4096, 0, 0, 0, 0
.long 5264, 14128, 19344, 7824, 6016, 12, 1, 4352, 0, 0, 0, 0
.long 6400, 14144, 19344, 7840, 6016, 12, 1, 4608, 0, 0, 0, 0
.long 6416, 14160, 19344, 7856, 6016, 12, 1, 4864, 0, 0, 0, 0
.long 6432, 14176, 19344, 7872, 6016, 12, 1, 5120, 0, 0, 0, 0
.long 6448, 14192, 19344, 7888, 6016, 12, 1, 5376, 0, 0, 0, 0
.long 6464, 14208, 19344, 7904, 6016, 12, 1, 5632, 0, 0, 0, 0
.long 6480, 14224, 19344, 7920, 6016, 12, 1, 5888, 0, 0, 0, 0
.long 6496, 15360, 19344, 7936, 6016, 12, 1, 6144, 0, 0, 0, 0
.long 6512, 15376, 19344, 7952, 6016, 12, 1, 6400, 0, 0, 0, 0
.long 6528, 15392, 19344, 7968, 6016, 12, 1, 6656, 0, 0, 0, 0
.long 6544, 15408, 19344, 7984, 6016, 12, 1, 6912, 0, 0, 0, 0
.long 7680, 15424, 19344, 8000, 6016, 12, 1, 7168, 0, 0, 0, 0
.long 7696, 15440, 19344, 8016, 6016, 12, 1, 7424, 0, 0, 0, 0
.long 7712, 15456, 19344, 8032, 6016, 12, 1, 7680, 0, 0, 0, 0
.long 7728, 15472, 19344, 8048, 6016, 12, 1, 7936, 0, 0, 0, 0
.long 0, 6720, 13440, 24352, 31072, 1073741824, 0, 8, 64, 72, 128, 0
.long 16, 6736, 13456, 24368, 31088, 1073741824, 16, 24, 80, 88, 136, 0
.long 32, 6752, 14592, 24384, 31104, 1073741824, 32, 40, 96, 104, 144, 0
.long 48, 6768, 14608, 24400, 31120, 1073741824, 48, 56, 112, 120, 152, 0
.long 64, 6784, 14624, 24416, 32256, 1073741824, 160, 168, 224, 232, 288, 160
.long 80, 6800, 14640, 24432, 32272, 1073741824, 176, 184, 240, 248, 296, 160
.long 96, 7936, 14656, 24448, 32288, 1073741824, 192, 200, 256, 264, 304, 160
.long 112, 7952, 14672, 24464, 32304, 1073741824, 208, 216, 272, 280, 312, 160
.long 128, 7968, 14688, 25600, 32320, 1073741824, 320, 328, 384, 392, 448, 320
.long 144, 7984, 14704, 25616, 32336, 1073741824, 336, 344, 400, 408, 456, 320
.long 1280, 8000, 14720, 25632, 32352, 1073741824, 352, 360, 416, 424, 464, 320
.long 1296, 8016, 14736, 25648, 32368, 1073741824, 368, 376, 432, 440, 472, 320
.long 1312, 8032, 15872, 25664, 32384, 1073741824, 480, 488, 544, 552, 608, 480
.long 1328, 8048, 15888, 25680, 32400, 1073741824, 496, 504, 560, 568, 616, 480
.long 1344, 8064, 15904, 25696, 33536, 1073741824, 512, 520, 576, 584, 624, 480
.long 1360, 8080, 15920, 25712, 33552, 1073741824, 528, 536, 592, 600, 632, 480
.long 1376, 9216, 15936, 25728, 33568, 1073741824, 1280, 1288, 1344, 1352, 1408, 1280
.long 1392, 9232, 15952, 25744, 33584, 1073741824, 1296, 1304, 1360, 1368, 1416, 1280
.long 1408, 9248, 15968, 26880, 33600, 1073741824, 1312, 1320, 1376, 1384, 1424, 1280
.long 1424, 9264, 15984, 26896, 33616, 1073741824, 1328, 1336, 1392, 1400, 1432, 1280
.long 2560, 9280, 16000, 26912, 33632, 1073741824, 1440, 1448, 1504, 1512, 1568, 1440
.long 2576, 9296, 16016, 26928, 33648, 1073741824, 1456, 1464, 1520, 1528, 1576, 1440
.long 2592, 9312, 17152, 26944, 33664, 1073741824, 1472, 1480, 1536, 1544, 1584, 1440
.long 2608, 9328, 17168, 26960, 33680, 1073741824, 1488, 1496, 1552, 1560, 1592, 1440
.long 2624, 9344, 17184, 26976, 34816, 1073741824, 1600, 1608, 1664, 1672, 1728, 1600
.long 2640, 9360, 17200, 26992, 34832, 1073741824, 1616, 1624, 1680, 1688, 1736, 1600
.long 2656, 10496, 17216, 27008, 34848, 1073741824, 1632, 1640, 1696, 1704, 1744, 1600
.long 2672, 10512, 17232, 27024, 34864, 1073741824, 1648, 1656, 1712, 1720, 1752, 1600
.long 2688, 10528, 17248, 28160, 34880, 1073741824, 1760, 1768, 1824, 1832, 1888, 1760
.long 2704, 10544, 17264, 28176, 34896, 1073741824, 1776, 1784, 1840, 1848, 1896, 1760
.long 3840, 10560, 17280, 28192, 34912, 1073741824, 1792, 1800, 1856, 1864, 1904, 1760
.long 3856, 10576, 17296, 28208, 34928, 1073741824, 1808, 1816, 1872, 1880, 1912, 1760
.long 3872, 10592, 18432, 28224, 34944, 1073741824, 2560, 2568, 2624, 2632, 2688, 2560
.long 3888, 10608, 18448, 28240, 34960, 1073741824, 2576, 2584, 2640, 2648, 2696, 2560
.long 3904, 10624, 18464, 28256, 36096, 1073741824, 2592, 2600, 2656, 2664, 2704, 2560
.long 3920, 10640, 18480, 28272, 36112, 1073741824, 2608, 2616, 2672, 2680, 2712, 2560
.long 3936, 11776, 18496, 28288, 36128, 1073741824, 2720, 2728, 2784, 2792, 2848, 2720
.long 3952, 11792, 18512, 28304, 36144, 1073741824, 2736, 2744, 2800, 2808, 2856, 2720
.long 3968, 11808, 18528, 29440, 36160, 1073741824, 2752, 2760, 2816, 2824, 2864, 2720
.long 3984, 11824, 18544, 29456, 36176, 1073741824, 2768, 2776, 2832, 2840, 2872, 2720
.long 5120, 11840, 18560, 29472, 36192, 1073741824, 2880, 2888, 2944, 2952, 3008, 2880
.long 5136, 11856, 18576, 29488, 36208, 1073741824, 2896, 2904, 2960, 2968, 3016, 2880
.long 5152, 11872, 19712, 29504, 36224, 1073741824, 2912, 2920, 2976, 2984, 3024, 2880
.long 5168, 11888, 19728, 29520, 36240, 1073741824, 2928, 2936, 2992, 3000, 3032, 2880
.long 5184, 11904, 19744, 29536, 37376, 1073741824, 3040, 3048, 3104, 3112, 3168, 3040
.long 5200, 11920, 19760, 29552, 37392, 1073741824, 3056, 3064, 3120, 3128, 3176, 3040
.long 5216, 13056, 19776, 29568, 37408, 1073741824, 3072, 3080, 3136, 3144, 3184, 3040
.long 5232, 13072, 19792, 29584, 37424, 1073741824, 3088, 3096, 3152, 3160, 3192, 3040
.long 5248, 13088, 19808, 30720, 37440, 1073741824, 3840, 3848, 3904, 3912, 3968, 3840
.long 5264, 13104, 19824, 30736, 37456, 1073741824, 3856, 3864, 3920, 3928, 3976, 3840
.long 6400, 13120, 19840, 30752, 37472, 1073741824, 3872, 3880, 3936, 3944, 3984, 3840
.long 6416, 13136, 19856, 30768, 37488, 1073741824, 3888, 3896, 3952, 3960, 3992, 3840
.long 6432, 13152, 20992, 30784, 37504, 1073741824, 4000, 4008, 4064, 4072, 4128, 4000
.long 6448, 13168, 21008, 30800, 37520, 1073741824, 4016, 4024, 4080, 4088, 4136, 4000
.long 6464, 13184, 21024, 30816, 38656, 1073741824, 4032, 4040, 4096, 4104, 4144, 4000
.long 6480, 13200, 21040, 30832, 38672, 1073741824, 4048, 4056, 4112, 4120, 4152, 4000
.long 6496, 14336, 21056, 30848, 38688, 1073741824, 4160, 4168, 4224, 4232, 4288, 4160
.long 6512, 14352, 21072, 30864, 38704, 1073741824, 4176, 4184, 4240, 4248, 4296, 4160
.long 6528, 14368, 21088, 32000, 38720, 1073741824, 4192, 4200, 4256, 4264, 4304, 4160
.long 6544, 14384, 21104, 32016, 38736, 1073741824, 4208, 4216, 4272, 4280, 4312, 4160
.long 7680, 14400, 21120, 32032, 38752, 1073741824, 4320, 4328, 4384, 4392, 4448, 4320
.long 7696, 14416, 21136, 32048, 38768, 1073741824, 4336, 4344, 4400, 4408, 4456, 4320
.long 7712, 14432, 22272, 32064, 38784, 1073741824, 4352, 4360, 4416, 4424, 4464, 4320
.long 7728, 14448, 22288, 32080, 38800, 1073741824, 4368, 4376, 4432, 4440, 4472, 4320
.long 0, 11840, 13440, 29472, 31072, 1073741824, 0, 8, 64, 72, 128, 0
.long 16, 11856, 13456, 29488, 31088, 1073741824, 16, 24, 80, 88, 136, 0
.long 32, 11872, 14592, 29504, 31104, 1073741824, 32, 40, 96, 104, 144, 0
.long 48, 11888, 14608, 29520, 31120, 1073741824, 48, 56, 112, 120, 152, 0
.long 64, 11904, 14624, 29536, 32256, 1073741824, 160, 168, 224, 232, 288, 160
.long 80, 11920, 14640, 29552, 32272, 1073741824, 176, 184, 240, 248, 296, 160
.long 96, 13056, 14656, 29568, 32288, 1073741824, 192, 200, 256, 264, 304, 160
.long 112, 13072, 14672, 29584, 32304, 1073741824, 208, 216, 272, 280, 312, 160
.long 128, 13088, 14688, 35840, 32320, 1073741824, 320, 328, 384, 392, 448, 320
.long 144, 13104, 14704, 35856, 32336, 1073741824, 336, 344, 400, 408, 456, 320
.long 1280, 13120, 14720, 35872, 32352, 1073741824, 352, 360, 416, 424, 464, 320
.long 1296, 13136, 14736, 35888, 32368, 1073741824, 368, 376, 432, 440, 472, 320
.long 1312, 13152, 15872, 35904, 32384, 1073741824, 480, 488, 544, 552, 608, 480
.long 1328, 13168, 15888, 35920, 32400, 1073741824, 496, 504, 560, 568, 616, 480
.long 1344, 13184, 15904, 35936, 33536, 1073741824, 512, 520, 576, 584, 624, 480
.long 1360, 13200, 15920, 35952, 33552, 1073741824, 528, 536, 592, 600, 632, 480
.long 1376, 4096, 15936, 35968, 33568, 1073741824, 1280, 1288, 1344, 1352, 1408, 1280
.long 1392, 4112, 15952, 35984, 33584, 1073741824, 1296, 1304, 1360, 1368, 1416, 1280
.long 1408, 4128, 15968, 37120, 33600, 1073741824, 1312, 1320, 1376, 1384, 1424, 1280
.long 1424, 4144, 15984, 37136, 33616, 1073741824, 1328, 1336, 1392, 1400, 1432, 1280
.long 2560, 4160, 16000, 37152, 33632, 1073741824, 1440, 1448, 1504, 1512, 1568, 1440
.long 2576, 4176, 16016, 37168, 33648, 1073741824, 1456, 1464, 1520, 1528, 1576, 1440
.long 2592, 4192, 17152, 37184, 33664, 1073741824, 1472, 1480, 1536, 1544, 1584, 1440
.long 2608, 4208, 17168, 37200, 33680, 1073741824, 1488, 1496, 1552, 1560, 1592, 1440
.long 2624, 4224, 17184, 37216, 39936, 1073741824, 1600, 1608, 1664, 1672, 1728, 1600
.long 2640, 4240, 17200, 37232, 39952, 1073741824, 1616, 1624, 1680, 1688, 1736, 1600
.long 2656, 5376, 17216, 37248, 39968, 1073741824, 1632, 1640, 1696, 1704, 1744, 1600
.long 2672, 5392, 17232, 37264, 39984, 1073741824, 1648, 1656, 1712, 1720, 1752, 1600
.long 2688, 5408, 17248, 38400, 40000, 1073741824, 1760, 1768, 1824, 1832, 1888, 1760
.long 2704, 5424, 17264, 38416, 40016, 1073741824, 1776, 1784, 1840, 1848, 1896, 1760
.long 3840, 5440, 17280, 38432, 40032, 1073741824, 1792, 1800, 1856, 1864, 1904, 1760
.long 3856, 5456, 17296, 38448, 40048, 1073741824, 1808, 1816, 1872, 1880, 1912, 1760
.long 3872, 5472, 23552, 38464, 40064, 1073741824, 2560, 2568, 2624, 2632, 2688, 2560
.long 3888, 5488, 23568, 38480, 40080, 1073741824, 2576, 2584, 2640, 2648, 2696, 2560
.long 3904, 5504, 23584, 38496, 41216, 1073741824, 2592, 2600, 2656, 2664, 2704, 2560
.long 3920, 5520, 23600, 38512, 41232, 1073741824, 2608, 2616, 2672, 2680, 2712, 2560
.long 3936, 6656, 23616, 38528, 41248, 1073741824, 2720, 2728, 2784, 2792, 2848, 2720
.long 3952, 6672, 23632, 38544, 41264, 1073741824, 2736, 2744, 2800, 2808, 2856, 2720
.long 3968, 6688, 23648, 39680, 41280, 1073741824, 2752, 2760, 2816, 2824, 2864, 2720
.long 3984, 6704, 23664, 39696, 41296, 1073741824, 2768, 2776, 2832, 2840, 2872, 2720
.long 10240, 6720, 23680, 39712, 41312, 1073741824, 2880, 2888, 2944, 2952, 3008, 2880
.long 10256, 6736, 23696, 39728, 41328, 1073741824, 2896, 2904, 2960, 2968, 3016, 2880
.long 10272, 6752, 24832, 39744, 41344, 1073741824, 2912, 2920, 2976, 2984, 3024, 2880
.long 10288, 6768, 24848, 39760, 41360, 1073741824, 2928, 2936, 2992, 3000, 3032, 2880
.long 10304, 6784, 24864, 39776, 42496, 1073741824, 3040, 3048, 3104, 3112, 3168, 3040
.long 10320, 6800, 24880, 39792, 42512, 1073741824, 3056, 3064, 3120, 3128, 3176, 3040
.long 10336, 7936, 24896, 39808, 42528, 1073741824, 3072, 3080, 3136, 3144, 3184, 3040
.long 10352, 7952, 24912, 39824, 42544, 1073741824, 3088, 3096, 3152, 3160, 3192, 3040
.long 10368, 7968, 24928, 30720, 42560, 1073741824, 3840, 3848, 3904, 3912, 3968, 3840
.long 10384, 7984, 24944, 30736, 42576, 1073741824, 3856, 3864, 3920, 3928, 3976, 3840
.long 11520, 8000, 24960, 30752, 42592, 1073741824, 3872, 3880, 3936, 3944, 3984, 3840
.long 11536, 8016, 24976, 30768, 42608, 1073741824, 3888, 3896, 3952, 3960, 3992, 3840
.long 11552, 8032, 26112, 30784, 42624, 1073741824, 4000, 4008, 4064, 4072, 4128, 4000
.long 11568, 8048, 26128, 30800, 42640, 1073741824, 4016, 4024, 4080, 4088, 4136, 4000
.long 11584, 8064, 26144, 30816, 43776, 1073741824, 4032, 4040, 4096, 4104, 4144, 4000
.long 11600, 8080, 26160, 30832, 43792, 1073741824, 4048, 4056, 4112, 4120, 4152, 4000
.long 11616, 14336, 26176, 30848, 43808, 1073741824, 4160, 4168, 4224, 4232, 4288, 4160
.long 11632, 14352, 26192, 30864, 43824, 1073741824, 4176, 4184, 4240, 4248, 4296, 4160
.long 11648, 14368, 26208, 32000, 43840, 1073741824, 4192, 4200, 4256, 4264, 4304, 4160
.long 11664, 14384, 26224, 32016, 43856, 1073741824, 4208, 4216, 4272, 4280, 4312, 4160
.long 12800, 14400, 26240, 32032, 43872, 1073741824, 4320, 4328, 4384, 4392, 4448, 4320
.long 12816, 14416, 26256, 32048, 43888, 1073741824, 4336, 4344, 4400, 4408, 4456, 4320
.long 12832, 14432, 27392, 32064, 43904, 1073741824, 4352, 4360, 4416, 4424, 4464, 4320
.long 12848, 14448, 27408, 32080, 43920, 1073741824, 4368, 4376, 4432, 4440, 4472, 4320
.long 0, 27200, 74880, 106272, 153952, 1073741824, 0, 8, 64, 72, 128, 0
.long 16, 27216, 74896, 106288, 153968, 1073741824, 16, 24, 80, 88, 136, 0
.long 32, 27232, 76032, 106304, 153984, 1073741824, 32, 40, 96, 104, 144, 0
.long 48, 27248, 76048, 106320, 154000, 1073741824, 48, 56, 112, 120, 152, 0
.long 64, 27264, 76064, 106336, 155136, 1073741824, 160, 168, 224, 232, 288, 160
.long 80, 27280, 76080, 106352, 155152, 1073741824, 176, 184, 240, 248, 296, 160
.long 96, 28416, 76096, 106368, 155168, 1073741824, 192, 200, 256, 264, 304, 160
.long 112, 28432, 76112, 106384, 155184, 1073741824, 208, 216, 272, 280, 312, 160
.long 128, 28448, 76128, 128000, 155200, 1073741824, 320, 328, 384, 392, 448, 320
.long 144, 28464, 76144, 128016, 155216, 1073741824, 336, 344, 400, 408, 456, 320
.long 1280, 28480, 76160, 128032, 155232, 1073741824, 352, 360, 416, 424, 464, 320
.long 1296, 28496, 76176, 128048, 155248, 1073741824, 368, 376, 432, 440, 472, 320
.long 1312, 28512, 77312, 128064, 155264, 1073741824, 480, 488, 544, 552, 608, 480
.long 1328, 28528, 77328, 128080, 155280, 1073741824, 496, 504, 560, 568, 616, 480
.long 1344, 28544, 77344, 128096, 156416, 1073741824, 512, 520, 576, 584, 624, 480
.long 1360, 28560, 77360, 128112, 156432, 1073741824, 528, 536, 592, 600, 632, 480
.long 1376, 50176, 77376, 128128, 156448, 1073741824, 1280, 1288, 1344, 1352, 1408, 1280
.long 1392, 50192, 77392, 128144, 156464, 1073741824, 1296, 1304, 1360, 1368, 1416, 1280
.long 1408, 50208, 77408, 129280, 156480, 1073741824, 1312, 1320, 1376, 1384, 1424, 1280
.long 1424, 50224, 77424, 129296, 156496, 1073741824, 1328, 1336, 1392, 1400, 1432, 1280
.long 2560, 50240, 77440, 129312, 156512, 1073741824, 1440, 1448, 1504, 1512, 1568, 1440
.long 2576, 50256, 77456, 129328, 156528, 1073741824, 1456, 1464, 1520, 1528, 1576, 1440
.long 2592, 50272, 78592, 129344, 156544, 1073741824, 1472, 1480, 1536, 1544, 1584, 1440
.long 2608, 50288, 78608, 129360, 156560, 1073741824, 1488, 1496, 1552, 1560, 1592, 1440
.long 2624, 50304, 78624, 129376, 178176, 1073741824, 1600, 1608, 1664, 1672, 1728, 1600
.long 2640, 50320, 78640, 129392, 178192, 1073741824, 1616, 1624, 1680, 1688, 1736, 1600
.long 2656, 51456, 78656, 129408, 178208, 1073741824, 1632, 1640, 1696, 1704, 1744, 1600
.long 2672, 51472, 78672, 129424, 178224, 1073741824, 1648, 1656, 1712, 1720, 1752, 1600
.long 2688, 51488, 78688, 130560, 178240, 1073741824, 1760, 1768, 1824, 1832, 1888, 1760
.long 2704, 51504, 78704, 130576, 178256, 1073741824, 1776, 1784, 1840, 1848, 1896, 1760
.long 3840, 51520, 78720, 130592, 178272, 1073741824, 1792, 1800, 1856, 1864, 1904, 1760
.long 3856, 51536, 78736, 130608, 178288, 1073741824, 1808, 1816, 1872, 1880, 1912, 1760
.long 3872, 51552, 100352, 130624, 178304, 1073741824, 2560, 2568, 2624, 2632, 2688, 2560
.long 3888, 51568, 100368, 130640, 178320, 1073741824, 2576, 2584, 2640, 2648, 2696, 2560
.long 3904, 51584, 100384, 130656, 179456, 1073741824, 2592, 2600, 2656, 2664, 2704, 2560
.long 3920, 51600, 100400, 130672, 179472, 1073741824, 2608, 2616, 2672, 2680, 2712, 2560
.long 3936, 52736, 100416, 130688, 179488, 1073741824, 2720, 2728, 2784, 2792, 2848, 2720
.long 3952, 52752, 100432, 130704, 179504, 1073741824, 2736, 2744, 2800, 2808, 2856, 2720
.long 3968, 52768, 100448, 131840, 179520, 1073741824, 2752, 2760, 2816, 2824, 2864, 2720
.long 3984, 52784, 100464, 131856, 179536, 1073741824, 2768, 2776, 2832, 2840, 2872, 2720
.long 25600, 52800, 100480, 131872, 179552, 1073741824, 2880, 2888, 2944, 2952, 3008, 2880
.long 25616, 52816, 100496, 131888, 179568, 1073741824, 2896, 2904, 2960, 2968, 3016, 2880
.long 25632, 52832, 101632, 131904, 179584, 1073741824, 2912, 2920, 2976, 2984, 3024, 2880
.long 25648, 52848, 101648, 131920, 179600, 1073741824, 2928, 2936, 2992, 3000, 3032, 2880
.long 25664, 52864, 101664, 131936, 180736, 1073741824, 3040, 3048, 3104, 3112, 3168, 3040
.long 25680, 52880, 101680, 131952, 180752, 1073741824, 3056, 3064, 3120, 3128, 3176, 3040
.long 25696, 54016, 101696, 131968, 180768, 1073741824, 3072, 3080, 3136, 3144, 3184, 3040
.long 25712, 54032, 101712, 131984, 180784, 1073741824, 3088, 3096, 3152, 3160, 3192, 3040
.long 25728, 54048, 101728, 153600, 180800, 1073741824, 3840, 3848, 3904, 3912, 3968, 3840
.long 25744, 54064, 101744, 153616, 180816, 1073741824, 3856, 3864, 3920, 3928, 3976, 3840
.long 26880, 54080, 101760, 153632, 180832, 1073741824, 3872, 3880, 3936, 3944, 3984, 3840
.long 26896, 54096, 101776, 153648, 180848, 1073741824, 3888, 3896, 3952, 3960, 3992, 3840
.long 26912, 54112, 102912, 153664, 180864, 1073741824, 4000, 4008, 4064, 4072, 4128, 4000
.long 26928, 54128, 102928, 153680, 180880, 1073741824, 4016, 4024, 4080, 4088, 4136, 4000
.long 26944, 54144, 102944, 153696, 182016, 1073741824, 4032, 4040, 4096, 4104, 4144, 4000
.long 26960, 54160, 102960, 153712, 182032, 1073741824, 4048, 4056, 4112, 4120, 4152, 4000
.long 26976, 75776, 102976, 153728, 182048, 1073741824, 4160, 4168, 4224, 4232, 4288, 4160
.long 26992, 75792, 102992, 153744, 182064, 1073741824, 4176, 4184, 4240, 4248, 4296, 4160
.long 27008, 75808, 103008, 154880, 182080, 1073741824, 4192, 4200, 4256, 4264, 4304, 4160
.long 27024, 75824, 103024, 154896, 182096, 1073741824, 4208, 4216, 4272, 4280, 4312, 4160
.long 28160, 75840, 103040, 154912, 182112, 1073741824, 4320, 4328, 4384, 4392, 4448, 4320
.long 28176, 75856, 103056, 154928, 182128, 1073741824, 4336, 4344, 4400, 4408, 4456, 4320
.long 28192, 75872, 104192, 154944, 182144, 1073741824, 4352, 4360, 4416, 4424, 4464, 4320
.long 28208, 75888, 104208, 154960, 182160, 1073741824, 4368, 4376, 4432, 4440, 4472, 4320
.long 0, 29760, 62496, 0, 29760, 62496, 0, 3072, 32, 48, 3120, 80
.long 16, 29776, 62512, 16, 29776, 62512, 8, 3080, 40, 56, 3128, 88
.long 32, 32768, 62528, 32, 32768, 62528, 16, 3088, 3104, 64, 3136, 3152
.long 48, 32784, 62544, 48, 32784, 62544, 24, 3096, 3112, 72, 3144, 3160
.long 64, 32800, 65536, 64, 32800, 65536, 96, 3168, 128, 144, 3216, 176
.long 80, 32816, 65552, 80, 32816, 65552, 104, 3176, 136, 152, 3224, 184
.long 3072, 32832, 65568, 3072, 32832, 65568, 112, 3184, 3200, 160, 3232, 3248
.long 3088, 32848, 65584, 3088, 32848, 65584, 120, 3192, 3208, 168, 3240, 3256
.long 3104, 35840, 65600, 3104, 35840, 65600, 192, 3264, 224, 240, 3312, 272
.long 3120, 35856, 65616, 3120, 35856, 65616, 200, 3272, 232, 248, 3320, 280
.long 3136, 35872, 68608, 3136, 35872, 68608, 208, 3280, 3296, 256, 3328, 3344
.long 3152, 35888, 68624, 3152, 35888, 68624, 216, 3288, 3304, 264, 3336, 3352
.long 6144, 35904, 68640, 6144, 35904, 68640, 288, 3360, 320, 336, 3408, 368
.long 6160, 35920, 68656, 6160, 35920, 68656, 296, 3368, 328, 344, 3416, 376
.long 6176, 38912, 68672, 6176, 38912, 68672, 304, 3376, 3392, 352, 3424, 3440
.long 6192, 38928, 68688, 6192, 38928, 68688, 312, 3384, 3400, 360, 3432, 3448
.long 6208, 38944, 71680, 6208, 38944, 71680, 768, 3840, 800, 816, 3888, 848
.long 6224, 38960, 71696, 6224, 38960, 71696, 776, 3848, 808, 824, 3896, 856
.long 9216, 38976, 71712, 9216, 38976, 71712, 784, 3856, 3872, 832, 3904, 3920
.long 9232, 38992, 71728, 9232, 38992, 71728, 792, 3864, 3880, 840, 3912, 3928
.long 9248, 41984, 71744, 9248, 41984, 71744, 864, 3936, 896, 912, 3984, 944
.long 9264, 42000, 71760, 9264, 42000, 71760, 872, 3944, 904, 920, 3992, 952
.long 9280, 42016, 74752, 9280, 42016, 74752, 880, 3952, 3968, 928, 4000, 4016
.long 9296, 42032, 74768, 9296, 42032, 74768, 888, 3960, 3976, 936, 4008, 4024
.long 12288, 42048, 74784, 12288, 42048, 74784, 960, 4032, 992, 1008, 4080, 1040
.long 12304, 42064, 74800, 12304, 42064, 74800, 968, 4040, 1000, 1016, 4088, 1048
.long 12320, 45056, 74816, 12320, 45056, 74816, 976, 4048, 4064, 1024, 4096, 4112
.long 12336, 45072, 74832, 12336, 45072, 74832, 984, 4056, 4072, 1032, 4104, 4120
.long 12352, 45088, 77824, 12352, 45088, 77824, 1056, 4128, 1088, 1104, 4176, 1136
.long 12368, 45104, 77840, 12368, 45104, 77840, 1064, 4136, 1096, 1112, 4184, 1144
.long 15360, 45120, 77856, 15360, 45120, 77856, 1072, 4144, 4160, 1120, 4192, 4208
.long 15376, 45136, 77872, 15376, 45136, 77872, 1080, 4152, 4168, 1128, 4200, 4216
.long 15392, 48128, 77888, 15392, 48128, 77888, 1536, 4608, 1568, 1584, 4656, 1616
.long 15408, 48144, 77904, 15408, 48144, 77904, 1544, 4616, 1576, 1592, 4664, 1624
.long 15424, 48160, 80896, 15424, 48160, 80896, 1552, 4624, 4640, 1600, 4672, 4688
.long 15440, 48176, 80912, 15440, 48176, 80912, 1560, 4632, 4648, 1608, 4680, 4696
.long 18432, 48192, 80928, 18432, 48192, 80928, 1632, 4704, 1664, 1680, 4752, 1712
.long 18448, 48208, 80944, 18448, 48208, 80944, 1640, 4712, 1672, 1688, 4760, 1720
.long 18464, 51200, 80960, 18464, 51200, 80960, 1648, 4720, 4736, 1696, 4768, 4784
.long 18480, 51216, 80976, 18480, 51216, 80976, 1656, 4728, 4744, 1704, 4776, 4792
.long 18496, 51232, 83968, 18496, 51232, 83968, 1728, 4800, 1760, 1776, 4848, 1808
.long 18512, 51248, 83984, 18512, 51248, 83984, 1736, 4808, 1768, 1784, 4856, 1816
.long 21504, 51264, 84000, 21504, 51264, 84000, 1744, 4816, 4832, 1792, 4864, 4880
.long 21520, 51280, 84016, 21520, 51280, 84016, 1752, 4824, 4840, 1800, 4872, 4888
.long 21536, 54272, 84032, 21536, 54272, 84032, 1824, 4896, 1856, 1872, 4944, 1904
.long 21552, 54288, 84048, 21552, 54288, 84048, 1832, 4904, 1864, 1880, 4952, 1912
.long 21568, 54304, 87040, 21568, 54304, 87040, 1840, 4912, 4928, 1888, 4960, 4976
.long 21584, 54320, 87056, 21584, 54320, 87056, 1848, 4920, 4936, 1896, 4968, 4984
.long 24576, 54336, 87072, 24576, 54336, 87072, 2304, 5376, 2336, 2352, 5424, 2384
.long 24592, 54352, 87088, 24592, 54352, 87088, 2312, 5384, 2344, 2360, 5432, 2392
.long 24608, 57344, 87104, 24608, 57344, 87104, 2320, 5392, 5408, 2368, 5440, 5456
.long 24624, 57360, 87120, 24624, 57360, 87120, 2328, 5400, 5416, 2376, 5448, 5464
.long 24640, 57376, 90112, 24640, 57376, 90112, 2400, 5472, 2432, 2448, 5520, 2480
.long 24656, 57392, 90128, 24656, 57392, 90128, 2408, 5480, 2440, 2456, 5528, 2488
.long 27648, 57408, 90144, 27648, 57408, 90144, 2416, 5488, 5504, 2464, 5536, 5552
.long 27664, 57424, 90160, 27664, 57424, 90160, 2424, 5496, 5512, 2472, 5544, 5560
.long 27680, 60416, 90176, 27680, 60416, 90176, 2496, 5568, 2528, 2544, 5616, 2576
.long 27696, 60432, 90192, 27696, 60432, 90192, 2504, 5576, 2536, 2552, 5624, 2584
.long 27712, 60448, 93184, 27712, 60448, 93184, 2512, 5584, 5600, 2560, 5632, 5648
.long 27728, 60464, 93200, 27728, 60464, 93200, 2520, 5592, 5608, 2568, 5640, 5656
.long 30720, 60480, 93216, 30720, 60480, 93216, 2592, 5664, 2624, 2640, 5712, 2672
.long 30736, 60496, 93232, 30736, 60496, 93232, 2600, 5672, 2632, 2648, 5720, 2680
.long 30752, 63488, 93248, 30752, 63488, 93248, 2608, 5680, 5696, 2656, 5728, 5744
.long 30768, 63504, 93264, 30768, 63504, 93264, 2616, 5688, 5704, 2664, 5736, 5752
.type L_wavetab,@object
L_wavetab:
.long 264320, 11280384, 262144, L_lanetab-L_back_pc_2+6144, 264320, 8192, 640, 0, 3145728, 5767168, 25427968, 28229632, 262144, 0, 0, 11272192, 0, 25427968, 25431040, 1073741824, 0, 65536, 280704, 16384
.fill 8, 4, 0
.long 264596, 11444224, 262144, L_lanetab-L_back_pc_2+3072, 264576, 7936, 640, 0, 3150848, 5767168, 25453568, 28291072, 262144, 40960, 1, 11436032, 491520, 26308608, 26311680, 1073741824, 2560, 65664, 1073741824, 16128
.fill 8, 4, 0
.long 265140, 11362304, 262144, L_lanetab-L_back_pc_2+3072, 264832, 7936, 640, 0, 3145728, 5767168, 25479168, 28352512, 262144, 81920, 1, 11354112, 1802240, 26472448, 26475520, 1073741824, 5120, 65792, 1073741824, 15872
.fill 8, 4, 0
.long 1073741824, 11526144, 262144, L_lanetab-L_back_pc_2+3072, 265088, 7680, 0, 0, 3150848, 5767168, 25504768, 28413952, 262144, 122880, 0, 11517952, 1073741824, 1073741824, 1073741824, 1073741824, 7680, 65920, 1073741824, 15616
.fill 8, 4, 0
.long 265344, 11281408, 262400, L_lanetab-L_back_pc_2+6144, 264320, 8192, 640, 0, 3473408, 6455296, 25427968, 28229632, 270336, 327680, 0, 11276288, 160, 25530368, 25533440, 1073741824, 327680, 81920, 281216, 16896
.fill 8, 4, 0
.long 265620, 11445248, 262400, L_lanetab-L_back_pc_2+3072, 264576, 7936, 640, 0, 3478528, 6455296, 25453568, 28291072, 270336, 368640, 1, 11440128, 491680, 26554368, 26557440, 1073741824, 330240, 82048, 1073741824, 16640
.fill 8, 4, 0
.long 266164, 11363328, 262400, L_lanetab-L_back_pc_2+3072, 264832, 7936, 640, 0, 3473408, 6455296, 25479168, 28352512, 270336, 409600, 1, 11358208, 1802400, 26718208, 26721280, 1073741824, 332800, 82176, 1073741824, 16384
.fill 8, 4, 0
.long 1073741824, 11527168, 262400, L_lanetab-L_back_pc_2+3072, 265088, 7680, 0, 0, 3478528, 6455296, 25504768, 28413952, 270336, 450560, 0, 11522048, 1073741824, 1073741824, 1073741824, 1073741824, 335360, 82304, 1073741824, 16128
.fill 8, 4, 0
.long 266368, 11290624, 262656, L_lanetab-L_back_pc_2+6144, 264320, 8192, 640, 0, 3801088, 7143424, 25427968, 28229632, 278528, 655360, 0, 11282432, 320, 25632768, 25635840, 1073741824, 655360, 98304, 281728, 17408
.fill 8, 4, 0
.long 266644, 11454464, 262656, L_lanetab-L_back_pc_2+3072, 264576, 7936, 640, 0, 3806208, 7143424, 25453568, 28291072, 278528, 696320, 1, 11446272, 491840, 26800128, 26803200, 1073741824, 657920, 98432, 1073741824, 17152
.fill 8, 4, 0
.long 267188, 11372544, 262656, L_lanetab-L_back_pc_2+3072, 264832, 7936, 640, 0, 3801088, 7143424, 25479168, 28352512, 278528, 737280, 1, 11364352, 1802560, 26963968, 26967040, 1073741824, 660480, 98560, 1073741824, 16896
.fill 8, 4, 0
.long 1073741824, 11536384, 262656, L_lanetab-L_back_pc_2+3072, 265088, 7680, 0, 0, 3806208, 7143424, 25504768, 28413952, 278528, 778240, 0, 11528192, 1073741824, 1073741824, 1073741824, 1073741824, 663040, 98688, 1073741824, 16640
.fill 8, 4, 0
.long 267392, 11291648, 262912, L_lanetab-L_back_pc_2+6144, 264320, 8192, 640, 0, 4128768, 7831552, 25427968, 28229632, 286720, 983040, 0, 11286528, 480, 25735168, 25738240, 1073741824, 983040, 114688, 282240, 17920
.fill 8, 4, 0
.long 267668, 11455488, 262912, L_lanetab-L_back_pc_2+3072, 264576, 7936, 640, 0, 4133888, 7831552, 25453568, 28291072, 286720, 1024000, 1, 11450368, 492000, 27045888, 27048960, 1073741824, 985600, 114816, 1073741824, 17664
.fill 8, 4, 0
.long 268212, 11373568, 262912, L_lanetab-L_back_pc_2+3072, 264832, 7936, 640, 0, 4128768, 7831552, 25479168, 28352512, 286720, 1064960, 1, 11368448, 1802720, 27209728, 27212800, 1073741824, 988160, 114944, 1073741824, 17408
.fill 8, 4, 0
.long 1073741824, 11537408, 262912, L_lanetab-L_back_pc_2+3072, 265088, 7680, 0, 0, 4133888, 7831552, 25504768, 28413952, 286720, 1105920, 0, 11532288, 1073741824, 1073741824, 1073741824, 1073741824, 990720, 115072, 1073741824, 17152
.fill 8, 4, 0
.long 268416, 11300864, 263168, L_lanetab-L_back_pc_2+6144, 264320, 8192, 640, 0, 4456448, 8519680, 25427968, 28229632, 294912, 1310720, 0, 11292672, 640, 25837568, 25840640, 1073741824, 1310720, 131072, 282752, 18432
.fill 8, 4, 0
.long 268692, 11464704, 263168, L_lanetab-L_back_pc_2+3072, 264576, 7936, 640, 0, 4461568, 8519680, 25453568, 28291072, 294912, 1351680, 1, 11456512, 492160, 27291648, 27294720, 1073741824, 1313280, 131200, 1073741824, 18176
.fill 8, 4, 0
.long 269236, 11382784, 263168, L_lanetab-L_back_pc_2+3072, 264832, 7936, 640, 0, 4456448, 8519680, 25479168, 28352512, 294912, 1392640, 1, 11374592, 1802880, 27455488, 27458560, 1073741824, 1315840, 131328, 1073741824, 17920
.fill 8, 4, 0
.long 1073741824, 11546624, 263168, L_lanetab-L_back_pc_2+3072, 265088, 7680, 0, 0, 4461568, 8519680, 25504768, 28413952, 294912, 1433600, 0, 11538432, 1073741824, 1073741824, 1073741824, 1073741824, 1318400, 131456, 1073741824, 17664
.fill 8, 4, 0
.long 269440, 11301888, 263424, L_lanetab-L_back_pc_2+6144, 264320, 8192, 640, 0, 4784128, 9207808, 25427968, 28229632, 303104, 1638400, 0, 11296768, 800, 25939968, 25943040, 1073741824, 1638400, 147456, 283264, 18944
.fill 8, 4, 0
.long 269716, 11465728, 263424, L_lanetab-L_back_pc_2+3072, 264576, 7936, 640, 0, 4789248, 9207808, 25453568, 28291072, 303104, 1679360, 1, 11460608, 492320, 27537408, 27540480, 1073741824, 1640960, 147584, 1073741824, 18688
.fill 8, 4, 0
.long 270260, 11383808, 263424, L_lanetab-L_back_pc_2+3072, 264832, 7936, 640, 0, 4784128, 9207808, 25479168, 28352512, 303104, 1720320, 1, 11378688, 1803040, 27701248, 27704320, 1073741824, 1643520, 147712, 1073741824, 18432
.fill 8, 4, 0
.long 1073741824, 11547648, 263424, L_lanetab-L_back_pc_2+3072, 265088, 7680, 0, 0, 4789248, 9207808, 25504768, 28413952, 303104, 1761280, 0, 11542528, 1073741824, 1073741824, 1073741824, 1073741824, 1646080, 147840, 1073741824, 18176
.fill 8, 4, 0
.long 270464, 11311104, 263680, L_lanetab-L_back_pc_2+6144, 264320, 8192, 640, 0, 5111808, 9895936, 25427968, 28229632, 311296, 1966080, 0, 11302912, 960, 26042368, 26045440, 1073741824, 1966080, 163840, 283776, 19456
.fill 8, 4, 0
.long 270740, 11474944, 263680, L_lanetab-L_back_pc_2+3072, 264576, 7936, 640, 0, 5116928, 9895936, 25453568, 28291072, 311296, 2007040, 1, 11466752, 492480, 27783168, 27786240, 1073741824, 1968640, 163968, 1073741824, 19200
.fill 8, 4, 0
.long 271284, 11393024, 263680, L_lanetab-L_back_pc_2+3072, 264832, 7936, 640, 0, 5111808, 9895936, 25479168, 28352512, 311296, 2048000, 1, 11384832, 1803200, 27947008, 27950080, 1073741824, 1971200, 164096, 1073741824, 18944
.fill 8, 4, 0
.long 1073741824, 11556864, 263680, L_lanetab-L_back_pc_2+3072, 265088, 7680, 0, 0, 5116928, 9895936, 25504768, 28413952, 311296, 2088960, 0, 11548672, 1073741824, 1073741824, 1073741824, 1073741824, 1973760, 164224, 1073741824, 18688
.fill 8, 4, 0
.long 271488, 11312128, 263936, L_lanetab-L_back_pc_2+6144, 264320, 8192, 640, 0, 5439488, 10584064, 25427968, 28229632, 319488, 2293760, 0, 11307008, 1120, 26144768, 26147840, 1073741824, 2293760, 180224, 284288, 19968
.fill 8, 4, 0
.long 271764, 11475968, 263936, L_lanetab-L_back_pc_2+3072, 264576, 7936, 640, 0, 5444608, 10584064, 25453568, 28291072, 319488, 2334720, 1, 11470848, 492640, 28028928, 28032000, 1073741824, 2296320, 180352, 1073741824, 19712
.fill 8, 4, 0
.long 272308, 11394048, 263936, L_lanetab-L_back_pc_2+3072, 264832, 7936, 640, 0, 5439488, 10584064, 25479168, 28352512, 319488, 2375680, 1, 11388928, 1803360, 28192768, 28195840, 1073741824, 2298880, 180480, 1073741824, 19456
.fill 8, 4, 0
.long 1073741824, 11557888, 263936, L_lanetab-L_back_pc_2+3072, 265088, 7680, 0, 0, 5444608, 10584064, 25504768, 28413952, 319488, 2416640, 0, 11552768, 1073741824, 1073741824, 1073741824, 1073741824, 2301440, 180608, 1073741824, 19200
.fill 8, 4, 0
.long 264324, 11280640, 262144, L_lanetab-L_back_pc_2+6144, 265344, 7680, 640, 320, 3227648, 5939200, 25530368, 28475392, 262144, 160, 0, 11273216, 51200, 25433088, 25436160, 1073741824, 10240, 66048, 280708, 15360
.fill 8, 4, 0
.long 264600, 11444480, 262144, L_lanetab-L_back_pc_2+3072, 265600, 7424, 640, 320, 3232768, 5939200, 25555968, 28536832, 262144, 41120, 1, 11437056, 532480, 26313728, 26316800, 1073741824, 12800, 66176, 1073741824, 15104
.fill 8, 4, 0
.long 265144, 11362560, 262144, L_lanetab-L_back_pc_2+3072, 265856, 7424, 640, 320, 3227648, 5939200, 25581568, 28598272, 262144, 82080, 1, 11355136, 1843200, 26477568, 26480640, 1073741824, 15360, 66304, 1073741824, 14848
.fill 8, 4, 0
.long 1073741824, 11526400, 262144, L_lanetab-L_back_pc_2+3072, 266112, 7168, 0, 320, 3232768, 5939200, 25607168, 28659712, 262144, 123040, 0, 11518976, 1073741824, 1073741824, 1073741824, 1073741824, 17920, 66432, 1073741824, 14592
.fill 8, 4, 0
.long 265348, 11281664, 262400, L_lanetab-L_back_pc_2+6144, 265344, 7680, 640, 320, 3555328, 6627328, 25530368, 28475392, 270336, 327840, 0, 11277312, 51360, 25535488, 25538560, 1073741824, 337920, 82432, 281220, 15872
.fill 8, 4, 0
.long 265624, 11445504, 262400, L_lanetab-L_back_pc_2+3072, 265600, 7424, 640, 320, 3560448, 6627328, 25555968, 28536832, 270336, 368800, 1, 11441152, 532640, 26559488, 26562560, 1073741824, 340480, 82560, 1073741824, 15616
.fill 8, 4, 0
.long 266168, 11363584, 262400, L_lanetab-L_back_pc_2+3072, 265856, 7424, 640, 320, 3555328, 6627328, 25581568, 28598272, 270336, 409760, 1, 11359232, 1843360, 26723328, 26726400, 1073741824, 343040, 82688, 1073741824, 15360
.fill 8, 4, 0
.long 1073741824, 11527424, 262400, L_lanetab-L_back_pc_2+3072, 266112, 7168, 0, 320, 3560448, 6627328, 25607168, 28659712, 270336, 450720, 0, 11523072, 1073741824, 1073741824, 1073741824, 1073741824, 345600, 82816, 1073741824, 15104
.fill 8, 4, 0
.long 266372, 11290880, 262656, L_lanetab-L_back_pc_2+6144, 265344, 7680, 640, 320, 3883008, 7315456, 25530368, 28475392, 278528, 655520, 0, 11283456, 51520, 25637888, 25640960, 1073741824, 665600, 98816, 281732, 16384
.fill 8, 4, 0
.long 266648, 11454720, 262656, L_lanetab-L_back_pc_2+3072, 265600, 7424, 640, 320, 3888128, 7315456, 25555968, 28536832, 278528, 696480, 1, 11447296, 532800, 26805248, 26808320, 1073741824, 668160, 98944, 1073741824, 16128
.fill 8, 4, 0
.long 267192, 11372800, 262656, L_lanetab-L_back_pc_2+3072, 265856, 7424, 640, 320, 3883008, 7315456, 25581568, 28598272, 278528, 737440, 1, 11365376, 1843520, 26969088, 26972160, 1073741824, 670720, 99072, 1073741824, 15872
.fill 8, 4, 0
.long 1073741824, 11536640, 262656, L_lanetab-L_back_pc_2+3072, 266112, 7168, 0, 320, 3888128, 7315456, 25607168, 28659712, 278528, 778400, 0, 11529216, 1073741824, 1073741824, 1073741824, 1073741824, 673280, 99200, 1073741824, 15616
.fill 8, 4, 0
.long 267396, 11291904, 262912, L_lanetab-L_back_pc_2+6144, 265344, 7680, 640, 320, 4210688, 8003584, 25530368, 28475392, 286720, 983200, 0, 11287552, 51680, 25740288, 25743360, 1073741824, 993280, 115200, 282244, 16896
.fill 8, 4, 0
.long 267672, 11455744, 262912, L_lanetab-L_back_pc_2+3072, 265600, 7424, 640, 320, 4215808, 8003584, 25555968, 28536832, 286720, 1024160, 1, 11451392, 532960, 27051008, 27054080, 1073741824, 995840, 115328, 1073741824, 16640
.fill 8, 4, 0
.long 268216, 11373824, 262912, L_lanetab-L_back_pc_2+3072, 265856, 7424, 640, 320, 4210688, 8003584, 25581568, 28598272, 286720, 1065120, 1, 11369472, 1843680, 27214848, 27217920, 1073741824, 998400, 115456, 1073741824, 16384
.fill 8, 4, 0
.long 1073741824, 11537664, 262912, L_lanetab-L_back_pc_2+3072, 266112, 7168, 0, 320, 4215808, 8003584, 25607168, 28659712, 286720, 1106080, 0, 11533312, 1073741824, 1073741824, 1073741824, 1073741824, 1000960, 115584, 1073741824, 16128
.fill 8, 4, 0
.long 268420, 11301120, 263168, L_lanetab-L_back_pc_2+6144, 265344, 7680, 640, 320, 4538368, 8691712, 25530368, 28475392, 294912, 1310880, 0, 11293696, 51840, 25842688, 25845760, 1073741824, 1320960, 131584, 282756, 17408
.fill 8, 4, 0
.long 268696, 11464960, 263168, L_lanetab-L_back_pc_2+3072, 265600, 7424, 640, 320, 4543488, 8691712, 25555968, 28536832, 294912, 1351840, 1, 11457536, 533120, 27296768, 27299840, 1073741824, 1323520, 131712, 1073741824, 17152
.fill 8, 4, 0
.long 269240, 11383040, 263168, L_lanetab-L_back_pc_2+3072, 265856, 7424, 640, 320, 4538368, 8691712, 25581568, 28598272, 294912, 1392800, 1, 11375616, 1843840, 27460608, 27463680, 1073741824, 1326080, 131840, 1073741824, 16896
.fill 8, 4, 0
.long 1073741824, 11546880, 263168, L_lanetab-L_back_pc_2+3072, 266112, 7168, 0, 320, 4543488, 8691712, 25607168, 28659712, 294912, 1433760, 0, 11539456, 1073741824, 1073741824, 1073741824, 1073741824, 1328640, 131968, 1073741824, 16640
.fill 8, 4, 0
.long 269444, 11302144, 263424, L_lanetab-L_back_pc_2+6144, 265344, 7680, 640, 320, 4866048, 9379840, 25530368, 28475392, 303104, 1638560, 0, 11297792, 52000, 25945088, 25948160, 1073741824, 1648640, 147968, 283268, 17920
.fill 8, 4, 0
.long 269720, 11465984, 263424, L_lanetab-L_back_pc_2+3072, 265600, 7424, 640, 320, 4871168, 9379840, 25555968, 28536832, 303104, 1679520, 1, 11461632, 533280, 27542528, 27545600, 1073741824, 1651200, 148096, 1073741824, 17664
.fill 8, 4, 0
.long 270264, 11384064, 263424, L_lanetab-L_back_pc_2+3072, 265856, 7424, 640, 320, 4866048, 9379840, 25581568, 28598272, 303104, 1720480, 1, 11379712, 1844000, 27706368, 27709440, 1073741824, 1653760, 148224, 1073741824, 17408
.fill 8, 4, 0
.long 1073741824, 11547904, 263424, L_lanetab-L_back_pc_2+3072, 266112, 7168, 0, 320, 4871168, 9379840, 25607168, 28659712, 303104, 1761440, 0, 11543552, 1073741824, 1073741824, 1073741824, 1073741824, 1656320, 148352, 1073741824, 17152
.fill 8, 4, 0
.long 270468, 11311360, 263680, L_lanetab-L_back_pc_2+6144, 265344, 7680, 640, 320, 5193728, 10067968, 25530368, 28475392, 311296, 1966240, 0, 11303936, 52160, 26047488, 26050560, 1073741824, 1976320, 164352, 283780, 18432
.fill 8, 4, 0
.long 270744, 11475200, 263680, L_lanetab-L_back_pc_2+3072, 265600, 7424, 640, 320, 5198848, 10067968, 25555968, 28536832, 311296, 2007200, 1, 11467776, 533440, 27788288, 27791360, 1073741824, 1978880, 164480, 1073741824, 18176
.fill 8, 4, 0
.long 271288, 11393280, 263680, L_lanetab-L_back_pc_2+3072, 265856, 7424, 640, 320, 5193728, 10067968, 25581568, 28598272, 311296, 2048160, 1, 11385856, 1844160, 27952128, 27955200, 1073741824, 1981440, 164608, 1073741824, 17920
.fill 8, 4, 0
.long 1073741824, 11557120, 263680, L_lanetab-L_back_pc_2+3072, 266112, 7168, 0, 320, 5198848, 10067968, 25607168, 28659712, 311296, 2089120, 0, 11549696, 1073741824, 1073741824, 1073741824, 1073741824, 1984000, 164736, 1073741824, 17664
.fill 8, 4, 0
.long 271492, 11312384, 263936, L_lanetab-L_back_pc_2+6144, 265344, 7680, 640, 320, 5521408, 10756096, 25530368, 28475392, 319488, 2293920, 0, 11308032, 52320, 26149888, 26152960, 1073741824, 2304000, 180736, 284292, 18944
.fill 8, 4, 0
.long 271768, 11476224, 263936, L_lanetab-L_back_pc_2+3072, 265600, 7424, 640, 320, 5526528, 10756096, 25555968, 28536832, 319488, 2334880, 1, 11471872, 533600, 28034048, 28037120, 1073741824, 2306560, 180864, 1073741824, 18688
.fill 8, 4, 0
.long 272312, 11394304, 263936, L_lanetab-L_back_pc_2+3072, 265856, 7424, 640, 320, 5521408, 10756096, 25581568, 28598272, 319488, 2375840, 1, 11389952, 1844320, 28197888, 28200960, 1073741824, 2309120, 180992, 1073741824, 18432
.fill 8, 4, 0
.long 1073741824, 11558144, 263936, L_lanetab-L_back_pc_2+3072, 266112, 7168, 0, 320, 5526528, 10756096, 25607168, 28659712, 319488, 2416800, 0, 11553792, 1073741824, 1073741824, 1073741824, 1073741824, 2311680, 181120, 1073741824, 18176
.fill 8, 4, 0
.long 264328, 11280896, 262144, L_lanetab-L_back_pc_2+6144, 266368, 7168, 640, 640, 3309568, 6111232, 25632768, 28721152, 262144, 320, 0, 11274240, 102400, 25438208, 25441280, 1073741824, 20480, 66560, 280712, 14336
.fill 8, 4, 0
.long 264604, 11444736, 262144, L_lanetab-L_back_pc_2+3072, 266624, 6912, 640, 640, 3314688, 6111232, 25658368, 28782592, 262144, 41280, 1, 11438080, 573440, 26318848, 26321920, 1073741824, 23040, 66688, 1073741824, 14080
.fill 8, 4, 0
.long 265148, 11362816, 262144, L_lanetab-L_back_pc_2+3072, 266880, 6912, 640, 640, 3309568, 6111232, 25683968, 28844032, 262144, 82240, 1, 11356160, 1884160, 26482688, 26485760, 1073741824, 25600, 66816, 1073741824, 13824
.fill 8, 4, 0
.long 1073741824, 11526656, 262144, L_lanetab-L_back_pc_2+3072, 267136, 6656, 0, 640, 3314688, 6111232, 25709568, 28905472, 262144, 123200, 0, 11520000, 1073741824, 1073741824, 1073741824, 1073741824, 28160, 66944, 1073741824, 13568
.fill 8, 4, 0
.long 265352, 11281920, 262400, L_lanetab-L_back_pc_2+6144, 266368, 7168, 640, 640, 3637248, 6799360, 25632768, 28721152, 270336, 328000, 0, 11278336, 102560, 25540608, 25543680, 1073741824, 348160, 82944, 281224, 14848
.fill 8, 4, 0
.long 265628, 11445760, 262400, L_lanetab-L_back_pc_2+3072, 266624, 6912, 640, 640, 3642368, 6799360, 25658368, 28782592, 270336, 368960, 1, 11442176, 573600, 26564608, 26567680, 1073741824, 350720, 83072, 1073741824, 14592
.fill 8, 4, 0
.long 266172, 11363840, 262400, L_lanetab-L_back_pc_2+3072, 266880, 6912, 640, 640, 3637248, 6799360, 25683968, 28844032, 270336, 409920, 1, 11360256, 1884320, 26728448, 26731520, 1073741824, 353280, 83200, 1073741824, 14336
.fill 8, 4, 0
.long 1073741824, 11527680, 262400, L_lanetab-L_back_pc_2+3072, 267136, 6656, 0, 640, 3642368, 6799360, 25709568, 28905472, 270336, 450880, 0, 11524096, 1073741824, 1073741824, 1073741824, 1073741824, 355840, 83328, 1073741824, 14080
.fill 8, 4, 0
.long 266376, 11291136, 262656, L_lanetab-L_back_pc_2+6144, 266368, 7168, 640, 640, 3964928, 7487488, 25632768, 28721152, 278528, 655680, 0, 11284480, 102720, 25643008, 25646080, 1073741824, 675840, 99328, 281736, 15360
.fill 8, 4, 0
.long 266652, 11454976, 262656, L_lanetab-L_back_pc_2+3072, 266624, 6912, 640, 640, 3970048, 7487488, 25658368, 28782592, 278528, 696640, 1, 11448320, 573760, 26810368, 26813440, 1073741824, 678400, 99456, 1073741824, 15104
.fill 8, 4, 0
.long 267196, 11373056, 262656, L_lanetab-L_back_pc_2+3072, 266880, 6912, 640, 640, 3964928, 7487488, 25683968, 28844032, 278528, 737600, 1, 11366400, 1884480, 26974208, 26977280, 1073741824, 680960, 99584, 1073741824, 14848
.fill 8, 4, 0
.long 1073741824, 11536896, 262656, L_lanetab-L_back_pc_2+3072, 267136, 6656, 0, 640, 3970048, 7487488, 25709568, 28905472, 278528, 778560, 0, 11530240, 1073741824, 1073741824, 1073741824, 1073741824, 683520, 99712, 1073741824, 14592
.fill 8, 4, 0
.long 267400, 11292160, 262912, L_lanetab-L_back_pc_2+6144, 266368, 7168, 640, 640, 4292608, 8175616, 25632768, 28721152, 286720, 983360, 0, 11288576, 102880, 25745408, 25748480, 1073741824, 1003520, 115712, 282248, 15872
.fill 8, 4, 0
.long 267676, 11456000, 262912, L_lanetab-L_back_pc_2+3072, 266624, 6912, 640, 640, 4297728, 8175616, 25658368, 28782592, 286720, 1024320, 1, 11452416, 573920, 27056128, 27059200, 1073741824, 1006080, 115840, 1073741824, 15616
.fill 8, 4, 0
.long 268220, 11374080, 262912, L_lanetab-L_back_pc_2+3072, 266880, 6912, 640, 640, 4292608, 8175616, 25683968, 28844032, 286720, 1065280, 1, 11370496, 1884640, 27219968, 27223040, 1073741824, 1008640, 115968, 1073741824, 15360
.fill 8, 4, 0
.long 1073741824, 11537920, 262912, L_lanetab-L_back_pc_2+3072, 267136, 6656, 0, 640, 4297728, 8175616, 25709568, 28905472, 286720, 1106240, 0, 11534336, 1073741824, 1073741824, 1073741824, 1073741824, 1011200, 116096, 1073741824, 15104
.fill 8, 4, 0
.long 268424, 11301376, 263168, L_lanetab-L_back_pc_2+6144, 266368, 7168, 640, 640, 4620288, 8863744, 25632768, 28721152, 294912, 1311040, 0, 11294720, 103040, 25847808, 25850880, 1073741824, 1331200, 132096, 282760, 16384
.fill 8, 4, 0
.long 268700, 11465216, 263168, L_lanetab-L_back_pc_2+3072, 266624, 6912, 640, 640, 4625408, 8863744, 25658368, 28782592, 294912, 1352000, 1, 11458560, 574080, 27301888, 27304960, 1073741824, 1333760, 132224, 1073741824, 16128
.fill 8, 4, 0
.long 269244, 11383296, 263168, L_lanetab-L_back_pc_2+3072, 266880, 6912, 640, 640, 4620288, 8863744, 25683968, 28844032, 294912, 1392960, 1, 11376640, 1884800, 27465728, 27468800, 1073741824, 1336320, 132352, 1073741824, 15872
.fill 8, 4, 0
.long 1073741824, 11547136, 263168, L_lanetab-L_back_pc_2+3072, 267136, 6656, 0, 640, 4625408, 8863744, 25709568, 28905472, 294912, 1433920, 0, 11540480, 1073741824, 1073741824, 1073741824, 1073741824, 1338880, 132480, 1073741824, 15616
.fill 8, 4, 0
.long 269448, 11302400, 263424, L_lanetab-L_back_pc_2+6144, 266368, 7168, 640, 640, 4947968, 9551872, 25632768, 28721152, 303104, 1638720, 0, 11298816, 103200, 25950208, 25953280, 1073741824, 1658880, 148480, 283272, 16896
.fill 8, 4, 0
.long 269724, 11466240, 263424, L_lanetab-L_back_pc_2+3072, 266624, 6912, 640, 640, 4953088, 9551872, 25658368, 28782592, 303104, 1679680, 1, 11462656, 574240, 27547648, 27550720, 1073741824, 1661440, 148608, 1073741824, 16640
.fill 8, 4, 0
.long 270268, 11384320, 263424, L_lanetab-L_back_pc_2+3072, 266880, 6912, 640, 640, 4947968, 9551872, 25683968, 28844032, 303104, 1720640, 1, 11380736, 1884960, 27711488, 27714560, 1073741824, 1664000, 148736, 1073741824, 16384
.fill 8, 4, 0
.long 1073741824, 11548160, 263424, L_lanetab-L_back_pc_2+3072, 267136, 6656, 0, 640, 4953088, 9551872, 25709568, 28905472, 303104, 1761600, 0, 11544576, 1073741824, 1073741824, 1073741824, 1073741824, 1666560, 148864, 1073741824, 16128
.fill 8, 4, 0
.long 270472, 11311616, 263680, L_lanetab-L_back_pc_2+6144, 266368, 7168, 640, 640, 5275648, 10240000, 25632768, 28721152, 311296, 1966400, 0, 11304960, 103360, 26052608, 26055680, 1073741824, 1986560, 164864, 283784, 17408
.fill 8, 4, 0
.long 270748, 11475456, 263680, L_lanetab-L_back_pc_2+3072, 266624, 6912, 640, 640, 5280768, 10240000, 25658368, 28782592, 311296, 2007360, 1, 11468800, 574400, 27793408, 27796480, 1073741824, 1989120, 164992, 1073741824, 17152
.fill 8, 4, 0
.long 271292, 11393536, 263680, L_lanetab-L_back_pc_2+3072, 266880, 6912, 640, 640, 5275648, 10240000, 25683968, 28844032, 311296, 2048320, 1, 11386880, 1885120, 27957248, 27960320, 1073741824, 1991680, 165120, 1073741824, 16896
.fill 8, 4, 0
.long 1073741824, 11557376, 263680, L_lanetab-L_back_pc_2+3072, 267136, 6656, 0, 640, 5280768, 10240000, 25709568, 28905472, 311296, 2089280, 0, 11550720, 1073741824, 1073741824, 1073741824, 1073741824, 1994240, 165248, 1073741824, 16640
.fill 8, 4, 0
.long 271496, 11312640, 263936, L_lanetab-L_back_pc_2+6144, 266368, 7168, 640, 640, 5603328, 10928128, 25632768, 28721152, 319488, 2294080, 0, 11309056, 103520, 26155008, 26158080, 1073741824, 2314240, 181248, 284296, 17920
.fill 8, 4, 0
.long 271772, 11476480, 263936, L_lanetab-L_back_pc_2+3072, 266624, 6912, 640, 640, 5608448, 10928128, 25658368, 28782592, 319488, 2335040, 1, 11472896, 574560, 28039168, 28042240, 1073741824, 2316800, 181376, 1073741824, 17664
.fill 8, 4, 0
.long 272316, 11394560, 263936, L_lanetab-L_back_pc_2+3072, 266880, 6912, 640, 640, 5603328, 10928128, 25683968, 28844032, 319488, 2376000, 1, 11390976, 1885280, 28203008, 28206080, 1073741824, 2319360, 181504, 1073741824, 17408
.fill 8, 4, 0
.long 1073741824, 11558400, 263936, L_lanetab-L_back_pc_2+3072, 267136, 6656, 0, 640, 5608448, 10928128, 25709568, 28905472, 319488, 2416960, 0, 11554816, 1073741824, 1073741824, 1073741824, 1073741824, 2321920, 181632, 1073741824, 17152
.fill 8, 4, 0
.long 264332, 11281152, 262144, L_lanetab-L_back_pc_2+6144, 267392, 6656, 640, 960, 3391488, 6283264, 25735168, 28966912, 262144, 480, 0, 11275264, 153600, 25443328, 25446400, 1073741824, 30720, 67072, 280716, 13312
.fill 8, 4, 0
.long 264608, 11444992, 262144, L_lanetab-L_back_pc_2+3072, 267648, 6400, 640, 960, 3396608, 6283264, 25760768, 29028352, 262144, 41440, 1, 11439104, 614400, 26323968, 26327040, 1073741824, 33280, 67200, 1073741824, 13056
.fill 8, 4, 0
.long 265152, 11363072, 262144, L_lanetab-L_back_pc_2+3072, 267904, 6400, 640, 960, 3391488, 6283264, 25786368, 29089792, 262144, 82400, 1, 11357184, 1925120, 26487808, 26490880, 1073741824, 35840, 67328, 1073741824, 12800
.fill 8, 4, 0
.long 1073741824, 11526912, 262144, L_lanetab-L_back_pc_2+3072, 268160, 6144, 0, 960, 3396608, 6283264, 25811968, 29151232, 262144, 123360, 0, 11521024, 1073741824, 1073741824, 1073741824, 1073741824, 38400, 67456, 1073741824, 12544
.fill 8, 4, 0
.long 265356, 11282176, 262400, L_lanetab-L_back_pc_2+6144, 267392, 6656, 640, 960, 3719168, 6971392, 25735168, 28966912, 270336, 328160, 0, 11279360, 153760, 25545728, 25548800, 1073741824, 358400, 83456, 281228, 13824
.fill 8, 4, 0
.long 265632, 11446016, 262400, L_lanetab-L_back_pc_2+3072, 267648, 6400, 640, 960, 3724288, 6971392, 25760768, 29028352, 270336, 369120, 1, 11443200, 614560, 26569728, 26572800, 1073741824, 360960, 83584, 1073741824, 13568
.fill 8, 4, 0
.long 266176, 11364096, 262400, L_lanetab-L_back_pc_2+3072, 267904, 6400, 640, 960, 3719168, 6971392, 25786368, 29089792, 270336, 410080, 1, 11361280, 1925280, 26733568, 26736640, 1073741824, 363520, 83712, 1073741824, 13312
.fill 8, 4, 0
.long 1073741824, 11527936, 262400, L_lanetab-L_back_pc_2+3072, 268160, 6144, 0, 960, 3724288, 6971392, 25811968, 29151232, 270336, 451040, 0, 11525120, 1073741824, 1073741824, 1073741824, 1073741824, 366080, 83840, 1073741824, 13056
.fill 8, 4, 0
.long 266380, 11291392, 262656, L_lanetab-L_back_pc_2+6144, 267392, 6656, 640, 960, 4046848, 7659520, 25735168, 28966912, 278528, 655840, 0, 11285504, 153920, 25648128, 25651200, 1073741824, 686080, 99840, 281740, 14336
.fill 8, 4, 0
.long 266656, 11455232, 262656, L_lanetab-L_back_pc_2+3072, 267648, 6400, 640, 960, 4051968, 7659520, 25760768, 29028352, 278528, 696800, 1, 11449344, 614720, 26815488, 26818560, 1073741824, 688640, 99968, 1073741824, 14080
.fill 8, 4, 0
.long 267200, 11373312, 262656, L_lanetab-L_back_pc_2+3072, 267904, 6400, 640, 960, 4046848, 7659520, 25786368, 29089792, 278528, 737760, 1, 11367424, 1925440, 26979328, 26982400, 1073741824, 691200, 100096, 1073741824, 13824
.fill 8, 4, 0
.long 1073741824, 11537152, 262656, L_lanetab-L_back_pc_2+3072, 268160, 6144, 0, 960, 4051968, 7659520, 25811968, 29151232, 278528, 778720, 0, 11531264, 1073741824, 1073741824, 1073741824, 1073741824, 693760, 100224, 1073741824, 13568
.fill 8, 4, 0
.long 267404, 11292416, 262912, L_lanetab-L_back_pc_2+6144, 267392, 6656, 640, 960, 4374528, 8347648, 25735168, 28966912, 286720, 983520, 0, 11289600, 154080, 25750528, 25753600, 1073741824, 1013760, 116224, 282252, 14848
.fill 8, 4, 0
.long 267680, 11456256, 262912, L_lanetab-L_back_pc_2+3072, 267648, 6400, 640, 960, 4379648, 8347648, 25760768, 29028352, 286720, 1024480, 1, 11453440, 614880, 27061248, 27064320, 1073741824, 1016320, 116352, 1073741824, 14592
.fill 8, 4, 0
.long 268224, 11374336, 262912, L_lanetab-L_back_pc_2+3072, 267904, 6400, 640, 960, 4374528, 8347648, 25786368, 29089792, 286720, 1065440, 1, 11371520, 1925600, 27225088, 27228160, 1073741824, 1018880, 116480, 1073741824, 14336
.fill 8, 4, 0
.long 1073741824, 11538176, 262912, L_lanetab-L_back_pc_2+3072, 268160, 6144, 0, 960, 4379648, 8347648, 25811968, 29151232, 286720, 1106400, 0, 11535360, 1073741824, 1073741824, 1073741824, 1073741824, 1021440, 116608, 1073741824, 14080
.fill 8, 4, 0
.long 268428, 11301632, 263168, L_lanetab-L_back_pc_2+6144, 267392, 6656, 640, 960, 4702208, 9035776, 25735168, 28966912, 294912, 1311200, 0, 11295744, 154240, 25852928, 25856000, 1073741824, 1341440, 132608, 282764, 15360
.fill 8, 4, 0
.long 268704, 11465472, 263168, L_lanetab-L_back_pc_2+3072, 267648, 6400, 640, 960, 4707328, 9035776, 25760768, 29028352, 294912, 1352160, 1, 11459584, 615040, 27307008, 27310080, 1073741824, 1344000, 132736, 1073741824, 15104
.fill 8, 4, 0
.long 269248, 11383552, 263168, L_lanetab-L_back_pc_2+3072, 267904, 6400, 640, 960, 4702208, 9035776, 25786368, 29089792, 294912, 1393120, 1, 11377664, 1925760, 27470848, 27473920, 1073741824, 1346560, 132864, 1073741824, 14848
.fill 8, 4, 0
.long 1073741824, 11547392, 263168, L_lanetab-L_back_pc_2+3072, 268160, 6144, 0, 960, 4707328, 9035776, 25811968, 29151232, 294912, 1434080, 0, 11541504, 1073741824, 1073741824, 1073741824, 1073741824, 1349120, 132992, 1073741824, 14592
.fill 8, 4, 0
.long 269452, 11302656, 263424, L_lanetab-L_back_pc_2+6144, 267392, 6656, 640, 960, 5029888, 9723904, 25735168, 28966912, 303104, 1638880, 0, 11299840, 154400, 25955328, 25958400, 1073741824, 1669120, 148992, 283276, 15872
.fill 8, 4, 0
.long 269728, 11466496, 263424, L_lanetab-L_back_pc_2+3072, 267648, 6400, 640, 960, 5035008, 9723904, 25760768, 29028352, 303104, 1679840, 1, 11463680, 615200, 27552768, 27555840, 1073741824, 1671680, 149120, 1073741824, 15616
.fill 8, 4, 0
.long 270272, 11384576, 263424, L_lanetab-L_back_pc_2+3072, 267904, 6400, 640, 960, 5029888, 9723904, 25786368, 29089792, 303104, 1720800, 1, 11381760, 1925920, 27716608, 27719680, 1073741824, 1674240, 149248, 1073741824, 15360
.fill 8, 4, 0
.long 1073741824, 11548416, 263424, L_lanetab-L_back_pc_2+3072, 268160, 6144, 0, 960, 5035008, 9723904, 25811968, 29151232, 303104, 1761760, 0, 11545600, 1073741824, 1073741824, 1073741824, 1073741824, 1676800, 149376, 1073741824, 15104
.fill 8, 4, 0
.long 270476, 11311872, 263680, L_lanetab-L_back_pc_2+6144, 267392, 6656, 640, 960, 5357568, 10412032, 25735168, 28966912, 311296, 1966560, 0, 11305984, 154560, 26057728, 26060800, 1073741824, 1996800, 165376, 283788, 16384
.fill 8, 4, 0
.long 270752, 11475712, 263680, L_lanetab-L_back_pc_2+3072, 267648, 6400, 640, 960, 5362688, 10412032, 25760768, 29028352, 311296, 2007520, 1, 11469824, 615360, 27798528, 27801600, 1073741824, 1999360, 165504, 1073741824, 16128
.fill 8, 4, 0
.long 271296, 11393792, 263680, L_lanetab-L_back_pc_2+3072, 267904, 6400, 640, 960, 5357568, 10412032, 25786368, 29089792, 311296, 2048480, 1, 11387904, 1926080, 27962368, 27965440, 1073741824, 2001920, 165632, 1073741824, 15872
.fill 8, 4, 0
.long 1073741824, 11557632, 263680, L_lanetab-L_back_pc_2+3072, 268160, 6144, 0, 960, 5362688, 10412032, 25811968, 29151232, 311296, 2089440, 0, 11551744, 1073741824, 1073741824, 1073741824, 1073741824, 2004480, 165760, 1073741824, 15616
.fill 8, 4, 0
.long 271500, 11312896, 263936, L_lanetab-L_back_pc_2+6144, 267392, 6656, 640, 960, 5685248, 11100160, 25735168, 28966912, 319488, 2294240, 0, 11310080, 154720, 26160128, 26163200, 1073741824, 2324480, 181760, 284300, 16896
.fill 8, 4, 0
.long 271776, 11476736, 263936, L_lanetab-L_back_pc_2+3072, 267648, 6400, 640, 960, 5690368, 11100160, 25760768, 29028352, 319488, 2335200, 1, 11473920, 615520, 28044288, 28047360, 1073741824, 2327040, 181888, 1073741824, 16640
.fill 8, 4, 0
.long 272320, 11394816, 263936, L_lanetab-L_back_pc_2+3072, 267904, 6400, 640, 960, 5685248, 11100160, 25786368, 29089792, 319488, 2376160, 1, 11392000, 1926240, 28208128, 28211200, 1073741824, 2329600, 182016, 1073741824, 16384
.fill 8, 4, 0
.long 1073741824, 11558656, 263936, L_lanetab-L_back_pc_2+3072, 268160, 6144, 0, 960, 5690368, 11100160, 25811968, 29151232, 319488, 2417120, 0, 11555840, 1073741824, 1073741824, 1073741824, 1073741824, 2332160, 182144, 1073741824, 16128
.fill 8, 4, 0
.long 264336, 11608064, 262144, L_lanetab-L_back_pc_2+9216, 268416, 6144, 640, 1280, 3155968, 5767168, 25837568, 29212672, 262144, 640, 0, 11599872, 20480, 25448448, 25451520, 1073741824, 40960, 67584, 280720, 12288
.fill 8, 4, 0
.long 264612, 11771904, 262144, L_lanetab-L_back_pc_2+3072, 268672, 5888, 640, 1280, 3161088, 5767168, 25863168, 29274112, 262144, 41600, 1, 11763712, 655360, 26329088, 26332160, 1073741824, 43520, 67712, 1073741824, 12032
.fill 8, 4, 0
.long 272512, 11689984, 262144, L_lanetab-L_back_pc_2+12288, 268928, 5888, 384, 1280, 3155968, 5767168, 25888768, 29335552, 262144, 82560, 2, 11681792, 0, 28213248, 28274688, 28274688, 46080, 67840, 1073741824, 11776
.fill 8, 4, 0
.long 1073741824, 11853824, 262144, L_lanetab-L_back_pc_2+3072, 269184, 5632, 0, 1280, 3161088, 5767168, 25914368, 29396992, 262144, 123520, 0, 11845632, 1073741824, 1073741824, 1073741824, 1073741824, 48640, 67968, 1073741824, 11520
.fill 8, 4, 0
.long 265360, 11609088, 262400, L_lanetab-L_back_pc_2+9216, 268416, 6144, 640, 1280, 3483648, 6455296, 25837568, 29212672, 270336, 328320, 0, 11603968, 20640, 25550848, 25553920, 1073741824, 368640, 83968, 281232, 12800
.fill 8, 4, 0
.long 265636, 11772928, 262400, L_lanetab-L_back_pc_2+3072, 268672, 5888, 640, 1280, 3488768, 6455296, 25863168, 29274112, 270336, 369280, 1, 11767808, 655520, 26574848, 26577920, 1073741824, 371200, 84096, 1073741824, 12544
.fill 8, 4, 0
.long 272768, 11691008, 262400, L_lanetab-L_back_pc_2+12288, 268928, 5888, 384, 1280, 3483648, 6455296, 25888768, 29335552, 270336, 410240, 2, 11685888, 96, 28336128, 28397568, 28397568, 373760, 84224, 1073741824, 12288
.fill 8, 4, 0
.long 1073741824, 11854848, 262400, L_lanetab-L_back_pc_2+3072, 269184, 5632, 0, 1280, 3488768, 6455296, 25914368, 29396992, 270336, 451200, 0, 11849728, 1073741824, 1073741824, 1073741824, 1073741824, 376320, 84352, 1073741824, 12032
.fill 8, 4, 0
.long 266384, 11618304, 262656, L_lanetab-L_back_pc_2+9216, 268416, 6144, 640, 1280, 3811328, 7143424, 25837568, 29212672, 278528, 656000, 0, 11610112, 20800, 25653248, 25656320, 1073741824, 696320, 100352, 281744, 13312
.fill 8, 4, 0
.long 266660, 11782144, 262656, L_lanetab-L_back_pc_2+3072, 268672, 5888, 640, 1280, 3816448, 7143424, 25863168, 29274112, 278528, 696960, 1, 11773952, 655680, 26820608, 26823680, 1073741824, 698880, 100480, 1073741824, 13056
.fill 8, 4, 0
.long 273024, 11700224, 262656, L_lanetab-L_back_pc_2+12288, 268928, 5888, 384, 1280, 3811328, 7143424, 25888768, 29335552, 278528, 737920, 2, 11692032, 192, 28459008, 28520448, 28520448, 701440, 100608, 1073741824, 12800
.fill 8, 4, 0
.long 1073741824, 11864064, 262656, L_lanetab-L_back_pc_2+3072, 269184, 5632, 0, 1280, 3816448, 7143424, 25914368, 29396992, 278528, 778880, 0, 11855872, 1073741824, 1073741824, 1073741824, 1073741824, 704000, 100736, 1073741824, 12544
.fill 8, 4, 0
.long 267408, 11619328, 262912, L_lanetab-L_back_pc_2+9216, 268416, 6144, 640, 1280, 4139008, 7831552, 25837568, 29212672, 286720, 983680, 0, 11614208, 20960, 25755648, 25758720, 1073741824, 1024000, 116736, 282256, 13824
.fill 8, 4, 0
.long 267684, 11783168, 262912, L_lanetab-L_back_pc_2+3072, 268672, 5888, 640, 1280, 4144128, 7831552, 25863168, 29274112, 286720, 1024640, 1, 11778048, 655840, 27066368, 27069440, 1073741824, 1026560, 116864, 1073741824, 13568
.fill 8, 4, 0
.long 273280, 11701248, 262912, L_lanetab-L_back_pc_2+12288, 268928, 5888, 384, 1280, 4139008, 7831552, 25888768, 29335552, 286720, 1065600, 2, 11696128, 288, 28581888, 28643328, 28643328, 1029120, 116992, 1073741824, 13312
.fill 8, 4, 0
.long 1073741824, 11865088, 262912, L_lanetab-L_back_pc_2+3072, 269184, 5632, 0, 1280, 4144128, 7831552, 25914368, 29396992, 286720, 1106560, 0, 11859968, 1073741824, 1073741824, 1073741824, 1073741824, 1031680, 117120, 1073741824, 13056
.fill 8, 4, 0
.long 268432, 11628544, 263168, L_lanetab-L_back_pc_2+9216, 268416, 6144, 640, 1280, 4466688, 8519680, 25837568, 29212672, 294912, 1311360, 0, 11620352, 21120, 25858048, 25861120, 1073741824, 1351680, 133120, 282768, 14336
.fill 8, 4, 0
.long 268708, 11792384, 263168, L_lanetab-L_back_pc_2+3072, 268672, 5888, 640, 1280, 4471808, 8519680, 25863168, 29274112, 294912, 1352320, 1, 11784192, 656000, 27312128, 27315200, 1073741824, 1354240, 133248, 1073741824, 14080
.fill 8, 4, 0
.long 273536, 11710464, 263168, L_lanetab-L_back_pc_2+12288, 268928, 5888, 384, 1280, 4466688, 8519680, 25888768, 29335552, 294912, 1393280, 2, 11702272, 384, 28704768, 28766208, 28766208, 1356800, 133376, 1073741824, 13824
.fill 8, 4, 0
.long 1073741824, 11874304, 263168, L_lanetab-L_back_pc_2+3072, 269184, 5632, 0, 1280, 4471808, 8519680, 25914368, 29396992, 294912, 1434240, 0, 11866112, 1073741824, 1073741824, 1073741824, 1073741824, 1359360, 133504, 1073741824, 13568
.fill 8, 4, 0
.long 269456, 11629568, 263424, L_lanetab-L_back_pc_2+9216, 268416, 6144, 640, 1280, 4794368, 9207808, 25837568, 29212672, 303104, 1639040, 0, 11624448, 21280, 25960448, 25963520, 1073741824, 1679360, 149504, 283280, 14848
.fill 8, 4, 0
.long 269732, 11793408, 263424, L_lanetab-L_back_pc_2+3072, 268672, 5888, 640, 1280, 4799488, 9207808, 25863168, 29274112, 303104, 1680000, 1, 11788288, 656160, 27557888, 27560960, 1073741824, 1681920, 149632, 1073741824, 14592
.fill 8, 4, 0
.long 273792, 11711488, 263424, L_lanetab-L_back_pc_2+12288, 268928, 5888, 384, 1280, 4794368, 9207808, 25888768, 29335552, 303104, 1720960, 2, 11706368, 480, 28827648, 28889088, 28889088, 1684480, 149760, 1073741824, 14336
.fill 8, 4, 0
.long 1073741824, 11875328, 263424, L_lanetab-L_back_pc_2+3072, 269184, 5632, 0, 1280, 4799488, 9207808, 25914368, 29396992, 303104, 1761920, 0, 11870208, 1073741824, 1073741824, 1073741824, 1073741824, 1687040, 149888, 1073741824, 14080
.fill 8, 4, 0
.long 270480, 11638784, 263680, L_lanetab-L_back_pc_2+9216, 268416, 6144, 640, 1280, 5122048, 9895936, 25837568, 29212672, 311296, 1966720, 0, 11630592, 21440, 26062848, 26065920, 1073741824, 2007040, 165888, 283792, 15360
.fill 8, 4, 0
.long 270756, 11802624, 263680, L_lanetab-L_back_pc_2+3072, 268672, 5888, 640, 1280, 5127168, 9895936, 25863168, 29274112, 311296, 2007680, 1, 11794432, 656320, 27803648, 27806720, 1073741824, 2009600, 166016, 1073741824, 15104
.fill 8, 4, 0
.long 274048, 11720704, 263680, L_lanetab-L_back_pc_2+12288, 268928, 5888, 384, 1280, 5122048, 9895936, 25888768, 29335552, 311296, 2048640, 2, 11712512, 576, 28950528, 29011968, 29011968, 2012160, 166144, 1073741824, 14848
.fill 8, 4, 0
.long 1073741824, 11884544, 263680, L_lanetab-L_back_pc_2+3072, 269184, 5632, 0, 1280, 5127168, 9895936, 25914368, 29396992, 311296, 2089600, 0, 11876352, 1073741824, 1073741824, 1073741824, 1073741824, 2014720, 166272, 1073741824, 14592
.fill 8, 4, 0
.long 271504, 11639808, 263936, L_lanetab-L_back_pc_2+9216, 268416, 6144, 640, 1280, 5449728, 10584064, 25837568, 29212672, 319488, 2294400, 0, 11634688, 21600, 26165248, 26168320, 1073741824, 2334720, 182272, 284304, 15872
.fill 8, 4, 0
.long 271780, 11803648, 263936, L_lanetab-L_back_pc_2+3072, 268672, 5888, 640, 1280, 5454848, 10584064, 25863168, 29274112, 319488, 2335360, 1, 11798528, 656480, 28049408, 28052480, 1073741824, 2337280, 182400, 1073741824, 15616
.fill 8, 4, 0
.long 274304, 11721728, 263936, L_lanetab-L_back_pc_2+12288, 268928, 5888, 384, 1280, 5449728, 10584064, 25888768, 29335552, 319488, 2376320, 2, 11716608, 672, 29073408, 29134848, 29134848, 2339840, 182528, 1073741824, 15360
.fill 8, 4, 0
.long 1073741824, 11885568, 263936, L_lanetab-L_back_pc_2+3072, 269184, 5632, 0, 1280, 5454848, 10584064, 25914368, 29396992, 319488, 2417280, 0, 11880448, 1073741824, 1073741824, 1073741824, 1073741824, 2342400, 182656, 1073741824, 15104
.fill 8, 4, 0
.long 264576, 11608320, 262144, L_lanetab-L_back_pc_2+6144, 269440, 5632, 640, 1600, 3237888, 5939200, 25939968, 29458432, 262144, 800, 0, 11600896, 204800, 25453568, 25456640, 1073741824, 51200, 68096, 280724, 11264
.fill 8, 4, 0
.long 264616, 11772160, 262144, L_lanetab-L_back_pc_2+3072, 269696, 5376, 640, 1600, 3243008, 5939200, 25965568, 29519872, 262144, 41760, 1, 11764736, 696320, 26334208, 26337280, 1073741824, 53760, 68224, 1073741824, 11008
.fill 8, 4, 0
.long 274560, 11690240, 262144, L_lanetab-L_back_pc_2+12288, 269952, 5376, 384, 1600, 3237888, 5939200, 25991168, 29581312, 262144, 82720, 2, 11682816, 768, 29196288, 29257728, 29257728, 56320, 68352, 1073741824, 10752
.fill 8, 4, 0
.long 1073741824, 11854080, 262144, L_lanetab-L_back_pc_2+3072, 270208, 5120, 0, 1600, 3243008, 5939200, 26016768, 29642752, 262144, 123680, 0, 11846656, 1073741824, 1073741824, 1073741824, 1073741824, 58880, 68480, 1073741824, 10496
.fill 8, 4, 0
.long 265600, 11609344, 262400, L_lanetab-L_back_pc_2+6144, 269440, 5632, 640, 1600, 3565568, 6627328, 25939968, 29458432, 270336, 328480, 0, 11604992, 204960, 25555968, 25559040, 1073741824, 378880, 84480, 281236, 11776
.fill 8, 4, 0
.long 265640, 11773184, 262400, L_lanetab-L_back_pc_2+3072, 269696, 5376, 640, 1600, 3570688, 6627328, 25965568, 29519872, 270336, 369440, 1, 11768832, 696480, 26579968, 26583040, 1073741824, 381440, 84608, 1073741824, 11520
.fill 8, 4, 0
.long 274816, 11691264, 262400, L_lanetab-L_back_pc_2+12288, 269952, 5376, 384, 1600, 3565568, 6627328, 25991168, 29581312, 270336, 410400, 2, 11686912, 864, 29319168, 29380608, 29380608, 384000, 84736, 1073741824, 11264
.fill 8, 4, 0
.long 1073741824, 11855104, 262400, L_lanetab-L_back_pc_2+3072, 270208, 5120, 0, 1600, 3570688, 6627328, 26016768, 29642752, 270336, 451360, 0, 11850752, 1073741824, 1073741824, 1073741824, 1073741824, 386560, 84864, 1073741824, 11008
.fill 8, 4, 0
.long 266624, 11618560, 262656, L_lanetab-L_back_pc_2+6144, 269440, 5632, 640, 1600, 3893248, 7315456, 25939968, 29458432, 278528, 656160, 0, 11611136, 205120, 25658368, 25661440, 1073741824, 706560, 100864, 281748, 12288
.fill 8, 4, 0
.long 266664, 11782400, 262656, L_lanetab-L_back_pc_2+3072, 269696, 5376, 640, 1600, 3898368, 7315456, 25965568, 29519872, 278528, 697120, 1, 11774976, 696640, 26825728, 26828800, 1073741824, 709120, 100992, 1073741824, 12032
.fill 8, 4, 0
.long 275072, 11700480, 262656, L_lanetab-L_back_pc_2+12288, 269952, 5376, 384, 1600, 3893248, 7315456, 25991168, 29581312, 278528, 738080, 2, 11693056, 960, 29442048, 29503488, 29503488, 711680, 101120, 1073741824, 11776
.fill 8, 4, 0
.long 1073741824, 11864320, 262656, L_lanetab-L_back_pc_2+3072, 270208, 5120, 0, 1600, 3898368, 7315456, 26016768, 29642752, 278528, 779040, 0, 11856896, 1073741824, 1073741824, 1073741824, 1073741824, 714240, 101248, 1073741824, 11520
.fill 8, 4, 0
.long 267648, 11619584, 262912, L_lanetab-L_back_pc_2+6144, 269440, 5632, 640, 1600, 4220928, 8003584, 25939968, 29458432, 286720, 983840, 0, 11615232, 205280, 25760768, 25763840, 1073741824, 1034240, 117248, 282260, 12800
.fill 8, 4, 0
.long 267688, 11783424, 262912, L_lanetab-L_back_pc_2+3072, 269696, 5376, 640, 1600, 4226048, 8003584, 25965568, 29519872, 286720, 1024800, 1, 11779072, 696800, 27071488, 27074560, 1073741824, 1036800, 117376, 1073741824, 12544
.fill 8, 4, 0
.long 275328, 11701504, 262912, L_lanetab-L_back_pc_2+12288, 269952, 5376, 384, 1600, 4220928, 8003584, 25991168, 29581312, 286720, 1065760, 2, 11697152, 1056, 29564928, 29626368, 29626368, 1039360, 117504, 1073741824, 12288
.fill 8, 4, 0
.long 1073741824, 11865344, 262912, L_lanetab-L_back_pc_2+3072, 270208, 5120, 0, 1600, 4226048, 8003584, 26016768, 29642752, 286720, 1106720, 0, 11860992, 1073741824, 1073741824, 1073741824, 1073741824, 1041920, 117632, 1073741824, 12032
.fill 8, 4, 0
.long 268672, 11628800, 263168, L_lanetab-L_back_pc_2+6144, 269440, 5632, 640, 1600, 4548608, 8691712, 25939968, 29458432, 294912, 1311520, 0, 11621376, 205440, 25863168, 25866240, 1073741824, 1361920, 133632, 282772, 13312
.fill 8, 4, 0
.long 268712, 11792640, 263168, L_lanetab-L_back_pc_2+3072, 269696, 5376, 640, 1600, 4553728, 8691712, 25965568, 29519872, 294912, 1352480, 1, 11785216, 696960, 27317248, 27320320, 1073741824, 1364480, 133760, 1073741824, 13056
.fill 8, 4, 0
.long 275584, 11710720, 263168, L_lanetab-L_back_pc_2+12288, 269952, 5376, 384, 1600, 4548608, 8691712, 25991168, 29581312, 294912, 1393440, 2, 11703296, 1152, 29687808, 29749248, 29749248, 1367040, 133888, 1073741824, 12800
.fill 8, 4, 0
.long 1073741824, 11874560, 263168, L_lanetab-L_back_pc_2+3072, 270208, 5120, 0, 1600, 4553728, 8691712, 26016768, 29642752, 294912, 1434400, 0, 11867136, 1073741824, 1073741824, 1073741824, 1073741824, 1369600, 134016, 1073741824, 12544
.fill 8, 4, 0
.long 269696, 11629824, 263424, L_lanetab-L_back_pc_2+6144, 269440, 5632, 640, 1600, 4876288, 9379840, 25939968, 29458432, 303104, 1639200, 0, 11625472, 205600, 25965568, 25968640, 1073741824, 1689600, 150016, 283284, 13824
.fill 8, 4, 0
.long 269736, 11793664, 263424, L_lanetab-L_back_pc_2+3072, 269696, 5376, 640, 1600, 4881408, 9379840, 25965568, 29519872, 303104, 1680160, 1, 11789312, 697120, 27563008, 27566080, 1073741824, 1692160, 150144, 1073741824, 13568
.fill 8, 4, 0
.long 275840, 11711744, 263424, L_lanetab-L_back_pc_2+12288, 269952, 5376, 384, 1600, 4876288, 9379840, 25991168, 29581312, 303104, 1721120, 2, 11707392, 1248, 29810688, 29872128, 29872128, 1694720, 150272, 1073741824, 13312
.fill 8, 4, 0
.long 1073741824, 11875584, 263424, L_lanetab-L_back_pc_2+3072, 270208, 5120, 0, 1600, 4881408, 9379840, 26016768, 29642752, 303104, 1762080, 0, 11871232, 1073741824, 1073741824, 1073741824, 1073741824, 1697280, 150400, 1073741824, 13056
.fill 8, 4, 0
.long 270720, 11639040, 263680, L_lanetab-L_back_pc_2+6144, 269440, 5632, 640, 1600, 5203968, 10067968, 25939968, 29458432, 311296, 1966880, 0, 11631616, 205760, 26067968, 26071040, 1073741824, 2017280, 166400, 283796, 14336
.fill 8, 4, 0
.long 270760, 11802880, 263680, L_lanetab-L_back_pc_2+3072, 269696, 5376, 640, 1600, 5209088, 10067968, 25965568, 29519872, 311296, 2007840, 1, 11795456, 697280, 27808768, 27811840, 1073741824, 2019840, 166528, 1073741824, 14080
.fill 8, 4, 0
.long 276096, 11720960, 263680, L_lanetab-L_back_pc_2+12288, 269952, 5376, 384, 1600, 5203968, 10067968, 25991168, 29581312, 311296, 2048800, 2, 11713536, 1344, 29933568, 29995008, 29995008, 2022400, 166656, 1073741824, 13824
.fill 8, 4, 0
.long 1073741824, 11884800, 263680, L_lanetab-L_back_pc_2+3072, 270208, 5120, 0, 1600, 5209088, 10067968, 26016768, 29642752, 311296, 2089760, 0, 11877376, 1073741824, 1073741824, 1073741824, 1073741824, 2024960, 166784, 1073741824, 13568
.fill 8, 4, 0
.long 271744, 11640064, 263936, L_lanetab-L_back_pc_2+6144, 269440, 5632, 640, 1600, 5531648, 10756096, 25939968, 29458432, 319488, 2294560, 0, 11635712, 205920, 26170368, 26173440, 1073741824, 2344960, 182784, 284308, 14848
.fill 8, 4, 0
.long 271784, 11803904, 263936, L_lanetab-L_back_pc_2+3072, 269696, 5376, 640, 1600, 5536768, 10756096, 25965568, 29519872, 319488, 2335520, 1, 11799552, 697440, 28054528, 28057600, 1073741824, 2347520, 182912, 1073741824, 14592
.fill 8, 4, 0
.long 276352, 11721984, 263936, L_lanetab-L_back_pc_2+12288, 269952, 5376, 384, 1600, 5531648, 10756096, 25991168, 29581312, 319488, 2376480, 2, 11717632, 1440, 30056448, 30117888, 30117888, 2350080, 183040, 1073741824, 14336
.fill 8, 4, 0
.long 1073741824, 11885824, 263936, L_lanetab-L_back_pc_2+3072, 270208, 5120, 0, 1600, 5536768, 10756096, 26016768, 29642752, 319488, 2417440, 0, 11881472, 1073741824, 1073741824, 1073741824, 1073741824, 2352640, 183168, 1073741824, 14080
.fill 8, 4, 0
.long 264580, 11608576, 262144, L_lanetab-L_back_pc_2+6144, 270464, 5120, 640, 1920, 3319808, 6111232, 26042368, 29704192, 262144, 960, 0, 11601920, 256000, 25458688, 25461760, 1073741824, 61440, 68608, 280728, 10240
.fill 8, 4, 0
.long 264620, 11772416, 262144, L_lanetab-L_back_pc_2+3072, 270720, 4864, 640, 1920, 3324928, 6111232, 26067968, 29765632, 262144, 41920, 1, 11765760, 737280, 26339328, 26342400, 1073741824, 64000, 68736, 1073741824, 9984
.fill 8, 4, 0
.long 276608, 11690496, 262144, L_lanetab-L_back_pc_2+12288, 270976, 4864, 384, 1920, 3319808, 6111232, 26093568, 29827072, 262144, 82880, 2, 11683840, 1536, 30179328, 30240768, 30240768, 66560, 68864, 1073741824, 9728
.fill 8, 4, 0
.long 1073741824, 11854336, 262144, L_lanetab-L_back_pc_2+3072, 271232, 4608, 0, 1920, 3324928, 6111232, 26119168, 29888512, 262144, 123840, 0, 11847680, 1073741824, 1073741824, 1073741824, 1073741824, 69120, 68992, 1073741824, 9472
.fill 8, 4, 0
.long 265604, 11609600, 262400, L_lanetab-L_back_pc_2+6144, 270464, 5120, 640, 1920, 3647488, 6799360, 26042368, 29704192, 270336, 328640, 0, 11606016, 256160, 25561088, 25564160, 1073741824, 389120, 84992, 281240, 10752
.fill 8, 4, 0
.long 265644, 11773440, 262400, L_lanetab-L_back_pc_2+3072, 270720, 4864, 640, 1920, 3652608, 6799360, 26067968, 29765632, 270336, 369600, 1, 11769856, 737440, 26585088, 26588160, 1073741824, 391680, 85120, 1073741824, 10496
.fill 8, 4, 0
.long 276864, 11691520, 262400, L_lanetab-L_back_pc_2+12288, 270976, 4864, 384, 1920, 3647488, 6799360, 26093568, 29827072, 270336, 410560, 2, 11687936, 1632, 30302208, 30363648, 30363648, 394240, 85248, 1073741824, 10240
.fill 8, 4, 0
.long 1073741824, 11855360, 262400, L_lanetab-L_back_pc_2+3072, 271232, 4608, 0, 1920, 3652608, 6799360, 26119168, 29888512, 270336, 451520, 0, 11851776, 1073741824, 1073741824, 1073741824, 1073741824, 396800, 85376, 1073741824, 9984
.fill 8, 4, 0
.long 266628, 11618816, 262656, L_lanetab-L_back_pc_2+6144, 270464, 5120, 640, 1920, 3975168, 7487488, 26042368, 29704192, 278528, 656320, 0, 11612160, 256320, 25663488, 25666560, 1073741824, 716800, 101376, 281752, 11264
.fill 8, 4, 0
.long 266668, 11782656, 262656, L_lanetab-L_back_pc_2+3072, 270720, 4864, 640, 1920, 3980288, 7487488, 26067968, 29765632, 278528, 697280, 1, 11776000, 737600, 26830848, 26833920, 1073741824, 719360, 101504, 1073741824, 11008
.fill 8, 4, 0
.long 277120, 11700736, 262656, L_lanetab-L_back_pc_2+12288, 270976, 4864, 384, 1920, 3975168, 7487488, 26093568, 29827072, 278528, 738240, 2, 11694080, 1728, 30425088, 30486528, 30486528, 721920, 101632, 1073741824, 10752
.fill 8, 4, 0
.long 1073741824, 11864576, 262656, L_lanetab-L_back_pc_2+3072, 271232, 4608, 0, 1920, 3980288, 7487488, 26119168, 29888512, 278528, 779200, 0, 11857920, 1073741824, 1073741824, 1073741824, 1073741824, 724480, 101760, 1073741824, 10496
.fill 8, 4, 0
.long 267652, 11619840, 262912, L_lanetab-L_back_pc_2+6144, 270464, 5120, 640, 1920, 4302848, 8175616, 26042368, 29704192, 286720, 984000, 0, 11616256, 256480, 25765888, 25768960, 1073741824, 1044480, 117760, 282264, 11776
.fill 8, 4, 0
.long 267692, 11783680, 262912, L_lanetab-L_back_pc_2+3072, 270720, 4864, 640, 1920, 4307968, 8175616, 26067968, 29765632, 286720, 1024960, 1, 11780096, 737760, 27076608, 27079680, 1073741824, 1047040, 117888, 1073741824, 11520
.fill 8, 4, 0
.long 277376, 11701760, 262912, L_lanetab-L_back_pc_2+12288, 270976, 4864, 384, 1920, 4302848, 8175616, 26093568, 29827072, 286720, 1065920, 2, 11698176, 1824, 30547968, 30609408, 30609408, 1049600, 118016, 1073741824, 11264
.fill 8, 4, 0
.long 1073741824, 11865600, 262912, L_lanetab-L_back_pc_2+3072, 271232, 4608, 0, 1920, 4307968, 8175616, 26119168, 29888512, 286720, 1106880, 0, 11862016, 1073741824, 1073741824, 1073741824, 1073741824, 1052160, 118144, 1073741824, 11008
.fill 8, 4, 0
.long 268676, 11629056, 263168, L_lanetab-L_back_pc_2+6144, 270464, 5120, 640, 1920, 4630528, 8863744, 26042368, 29704192, 294912, 1311680, 0, 11622400, 256640, 25868288, 25871360, 1073741824, 1372160, 134144, 282776, 12288
.fill 8, 4, 0
.long 268716, 11792896, 263168, L_lanetab-L_back_pc_2+3072, 270720, 4864, 640, 1920, 4635648, 8863744, 26067968, 29765632, 294912, 1352640, 1, 11786240, 737920, 27322368, 27325440, 1073741824, 1374720, 134272, 1073741824, 12032
.fill 8, 4, 0
.long 277632, 11710976, 263168, L_lanetab-L_back_pc_2+12288, 270976, 4864, 384, 1920, 4630528, 8863744, 26093568, 29827072, 294912, 1393600, 2, 11704320, 1920, 30670848, 30732288, 30732288, 1377280, 134400, 1073741824, 11776
.fill 8, 4, 0
.long 1073741824, 11874816, 263168, L_lanetab-L_back_pc_2+3072, 271232, 4608, 0, 1920, 4635648, 8863744, 26119168, 29888512, 294912, 1434560, 0, 11868160, 1073741824, 1073741824, 1073741824, 1073741824, 1379840, 134528, 1073741824, 11520
.fill 8, 4, 0
.long 269700, 11630080, 263424, L_lanetab-L_back_pc_2+6144, 270464, 5120, 640, 1920, 4958208, 9551872, 26042368, 29704192, 303104, 1639360, 0, 11626496, 256800, 25970688, 25973760, 1073741824, 1699840, 150528, 283288, 12800
.fill 8, 4, 0
.long 269740, 11793920, 263424, L_lanetab-L_back_pc_2+3072, 270720, 4864, 640, 1920, 4963328, 9551872, 26067968, 29765632, 303104, 1680320, 1, 11790336, 738080, 27568128, 27571200, 1073741824, 1702400, 150656, 1073741824, 12544
.fill 8, 4, 0
.long 277888, 11712000, 263424, L_lanetab-L_back_pc_2+12288, 270976, 4864, 384, 1920, 4958208, 9551872, 26093568, 29827072, 303104, 1721280, 2, 11708416, 2016, 30793728, 30855168, 30855168, 1704960, 150784, 1073741824, 12288
.fill 8, 4, 0
.long 1073741824, 11875840, 263424, L_lanetab-L_back_pc_2+3072, 271232, 4608, 0, 1920, 4963328, 9551872, 26119168, 29888512, 303104, 1762240, 0, 11872256, 1073741824, 1073741824, 1073741824, 1073741824, 1707520, 150912, 1073741824, 12032
.fill 8, 4, 0
.long 270724, 11639296, 263680, L_lanetab-L_back_pc_2+6144, 270464, 5120, 640, 1920, 5285888, 10240000, 26042368, 29704192, 311296, 1967040, 0, 11632640, 256960, 26073088, 26076160, 1073741824, 2027520, 166912, 283800, 13312
.fill 8, 4, 0
.long 270764, 11803136, 263680, L_lanetab-L_back_pc_2+3072, 270720, 4864, 640, 1920, 5291008, 10240000, 26067968, 29765632, 311296, 2008000, 1, 11796480, 738240, 27813888, 27816960, 1073741824, 2030080, 167040, 1073741824, 13056
.fill 8, 4, 0
.long 278144, 11721216, 263680, L_lanetab-L_back_pc_2+12288, 270976, 4864, 384, 1920, 5285888, 10240000, 26093568, 29827072, 311296, 2048960, 2, 11714560, 2112, 30916608, 30978048, 30978048, 2032640, 167168, 1073741824, 12800
.fill 8, 4, 0
.long 1073741824, 11885056, 263680, L_lanetab-L_back_pc_2+3072, 271232, 4608, 0, 1920, 5291008, 10240000, 26119168, 29888512, 311296, 2089920, 0, 11878400, 1073741824, 1073741824, 1073741824, 1073741824, 2035200, 167296, 1073741824, 12544
.fill 8, 4, 0
.long 271748, 11640320, 263936, L_lanetab-L_back_pc_2+6144, 270464, 5120, 640, 1920, 5613568, 10928128, 26042368, 29704192, 319488, 2294720, 0, 11636736, 257120, 26175488, 26178560, 1073741824, 2355200, 183296, 284312, 13824
.fill 8, 4, 0
.long 271788, 11804160, 263936, L_lanetab-L_back_pc_2+3072, 270720, 4864, 640, 1920, 5618688, 10928128, 26067968, 29765632, 319488, 2335680, 1, 11800576, 738400, 28059648, 28062720, 1073741824, 2357760, 183424, 1073741824, 13568
.fill 8, 4, 0
.long 278400, 11722240, 263936, L_lanetab-L_back_pc_2+12288, 270976, 4864, 384, 1920, 5613568, 10928128, 26093568, 29827072, 319488, 2376640, 2, 11718656, 2208, 31039488, 31100928, 31100928, 2360320, 183552, 1073741824, 13312
.fill 8, 4, 0
.long 1073741824, 11886080, 263936, L_lanetab-L_back_pc_2+3072, 271232, 4608, 0, 1920, 5618688, 10928128, 26119168, 29888512, 319488, 2417600, 0, 11882496, 1073741824, 1073741824, 1073741824, 1073741824, 2362880, 183680, 1073741824, 13056
.fill 8, 4, 0
.long 264584, 11608832, 262144, L_lanetab-L_back_pc_2+6144, 271488, 4608, 640, 2240, 3401728, 6283264, 26144768, 29949952, 262144, 1120, 0, 11602944, 307200, 25463808, 25466880, 1073741824, 71680, 69120, 280732, 9216
.fill 8, 4, 0
.long 264624, 11772672, 262144, L_lanetab-L_back_pc_2+3072, 271744, 4352, 640, 2240, 3406848, 6283264, 26170368, 30011392, 262144, 42080, 1, 11766784, 778240, 26344448, 26347520, 1073741824, 74240, 69248, 1073741824, 8960
.fill 8, 4, 0
.long 278656, 11690752, 262144, L_lanetab-L_back_pc_2+12288, 272000, 4352, 384, 2240, 3401728, 6283264, 26195968, 30072832, 262144, 83040, 2, 11684864, 2304, 31162368, 31223808, 31223808, 76800, 69376, 1073741824, 8704
.fill 8, 4, 0
.long 1073741824, 11854592, 262144, L_lanetab-L_back_pc_2+3072, 272256, 4096, 0, 2240, 3406848, 6283264, 26221568, 30134272, 262144, 124000, 0, 11848704, 1073741824, 1073741824, 1073741824, 1073741824, 79360, 69504, 1073741824, 8448
.fill 8, 4, 0
.long 265608, 11609856, 262400, L_lanetab-L_back_pc_2+6144, 271488, 4608, 640, 2240, 3729408, 6971392, 26144768, 29949952, 270336, 328800, 0, 11607040, 307360, 25566208, 25569280, 1073741824, 399360, 85504, 281244, 9728
.fill 8, 4, 0
.long 265648, 11773696, 262400, L_lanetab-L_back_pc_2+3072, 271744, 4352, 640, 2240, 3734528, 6971392, 26170368, 30011392, 270336, 369760, 1, 11770880, 778400, 26590208, 26593280, 1073741824, 401920, 85632, 1073741824, 9472
.fill 8, 4, 0
.long 278912, 11691776, 262400, L_lanetab-L_back_pc_2+12288, 272000, 4352, 384, 2240, 3729408, 6971392, 26195968, 30072832, 270336, 410720, 2, 11688960, 2400, 31285248, 31346688, 31346688, 404480, 85760, 1073741824, 9216
.fill 8, 4, 0
.long 1073741824, 11855616, 262400, L_lanetab-L_back_pc_2+3072, 272256, 4096, 0, 2240, 3734528, 6971392, 26221568, 30134272, 270336, 451680, 0, 11852800, 1073741824, 1073741824, 1073741824, 1073741824, 407040, 85888, 1073741824, 8960
.fill 8, 4, 0
.long 266632, 11619072, 262656, L_lanetab-L_back_pc_2+6144, 271488, 4608, 640, 2240, 4057088, 7659520, 26144768, 29949952, 278528, 656480, 0, 11613184, 307520, 25668608, 25671680, 1073741824, 727040, 101888, 281756, 10240
.fill 8, 4, 0
.long 266672, 11782912, 262656, L_lanetab-L_back_pc_2+3072, 271744, 4352, 640, 2240, 4062208, 7659520, 26170368, 30011392, 278528, 697440, 1, 11777024, 778560, 26835968, 26839040, 1073741824, 729600, 102016, 1073741824, 9984
.fill 8, 4, 0
.long 279168, 11700992, 262656, L_lanetab-L_back_pc_2+12288, 272000, 4352, 384, 2240, 4057088, 7659520, 26195968, 30072832, 278528, 738400, 2, 11695104, 2496, 31408128, 31469568, 31469568, 732160, 102144, 1073741824, 9728
.fill 8, 4, 0
.long 1073741824, 11864832, 262656, L_lanetab-L_back_pc_2+3072, 272256, 4096, 0, 2240, 4062208, 7659520, 26221568, 30134272, 278528, 779360, 0, 11858944, 1073741824, 1073741824, 1073741824, 1073741824, 734720, 102272, 1073741824, 9472
.fill 8, 4, 0
.long 267656, 11620096, 262912, L_lanetab-L_back_pc_2+6144, 271488, 4608, 640, 2240, 4384768, 8347648, 26144768, 29949952, 286720, 984160, 0, 11617280, 307680, 25771008, 25774080, 1073741824, 1054720, 118272, 282268, 10752
.fill 8, 4, 0
.long 267696, 11783936, 262912, L_lanetab-L_back_pc_2+3072, 271744, 4352, 640, 2240, 4389888, 8347648, 26170368, 30011392, 286720, 1025120, 1, 11781120, 778720, 27081728, 27084800, 1073741824, 1057280, 118400, 1073741824, 10496
.fill 8, 4, 0
.long 279424, 11702016, 262912, L_lanetab-L_back_pc_2+12288, 272000, 4352, 384, 2240, 4384768, 8347648, 26195968, 30072832, 286720, 1066080, 2, 11699200, 2592, 31531008, 31592448, 31592448, 1059840, 118528, 1073741824, 10240
.fill 8, 4, 0
.long 1073741824, 11865856, 262912, L_lanetab-L_back_pc_2+3072, 272256, 4096, 0, 2240, 4389888, 8347648, 26221568, 30134272, 286720, 1107040, 0, 11863040, 1073741824, 1073741824, 1073741824, 1073741824, 1062400, 118656, 1073741824, 9984
.fill 8, 4, 0
.long 268680, 11629312, 263168, L_lanetab-L_back_pc_2+6144, 271488, 4608, 640, 2240, 4712448, 9035776, 26144768, 29949952, 294912, 1311840, 0, 11623424, 307840, 25873408, 25876480, 1073741824, 1382400, 134656, 282780, 11264
.fill 8, 4, 0
.long 268720, 11793152, 263168, L_lanetab-L_back_pc_2+3072, 271744, 4352, 640, 2240, 4717568, 9035776, 26170368, 30011392, 294912, 1352800, 1, 11787264, 778880, 27327488, 27330560, 1073741824, 1384960, 134784, 1073741824, 11008
.fill 8, 4, 0
.long 279680, 11711232, 263168, L_lanetab-L_back_pc_2+12288, 272000, 4352, 384, 2240, 4712448, 9035776, 26195968, 30072832, 294912, 1393760, 2, 11705344, 2688, 31653888, 31715328, 31715328, 1387520, 134912, 1073741824, 10752
.fill 8, 4, 0
.long 1073741824, 11875072, 263168, L_lanetab-L_back_pc_2+3072, 272256, 4096, 0, 2240, 4717568, 9035776, 26221568, 30134272, 294912, 1434720, 0, 11869184, 1073741824, 1073741824, 1073741824, 1073741824, 1390080, 135040, 1073741824, 10496
.fill 8, 4, 0
.long 269704, 11630336, 263424, L_lanetab-L_back_pc_2+6144, 271488, 4608, 640, 2240, 5040128, 9723904, 26144768, 29949952, 303104, 1639520, 0, 11627520, 308000, 25975808, 25978880, 1073741824, 1710080, 151040, 283292, 11776
.fill 8, 4, 0
.long 269744, 11794176, 263424, L_lanetab-L_back_pc_2+3072, 271744, 4352, 640, 2240, 5045248, 9723904, 26170368, 30011392, 303104, 1680480, 1, 11791360, 779040, 27573248, 27576320, 1073741824, 1712640, 151168, 1073741824, 11520
.fill 8, 4, 0
.long 279936, 11712256, 263424, L_lanetab-L_back_pc_2+12288, 272000, 4352, 384, 2240, 5040128, 9723904, 26195968, 30072832, 303104, 1721440, 2, 11709440, 2784, 31776768, 31838208, 31838208, 1715200, 151296, 1073741824, 11264
.fill 8, 4, 0
.long 1073741824, 11876096, 263424, L_lanetab-L_back_pc_2+3072, 272256, 4096, 0, 2240, 5045248, 9723904, 26221568, 30134272, 303104, 1762400, 0, 11873280, 1073741824, 1073741824, 1073741824, 1073741824, 1717760, 151424, 1073741824, 11008
.fill 8, 4, 0
.long 270728, 11639552, 263680, L_lanetab-L_back_pc_2+6144, 271488, 4608, 640, 2240, 5367808, 10412032, 26144768, 29949952, 311296, 1967200, 0, 11633664, 308160, 26078208, 26081280, 1073741824, 2037760, 167424, 283804, 12288
.fill 8, 4, 0
.long 270768, 11803392, 263680, L_lanetab-L_back_pc_2+3072, 271744, 4352, 640, 2240, 5372928, 10412032, 26170368, 30011392, 311296, 2008160, 1, 11797504, 779200, 27819008, 27822080, 1073741824, 2040320, 167552, 1073741824, 12032
.fill 8, 4, 0
.long 280192, 11721472, 263680, L_lanetab-L_back_pc_2+12288, 272000, 4352, 384, 2240, 5367808, 10412032, 26195968, 30072832, 311296, 2049120, 2, 11715584, 2880, 31899648, 31961088, 31961088, 2042880, 167680, 1073741824, 11776
.fill 8, 4, 0
.long 1073741824, 11885312, 263680, L_lanetab-L_back_pc_2+3072, 272256, 4096, 0, 2240, 5372928, 10412032, 26221568, 30134272, 311296, 2090080, 0, 11879424, 1073741824, 1073741824, 1073741824, 1073741824, 2045440, 167808, 1073741824, 11520
.fill 8, 4, 0
.long 271752, 11640576, 263936, L_lanetab-L_back_pc_2+6144, 271488, 4608, 640, 2240, 5695488, 11100160, 26144768, 29949952, 319488, 2294880, 0, 11637760, 308320, 26180608, 26183680, 1073741824, 2365440, 183808, 284316, 12800
.fill 8, 4, 0
.long 271792, 11804416, 263936, L_lanetab-L_back_pc_2+3072, 271744, 4352, 640, 2240, 5700608, 11100160, 26170368, 30011392, 319488, 2335840, 1, 11801600, 779360, 28064768, 28067840, 1073741824, 2368000, 183936, 1073741824, 12544
.fill 8, 4, 0
.long 280448, 11722496, 263936, L_lanetab-L_back_pc_2+12288, 272000, 4352, 384, 2240, 5695488, 11100160, 26195968, 30072832, 319488, 2376800, 2, 11719680, 2976, 32022528, 32083968, 32083968, 2370560, 184064, 1073741824, 12288
.fill 8, 4, 0
.long 1073741824, 11886336, 263936, L_lanetab-L_back_pc_2+3072, 272256, 4096, 0, 2240, 5700608, 11100160, 26221568, 30134272, 319488, 2417760, 0, 11883520, 1073741824, 1073741824, 1073741824, 1073741824, 2373120, 184192, 1073741824, 12032
.fill 8, 4, 0
.long 264588, 11935744, 262144, L_lanetab-L_back_pc_2+6144, 264320, 12288, 640, 0, 3166208, 5767168, 25427968, 30195712, 262144, 20480, 0, 11927552, 358400, 25468928, 25472000, 1073741824, 81920, 69632, 280736, 16384
.fill 8, 4, 0
.long 264628, 12099584, 262144, L_lanetab-L_back_pc_2+3072, 264576, 12032, 640, 0, 3171328, 5767168, 25453568, 30257152, 262144, 61440, 1, 12091392, 819200, 26349568, 26352640, 1073741824, 84480, 69760, 1073741824, 16128
.fill 8, 4, 0
.long 272516, 12017664, 262144, L_lanetab-L_back_pc_2+12288, 264832, 12032, 384, 0, 3166208, 5767168, 25479168, 30318592, 262144, 102400, 2, 12009472, 98304, 28216320, 28277760, 28277760, 87040, 69888, 1073741824, 15872
.fill 8, 4, 0
.long 1073741824, 12181504, 262144, L_lanetab-L_back_pc_2+3072, 265088, 11776, 0, 0, 3171328, 5767168, 25504768, 30380032, 262144, 143360, 0, 12173312, 1073741824, 1073741824, 1073741824, 1073741824, 89600, 70016, 1073741824, 15616
.fill 8, 4, 0
.long 265612, 11936768, 262400, L_lanetab-L_back_pc_2+6144, 264320, 12288, 640, 0, 3493888, 6455296, 25427968, 30195712, 270336, 348160, 0, 11931648, 358560, 25571328, 25574400, 1073741824, 409600, 86016, 281248, 16896
.fill 8, 4, 0
.long 265652, 12100608, 262400, L_lanetab-L_back_pc_2+3072, 264576, 12032, 640, 0, 3499008, 6455296, 25453568, 30257152, 270336, 389120, 1, 12095488, 819360, 26595328, 26598400, 1073741824, 412160, 86144, 1073741824, 16640
.fill 8, 4, 0
.long 272772, 12018688, 262400, L_lanetab-L_back_pc_2+12288, 264832, 12032, 384, 0, 3493888, 6455296, 25479168, 30318592, 270336, 430080, 2, 12013568, 98400, 28339200, 28400640, 28400640, 414720, 86272, 1073741824, 16384
.fill 8, 4, 0
.long 1073741824, 12182528, 262400, L_lanetab-L_back_pc_2+3072, 265088, 11776, 0, 0, 3499008, 6455296, 25504768, 30380032, 270336, 471040, 0, 12177408, 1073741824, 1073741824, 1073741824, 1073741824, 417280, 86400, 1073741824, 16128
.fill 8, 4, 0
.long 266636, 11945984, 262656, L_lanetab-L_back_pc_2+6144, 264320, 12288, 640, 0, 3821568, 7143424, 25427968, 30195712, 278528, 675840, 0, 11937792, 358720, 25673728, 25676800, 1073741824, 737280, 102400, 281760, 17408
.fill 8, 4, 0
.long 266676, 12109824, 262656, L_lanetab-L_back_pc_2+3072, 264576, 12032, 640, 0, 3826688, 7143424, 25453568, 30257152, 278528, 716800, 1, 12101632, 819520, 26841088, 26844160, 1073741824, 739840, 102528, 1073741824, 17152
.fill 8, 4, 0
.long 273028, 12027904, 262656, L_lanetab-L_back_pc_2+12288, 264832, 12032, 384, 0, 3821568, 7143424, 25479168, 30318592, 278528, 757760, 2, 12019712, 98496, 28462080, 28523520, 28523520, 742400, 102656, 1073741824, 16896
.fill 8, 4, 0
.long 1073741824, 12191744, 262656, L_lanetab-L_back_pc_2+3072, 265088, 11776, 0, 0, 3826688, 7143424, 25504768, 30380032, 278528, 798720, 0, 12183552, 1073741824, 1073741824, 1073741824, 1073741824, 744960, 102784, 1073741824, 16640
.fill 8, 4, 0
.long 267660, 11947008, 262912, L_lanetab-L_back_pc_2+6144, 264320, 12288, 640, 0, 4149248, 7831552, 25427968, 30195712, 286720, 1003520, 0, 11941888, 358880, 25776128, 25779200, 1073741824, 1064960, 118784, 282272, 17920
.fill 8, 4, 0
.long 267700, 12110848, 262912, L_lanetab-L_back_pc_2+3072, 264576, 12032, 640, 0, 4154368, 7831552, 25453568, 30257152, 286720, 1044480, 1, 12105728, 819680, 27086848, 27089920, 1073741824, 1067520, 118912, 1073741824, 17664
.fill 8, 4, 0
.long 273284, 12028928, 262912, L_lanetab-L_back_pc_2+12288, 264832, 12032, 384, 0, 4149248, 7831552, 25479168, 30318592, 286720, 1085440, 2, 12023808, 98592, 28584960, 28646400, 28646400, 1070080, 119040, 1073741824, 17408
.fill 8, 4, 0
.long 1073741824, 12192768, 262912, L_lanetab-L_back_pc_2+3072, 265088, 11776, 0, 0, 4154368, 7831552, 25504768, 30380032, 286720, 1126400, 0, 12187648, 1073741824, 1073741824, 1073741824, 1073741824, 1072640, 119168, 1073741824, 17152
.fill 8, 4, 0
.long 268684, 11956224, 263168, L_lanetab-L_back_pc_2+6144, 264320, 12288, 640, 0, 4476928, 8519680, 25427968, 30195712, 294912, 1331200, 0, 11948032, 359040, 25878528, 25881600, 1073741824, 1392640, 135168, 282784, 18432
.fill 8, 4, 0
.long 268724, 12120064, 263168, L_lanetab-L_back_pc_2+3072, 264576, 12032, 640, 0, 4482048, 8519680, 25453568, 30257152, 294912, 1372160, 1, 12111872, 819840, 27332608, 27335680, 1073741824, 1395200, 135296, 1073741824, 18176
.fill 8, 4, 0
.long 273540, 12038144, 263168, L_lanetab-L_back_pc_2+12288, 264832, 12032, 384, 0, 4476928, 8519680, 25479168, 30318592, 294912, 1413120, 2, 12029952, 98688, 28707840, 28769280, 28769280, 1397760, 135424, 1073741824, 17920
.fill 8, 4, 0
.long 1073741824, 12201984, 263168, L_lanetab-L_back_pc_2+3072, 265088, 11776, 0, 0, 4482048, 8519680, 25504768, 30380032, 294912, 1454080, 0, 12193792, 1073741824, 1073741824, 1073741824, 1073741824, 1400320, 135552, 1073741824, 17664
.fill 8, 4, 0
.long 269708, 11957248, 263424, L_lanetab-L_back_pc_2+6144, 264320, 12288, 640, 0, 4804608, 9207808, 25427968, 30195712, 303104, 1658880, 0, 11952128, 359200, 25980928, 25984000, 1073741824, 1720320, 151552, 283296, 18944
.fill 8, 4, 0
.long 269748, 12121088, 263424, L_lanetab-L_back_pc_2+3072, 264576, 12032, 640, 0, 4809728, 9207808, 25453568, 30257152, 303104, 1699840, 1, 12115968, 820000, 27578368, 27581440, 1073741824, 1722880, 151680, 1073741824, 18688
.fill 8, 4, 0
.long 273796, 12039168, 263424, L_lanetab-L_back_pc_2+12288, 264832, 12032, 384, 0, 4804608, 9207808, 25479168, 30318592, 303104, 1740800, 2, 12034048, 98784, 28830720, 28892160, 28892160, 1725440, 151808, 1073741824, 18432
.fill 8, 4, 0
.long 1073741824, 12203008, 263424, L_lanetab-L_back_pc_2+3072, 265088, 11776, 0, 0, 4809728, 9207808, 25504768, 30380032, 303104, 1781760, 0, 12197888, 1073741824, 1073741824, 1073741824, 1073741824, 1728000, 151936, 1073741824, 18176
.fill 8, 4, 0
.long 270732, 11966464, 263680, L_lanetab-L_back_pc_2+6144, 264320, 12288, 640, 0, 5132288, 9895936, 25427968, 30195712, 311296, 1986560, 0, 11958272, 359360, 26083328, 26086400, 1073741824, 2048000, 167936, 283808, 19456
.fill 8, 4, 0
.long 270772, 12130304, 263680, L_lanetab-L_back_pc_2+3072, 264576, 12032, 640, 0, 5137408, 9895936, 25453568, 30257152, 311296, 2027520, 1, 12122112, 820160, 27824128, 27827200, 1073741824, 2050560, 168064, 1073741824, 19200
.fill 8, 4, 0
.long 274052, 12048384, 263680, L_lanetab-L_back_pc_2+12288, 264832, 12032, 384, 0, 5132288, 9895936, 25479168, 30318592, 311296, 2068480, 2, 12040192, 98880, 28953600, 29015040, 29015040, 2053120, 168192, 1073741824, 18944
.fill 8, 4, 0
.long 1073741824, 12212224, 263680, L_lanetab-L_back_pc_2+3072, 265088, 11776, 0, 0, 5137408, 9895936, 25504768, 30380032, 311296, 2109440, 0, 12204032, 1073741824, 1073741824, 1073741824, 1073741824, 2055680, 168320, 1073741824, 18688
.fill 8, 4, 0
.long 271756, 11967488, 263936, L_lanetab-L_back_pc_2+6144, 264320, 12288, 640, 0, 5459968, 10584064, 25427968, 30195712, 319488, 2314240, 0, 11962368, 359520, 26185728, 26188800, 1073741824, 2375680, 184320, 284320, 19968
.fill 8, 4, 0
.long 271796, 12131328, 263936, L_lanetab-L_back_pc_2+3072, 264576, 12032, 640, 0, 5465088, 10584064, 25453568, 30257152, 319488, 2355200, 1, 12126208, 820320, 28069888, 28072960, 1073741824, 2378240, 184448, 1073741824, 19712
.fill 8, 4, 0
.long 274308, 12049408, 263936, L_lanetab-L_back_pc_2+12288, 264832, 12032, 384, 0, 5459968, 10584064, 25479168, 30318592, 319488, 2396160, 2, 12044288, 98976, 29076480, 29137920, 29137920, 2380800, 184576, 1073741824, 19456
.fill 8, 4, 0
.long 1073741824, 12213248, 263936, L_lanetab-L_back_pc_2+3072, 265088, 11776, 0, 0, 5465088, 10584064, 25504768, 30380032, 319488, 2437120, 0, 12208128, 1073741824, 1073741824, 1073741824, 1073741824, 2383360, 184704, 1073741824, 19200
.fill 8, 4, 0
.long 264592, 11936000, 262144, L_lanetab-L_back_pc_2+9216, 265344, 11776, 640, 320, 3248128, 5939200, 25530368, 30441472, 262144, 20640, 0, 11928576, 225280, 25474048, 25477120, 1073741824, 92160, 70144, 280740, 15360
.fill 8, 4, 0
.long 264632, 12099840, 262144, L_lanetab-L_back_pc_2+3072, 265600, 11520, 640, 320, 3253248, 5939200, 25555968, 30502912, 262144, 61600, 1, 12092416, 860160, 26354688, 26357760, 1073741824, 94720, 70272, 1073741824, 15104
.fill 8, 4, 0
.long 274564, 12017920, 262144, L_lanetab-L_back_pc_2+12288, 265856, 11520, 384, 320, 3248128, 5939200, 25581568, 30564352, 262144, 102560, 2, 12010496, 99072, 29199360, 29260800, 29260800, 97280, 70400, 1073741824, 14848
.fill 8, 4, 0
.long 1073741824, 12181760, 262144, L_lanetab-L_back_pc_2+3072, 266112, 11264, 0, 320, 3253248, 5939200, 25607168, 30625792, 262144, 143520, 0, 12174336, 1073741824, 1073741824, 1073741824, 1073741824, 99840, 70528, 1073741824, 14592
.fill 8, 4, 0
.long 265616, 11937024, 262400, L_lanetab-L_back_pc_2+9216, 265344, 11776, 640, 320, 3575808, 6627328, 25530368, 30441472, 270336, 348320, 0, 11932672, 225440, 25576448, 25579520, 1073741824, 419840, 86528, 281252, 15872
.fill 8, 4, 0
.long 265656, 12100864, 262400, L_lanetab-L_back_pc_2+3072, 265600, 11520, 640, 320, 3580928, 6627328, 25555968, 30502912, 270336, 389280, 1, 12096512, 860320, 26600448, 26603520, 1073741824, 422400, 86656, 1073741824, 15616
.fill 8, 4, 0
.long 274820, 12018944, 262400, L_lanetab-L_back_pc_2+12288, 265856, 11520, 384, 320, 3575808, 6627328, 25581568, 30564352, 270336, 430240, 2, 12014592, 99168, 29322240, 29383680, 29383680, 424960, 86784, 1073741824, 15360
.fill 8, 4, 0
.long 1073741824, 12182784, 262400, L_lanetab-L_back_pc_2+3072, 266112, 11264, 0, 320, 3580928, 6627328, 25607168, 30625792, 270336, 471200, 0, 12178432, 1073741824, 1073741824, 1073741824, 1073741824, 427520, 86912, 1073741824, 15104
.fill 8, 4, 0
.long 266640, 11946240, 262656, L_lanetab-L_back_pc_2+9216, 265344, 11776, 640, 320, 3903488, 7315456, 25530368, 30441472, 278528, 676000, 0, 11938816, 225600, 25678848, 25681920, 1073741824, 747520, 102912, 281764, 16384
.fill 8, 4, 0
.long 266680, 12110080, 262656, L_lanetab-L_back_pc_2+3072, 265600, 11520, 640, 320, 3908608, 7315456, 25555968, 30502912, 278528, 716960, 1, 12102656, 860480, 26846208, 26849280, 1073741824, 750080, 103040, 1073741824, 16128
.fill 8, 4, 0
.long 275076, 12028160, 262656, L_lanetab-L_back_pc_2+12288, 265856, 11520, 384, 320, 3903488, 7315456, 25581568, 30564352, 278528, 757920, 2, 12020736, 99264, 29445120, 29506560, 29506560, 752640, 103168, 1073741824, 15872
.fill 8, 4, 0
.long 1073741824, 12192000, 262656, L_lanetab-L_back_pc_2+3072, 266112, 11264, 0, 320, 3908608, 7315456, 25607168, 30625792, 278528, 798880, 0, 12184576, 1073741824, 1073741824, 1073741824, 1073741824, 755200, 103296, 1073741824, 15616
.fill 8, 4, 0
.long 267664, 11947264, 262912, L_lanetab-L_back_pc_2+9216, 265344, 11776, 640, 320, 4231168, 8003584, 25530368, 30441472, 286720, 1003680, 0, 11942912, 225760, 25781248, 25784320, 1073741824, 1075200, 119296, 282276, 16896
.fill 8, 4, 0
.long 267704, 12111104, 262912, L_lanetab-L_back_pc_2+3072, 265600, 11520, 640, 320, 4236288, 8003584, 25555968, 30502912, 286720, 1044640, 1, 12106752, 860640, 27091968, 27095040, 1073741824, 1077760, 119424, 1073741824, 16640
.fill 8, 4, 0
.long 275332, 12029184, 262912, L_lanetab-L_back_pc_2+12288, 265856, 11520, 384, 320, 4231168, 8003584, 25581568, 30564352, 286720, 1085600, 2, 12024832, 99360, 29568000, 29629440, 29629440, 1080320, 119552, 1073741824, 16384
.fill 8, 4, 0
.long 1073741824, 12193024, 262912, L_lanetab-L_back_pc_2+3072, 266112, 11264, 0, 320, 4236288, 8003584, 25607168, 30625792, 286720, 1126560, 0, 12188672, 1073741824, 1073741824, 1073741824, 1073741824, 1082880, 119680, 1073741824, 16128
.fill 8, 4, 0
.long 268688, 11956480, 263168, L_lanetab-L_back_pc_2+9216, 265344, 11776, 640, 320, 4558848, 8691712, 25530368, 30441472, 294912, 1331360, 0, 11949056, 225920, 25883648, 25886720, 1073741824, 1402880, 135680, 282788, 17408
.fill 8, 4, 0
.long 268728, 12120320, 263168, L_lanetab-L_back_pc_2+3072, 265600, 11520, 640, 320, 4563968, 8691712, 25555968, 30502912, 294912, 1372320, 1, 12112896, 860800, 27337728, 27340800, 1073741824, 1405440, 135808, 1073741824, 17152
.fill 8, 4, 0
.long 275588, 12038400, 263168, L_lanetab-L_back_pc_2+12288, 265856, 11520, 384, 320, 4558848, 8691712, 25581568, 30564352, 294912, 1413280, 2, 12030976, 99456, 29690880, 29752320, 29752320, 1408000, 135936, 1073741824, 16896
.fill 8, 4, 0
.long 1073741824, 12202240, 263168, L_lanetab-L_back_pc_2+3072, 266112, 11264, 0, 320, 4563968, 8691712, 25607168, 30625792, 294912, 1454240, 0, 12194816, 1073741824, 1073741824, 1073741824, 1073741824, 1410560, 136064, 1073741824, 16640
.fill 8, 4, 0
.long 269712, 11957504, 263424, L_lanetab-L_back_pc_2+9216, 265344, 11776, 640, 320, 4886528, 9379840, 25530368, 30441472, 303104, 1659040, 0, 11953152, 226080, 25986048, 25989120, 1073741824, 1730560, 152064, 283300, 17920
.fill 8, 4, 0
.long 269752, 12121344, 263424, L_lanetab-L_back_pc_2+3072, 265600, 11520, 640, 320, 4891648, 9379840, 25555968, 30502912, 303104, 1700000, 1, 12116992, 860960, 27583488, 27586560, 1073741824, 1733120, 152192, 1073741824, 17664
.fill 8, 4, 0
.long 275844, 12039424, 263424, L_lanetab-L_back_pc_2+12288, 265856, 11520, 384, 320, 4886528, 9379840, 25581568, 30564352, 303104, 1740960, 2, 12035072, 99552, 29813760, 29875200, 29875200, 1735680, 152320, 1073741824, 17408
.fill 8, 4, 0
.long 1073741824, 12203264, 263424, L_lanetab-L_back_pc_2+3072, 266112, 11264, 0, 320, 4891648, 9379840, 25607168, 30625792, 303104, 1781920, 0, 12198912, 1073741824, 1073741824, 1073741824, 1073741824, 1738240, 152448, 1073741824, 17152
.fill 8, 4, 0
.long 270736, 11966720, 263680, L_lanetab-L_back_pc_2+9216, 265344, 11776, 640, 320, 5214208, 10067968, 25530368, 30441472, 311296, 1986720, 0, 11959296, 226240, 26088448, 26091520, 1073741824, 2058240, 168448, 283812, 18432
.fill 8, 4, 0
.long 270776, 12130560, 263680, L_lanetab-L_back_pc_2+3072, 265600, 11520, 640, 320, 5219328, 10067968, 25555968, 30502912, 311296, 2027680, 1, 12123136, 861120, 27829248, 27832320, 1073741824, 2060800, 168576, 1073741824, 18176
.fill 8, 4, 0
.long 276100, 12048640, 263680, L_lanetab-L_back_pc_2+12288, 265856, 11520, 384, 320, 5214208, 10067968, 25581568, 30564352, 311296, 2068640, 2, 12041216, 99648, 29936640, 29998080, 29998080, 2063360, 168704, 1073741824, 17920
.fill 8, 4, 0
.long 1073741824, 12212480, 263680, L_lanetab-L_back_pc_2+3072, 266112, 11264, 0, 320, 5219328, 10067968, 25607168, 30625792, 311296, 2109600, 0, 12205056, 1073741824, 1073741824, 1073741824, 1073741824, 2065920, 168832, 1073741824, 17664
.fill 8, 4, 0
.long 271760, 11967744, 263936, L_lanetab-L_back_pc_2+9216, 265344, 11776, 640, 320, 5541888, 10756096, 25530368, 30441472, 319488, 2314400, 0, 11963392, 226400, 26190848, 26193920, 1073741824, 2385920, 184832, 284324, 18944
.fill 8, 4, 0
.long 271800, 12131584, 263936, L_lanetab-L_back_pc_2+3072, 265600, 11520, 640, 320, 5547008, 10756096, 25555968, 30502912, 319488, 2355360, 1, 12127232, 861280, 28075008, 28078080, 1073741824, 2388480, 184960, 1073741824, 18688
.fill 8, 4, 0
.long 276356, 12049664, 263936, L_lanetab-L_back_pc_2+12288, 265856, 11520, 384, 320, 5541888, 10756096, 25581568, 30564352, 319488, 2396320, 2, 12045312, 99744, 30059520, 30120960, 30120960, 2391040, 185088, 1073741824, 18432
.fill 8, 4, 0
.long 1073741824, 12213504, 263936, L_lanetab-L_back_pc_2+3072, 266112, 11264, 0, 320, 5547008, 10756096, 25607168, 30625792, 319488, 2437280, 0, 12209152, 1073741824, 1073741824, 1073741824, 1073741824, 2393600, 185216, 1073741824, 18176
.fill 8, 4, 0
.long 264832, 11936256, 262144, L_lanetab-L_back_pc_2+6144, 266368, 11264, 640, 640, 3330048, 6111232, 25632768, 30687232, 262144, 20800, 0, 11929600, 409600, 25479168, 25482240, 1073741824, 102400, 70656, 280744, 14336
.fill 8, 4, 0
.long 264636, 12100096, 262144, L_lanetab-L_back_pc_2+3072, 266624, 11008, 640, 640, 3335168, 6111232, 25658368, 30748672, 262144, 61760, 1, 12093440, 901120, 26359808, 26362880, 1073741824, 104960, 70784, 1073741824, 14080
.fill 8, 4, 0
.long 276612, 12018176, 262144, L_lanetab-L_back_pc_2+12288, 266880, 11008, 384, 640, 3330048, 6111232, 25683968, 30810112, 262144, 102720, 2, 12011520, 99840, 30182400, 30243840, 30243840, 107520, 70912, 1073741824, 13824
.fill 8, 4, 0
.long 1073741824, 12182016, 262144, L_lanetab-L_back_pc_2+3072, 267136, 10752, 0, 640, 3335168, 6111232, 25709568, 30871552, 262144, 143680, 0, 12175360, 1073741824, 1073741824, 1073741824, 1073741824, 110080, 71040, 1073741824, 13568
.fill 8, 4, 0
.long 265856, 11937280, 262400, L_lanetab-L_back_pc_2+6144, 266368, 11264, 640, 640, 3657728, 6799360, 25632768, 30687232, 270336, 348480, 0, 11933696, 409760, 25581568, 25584640, 1073741824, 430080, 87040, 281256, 14848
.fill 8, 4, 0
.long 265660, 12101120, 262400, L_lanetab-L_back_pc_2+3072, 266624, 11008, 640, 640, 3662848, 6799360, 25658368, 30748672, 270336, 389440, 1, 12097536, 901280, 26605568, 26608640, 1073741824, 432640, 87168, 1073741824, 14592
.fill 8, 4, 0
.long 276868, 12019200, 262400, L_lanetab-L_back_pc_2+12288, 266880, 11008, 384, 640, 3657728, 6799360, 25683968, 30810112, 270336, 430400, 2, 12015616, 99936, 30305280, 30366720, 30366720, 435200, 87296, 1073741824, 14336
.fill 8, 4, 0
.long 1073741824, 12183040, 262400, L_lanetab-L_back_pc_2+3072, 267136, 10752, 0, 640, 3662848, 6799360, 25709568, 30871552, 270336, 471360, 0, 12179456, 1073741824, 1073741824, 1073741824, 1073741824, 437760, 87424, 1073741824, 14080
.fill 8, 4, 0
.long 266880, 11946496, 262656, L_lanetab-L_back_pc_2+6144, 266368, 11264, 640, 640, 3985408, 7487488, 25632768, 30687232, 278528, 676160, 0, 11939840, 409920, 25683968, 25687040, 1073741824, 757760, 103424, 281768, 15360
.fill 8, 4, 0
.long 266684, 12110336, 262656, L_lanetab-L_back_pc_2+3072, 266624, 11008, 640, 640, 3990528, 7487488, 25658368, 30748672, 278528, 717120, 1, 12103680, 901440, 26851328, 26854400, 1073741824, 760320, 103552, 1073741824, 15104
.fill 8, 4, 0
.long 277124, 12028416, 262656, L_lanetab-L_back_pc_2+12288, 266880, 11008, 384, 640, 3985408, 7487488, 25683968, 30810112, 278528, 758080, 2, 12021760, 100032, 30428160, 30489600, 30489600, 762880, 103680, 1073741824, 14848
.fill 8, 4, 0
.long 1073741824, 12192256, 262656, L_lanetab-L_back_pc_2+3072, 267136, 10752, 0, 640, 3990528, 7487488, 25709568, 30871552, 278528, 799040, 0, 12185600, 1073741824, 1073741824, 1073741824, 1073741824, 765440, 103808, 1073741824, 14592
.fill 8, 4, 0
.long 267904, 11947520, 262912, L_lanetab-L_back_pc_2+6144, 266368, 11264, 640, 640, 4313088, 8175616, 25632768, 30687232, 286720, 1003840, 0, 11943936, 410080, 25786368, 25789440, 1073741824, 1085440, 119808, 282280, 15872
.fill 8, 4, 0
.long 267708, 12111360, 262912, L_lanetab-L_back_pc_2+3072, 266624, 11008, 640, 640, 4318208, 8175616, 25658368, 30748672, 286720, 1044800, 1, 12107776, 901600, 27097088, 27100160, 1073741824, 1088000, 119936, 1073741824, 15616
.fill 8, 4, 0
.long 277380, 12029440, 262912, L_lanetab-L_back_pc_2+12288, 266880, 11008, 384, 640, 4313088, 8175616, 25683968, 30810112, 286720, 1085760, 2, 12025856, 100128, 30551040, 30612480, 30612480, 1090560, 120064, 1073741824, 15360
.fill 8, 4, 0
.long 1073741824, 12193280, 262912, L_lanetab-L_back_pc_2+3072, 267136, 10752, 0, 640, 4318208, 8175616, 25709568, 30871552, 286720, 1126720, 0, 12189696, 1073741824, 1073741824, 1073741824, 1073741824, 1093120, 120192, 1073741824, 15104
.fill 8, 4, 0
.long 268928, 11956736, 263168, L_lanetab-L_back_pc_2+6144, 266368, 11264, 640, 640, 4640768, 8863744, 25632768, 30687232, 294912, 1331520, 0, 11950080, 410240, 25888768, 25891840, 1073741824, 1413120, 136192, 282792, 16384
.fill 8, 4, 0
.long 268732, 12120576, 263168, L_lanetab-L_back_pc_2+3072, 266624, 11008, 640, 640, 4645888, 8863744, 25658368, 30748672, 294912, 1372480, 1, 12113920, 901760, 27342848, 27345920, 1073741824, 1415680, 136320, 1073741824, 16128
.fill 8, 4, 0
.long 277636, 12038656, 263168, L_lanetab-L_back_pc_2+12288, 266880, 11008, 384, 640, 4640768, 8863744, 25683968, 30810112, 294912, 1413440, 2, 12032000, 100224, 30673920, 30735360, 30735360, 1418240, 136448, 1073741824, 15872
.fill 8, 4, 0
.long 1073741824, 12202496, 263168, L_lanetab-L_back_pc_2+3072, 267136, 10752, 0, 640, 4645888, 8863744, 25709568, 30871552, 294912, 1454400, 0, 12195840, 1073741824, 1073741824, 1073741824, 1073741824, 1420800, 136576, 1073741824, 15616
.fill 8, 4, 0
.long 269952, 11957760, 263424, L_lanetab-L_back_pc_2+6144, 266368, 11264, 640, 640, 4968448, 9551872, 25632768, 30687232, 303104, 1659200, 0, 11954176, 410400, 25991168, 25994240, 1073741824, 1740800, 152576, 283304, 16896
.fill 8, 4, 0
.long 269756, 12121600, 263424, L_lanetab-L_back_pc_2+3072, 266624, 11008, 640, 640, 4973568, 9551872, 25658368, 30748672, 303104, 1700160, 1, 12118016, 901920, 27588608, 27591680, 1073741824, 1743360, 152704, 1073741824, 16640
.fill 8, 4, 0
.long 277892, 12039680, 263424, L_lanetab-L_back_pc_2+12288, 266880, 11008, 384, 640, 4968448, 9551872, 25683968, 30810112, 303104, 1741120, 2, 12036096, 100320, 30796800, 30858240, 30858240, 1745920, 152832, 1073741824, 16384
.fill 8, 4, 0
.long 1073741824, 12203520, 263424, L_lanetab-L_back_pc_2+3072, 267136, 10752, 0, 640, 4973568, 9551872, 25709568, 30871552, 303104, 1782080, 0, 12199936, 1073741824, 1073741824, 1073741824, 1073741824, 1748480, 152960, 1073741824, 16128
.fill 8, 4, 0
.long 270976, 11966976, 263680, L_lanetab-L_back_pc_2+6144, 266368, 11264, 640, 640, 5296128, 10240000, 25632768, 30687232, 311296, 1986880, 0, 11960320, 410560, 26093568, 26096640, 1073741824, 2068480, 168960, 283816, 17408
.fill 8, 4, 0
.long 270780, 12130816, 263680, L_lanetab-L_back_pc_2+3072, 266624, 11008, 640, 640, 5301248, 10240000, 25658368, 30748672, 311296, 2027840, 1, 12124160, 902080, 27834368, 27837440, 1073741824, 2071040, 169088, 1073741824, 17152
.fill 8, 4, 0
.long 278148, 12048896, 263680, L_lanetab-L_back_pc_2+12288, 266880, 11008, 384, 640, 5296128, 10240000, 25683968, 30810112, 311296, 2068800, 2, 12042240, 100416, 30919680, 30981120, 30981120, 2073600, 169216, 1073741824, 16896
.fill 8, 4, 0
.long 1073741824, 12212736, 263680, L_lanetab-L_back_pc_2+3072, 267136, 10752, 0, 640, 5301248, 10240000, 25709568, 30871552, 311296, 2109760, 0, 12206080, 1073741824, 1073741824, 1073741824, 1073741824, 2076160, 169344, 1073741824, 16640
.fill 8, 4, 0
.long 272000, 11968000, 263936, L_lanetab-L_back_pc_2+6144, 266368, 11264, 640, 640, 5623808, 10928128, 25632768, 30687232, 319488, 2314560, 0, 11964416, 410720, 26195968, 26199040, 1073741824, 2396160, 185344, 284328, 17920
.fill 8, 4, 0
.long 271804, 12131840, 263936, L_lanetab-L_back_pc_2+3072, 266624, 11008, 640, 640, 5628928, 10928128, 25658368, 30748672, 319488, 2355520, 1, 12128256, 902240, 28080128, 28083200, 1073741824, 2398720, 185472, 1073741824, 17664
.fill 8, 4, 0
.long 278404, 12049920, 263936, L_lanetab-L_back_pc_2+12288, 266880, 11008, 384, 640, 5623808, 10928128, 25683968, 30810112, 319488, 2396480, 2, 12046336, 100512, 31042560, 31104000, 31104000, 2401280, 185600, 1073741824, 17408
.fill 8, 4, 0
.long 1073741824, 12213760, 263936, L_lanetab-L_back_pc_2+3072, 267136, 10752, 0, 640, 5628928, 10928128, 25709568, 30871552, 319488, 2437440, 0, 12210176, 1073741824, 1073741824, 1073741824, 1073741824, 2403840, 185728, 1073741824, 17152
.fill 8, 4, 0
.long 264836, 11936512, 262144, L_lanetab-L_back_pc_2+6144, 267392, 10752, 640, 960, 3411968, 6283264, 25735168, 30932992, 262144, 20960, 0, 11930624, 460800, 25484288, 25487360, 1073741824, 112640, 71168, 280748, 13312
.fill 8, 4, 0
.long 264640, 12100352, 262144, L_lanetab-L_back_pc_2+3072, 267648, 10496, 640, 960, 3417088, 6283264, 25760768, 30994432, 262144, 61920, 1, 12094464, 942080, 26364928, 26368000, 1073741824, 115200, 71296, 1073741824, 13056
.fill 8, 4, 0
.long 278660, 12018432, 262144, L_lanetab-L_back_pc_2+12288, 267904, 10496, 384, 960, 3411968, 6283264, 25786368, 31055872, 262144, 102880, 2, 12012544, 100608, 31165440, 31226880, 31226880, 117760, 71424, 1073741824, 12800
.fill 8, 4, 0
.long 1073741824, 12182272, 262144, L_lanetab-L_back_pc_2+3072, 268160, 10240, 0, 960, 3417088, 6283264, 25811968, 31117312, 262144, 143840, 0, 12176384, 1073741824, 1073741824, 1073741824, 1073741824, 120320, 71552, 1073741824, 12544
.fill 8, 4, 0
.long 265860, 11937536, 262400, L_lanetab-L_back_pc_2+6144, 267392, 10752, 640, 960, 3739648, 6971392, 25735168, 30932992, 270336, 348640, 0, 11934720, 460960, 25586688, 25589760, 1073741824, 440320, 87552, 281260, 13824
.fill 8, 4, 0
.long 265664, 12101376, 262400, L_lanetab-L_back_pc_2+3072, 267648, 10496, 640, 960, 3744768, 6971392, 25760768, 30994432, 270336, 389600, 1, 12098560, 942240, 26610688, 26613760, 1073741824, 442880, 87680, 1073741824, 13568
.fill 8, 4, 0
.long 278916, 12019456, 262400, L_lanetab-L_back_pc_2+12288, 267904, 10496, 384, 960, 3739648, 6971392, 25786368, 31055872, 270336, 430560, 2, 12016640, 100704, 31288320, 31349760, 31349760, 445440, 87808, 1073741824, 13312
.fill 8, 4, 0
.long 1073741824, 12183296, 262400, L_lanetab-L_back_pc_2+3072, 268160, 10240, 0, 960, 3744768, 6971392, 25811968, 31117312, 270336, 471520, 0, 12180480, 1073741824, 1073741824, 1073741824, 1073741824, 448000, 87936, 1073741824, 13056
.fill 8, 4, 0
.long 266884, 11946752, 262656, L_lanetab-L_back_pc_2+6144, 267392, 10752, 640, 960, 4067328, 7659520, 25735168, 30932992, 278528, 676320, 0, 11940864, 461120, 25689088, 25692160, 1073741824, 768000, 103936, 281772, 14336
.fill 8, 4, 0
.long 266688, 12110592, 262656, L_lanetab-L_back_pc_2+3072, 267648, 10496, 640, 960, 4072448, 7659520, 25760768, 30994432, 278528, 717280, 1, 12104704, 942400, 26856448, 26859520, 1073741824, 770560, 104064, 1073741824, 14080
.fill 8, 4, 0
.long 279172, 12028672, 262656, L_lanetab-L_back_pc_2+12288, 267904, 10496, 384, 960, 4067328, 7659520, 25786368, 31055872, 278528, 758240, 2, 12022784, 100800, 31411200, 31472640, 31472640, 773120, 104192, 1073741824, 13824
.fill 8, 4, 0
.long 1073741824, 12192512, 262656, L_lanetab-L_back_pc_2+3072, 268160, 10240, 0, 960, 4072448, 7659520, 25811968, 31117312, 278528, 799200, 0, 12186624, 1073741824, 1073741824, 1073741824, 1073741824, 775680, 104320, 1073741824, 13568
.fill 8, 4, 0
.long 267908, 11947776, 262912, L_lanetab-L_back_pc_2+6144, 267392, 10752, 640, 960, 4395008, 8347648, 25735168, 30932992, 286720, 1004000, 0, 11944960, 461280, 25791488, 25794560, 1073741824, 1095680, 120320, 282284, 14848
.fill 8, 4, 0
.long 267712, 12111616, 262912, L_lanetab-L_back_pc_2+3072, 267648, 10496, 640, 960, 4400128, 8347648, 25760768, 30994432, 286720, 1044960, 1, 12108800, 942560, 27102208, 27105280, 1073741824, 1098240, 120448, 1073741824, 14592
.fill 8, 4, 0
.long 279428, 12029696, 262912, L_lanetab-L_back_pc_2+12288, 267904, 10496, 384, 960, 4395008, 8347648, 25786368, 31055872, 286720, 1085920, 2, 12026880, 100896, 31534080, 31595520, 31595520, 1100800, 120576, 1073741824, 14336
.fill 8, 4, 0
.long 1073741824, 12193536, 262912, L_lanetab-L_back_pc_2+3072, 268160, 10240, 0, 960, 4400128, 8347648, 25811968, 31117312, 286720, 1126880, 0, 12190720, 1073741824, 1073741824, 1073741824, 1073741824, 1103360, 120704, 1073741824, 14080
.fill 8, 4, 0
.long 268932, 11956992, 263168, L_lanetab-L_back_pc_2+6144, 267392, 10752, 640, 960, 4722688, 9035776, 25735168, 30932992, 294912, 1331680, 0, 11951104, 461440, 25893888, 25896960, 1073741824, 1423360, 136704, 282796, 15360
.fill 8, 4, 0
.long 268736, 12120832, 263168, L_lanetab-L_back_pc_2+3072, 267648, 10496, 640, 960, 4727808, 9035776, 25760768, 30994432, 294912, 1372640, 1, 12114944, 942720, 27347968, 27351040, 1073741824, 1425920, 136832, 1073741824, 15104
.fill 8, 4, 0
.long 279684, 12038912, 263168, L_lanetab-L_back_pc_2+12288, 267904, 10496, 384, 960, 4722688, 9035776, 25786368, 31055872, 294912, 1413600, 2, 12033024, 100992, 31656960, 31718400, 31718400, 1428480, 136960, 1073741824, 14848
.fill 8, 4, 0
.long 1073741824, 12202752, 263168, L_lanetab-L_back_pc_2+3072, 268160, 10240, 0, 960, 4727808, 9035776, 25811968, 31117312, 294912, 1454560, 0, 12196864, 1073741824, 1073741824, 1073741824, 1073741824, 1431040, 137088, 1073741824, 14592
.fill 8, 4, 0
.long 269956, 11958016, 263424, L_lanetab-L_back_pc_2+6144, 267392, 10752, 640, 960, 5050368, 9723904, 25735168, 30932992, 303104, 1659360, 0, 11955200, 461600, 25996288, 25999360, 1073741824, 1751040, 153088, 283308, 15872
.fill 8, 4, 0
.long 269760, 12121856, 263424, L_lanetab-L_back_pc_2+3072, 267648, 10496, 640, 960, 5055488, 9723904, 25760768, 30994432, 303104, 1700320, 1, 12119040, 942880, 27593728, 27596800, 1073741824, 1753600, 153216, 1073741824, 15616
.fill 8, 4, 0
.long 279940, 12039936, 263424, L_lanetab-L_back_pc_2+12288, 267904, 10496, 384, 960, 5050368, 9723904, 25786368, 31055872, 303104, 1741280, 2, 12037120, 101088, 31779840, 31841280, 31841280, 1756160, 153344, 1073741824, 15360
.fill 8, 4, 0
.long 1073741824, 12203776, 263424, L_lanetab-L_back_pc_2+3072, 268160, 10240, 0, 960, 5055488, 9723904, 25811968, 31117312, 303104, 1782240, 0, 12200960, 1073741824, 1073741824, 1073741824, 1073741824, 1758720, 153472, 1073741824, 15104
.fill 8, 4, 0
.long 270980, 11967232, 263680, L_lanetab-L_back_pc_2+6144, 267392, 10752, 640, 960, 5378048, 10412032, 25735168, 30932992, 311296, 1987040, 0, 11961344, 461760, 26098688, 26101760, 1073741824, 2078720, 169472, 283820, 16384
.fill 8, 4, 0
.long 270784, 12131072, 263680, L_lanetab-L_back_pc_2+3072, 267648, 10496, 640, 960, 5383168, 10412032, 25760768, 30994432, 311296, 2028000, 1, 12125184, 943040, 27839488, 27842560, 1073741824, 2081280, 169600, 1073741824, 16128
.fill 8, 4, 0
.long 280196, 12049152, 263680, L_lanetab-L_back_pc_2+12288, 267904, 10496, 384, 960, 5378048, 10412032, 25786368, 31055872, 311296, 2068960, 2, 12043264, 101184, 31902720, 31964160, 31964160, 2083840, 169728, 1073741824, 15872
.fill 8, 4, 0
.long 1073741824, 12212992, 263680, L_lanetab-L_back_pc_2+3072, 268160, 10240, 0, 960, 5383168, 10412032, 25811968, 31117312, 311296, 2109920, 0, 12207104, 1073741824, 1073741824, 1073741824, 1073741824, 2086400, 169856, 1073741824, 15616
.fill 8, 4, 0
.long 272004, 11968256, 263936, L_lanetab-L_back_pc_2+6144, 267392, 10752, 640, 960, 5705728, 11100160, 25735168, 30932992, 319488, 2314720, 0, 11965440, 461920, 26201088, 26204160, 1073741824, 2406400, 185856, 284332, 16896
.fill 8, 4, 0
.long 271808, 12132096, 263936, L_lanetab-L_back_pc_2+3072, 267648, 10496, 640, 960, 5710848, 11100160, 25760768, 30994432, 319488, 2355680, 1, 12129280, 943200, 28085248, 28088320, 1073741824, 2408960, 185984, 1073741824, 16640
.fill 8, 4, 0
.long 280452, 12050176, 263936, L_lanetab-L_back_pc_2+12288, 267904, 10496, 384, 960, 5705728, 11100160, 25786368, 31055872, 319488, 2396640, 2, 12047360, 101280, 32025600, 32087040, 32087040, 2411520, 186112, 1073741824, 16384
.fill 8, 4, 0
.long 1073741824, 12214016, 263936, L_lanetab-L_back_pc_2+3072, 268160, 10240, 0, 960, 5710848, 11100160, 25811968, 31117312, 319488, 2437600, 0, 12211200, 1073741824, 1073741824, 1073741824, 1073741824, 2414080, 186240, 1073741824, 16128
.fill 8, 4, 0
.long 264840, 12263424, 262144, L_lanetab-L_back_pc_2+6144, 268416, 10240, 640, 1280, 3176448, 5767168, 25837568, 31178752, 262144, 21120, 0, 12255232, 512000, 25489408, 25492480, 1073741824, 122880, 71680, 280752, 12288
.fill 8, 4, 0
.long 264852, 12427264, 262144, L_lanetab-L_back_pc_2+3072, 268672, 9984, 640, 1280, 3181568, 5767168, 25863168, 31240192, 262144, 62080, 1, 12419072, 983040, 26370048, 26373120, 1073741824, 125440, 71808, 1073741824, 12032
.fill 8, 4, 0
.long 272520, 12345344, 262144, L_lanetab-L_back_pc_2+12288, 268928, 9984, 384, 1280, 3176448, 5767168, 25888768, 31301632, 262144, 103040, 2, 12337152, 196608, 28219392, 28280832, 28280832, 128000, 71936, 1073741824, 11776
.fill 8, 4, 0
.long 1073741824, 12509184, 262144, L_lanetab-L_back_pc_2+3072, 269184, 9728, 0, 1280, 3181568, 5767168, 25914368, 31363072, 262144, 144000, 0, 12500992, 1073741824, 1073741824, 1073741824, 1073741824, 130560, 72064, 1073741824, 11520
.fill 8, 4, 0
.long 265864, 12264448, 262400, L_lanetab-L_back_pc_2+6144, 268416, 10240, 640, 1280, 3504128, 6455296, 25837568, 31178752, 270336, 348800, 0, 12259328, 512160, 25591808, 25594880, 1073741824, 450560, 88064, 281264, 12800
.fill 8, 4, 0
.long 265876, 12428288, 262400, L_lanetab-L_back_pc_2+3072, 268672, 9984, 640, 1280, 3509248, 6455296, 25863168, 31240192, 270336, 389760, 1, 12423168, 983200, 26615808, 26618880, 1073741824, 453120, 88192, 1073741824, 12544
.fill 8, 4, 0
.long 272776, 12346368, 262400, L_lanetab-L_back_pc_2+12288, 268928, 9984, 384, 1280, 3504128, 6455296, 25888768, 31301632, 270336, 430720, 2, 12341248, 196704, 28342272, 28403712, 28403712, 455680, 88320, 1073741824, 12288
.fill 8, 4, 0
.long 1073741824, 12510208, 262400, L_lanetab-L_back_pc_2+3072, 269184, 9728, 0, 1280, 3509248, 6455296, 25914368, 31363072, 270336, 471680, 0, 12505088, 1073741824, 1073741824, 1073741824, 1073741824, 458240, 88448, 1073741824, 12032
.fill 8, 4, 0
.long 266888, 12273664, 262656, L_lanetab-L_back_pc_2+6144, 268416, 10240, 640, 1280, 3831808, 7143424, 25837568, 31178752, 278528, 676480, 0, 12265472, 512320, 25694208, 25697280, 1073741824, 778240, 104448, 281776, 13312
.fill 8, 4, 0
.long 266900, 12437504, 262656, L_lanetab-L_back_pc_2+3072, 268672, 9984, 640, 1280, 3836928, 7143424, 25863168, 31240192, 278528, 717440, 1, 12429312, 983360, 26861568, 26864640, 1073741824, 780800, 104576, 1073741824, 13056
.fill 8, 4, 0
.long 273032, 12355584, 262656, L_lanetab-L_back_pc_2+12288, 268928, 9984, 384, 1280, 3831808, 7143424, 25888768, 31301632, 278528, 758400, 2, 12347392, 196800, 28465152, 28526592, 28526592, 783360, 104704, 1073741824, 12800
.fill 8, 4, 0
.long 1073741824, 12519424, 262656, L_lanetab-L_back_pc_2+3072, 269184, 9728, 0, 1280, 3836928, 7143424, 25914368, 31363072, 278528, 799360, 0, 12511232, 1073741824, 1073741824, 1073741824, 1073741824, 785920, 104832, 1073741824, 12544
.fill 8, 4, 0
.long 267912, 12274688, 262912, L_lanetab-L_back_pc_2+6144, 268416, 10240, 640, 1280, 4159488, 7831552, 25837568, 31178752, 286720, 1004160, 0, 12269568, 512480, 25796608, 25799680, 1073741824, 1105920, 120832, 282288, 13824
.fill 8, 4, 0
.long 267924, 12438528, 262912, L_lanetab-L_back_pc_2+3072, 268672, 9984, 640, 1280, 4164608, 7831552, 25863168, 31240192, 286720, 1045120, 1, 12433408, 983520, 27107328, 27110400, 1073741824, 1108480, 120960, 1073741824, 13568
.fill 8, 4, 0
.long 273288, 12356608, 262912, L_lanetab-L_back_pc_2+12288, 268928, 9984, 384, 1280, 4159488, 7831552, 25888768, 31301632, 286720, 1086080, 2, 12351488, 196896, 28588032, 28649472, 28649472, 1111040, 121088, 1073741824, 13312
.fill 8, 4, 0
.long 1073741824, 12520448, 262912, L_lanetab-L_back_pc_2+3072, 269184, 9728, 0, 1280, 4164608, 7831552, 25914368, 31363072, 286720, 1127040, 0, 12515328, 1073741824, 1073741824, 1073741824, 1073741824, 1113600, 121216, 1073741824, 13056
.fill 8, 4, 0
.long 268936, 12283904, 263168, L_lanetab-L_back_pc_2+6144, 268416, 10240, 640, 1280, 4487168, 8519680, 25837568, 31178752, 294912, 1331840, 0, 12275712, 512640, 25899008, 25902080, 1073741824, 1433600, 137216, 282800, 14336
.fill 8, 4, 0
.long 268948, 12447744, 263168, L_lanetab-L_back_pc_2+3072, 268672, 9984, 640, 1280, 4492288, 8519680, 25863168, 31240192, 294912, 1372800, 1, 12439552, 983680, 27353088, 27356160, 1073741824, 1436160, 137344, 1073741824, 14080
.fill 8, 4, 0
.long 273544, 12365824, 263168, L_lanetab-L_back_pc_2+12288, 268928, 9984, 384, 1280, 4487168, 8519680, 25888768, 31301632, 294912, 1413760, 2, 12357632, 196992, 28710912, 28772352, 28772352, 1438720, 137472, 1073741824, 13824
.fill 8, 4, 0
.long 1073741824, 12529664, 263168, L_lanetab-L_back_pc_2+3072, 269184, 9728, 0, 1280, 4492288, 8519680, 25914368, 31363072, 294912, 1454720, 0, 12521472, 1073741824, 1073741824, 1073741824, 1073741824, 1441280, 137600, 1073741824, 13568
.fill 8, 4, 0
.long 269960, 12284928, 263424, L_lanetab-L_back_pc_2+6144, 268416, 10240, 640, 1280, 4814848, 9207808, 25837568, 31178752, 303104, 1659520, 0, 12279808, 512800, 26001408, 26004480, 1073741824, 1761280, 153600, 283312, 14848
.fill 8, 4, 0
.long 269972, 12448768, 263424, L_lanetab-L_back_pc_2+3072, 268672, 9984, 640, 1280, 4819968, 9207808, 25863168, 31240192, 303104, 1700480, 1, 12443648, 983840, 27598848, 27601920, 1073741824, 1763840, 153728, 1073741824, 14592
.fill 8, 4, 0
.long 273800, 12366848, 263424, L_lanetab-L_back_pc_2+12288, 268928, 9984, 384, 1280, 4814848, 9207808, 25888768, 31301632, 303104, 1741440, 2, 12361728, 197088, 28833792, 28895232, 28895232, 1766400, 153856, 1073741824, 14336
.fill 8, 4, 0
.long 1073741824, 12530688, 263424, L_lanetab-L_back_pc_2+3072, 269184, 9728, 0, 1280, 4819968, 9207808, 25914368, 31363072, 303104, 1782400, 0, 12525568, 1073741824, 1073741824, 1073741824, 1073741824, 1768960, 153984, 1073741824, 14080
.fill 8, 4, 0
.long 270984, 12294144, 263680, L_lanetab-L_back_pc_2+6144, 268416, 10240, 640, 1280, 5142528, 9895936, 25837568, 31178752, 311296, 1987200, 0, 12285952, 512960, 26103808, 26106880, 1073741824, 2088960, 169984, 283824, 15360
.fill 8, 4, 0
.long 270996, 12457984, 263680, L_lanetab-L_back_pc_2+3072, 268672, 9984, 640, 1280, 5147648, 9895936, 25863168, 31240192, 311296, 2028160, 1, 12449792, 984000, 27844608, 27847680, 1073741824, 2091520, 170112, 1073741824, 15104
.fill 8, 4, 0
.long 274056, 12376064, 263680, L_lanetab-L_back_pc_2+12288, 268928, 9984, 384, 1280, 5142528, 9895936, 25888768, 31301632, 311296, 2069120, 2, 12367872, 197184, 28956672, 29018112, 29018112, 2094080, 170240, 1073741824, 14848
.fill 8, 4, 0
.long 1073741824, 12539904, 263680, L_lanetab-L_back_pc_2+3072, 269184, 9728, 0, 1280, 5147648, 9895936, 25914368, 31363072, 311296, 2110080, 0, 12531712, 1073741824, 1073741824, 1073741824, 1073741824, 2096640, 170368, 1073741824, 14592
.fill 8, 4, 0
.long 272008, 12295168, 263936, L_lanetab-L_back_pc_2+6144, 268416, 10240, 640, 1280, 5470208, 10584064, 25837568, 31178752, 319488, 2314880, 0, 12290048, 513120, 26206208, 26209280, 1073741824, 2416640, 186368, 284336, 15872
.fill 8, 4, 0
.long 272020, 12459008, 263936, L_lanetab-L_back_pc_2+3072, 268672, 9984, 640, 1280, 5475328, 10584064, 25863168, 31240192, 319488, 2355840, 1, 12453888, 984160, 28090368, 28093440, 1073741824, 2419200, 186496, 1073741824, 15616
.fill 8, 4, 0
.long 274312, 12377088, 263936, L_lanetab-L_back_pc_2+12288, 268928, 9984, 384, 1280, 5470208, 10584064, 25888768, 31301632, 319488, 2396800, 2, 12371968, 197280, 29079552, 29140992, 29140992, 2421760, 186624, 1073741824, 15360
.fill 8, 4, 0
.long 1073741824, 12540928, 263936, L_lanetab-L_back_pc_2+3072, 269184, 9728, 0, 1280, 5475328, 10584064, 25914368, 31363072, 319488, 2437760, 0, 12535808, 1073741824, 1073741824, 1073741824, 1073741824, 2424320, 186752, 1073741824, 15104
.fill 8, 4, 0
.long 264844, 12263680, 262144, L_lanetab-L_back_pc_2+6144, 269440, 9728, 640, 1600, 3258368, 5939200, 25939968, 31424512, 262144, 21280, 0, 12256256, 563200, 25494528, 25497600, 1073741824, 133120, 72192, 280756, 11264
.fill 8, 4, 0
.long 264856, 12427520, 262144, L_lanetab-L_back_pc_2+3072, 269696, 9472, 640, 1600, 3263488, 5939200, 25965568, 31485952, 262144, 62240, 1, 12420096, 1024000, 26375168, 26378240, 1073741824, 135680, 72320, 1073741824, 11008
.fill 8, 4, 0
.long 274568, 12345600, 262144, L_lanetab-L_back_pc_2+12288, 269952, 9472, 384, 1600, 3258368, 5939200, 25991168, 31547392, 262144, 103200, 2, 12338176, 197376, 29202432, 29263872, 29263872, 138240, 72448, 1073741824, 10752
.fill 8, 4, 0
.long 1073741824, 12509440, 262144, L_lanetab-L_back_pc_2+3072, 270208, 9216, 0, 1600, 3263488, 5939200, 26016768, 31608832, 262144, 144160, 0, 12502016, 1073741824, 1073741824, 1073741824, 1073741824, 140800, 72576, 1073741824, 10496
.fill 8, 4, 0
.long 265868, 12264704, 262400, L_lanetab-L_back_pc_2+6144, 269440, 9728, 640, 1600, 3586048, 6627328, 25939968, 31424512, 270336, 348960, 0, 12260352, 563360, 25596928, 25600000, 1073741824, 460800, 88576, 281268, 11776
.fill 8, 4, 0
.long 265880, 12428544, 262400, L_lanetab-L_back_pc_2+3072, 269696, 9472, 640, 1600, 3591168, 6627328, 25965568, 31485952, 270336, 389920, 1, 12424192, 1024160, 26620928, 26624000, 1073741824, 463360, 88704, 1073741824, 11520
.fill 8, 4, 0
.long 274824, 12346624, 262400, L_lanetab-L_back_pc_2+12288, 269952, 9472, 384, 1600, 3586048, 6627328, 25991168, 31547392, 270336, 430880, 2, 12342272, 197472, 29325312, 29386752, 29386752, 465920, 88832, 1073741824, 11264
.fill 8, 4, 0
.long 1073741824, 12510464, 262400, L_lanetab-L_back_pc_2+3072, 270208, 9216, 0, 1600, 3591168, 6627328, 26016768, 31608832, 270336, 471840, 0, 12506112, 1073741824, 1073741824, 1073741824, 1073741824, 468480, 88960, 1073741824, 11008
.fill 8, 4, 0
.long 266892, 12273920, 262656, L_lanetab-L_back_pc_2+6144, 269440, 9728, 640, 1600, 3913728, 7315456, 25939968, 31424512, 278528, 676640, 0, 12266496, 563520, 25699328, 25702400, 1073741824, 788480, 104960, 281780, 12288
.fill 8, 4, 0
.long 266904, 12437760, 262656, L_lanetab-L_back_pc_2+3072, 269696, 9472, 640, 1600, 3918848, 7315456, 25965568, 31485952, 278528, 717600, 1, 12430336, 1024320, 26866688, 26869760, 1073741824, 791040, 105088, 1073741824, 12032
.fill 8, 4, 0
.long 275080, 12355840, 262656, L_lanetab-L_back_pc_2+12288, 269952, 9472, 384, 1600, 3913728, 7315456, 25991168, 31547392, 278528, 758560, 2, 12348416, 197568, 29448192, 29509632, 29509632, 793600, 105216, 1073741824, 11776
.fill 8, 4, 0
.long 1073741824, 12519680, 262656, L_lanetab-L_back_pc_2+3072, 270208, 9216, 0, 1600, 3918848, 7315456, 26016768, 31608832, 278528, 799520, 0, 12512256, 1073741824, 1073741824, 1073741824, 1073741824, 796160, 105344, 1073741824, 11520
.fill 8, 4, 0
.long 267916, 12274944, 262912, L_lanetab-L_back_pc_2+6144, 269440, 9728, 640, 1600, 4241408, 8003584, 25939968, 31424512, 286720, 1004320, 0, 12270592, 563680, 25801728, 25804800, 1073741824, 1116160, 121344, 282292, 12800
.fill 8, 4, 0
.long 267928, 12438784, 262912, L_lanetab-L_back_pc_2+3072, 269696, 9472, 640, 1600, 4246528, 8003584, 25965568, 31485952, 286720, 1045280, 1, 12434432, 1024480, 27112448, 27115520, 1073741824, 1118720, 121472, 1073741824, 12544
.fill 8, 4, 0
.long 275336, 12356864, 262912, L_lanetab-L_back_pc_2+12288, 269952, 9472, 384, 1600, 4241408, 8003584, 25991168, 31547392, 286720, 1086240, 2, 12352512, 197664, 29571072, 29632512, 29632512, 1121280, 121600, 1073741824, 12288
.fill 8, 4, 0
.long 1073741824, 12520704, 262912, L_lanetab-L_back_pc_2+3072, 270208, 9216, 0, 1600, 4246528, 8003584, 26016768, 31608832, 286720, 1127200, 0, 12516352, 1073741824, 1073741824, 1073741824, 1073741824, 1123840, 121728, 1073741824, 12032
.fill 8, 4, 0
.long 268940, 12284160, 263168, L_lanetab-L_back_pc_2+6144, 269440, 9728, 640, 1600, 4569088, 8691712, 25939968, 31424512, 294912, 1332000, 0, 12276736, 563840, 25904128, 25907200, 1073741824, 1443840, 137728, 282804, 13312
.fill 8, 4, 0
.long 268952, 12448000, 263168, L_lanetab-L_back_pc_2+3072, 269696, 9472, 640, 1600, 4574208, 8691712, 25965568, 31485952, 294912, 1372960, 1, 12440576, 1024640, 27358208, 27361280, 1073741824, 1446400, 137856, 1073741824, 13056
.fill 8, 4, 0
.long 275592, 12366080, 263168, L_lanetab-L_back_pc_2+12288, 269952, 9472, 384, 1600, 4569088, 8691712, 25991168, 31547392, 294912, 1413920, 2, 12358656, 197760, 29693952, 29755392, 29755392, 1448960, 137984, 1073741824, 12800
.fill 8, 4, 0
.long 1073741824, 12529920, 263168, L_lanetab-L_back_pc_2+3072, 270208, 9216, 0, 1600, 4574208, 8691712, 26016768, 31608832, 294912, 1454880, 0, 12522496, 1073741824, 1073741824, 1073741824, 1073741824, 1451520, 138112, 1073741824, 12544
.fill 8, 4, 0
.long 269964, 12285184, 263424, L_lanetab-L_back_pc_2+6144, 269440, 9728, 640, 1600, 4896768, 9379840, 25939968, 31424512, 303104, 1659680, 0, 12280832, 564000, 26006528, 26009600, 1073741824, 1771520, 154112, 283316, 13824
.fill 8, 4, 0
.long 269976, 12449024, 263424, L_lanetab-L_back_pc_2+3072, 269696, 9472, 640, 1600, 4901888, 9379840, 25965568, 31485952, 303104, 1700640, 1, 12444672, 1024800, 27603968, 27607040, 1073741824, 1774080, 154240, 1073741824, 13568
.fill 8, 4, 0
.long 275848, 12367104, 263424, L_lanetab-L_back_pc_2+12288, 269952, 9472, 384, 1600, 4896768, 9379840, 25991168, 31547392, 303104, 1741600, 2, 12362752, 197856, 29816832, 29878272, 29878272, 1776640, 154368, 1073741824, 13312
.fill 8, 4, 0
.long 1073741824, 12530944, 263424, L_lanetab-L_back_pc_2+3072, 270208, 9216, 0, 1600, 4901888, 9379840, 26016768, 31608832, 303104, 1782560, 0, 12526592, 1073741824, 1073741824, 1073741824, 1073741824, 1779200, 154496, 1073741824, 13056
.fill 8, 4, 0
.long 270988, 12294400, 263680, L_lanetab-L_back_pc_2+6144, 269440, 9728, 640, 1600, 5224448, 10067968, 25939968, 31424512, 311296, 1987360, 0, 12286976, 564160, 26108928, 26112000, 1073741824, 2099200, 170496, 283828, 14336
.fill 8, 4, 0
.long 271000, 12458240, 263680, L_lanetab-L_back_pc_2+3072, 269696, 9472, 640, 1600, 5229568, 10067968, 25965568, 31485952, 311296, 2028320, 1, 12450816, 1024960, 27849728, 27852800, 1073741824, 2101760, 170624, 1073741824, 14080
.fill 8, 4, 0
.long 276104, 12376320, 263680, L_lanetab-L_back_pc_2+12288, 269952, 9472, 384, 1600, 5224448, 10067968, 25991168, 31547392, 311296, 2069280, 2, 12368896, 197952, 29939712, 30001152, 30001152, 2104320, 170752, 1073741824, 13824
.fill 8, 4, 0
.long 1073741824, 12540160, 263680, L_lanetab-L_back_pc_2+3072, 270208, 9216, 0, 1600, 5229568, 10067968, 26016768, 31608832, 311296, 2110240, 0, 12532736, 1073741824, 1073741824, 1073741824, 1073741824, 2106880, 170880, 1073741824, 13568
.fill 8, 4, 0
.long 272012, 12295424, 263936, L_lanetab-L_back_pc_2+6144, 269440, 9728, 640, 1600, 5552128, 10756096, 25939968, 31424512, 319488, 2315040, 0, 12291072, 564320, 26211328, 26214400, 1073741824, 2426880, 186880, 284340, 14848
.fill 8, 4, 0
.long 272024, 12459264, 263936, L_lanetab-L_back_pc_2+3072, 269696, 9472, 640, 1600, 5557248, 10756096, 25965568, 31485952, 319488, 2356000, 1, 12454912, 1025120, 28095488, 28098560, 1073741824, 2429440, 187008, 1073741824, 14592
.fill 8, 4, 0
.long 276360, 12377344, 263936, L_lanetab-L_back_pc_2+12288, 269952, 9472, 384, 1600, 5552128, 10756096, 25991168, 31547392, 319488, 2396960, 2, 12372992, 198048, 30062592, 30124032, 30124032, 2432000, 187136, 1073741824, 14336
.fill 8, 4, 0
.long 1073741824, 12541184, 263936, L_lanetab-L_back_pc_2+3072, 270208, 9216, 0, 1600, 5557248, 10756096, 26016768, 31608832, 319488, 2437920, 0, 12536832, 1073741824, 1073741824, 1073741824, 1073741824, 2434560, 187264, 1073741824, 14080
.fill 8, 4, 0
.long 264848, 12263936, 262144, L_lanetab-L_back_pc_2+9216, 270464, 9216, 640, 1920, 3340288, 6111232, 26042368, 31670272, 262144, 21440, 0, 12257280, 430080, 25499648, 25502720, 1073741824, 143360, 72704, 280760, 10240
.fill 8, 4, 0
.long 264860, 12427776, 262144, L_lanetab-L_back_pc_2+3072, 270720, 8960, 640, 1920, 3345408, 6111232, 26067968, 31731712, 262144, 62400, 1, 12421120, 1064960, 26380288, 26383360, 1073741824, 145920, 72832, 1073741824, 9984
.fill 8, 4, 0
.long 276616, 12345856, 262144, L_lanetab-L_back_pc_2+12288, 270976, 8960, 384, 1920, 3340288, 6111232, 26093568, 31793152, 262144, 103360, 2, 12339200, 198144, 30185472, 30246912, 30246912, 148480, 72960, 1073741824, 9728
.fill 8, 4, 0
.long 1073741824, 12509696, 262144, L_lanetab-L_back_pc_2+3072, 271232, 8704, 0, 1920, 3345408, 6111232, 26119168, 31854592, 262144, 144320, 0, 12503040, 1073741824, 1073741824, 1073741824, 1073741824, 151040, 73088, 1073741824, 9472
.fill 8, 4, 0
.long 265872, 12264960, 262400, L_lanetab-L_back_pc_2+9216, 270464, 9216, 640, 1920, 3667968, 6799360, 26042368, 31670272, 270336, 349120, 0, 12261376, 430240, 25602048, 25605120, 1073741824, 471040, 89088, 281272, 10752
.fill 8, 4, 0
.long 265884, 12428800, 262400, L_lanetab-L_back_pc_2+3072, 270720, 8960, 640, 1920, 3673088, 6799360, 26067968, 31731712, 270336, 390080, 1, 12425216, 1065120, 26626048, 26629120, 1073741824, 473600, 89216, 1073741824, 10496
.fill 8, 4, 0
.long 276872, 12346880, 262400, L_lanetab-L_back_pc_2+12288, 270976, 8960, 384, 1920, 3667968, 6799360, 26093568, 31793152, 270336, 431040, 2, 12343296, 198240, 30308352, 30369792, 30369792, 476160, 89344, 1073741824, 10240
.fill 8, 4, 0
.long 1073741824, 12510720, 262400, L_lanetab-L_back_pc_2+3072, 271232, 8704, 0, 1920, 3673088, 6799360, 26119168, 31854592, 270336, 472000, 0, 12507136, 1073741824, 1073741824, 1073741824, 1073741824, 478720, 89472, 1073741824, 9984
.fill 8, 4, 0
.long 266896, 12274176, 262656, L_lanetab-L_back_pc_2+9216, 270464, 9216, 640, 1920, 3995648, 7487488, 26042368, 31670272, 278528, 676800, 0, 12267520, 430400, 25704448, 25707520, 1073741824, 798720, 105472, 281784, 11264
.fill 8, 4, 0
.long 266908, 12438016, 262656, L_lanetab-L_back_pc_2+3072, 270720, 8960, 640, 1920, 4000768, 7487488, 26067968, 31731712, 278528, 717760, 1, 12431360, 1065280, 26871808, 26874880, 1073741824, 801280, 105600, 1073741824, 11008
.fill 8, 4, 0
.long 277128, 12356096, 262656, L_lanetab-L_back_pc_2+12288, 270976, 8960, 384, 1920, 3995648, 7487488, 26093568, 31793152, 278528, 758720, 2, 12349440, 198336, 30431232, 30492672, 30492672, 803840, 105728, 1073741824, 10752
.fill 8, 4, 0
.long 1073741824, 12519936, 262656, L_lanetab-L_back_pc_2+3072, 271232, 8704, 0, 1920, 4000768, 7487488, 26119168, 31854592, 278528, 799680, 0, 12513280, 1073741824, 1073741824, 1073741824, 1073741824, 806400, 105856, 1073741824, 10496
.fill 8, 4, 0
.long 267920, 12275200, 262912, L_lanetab-L_back_pc_2+9216, 270464, 9216, 640, 1920, 4323328, 8175616, 26042368, 31670272, 286720, 1004480, 0, 12271616, 430560, 25806848, 25809920, 1073741824, 1126400, 121856, 282296, 11776
.fill 8, 4, 0
.long 267932, 12439040, 262912, L_lanetab-L_back_pc_2+3072, 270720, 8960, 640, 1920, 4328448, 8175616, 26067968, 31731712, 286720, 1045440, 1, 12435456, 1065440, 27117568, 27120640, 1073741824, 1128960, 121984, 1073741824, 11520
.fill 8, 4, 0
.long 277384, 12357120, 262912, L_lanetab-L_back_pc_2+12288, 270976, 8960, 384, 1920, 4323328, 8175616, 26093568, 31793152, 286720, 1086400, 2, 12353536, 198432, 30554112, 30615552, 30615552, 1131520, 122112, 1073741824, 11264
.fill 8, 4, 0
.long 1073741824, 12520960, 262912, L_lanetab-L_back_pc_2+3072, 271232, 8704, 0, 1920, 4328448, 8175616, 26119168, 31854592, 286720, 1127360, 0, 12517376, 1073741824, 1073741824, 1073741824, 1073741824, 1134080, 122240, 1073741824, 11008
.fill 8, 4, 0
.long 268944, 12284416, 263168, L_lanetab-L_back_pc_2+9216, 270464, 9216, 640, 1920, 4651008, 8863744, 26042368, 31670272, 294912, 1332160, 0, 12277760, 430720, 25909248, 25912320, 1073741824, 1454080, 138240, 282808, 12288
.fill 8, 4, 0
.long 268956, 12448256, 263168, L_lanetab-L_back_pc_2+3072, 270720, 8960, 640, 1920, 4656128, 8863744, 26067968, 31731712, 294912, 1373120, 1, 12441600, 1065600, 27363328, 27366400, 1073741824, 1456640, 138368, 1073741824, 12032
.fill 8, 4, 0
.long 277640, 12366336, 263168, L_lanetab-L_back_pc_2+12288, 270976, 8960, 384, 1920, 4651008, 8863744, 26093568, 31793152, 294912, 1414080, 2, 12359680, 198528, 30676992, 30738432, 30738432, 1459200, 138496, 1073741824, 11776
.fill 8, 4, 0
.long 1073741824, 12530176, 263168, L_lanetab-L_back_pc_2+3072, 271232, 8704, 0, 1920, 4656128, 8863744, 26119168, 31854592, 294912, 1455040, 0, 12523520, 1073741824, 1073741824, 1073741824, 1073741824, 1461760, 138624, 1073741824, 11520
.fill 8, 4, 0
.long 269968, 12285440, 263424, L_lanetab-L_back_pc_2+9216, 270464, 9216, 640, 1920, 4978688, 9551872, 26042368, 31670272, 303104, 1659840, 0, 12281856, 430880, 26011648, 26014720, 1073741824, 1781760, 154624, 283320, 12800
.fill 8, 4, 0
.long 269980, 12449280, 263424, L_lanetab-L_back_pc_2+3072, 270720, 8960, 640, 1920, 4983808, 9551872, 26067968, 31731712, 303104, 1700800, 1, 12445696, 1065760, 27609088, 27612160, 1073741824, 1784320, 154752, 1073741824, 12544
.fill 8, 4, 0
.long 277896, 12367360, 263424, L_lanetab-L_back_pc_2+12288, 270976, 8960, 384, 1920, 4978688, 9551872, 26093568, 31793152, 303104, 1741760, 2, 12363776, 198624, 30799872, 30861312, 30861312, 1786880, 154880, 1073741824, 12288
.fill 8, 4, 0
.long 1073741824, 12531200, 263424, L_lanetab-L_back_pc_2+3072, 271232, 8704, 0, 1920, 4983808, 9551872, 26119168, 31854592, 303104, 1782720, 0, 12527616, 1073741824, 1073741824, 1073741824, 1073741824, 1789440, 155008, 1073741824, 12032
.fill 8, 4, 0
.long 270992, 12294656, 263680, L_lanetab-L_back_pc_2+9216, 270464, 9216, 640, 1920, 5306368, 10240000, 26042368, 31670272, 311296, 1987520, 0, 12288000, 431040, 26114048, 26117120, 1073741824, 2109440, 171008, 283832, 13312
.fill 8, 4, 0
.long 271004, 12458496, 263680, L_lanetab-L_back_pc_2+3072, 270720, 8960, 640, 1920, 5311488, 10240000, 26067968, 31731712, 311296, 2028480, 1, 12451840, 1065920, 27854848, 27857920, 1073741824, 2112000, 171136, 1073741824, 13056
.fill 8, 4, 0
.long 278152, 12376576, 263680, L_lanetab-L_back_pc_2+12288, 270976, 8960, 384, 1920, 5306368, 10240000, 26093568, 31793152, 311296, 2069440, 2, 12369920, 198720, 30922752, 30984192, 30984192, 2114560, 171264, 1073741824, 12800
.fill 8, 4, 0
.long 1073741824, 12540416, 263680, L_lanetab-L_back_pc_2+3072, 271232, 8704, 0, 1920, 5311488, 10240000, 26119168, 31854592, 311296, 2110400, 0, 12533760, 1073741824, 1073741824, 1073741824, 1073741824, 2117120, 171392, 1073741824, 12544
.fill 8, 4, 0
.long 272016, 12295680, 263936, L_lanetab-L_back_pc_2+9216, 270464, 9216, 640, 1920, 5634048, 10928128, 26042368, 31670272, 319488, 2315200, 0, 12292096, 431200, 26216448, 26219520, 1073741824, 2437120, 187392, 284344, 13824
.fill 8, 4, 0
.long 272028, 12459520, 263936, L_lanetab-L_back_pc_2+3072, 270720, 8960, 640, 1920, 5639168, 10928128, 26067968, 31731712, 319488, 2356160, 1, 12455936, 1066080, 28100608, 28103680, 1073741824, 2439680, 187520, 1073741824, 13568
.fill 8, 4, 0
.long 278408, 12377600, 263936, L_lanetab-L_back_pc_2+12288, 270976, 8960, 384, 1920, 5634048, 10928128, 26093568, 31793152, 319488, 2397120, 2, 12374016, 198816, 31045632, 31107072, 31107072, 2442240, 187648, 1073741824, 13312
.fill 8, 4, 0
.long 1073741824, 12541440, 263936, L_lanetab-L_back_pc_2+3072, 271232, 8704, 0, 1920, 5639168, 10928128, 26119168, 31854592, 319488, 2438080, 0, 12537856, 1073741824, 1073741824, 1073741824, 1073741824, 2444800, 187776, 1073741824, 13056
.fill 8, 4, 0
.long 265088, 12264192, 262144, L_lanetab-L_back_pc_2+6144, 271488, 8704, 640, 2240, 3422208, 6283264, 26144768, 31916032, 262144, 21600, 0, 12258304, 614400, 25504768, 25507840, 1073741824, 153600, 73216, 280764, 9216
.fill 8, 4, 0
.long 264864, 12428032, 262144, L_lanetab-L_back_pc_2+3072, 271744, 8448, 640, 2240, 3427328, 6283264, 26170368, 31977472, 262144, 62560, 1, 12422144, 1105920, 26385408, 26388480, 1073741824, 156160, 73344, 1073741824, 8960
.fill 8, 4, 0
.long 278664, 12346112, 262144, L_lanetab-L_back_pc_2+12288, 272000, 8448, 384, 2240, 3422208, 6283264, 26195968, 32038912, 262144, 103520, 2, 12340224, 198912, 31168512, 31229952, 31229952, 158720, 73472, 1073741824, 8704
.fill 8, 4, 0
.long 1073741824, 12509952, 262144, L_lanetab-L_back_pc_2+3072, 272256, 8192, 0, 2240, 3427328, 6283264, 26221568, 32100352, 262144, 144480, 0, 12504064, 1073741824, 1073741824, 1073741824, 1073741824, 161280, 73600, 1073741824, 8448
.fill 8, 4, 0
.long 266112, 12265216, 262400, L_lanetab-L_back_pc_2+6144, 271488, 8704, 640, 2240, 3749888, 6971392, 26144768, 31916032, 270336, 349280, 0, 12262400, 614560, 25607168, 25610240, 1073741824, 481280, 89600, 281276, 9728
.fill 8, 4, 0
.long 265888, 12429056, 262400, L_lanetab-L_back_pc_2+3072, 271744, 8448, 640, 2240, 3755008, 6971392, 26170368, 31977472, 270336, 390240, 1, 12426240, 1106080, 26631168, 26634240, 1073741824, 483840, 89728, 1073741824, 9472
.fill 8, 4, 0
.long 278920, 12347136, 262400, L_lanetab-L_back_pc_2+12288, 272000, 8448, 384, 2240, 3749888, 6971392, 26195968, 32038912, 270336, 431200, 2, 12344320, 199008, 31291392, 31352832, 31352832, 486400, 89856, 1073741824, 9216
.fill 8, 4, 0
.long 1073741824, 12510976, 262400, L_lanetab-L_back_pc_2+3072, 272256, 8192, 0, 2240, 3755008, 6971392, 26221568, 32100352, 270336, 472160, 0, 12508160, 1073741824, 1073741824, 1073741824, 1073741824, 488960, 89984, 1073741824, 8960
.fill 8, 4, 0
.long 267136, 12274432, 262656, L_lanetab-L_back_pc_2+6144, 271488, 8704, 640, 2240, 4077568, 7659520, 26144768, 31916032, 278528, 676960, 0, 12268544, 614720, 25709568, 25712640, 1073741824, 808960, 105984, 281788, 10240
.fill 8, 4, 0
.long 266912, 12438272, 262656, L_lanetab-L_back_pc_2+3072, 271744, 8448, 640, 2240, 4082688, 7659520, 26170368, 31977472, 278528, 717920, 1, 12432384, 1106240, 26876928, 26880000, 1073741824, 811520, 106112, 1073741824, 9984
.fill 8, 4, 0
.long 279176, 12356352, 262656, L_lanetab-L_back_pc_2+12288, 272000, 8448, 384, 2240, 4077568, 7659520, 26195968, 32038912, 278528, 758880, 2, 12350464, 199104, 31414272, 31475712, 31475712, 814080, 106240, 1073741824, 9728
.fill 8, 4, 0
.long 1073741824, 12520192, 262656, L_lanetab-L_back_pc_2+3072, 272256, 8192, 0, 2240, 4082688, 7659520, 26221568, 32100352, 278528, 799840, 0, 12514304, 1073741824, 1073741824, 1073741824, 1073741824, 816640, 106368, 1073741824, 9472
.fill 8, 4, 0
.long 268160, 12275456, 262912, L_lanetab-L_back_pc_2+6144, 271488, 8704, 640, 2240, 4405248, 8347648, 26144768, 31916032, 286720, 1004640, 0, 12272640, 614880, 25811968, 25815040, 1073741824, 1136640, 122368, 282300, 10752
.fill 8, 4, 0
.long 267936, 12439296, 262912, L_lanetab-L_back_pc_2+3072, 271744, 8448, 640, 2240, 4410368, 8347648, 26170368, 31977472, 286720, 1045600, 1, 12436480, 1106400, 27122688, 27125760, 1073741824, 1139200, 122496, 1073741824, 10496
.fill 8, 4, 0
.long 279432, 12357376, 262912, L_lanetab-L_back_pc_2+12288, 272000, 8448, 384, 2240, 4405248, 8347648, 26195968, 32038912, 286720, 1086560, 2, 12354560, 199200, 31537152, 31598592, 31598592, 1141760, 122624, 1073741824, 10240
.fill 8, 4, 0
.long 1073741824, 12521216, 262912, L_lanetab-L_back_pc_2+3072, 272256, 8192, 0, 2240, 4410368, 8347648, 26221568, 32100352, 286720, 1127520, 0, 12518400, 1073741824, 1073741824, 1073741824, 1073741824, 1144320, 122752, 1073741824, 9984
.fill 8, 4, 0
.long 269184, 12284672, 263168, L_lanetab-L_back_pc_2+6144, 271488, 8704, 640, 2240, 4732928, 9035776, 26144768, 31916032, 294912, 1332320, 0, 12278784, 615040, 25914368, 25917440, 1073741824, 1464320, 138752, 282812, 11264
.fill 8, 4, 0
.long 268960, 12448512, 263168, L_lanetab-L_back_pc_2+3072, 271744, 8448, 640, 2240, 4738048, 9035776, 26170368, 31977472, 294912, 1373280, 1, 12442624, 1106560, 27368448, 27371520, 1073741824, 1466880, 138880, 1073741824, 11008
.fill 8, 4, 0
.long 279688, 12366592, 263168, L_lanetab-L_back_pc_2+12288, 272000, 8448, 384, 2240, 4732928, 9035776, 26195968, 32038912, 294912, 1414240, 2, 12360704, 199296, 31660032, 31721472, 31721472, 1469440, 139008, 1073741824, 10752
.fill 8, 4, 0
.long 1073741824, 12530432, 263168, L_lanetab-L_back_pc_2+3072, 272256, 8192, 0, 2240, 4738048, 9035776, 26221568, 32100352, 294912, 1455200, 0, 12524544, 1073741824, 1073741824, 1073741824, 1073741824, 1472000, 139136, 1073741824, 10496
.fill 8, 4, 0
.long 270208, 12285696, 263424, L_lanetab-L_back_pc_2+6144, 271488, 8704, 640, 2240, 5060608, 9723904, 26144768, 31916032, 303104, 1660000, 0, 12282880, 615200, 26016768, 26019840, 1073741824, 1792000, 155136, 283324, 11776
.fill 8, 4, 0
.long 269984, 12449536, 263424, L_lanetab-L_back_pc_2+3072, 271744, 8448, 640, 2240, 5065728, 9723904, 26170368, 31977472, 303104, 1700960, 1, 12446720, 1106720, 27614208, 27617280, 1073741824, 1794560, 155264, 1073741824, 11520
.fill 8, 4, 0
.long 279944, 12367616, 263424, L_lanetab-L_back_pc_2+12288, 272000, 8448, 384, 2240, 5060608, 9723904, 26195968, 32038912, 303104, 1741920, 2, 12364800, 199392, 31782912, 31844352, 31844352, 1797120, 155392, 1073741824, 11264
.fill 8, 4, 0
.long 1073741824, 12531456, 263424, L_lanetab-L_back_pc_2+3072, 272256, 8192, 0, 2240, 5065728, 9723904, 26221568, 32100352, 303104, 1782880, 0, 12528640, 1073741824, 1073741824, 1073741824, 1073741824, 1799680, 155520, 1073741824, 11008
.fill 8, 4, 0
.long 271232, 12294912, 263680, L_lanetab-L_back_pc_2+6144, 271488, 8704, 640, 2240, 5388288, 10412032, 26144768, 31916032, 311296, 1987680, 0, 12289024, 615360, 26119168, 26122240, 1073741824, 2119680, 171520, 283836, 12288
.fill 8, 4, 0
.long 271008, 12458752, 263680, L_lanetab-L_back_pc_2+3072, 271744, 8448, 640, 2240, 5393408, 10412032, 26170368, 31977472, 311296, 2028640, 1, 12452864, 1106880, 27859968, 27863040, 1073741824, 2122240, 171648, 1073741824, 12032
.fill 8, 4, 0
.long 280200, 12376832, 263680, L_lanetab-L_back_pc_2+12288, 272000, 8448, 384, 2240, 5388288, 10412032, 26195968, 32038912, 311296, 2069600, 2, 12370944, 199488, 31905792, 31967232, 31967232, 2124800, 171776, 1073741824, 11776
.fill 8, 4, 0
.long 1073741824, 12540672, 263680, L_lanetab-L_back_pc_2+3072, 272256, 8192, 0, 2240, 5393408, 10412032, 26221568, 32100352, 311296, 2110560, 0, 12534784, 1073741824, 1073741824, 1073741824, 1073741824, 2127360, 171904, 1073741824, 11520
.fill 8, 4, 0
.long 272256, 12295936, 263936, L_lanetab-L_back_pc_2+6144, 271488, 8704, 640, 2240, 5715968, 11100160, 26144768, 31916032, 319488, 2315360, 0, 12293120, 615520, 26221568, 26224640, 1073741824, 2447360, 187904, 284348, 12800
.fill 8, 4, 0
.long 272032, 12459776, 263936, L_lanetab-L_back_pc_2+3072, 271744, 8448, 640, 2240, 5721088, 11100160, 26170368, 31977472, 319488, 2356320, 1, 12456960, 1107040, 28105728, 28108800, 1073741824, 2449920, 188032, 1073741824, 12544
.fill 8, 4, 0
.long 280456, 12377856, 263936, L_lanetab-L_back_pc_2+12288, 272000, 8448, 384, 2240, 5715968, 11100160, 26195968, 32038912, 319488, 2397280, 2, 12375040, 199584, 32028672, 32090112, 32090112, 2452480, 188160, 1073741824, 12288
.fill 8, 4, 0
.long 1073741824, 12541696, 263936, L_lanetab-L_back_pc_2+3072, 272256, 8192, 0, 2240, 5721088, 11100160, 26221568, 32100352, 319488, 2438240, 0, 12538880, 1073741824, 1073741824, 1073741824, 1073741824, 2455040, 188288, 1073741824, 12032
.fill 8, 4, 0
.long 265092, 12591104, 294912, L_lanetab-L_back_pc_2+6144, 264320, 8192, 640, 0, 3186688, 5767168, 25427968, 28229632, 262144, 163840, 0, 12582912, 665600, 25509888, 25512960, 1073741824, 163840, 73728, 280960, 16640
.fill 8, 4, 0
.long 264868, 12754944, 294912, L_lanetab-L_back_pc_2+3072, 264576, 7936, 640, 0, 3191808, 5767168, 25453568, 28291072, 262144, 204800, 1, 12746752, 1146880, 26390528, 26393600, 1073741824, 166400, 73856, 1073741824, 16384
.fill 8, 4, 0
.long 272524, 12673024, 294912, L_lanetab-L_back_pc_2+12288, 264832, 7936, 384, 0, 3186688, 5767168, 25479168, 28352512, 262144, 245760, 2, 12664832, 294912, 28222464, 28283904, 28283904, 168960, 73984, 1073741824, 16128
.fill 8, 4, 0
.long 1073741824, 12836864, 294912, L_lanetab-L_back_pc_2+3072, 265088, 7680, 0, 0, 3191808, 5767168, 25504768, 28413952, 262144, 286720, 0, 12828672, 1073741824, 1073741824, 1073741824, 1073741824, 171520, 74112, 1073741824, 15872
.fill 8, 4, 0
.long 266116, 12592128, 295168, L_lanetab-L_back_pc_2+6144, 264320, 8192, 640, 0, 3514368, 6455296, 25427968, 28229632, 270336, 491520, 0, 12587008, 665760, 25612288, 25615360, 1073741824, 491520, 90112, 281472, 17152
.fill 8, 4, 0
.long 265892, 12755968, 295168, L_lanetab-L_back_pc_2+3072, 264576, 7936, 640, 0, 3519488, 6455296, 25453568, 28291072, 270336, 532480, 1, 12750848, 1147040, 26636288, 26639360, 1073741824, 494080, 90240, 1073741824, 16896
.fill 8, 4, 0
.long 272780, 12674048, 295168, L_lanetab-L_back_pc_2+12288, 264832, 7936, 384, 0, 3514368, 6455296, 25479168, 28352512, 270336, 573440, 2, 12668928, 295008, 28345344, 28406784, 28406784, 496640, 90368, 1073741824, 16640
.fill 8, 4, 0
.long 1073741824, 12837888, 295168, L_lanetab-L_back_pc_2+3072, 265088, 7680, 0, 0, 3519488, 6455296, 25504768, 28413952, 270336, 614400, 0, 12832768, 1073741824, 1073741824, 1073741824, 1073741824, 499200, 90496, 1073741824, 16384
.fill 8, 4, 0
.long 267140, 12601344, 295424, L_lanetab-L_back_pc_2+6144, 264320, 8192, 640, 0, 3842048, 7143424, 25427968, 28229632, 278528, 819200, 0, 12593152, 665920, 25714688, 25717760, 1073741824, 819200, 106496, 281984, 17664
.fill 8, 4, 0
.long 266916, 12765184, 295424, L_lanetab-L_back_pc_2+3072, 264576, 7936, 640, 0, 3847168, 7143424, 25453568, 28291072, 278528, 860160, 1, 12756992, 1147200, 26882048, 26885120, 1073741824, 821760, 106624, 1073741824, 17408
.fill 8, 4, 0
.long 273036, 12683264, 295424, L_lanetab-L_back_pc_2+12288, 264832, 7936, 384, 0, 3842048, 7143424, 25479168, 28352512, 278528, 901120, 2, 12675072, 295104, 28468224, 28529664, 28529664, 824320, 106752, 1073741824, 17152
.fill 8, 4, 0
.long 1073741824, 12847104, 295424, L_lanetab-L_back_pc_2+3072, 265088, 7680, 0, 0, 3847168, 7143424, 25504768, 28413952, 278528, 942080, 0, 12838912, 1073741824, 1073741824, 1073741824, 1073741824, 826880, 106880, 1073741824, 16896
.fill 8, 4, 0
.long 268164, 12602368, 295680, L_lanetab-L_back_pc_2+6144, 264320, 8192, 640, 0, 4169728, 7831552, 25427968, 28229632, 286720, 1146880, 0, 12597248, 666080, 25817088, 25820160, 1073741824, 1146880, 122880, 282496, 18176
.fill 8, 4, 0
.long 267940, 12766208, 295680, L_lanetab-L_back_pc_2+3072, 264576, 7936, 640, 0, 4174848, 7831552, 25453568, 28291072, 286720, 1187840, 1, 12761088, 1147360, 27127808, 27130880, 1073741824, 1149440, 123008, 1073741824, 17920
.fill 8, 4, 0
.long 273292, 12684288, 295680, L_lanetab-L_back_pc_2+12288, 264832, 7936, 384, 0, 4169728, 7831552, 25479168, 28352512, 286720, 1228800, 2, 12679168, 295200, 28591104, 28652544, 28652544, 1152000, 123136, 1073741824, 17664
.fill 8, 4, 0
.long 1073741824, 12848128, 295680, L_lanetab-L_back_pc_2+3072, 265088, 7680, 0, 0, 4174848, 7831552, 25504768, 28413952, 286720, 1269760, 0, 12843008, 1073741824, 1073741824, 1073741824, 1073741824, 1154560, 123264, 1073741824, 17408
.fill 8, 4, 0
.long 269188, 12611584, 295936, L_lanetab-L_back_pc_2+6144, 264320, 8192, 640, 0, 4497408, 8519680, 25427968, 28229632, 294912, 1474560, 0, 12603392, 666240, 25919488, 25922560, 1073741824, 1474560, 139264, 283008, 18688
.fill 8, 4, 0
.long 268964, 12775424, 295936, L_lanetab-L_back_pc_2+3072, 264576, 7936, 640, 0, 4502528, 8519680, 25453568, 28291072, 294912, 1515520, 1, 12767232, 1147520, 27373568, 27376640, 1073741824, 1477120, 139392, 1073741824, 18432
.fill 8, 4, 0
.long 273548, 12693504, 295936, L_lanetab-L_back_pc_2+12288, 264832, 7936, 384, 0, 4497408, 8519680, 25479168, 28352512, 294912, 1556480, 2, 12685312, 295296, 28713984, 28775424, 28775424, 1479680, 139520, 1073741824, 18176
.fill 8, 4, 0
.long 1073741824, 12857344, 295936, L_lanetab-L_back_pc_2+3072, 265088, 7680, 0, 0, 4502528, 8519680, 25504768, 28413952, 294912, 1597440, 0, 12849152, 1073741824, 1073741824, 1073741824, 1073741824, 1482240, 139648, 1073741824, 17920
.fill 8, 4, 0
.long 270212, 12612608, 296192, L_lanetab-L_back_pc_2+6144, 264320, 8192, 640, 0, 4825088, 9207808, 25427968, 28229632, 303104, 1802240, 0, 12607488, 666400, 26021888, 26024960, 1073741824, 1802240, 155648, 283520, 19200
.fill 8, 4, 0
.long 269988, 12776448, 296192, L_lanetab-L_back_pc_2+3072, 264576, 7936, 640, 0, 4830208, 9207808, 25453568, 28291072, 303104, 1843200, 1, 12771328, 1147680, 27619328, 27622400, 1073741824, 1804800, 155776, 1073741824, 18944
.fill 8, 4, 0
.long 273804, 12694528, 296192, L_lanetab-L_back_pc_2+12288, 264832, 7936, 384, 0, 4825088, 9207808, 25479168, 28352512, 303104, 1884160, 2, 12689408, 295392, 28836864, 28898304, 28898304, 1807360, 155904, 1073741824, 18688
.fill 8, 4, 0
.long 1073741824, 12858368, 296192, L_lanetab-L_back_pc_2+3072, 265088, 7680, 0, 0, 4830208, 9207808, 25504768, 28413952, 303104, 1925120, 0, 12853248, 1073741824, 1073741824, 1073741824, 1073741824, 1809920, 156032, 1073741824, 18432
.fill 8, 4, 0
.long 271236, 12621824, 296448, L_lanetab-L_back_pc_2+6144, 264320, 8192, 640, 0, 5152768, 9895936, 25427968, 28229632, 311296, 2129920, 0, 12613632, 666560, 26124288, 26127360, 1073741824, 2129920, 172032, 284032, 19712
.fill 8, 4, 0
.long 271012, 12785664, 296448, L_lanetab-L_back_pc_2+3072, 264576, 7936, 640, 0, 5157888, 9895936, 25453568, 28291072, 311296, 2170880, 1, 12777472, 1147840, 27865088, 27868160, 1073741824, 2132480, 172160, 1073741824, 19456
.fill 8, 4, 0
.long 274060, 12703744, 296448, L_lanetab-L_back_pc_2+12288, 264832, 7936, 384, 0, 5152768, 9895936, 25479168, 28352512, 311296, 2211840, 2, 12695552, 295488, 28959744, 29021184, 29021184, 2135040, 172288, 1073741824, 19200
.fill 8, 4, 0
.long 1073741824, 12867584, 296448, L_lanetab-L_back_pc_2+3072, 265088, 7680, 0, 0, 5157888, 9895936, 25504768, 28413952, 311296, 2252800, 0, 12859392, 1073741824, 1073741824, 1073741824, 1073741824, 2137600, 172416, 1073741824, 18944
.fill 8, 4, 0
.long 272260, 12622848, 296704, L_lanetab-L_back_pc_2+6144, 264320, 8192, 640, 0, 5480448, 10584064, 25427968, 28229632, 319488, 2457600, 0, 12617728, 666720, 26226688, 26229760, 1073741824, 2457600, 188416, 284544, 20224
.fill 8, 4, 0
.long 272036, 12786688, 296704, L_lanetab-L_back_pc_2+3072, 264576, 7936, 640, 0, 5485568, 10584064, 25453568, 28291072, 319488, 2498560, 1, 12781568, 1148000, 28110848, 28113920, 1073741824, 2460160, 188544, 1073741824, 19968
.fill 8, 4, 0
.long 274316, 12704768, 296704, L_lanetab-L_back_pc_2+12288, 264832, 7936, 384, 0, 5480448, 10584064, 25479168, 28352512, 319488, 2539520, 2, 12699648, 295584, 29082624, 29144064, 29144064, 2462720, 188672, 1073741824, 19712
.fill 8, 4, 0
.long 1073741824, 12868608, 296704, L_lanetab-L_back_pc_2+3072, 265088, 7680, 0, 0, 5485568, 10584064, 25504768, 28413952, 319488, 2580480, 0, 12863488, 1073741824, 1073741824, 1073741824, 1073741824, 2465280, 188800, 1073741824, 19456
.fill 8, 4, 0
.long 265096, 12591360, 294912, L_lanetab-L_back_pc_2+6144, 265344, 7680, 640, 320, 3268608, 5939200, 25530368, 28475392, 262144, 164000, 0, 12583936, 716800, 25515008, 25518080, 1073741824, 174080, 74240, 280964, 15616
.fill 8, 4, 0
.long 264872, 12755200, 294912, L_lanetab-L_back_pc_2+3072, 265600, 7424, 640, 320, 3273728, 5939200, 25555968, 28536832, 262144, 204960, 1, 12747776, 1187840, 26395648, 26398720, 1073741824, 176640, 74368, 1073741824, 15360
.fill 8, 4, 0
.long 274572, 12673280, 294912, L_lanetab-L_back_pc_2+12288, 265856, 7424, 384, 320, 3268608, 5939200, 25581568, 28598272, 262144, 245920, 2, 12665856, 295680, 29205504, 29266944, 29266944, 179200, 74496, 1073741824, 15104
.fill 8, 4, 0
.long 1073741824, 12837120, 294912, L_lanetab-L_back_pc_2+3072, 266112, 7168, 0, 320, 3273728, 5939200, 25607168, 28659712, 262144, 286880, 0, 12829696, 1073741824, 1073741824, 1073741824, 1073741824, 181760, 74624, 1073741824, 14848
.fill 8, 4, 0
.long 266120, 12592384, 295168, L_lanetab-L_back_pc_2+6144, 265344, 7680, 640, 320, 3596288, 6627328, 25530368, 28475392, 270336, 491680, 0, 12588032, 716960, 25617408, 25620480, 1073741824, 501760, 90624, 281476, 16128
.fill 8, 4, 0
.long 265896, 12756224, 295168, L_lanetab-L_back_pc_2+3072, 265600, 7424, 640, 320, 3601408, 6627328, 25555968, 28536832, 270336, 532640, 1, 12751872, 1188000, 26641408, 26644480, 1073741824, 504320, 90752, 1073741824, 15872
.fill 8, 4, 0
.long 274828, 12674304, 295168, L_lanetab-L_back_pc_2+12288, 265856, 7424, 384, 320, 3596288, 6627328, 25581568, 28598272, 270336, 573600, 2, 12669952, 295776, 29328384, 29389824, 29389824, 506880, 90880, 1073741824, 15616
.fill 8, 4, 0
.long 1073741824, 12838144, 295168, L_lanetab-L_back_pc_2+3072, 266112, 7168, 0, 320, 3601408, 6627328, 25607168, 28659712, 270336, 614560, 0, 12833792, 1073741824, 1073741824, 1073741824, 1073741824, 509440, 91008, 1073741824, 15360
.fill 8, 4, 0
.long 267144, 12601600, 295424, L_lanetab-L_back_pc_2+6144, 265344, 7680, 640, 320, 3923968, 7315456, 25530368, 28475392, 278528, 819360, 0, 12594176, 717120, 25719808, 25722880, 1073741824, 829440, 107008, 281988, 16640
.fill 8, 4, 0
.long 266920, 12765440, 295424, L_lanetab-L_back_pc_2+3072, 265600, 7424, 640, 320, 3929088, 7315456, 25555968, 28536832, 278528, 860320, 1, 12758016, 1188160, 26887168, 26890240, 1073741824, 832000, 107136, 1073741824, 16384
.fill 8, 4, 0
.long 275084, 12683520, 295424, L_lanetab-L_back_pc_2+12288, 265856, 7424, 384, 320, 3923968, 7315456, 25581568, 28598272, 278528, 901280, 2, 12676096, 295872, 29451264, 29512704, 29512704, 834560, 107264, 1073741824, 16128
.fill 8, 4, 0
.long 1073741824, 12847360, 295424, L_lanetab-L_back_pc_2+3072, 266112, 7168, 0, 320, 3929088, 7315456, 25607168, 28659712, 278528, 942240, 0, 12839936, 1073741824, 1073741824, 1073741824, 1073741824, 837120, 107392, 1073741824, 15872
.fill 8, 4, 0
.long 268168, 12602624, 295680, L_lanetab-L_back_pc_2+6144, 265344, 7680, 640, 320, 4251648, 8003584, 25530368, 28475392, 286720, 1147040, 0, 12598272, 717280, 25822208, 25825280, 1073741824, 1157120, 123392, 282500, 17152
.fill 8, 4, 0
.long 267944, 12766464, 295680, L_lanetab-L_back_pc_2+3072, 265600, 7424, 640, 320, 4256768, 8003584, 25555968, 28536832, 286720, 1188000, 1, 12762112, 1188320, 27132928, 27136000, 1073741824, 1159680, 123520, 1073741824, 16896
.fill 8, 4, 0
.long 275340, 12684544, 295680, L_lanetab-L_back_pc_2+12288, 265856, 7424, 384, 320, 4251648, 8003584, 25581568, 28598272, 286720, 1228960, 2, 12680192, 295968, 29574144, 29635584, 29635584, 1162240, 123648, 1073741824, 16640
.fill 8, 4, 0
.long 1073741824, 12848384, 295680, L_lanetab-L_back_pc_2+3072, 266112, 7168, 0, 320, 4256768, 8003584, 25607168, 28659712, 286720, 1269920, 0, 12844032, 1073741824, 1073741824, 1073741824, 1073741824, 1164800, 123776, 1073741824, 16384
.fill 8, 4, 0
.long 269192, 12611840, 295936, L_lanetab-L_back_pc_2+6144, 265344, 7680, 640, 320, 4579328, 8691712, 25530368, 28475392, 294912, 1474720, 0, 12604416, 717440, 25924608, 25927680, 1073741824, 1484800, 139776, 283012, 17664
.fill 8, 4, 0
.long 268968, 12775680, 295936, L_lanetab-L_back_pc_2+3072, 265600, 7424, 640, 320, 4584448, 8691712, 25555968, 28536832, 294912, 1515680, 1, 12768256, 1188480, 27378688, 27381760, 1073741824, 1487360, 139904, 1073741824, 17408
.fill 8, 4, 0
.long 275596, 12693760, 295936, L_lanetab-L_back_pc_2+12288, 265856, 7424, 384, 320, 4579328, 8691712, 25581568, 28598272, 294912, 1556640, 2, 12686336, 296064, 29697024, 29758464, 29758464, 1489920, 140032, 1073741824, 17152
.fill 8, 4, 0
.long 1073741824, 12857600, 295936, L_lanetab-L_back_pc_2+3072, 266112, 7168, 0, 320, 4584448, 8691712, 25607168, 28659712, 294912, 1597600, 0, 12850176, 1073741824, 1073741824, 1073741824, 1073741824, 1492480, 140160, 1073741824, 16896
.fill 8, 4, 0
.long 270216, 12612864, 296192, L_lanetab-L_back_pc_2+6144, 265344, 7680, 640, 320, 4907008, 9379840, 25530368, 28475392, 303104, 1802400, 0, 12608512, 717600, 26027008, 26030080, 1073741824, 1812480, 156160, 283524, 18176
.fill 8, 4, 0
.long 269992, 12776704, 296192, L_lanetab-L_back_pc_2+3072, 265600, 7424, 640, 320, 4912128, 9379840, 25555968, 28536832, 303104, 1843360, 1, 12772352, 1188640, 27624448, 27627520, 1073741824, 1815040, 156288, 1073741824, 17920
.fill 8, 4, 0
.long 275852, 12694784, 296192, L_lanetab-L_back_pc_2+12288, 265856, 7424, 384, 320, 4907008, 9379840, 25581568, 28598272, 303104, 1884320, 2, 12690432, 296160, 29819904, 29881344, 29881344, 1817600, 156416, 1073741824, 17664
.fill 8, 4, 0
.long 1073741824, 12858624, 296192, L_lanetab-L_back_pc_2+3072, 266112, 7168, 0, 320, 4912128, 9379840, 25607168, 28659712, 303104, 1925280, 0, 12854272, 1073741824, 1073741824, 1073741824, 1073741824, 1820160, 156544, 1073741824, 17408
.fill 8, 4, 0
.long 271240, 12622080, 296448, L_lanetab-L_back_pc_2+6144, 265344, 7680, 640, 320, 5234688, 10067968, 25530368, 28475392, 311296, 2130080, 0, 12614656, 717760, 26129408, 26132480, 1073741824, 2140160, 172544, 284036, 18688
.fill 8, 4, 0
.long 271016, 12785920, 296448, L_lanetab-L_back_pc_2+3072, 265600, 7424, 640, 320, 5239808, 10067968, 25555968, 28536832, 311296, 2171040, 1, 12778496, 1188800, 27870208, 27873280, 1073741824, 2142720, 172672, 1073741824, 18432
.fill 8, 4, 0
.long 276108, 12704000, 296448, L_lanetab-L_back_pc_2+12288, 265856, 7424, 384, 320, 5234688, 10067968, 25581568, 28598272, 311296, 2212000, 2, 12696576, 296256, 29942784, 30004224, 30004224, 2145280, 172800, 1073741824, 18176
.fill 8, 4, 0
.long 1073741824, 12867840, 296448, L_lanetab-L_back_pc_2+3072, 266112, 7168, 0, 320, 5239808, 10067968, 25607168, 28659712, 311296, 2252960, 0, 12860416, 1073741824, 1073741824, 1073741824, 1073741824, 2147840, 172928, 1073741824, 17920
.fill 8, 4, 0
.long 272264, 12623104, 296704, L_lanetab-L_back_pc_2+6144, 265344, 7680, 640, 320, 5562368, 10756096, 25530368, 28475392, 319488, 2457760, 0, 12618752, 717920, 26231808, 26234880, 1073741824, 2467840, 188928, 284548, 19200
.fill 8, 4, 0
.long 272040, 12786944, 296704, L_lanetab-L_back_pc_2+3072, 265600, 7424, 640, 320, 5567488, 10756096, 25555968, 28536832, 319488, 2498720, 1, 12782592, 1188960, 28115968, 28119040, 1073741824, 2470400, 189056, 1073741824, 18944
.fill 8, 4, 0
.long 276364, 12705024, 296704, L_lanetab-L_back_pc_2+12288, 265856, 7424, 384, 320, 5562368, 10756096, 25581568, 28598272, 319488, 2539680, 2, 12700672, 296352, 30065664, 30127104, 30127104, 2472960, 189184, 1073741824, 18688
.fill 8, 4, 0
.long 1073741824, 12868864, 296704, L_lanetab-L_back_pc_2+3072, 266112, 7168, 0, 320, 5567488, 10756096, 25607168, 28659712, 319488, 2580640, 0, 12864512, 1073741824, 1073741824, 1073741824, 1073741824, 2475520, 189312, 1073741824, 18432
.fill 8, 4, 0
.long 265100, 12591616, 294912, L_lanetab-L_back_pc_2+6144, 266368, 7168, 640, 640, 3350528, 6111232, 25632768, 28721152, 262144, 164160, 0, 12584960, 768000, 25520128, 25523200, 1073741824, 184320, 74752, 280968, 14592
.fill 8, 4, 0
.long 264876, 12755456, 294912, L_lanetab-L_back_pc_2+3072, 266624, 6912, 640, 640, 3355648, 6111232, 25658368, 28782592, 262144, 205120, 1, 12748800, 1228800, 26400768, 26403840, 1073741824, 186880, 74880, 1073741824, 14336
.fill 8, 4, 0
.long 276620, 12673536, 294912, L_lanetab-L_back_pc_2+12288, 266880, 6912, 384, 640, 3350528, 6111232, 25683968, 28844032, 262144, 246080, 2, 12666880, 296448, 30188544, 30249984, 30249984, 189440, 75008, 1073741824, 14080
.fill 8, 4, 0
.long 1073741824, 12837376, 294912, L_lanetab-L_back_pc_2+3072, 267136, 6656, 0, 640, 3355648, 6111232, 25709568, 28905472, 262144, 287040, 0, 12830720, 1073741824, 1073741824, 1073741824, 1073741824, 192000, 75136, 1073741824, 13824
.fill 8, 4, 0
.long 266124, 12592640, 295168, L_lanetab-L_back_pc_2+6144, 266368, 7168, 640, 640, 3678208, 6799360, 25632768, 28721152, 270336, 491840, 0, 12589056, 768160, 25622528, 25625600, 1073741824, 512000, 91136, 281480, 15104
.fill 8, 4, 0
.long 265900, 12756480, 295168, L_lanetab-L_back_pc_2+3072, 266624, 6912, 640, 640, 3683328, 6799360, 25658368, 28782592, 270336, 532800, 1, 12752896, 1228960, 26646528, 26649600, 1073741824, 514560, 91264, 1073741824, 14848
.fill 8, 4, 0
.long 276876, 12674560, 295168, L_lanetab-L_back_pc_2+12288, 266880, 6912, 384, 640, 3678208, 6799360, 25683968, 28844032, 270336, 573760, 2, 12670976, 296544, 30311424, 30372864, 30372864, 517120, 91392, 1073741824, 14592
.fill 8, 4, 0
.long 1073741824, 12838400, 295168, L_lanetab-L_back_pc_2+3072, 267136, 6656, 0, 640, 3683328, 6799360, 25709568, 28905472, 270336, 614720, 0, 12834816, 1073741824, 1073741824, 1073741824, 1073741824, 519680, 91520, 1073741824, 14336
.fill 8, 4, 0
.long 267148, 12601856, 295424, L_lanetab-L_back_pc_2+6144, 266368, 7168, 640, 640, 4005888, 7487488, 25632768, 28721152, 278528, 819520, 0, 12595200, 768320, 25724928, 25728000, 1073741824, 839680, 107520, 281992, 15616
.fill 8, 4, 0
.long 266924, 12765696, 295424, L_lanetab-L_back_pc_2+3072, 266624, 6912, 640, 640, 4011008, 7487488, 25658368, 28782592, 278528, 860480, 1, 12759040, 1229120, 26892288, 26895360, 1073741824, 842240, 107648, 1073741824, 15360
.fill 8, 4, 0
.long 277132, 12683776, 295424, L_lanetab-L_back_pc_2+12288, 266880, 6912, 384, 640, 4005888, 7487488, 25683968, 28844032, 278528, 901440, 2, 12677120, 296640, 30434304, 30495744, 30495744, 844800, 107776, 1073741824, 15104
.fill 8, 4, 0
.long 1073741824, 12847616, 295424, L_lanetab-L_back_pc_2+3072, 267136, 6656, 0, 640, 4011008, 7487488, 25709568, 28905472, 278528, 942400, 0, 12840960, 1073741824, 1073741824, 1073741824, 1073741824, 847360, 107904, 1073741824, 14848
.fill 8, 4, 0
.long 268172, 12602880, 295680, L_lanetab-L_back_pc_2+6144, 266368, 7168, 640, 640, 4333568, 8175616, 25632768, 28721152, 286720, 1147200, 0, 12599296, 768480, 25827328, 25830400, 1073741824, 1167360, 123904, 282504, 16128
.fill 8, 4, 0
.long 267948, 12766720, 295680, L_lanetab-L_back_pc_2+3072, 266624, 6912, 640, 640, 4338688, 8175616, 25658368, 28782592, 286720, 1188160, 1, 12763136, 1229280, 27138048, 27141120, 1073741824, 1169920, 124032, 1073741824, 15872
.fill 8, 4, 0
.long 277388, 12684800, 295680, L_lanetab-L_back_pc_2+12288, 266880, 6912, 384, 640, 4333568, 8175616, 25683968, 28844032, 286720, 1229120, 2, 12681216, 296736, 30557184, 30618624, 30618624, 1172480, 124160, 1073741824, 15616
.fill 8, 4, 0
.long 1073741824, 12848640, 295680, L_lanetab-L_back_pc_2+3072, 267136, 6656, 0, 640, 4338688, 8175616, 25709568, 28905472, 286720, 1270080, 0, 12845056, 1073741824, 1073741824, 1073741824, 1073741824, 1175040, 124288, 1073741824, 15360
.fill 8, 4, 0
.long 269196, 12612096, 295936, L_lanetab-L_back_pc_2+6144, 266368, 7168, 640, 640, 4661248, 8863744, 25632768, 28721152, 294912, 1474880, 0, 12605440, 768640, 25929728, 25932800, 1073741824, 1495040, 140288, 283016, 16640
.fill 8, 4, 0
.long 268972, 12775936, 295936, L_lanetab-L_back_pc_2+3072, 266624, 6912, 640, 640, 4666368, 8863744, 25658368, 28782592, 294912, 1515840, 1, 12769280, 1229440, 27383808, 27386880, 1073741824, 1497600, 140416, 1073741824, 16384
.fill 8, 4, 0
.long 277644, 12694016, 295936, L_lanetab-L_back_pc_2+12288, 266880, 6912, 384, 640, 4661248, 8863744, 25683968, 28844032, 294912, 1556800, 2, 12687360, 296832, 30680064, 30741504, 30741504, 1500160, 140544, 1073741824, 16128
.fill 8, 4, 0
.long 1073741824, 12857856, 295936, L_lanetab-L_back_pc_2+3072, 267136, 6656, 0, 640, 4666368, 8863744, 25709568, 28905472, 294912, 1597760, 0, 12851200, 1073741824, 1073741824, 1073741824, 1073741824, 1502720, 140672, 1073741824, 15872
.fill 8, 4, 0
.long 270220, 12613120, 296192, L_lanetab-L_back_pc_2+6144, 266368, 7168, 640, 640, 4988928, 9551872, 25632768, 28721152, 303104, 1802560, 0, 12609536, 768800, 26032128, 26035200, 1073741824, 1822720, 156672, 283528, 17152
.fill 8, 4, 0
.long 269996, 12776960, 296192, L_lanetab-L_back_pc_2+3072, 266624, 6912, 640, 640, 4994048, 9551872, 25658368, 28782592, 303104, 1843520, 1, 12773376, 1229600, 27629568, 27632640, 1073741824, 1825280, 156800, 1073741824, 16896
.fill 8, 4, 0
.long 277900, 12695040, 296192, L_lanetab-L_back_pc_2+12288, 266880, 6912, 384, 640, 4988928, 9551872, 25683968, 28844032, 303104, 1884480, 2, 12691456, 296928, 30802944, 30864384, 30864384, 1827840, 156928, 1073741824, 16640
.fill 8, 4, 0
.long 1073741824, 12858880, 296192, L_lanetab-L_back_pc_2+3072, 267136, 6656, 0, 640, 4994048, 9551872, 25709568, 28905472, 303104, 1925440, 0, 12855296, 1073741824, 1073741824, 1073741824, 1073741824, 1830400, 157056, 1073741824, 16384
.fill 8, 4, 0
.long 271244, 12622336, 296448, L_lanetab-L_back_pc_2+6144, 266368, 7168, 640, 640, 5316608, 10240000, 25632768, 28721152, 311296, 2130240, 0, 12615680, 768960, 26134528, 26137600, 1073741824, 2150400, 173056, 284040, 17664
.fill 8, 4, 0
.long 271020, 12786176, 296448, L_lanetab-L_back_pc_2+3072, 266624, 6912, 640, 640, 5321728, 10240000, 25658368, 28782592, 311296, 2171200, 1, 12779520, 1229760, 27875328, 27878400, 1073741824, 2152960, 173184, 1073741824, 17408
.fill 8, 4, 0
.long 278156, 12704256, 296448, L_lanetab-L_back_pc_2+12288, 266880, 6912, 384, 640, 5316608, 10240000, 25683968, 28844032, 311296, 2212160, 2, 12697600, 297024, 30925824, 30987264, 30987264, 2155520, 173312, 1073741824, 17152
.fill 8, 4, 0
.long 1073741824, 12868096, 296448, L_lanetab-L_back_pc_2+3072, 267136, 6656, 0, 640, 5321728, 10240000, 25709568, 28905472, 311296, 2253120, 0, 12861440, 1073741824, 1073741824, 1073741824, 1073741824, 2158080, 173440, 1073741824, 16896
.fill 8, 4, 0
.long 272268, 12623360, 296704, L_lanetab-L_back_pc_2+6144, 266368, 7168, 640, 640, 5644288, 10928128, 25632768, 28721152, 319488, 2457920, 0, 12619776, 769120, 26236928, 26240000, 1073741824, 2478080, 189440, 284552, 18176
.fill 8, 4, 0
.long 272044, 12787200, 296704, L_lanetab-L_back_pc_2+3072, 266624, 6912, 640, 640, 5649408, 10928128, 25658368, 28782592, 319488, 2498880, 1, 12783616, 1229920, 28121088, 28124160, 1073741824, 2480640, 189568, 1073741824, 17920
.fill 8, 4, 0
.long 278412, 12705280, 296704, L_lanetab-L_back_pc_2+12288, 266880, 6912, 384, 640, 5644288, 10928128, 25683968, 28844032, 319488, 2539840, 2, 12701696, 297120, 31048704, 31110144, 31110144, 2483200, 189696, 1073741824, 17664
.fill 8, 4, 0
.long 1073741824, 12869120, 296704, L_lanetab-L_back_pc_2+3072, 267136, 6656, 0, 640, 5649408, 10928128, 25709568, 28905472, 319488, 2580800, 0, 12865536, 1073741824, 1073741824, 1073741824, 1073741824, 2485760, 189824, 1073741824, 17408
.fill 8, 4, 0
.long 265104, 12591872, 294912, L_lanetab-L_back_pc_2+9216, 267392, 6656, 640, 960, 3432448, 6283264, 25735168, 28966912, 262144, 164320, 0, 12585984, 634880, 25525248, 25528320, 1073741824, 194560, 75264, 280972, 13568
.fill 8, 4, 0
.long 264880, 12755712, 294912, L_lanetab-L_back_pc_2+3072, 267648, 6400, 640, 960, 3437568, 6283264, 25760768, 29028352, 262144, 205280, 1, 12749824, 1269760, 26405888, 26408960, 1073741824, 197120, 75392, 1073741824, 13312
.fill 8, 4, 0
.long 278668, 12673792, 294912, L_lanetab-L_back_pc_2+12288, 267904, 6400, 384, 960, 3432448, 6283264, 25786368, 29089792, 262144, 246240, 2, 12667904, 297216, 31171584, 31233024, 31233024, 199680, 75520, 1073741824, 13056
.fill 8, 4, 0
.long 1073741824, 12837632, 294912, L_lanetab-L_back_pc_2+3072, 268160, 6144, 0, 960, 3437568, 6283264, 25811968, 29151232, 262144, 287200, 0, 12831744, 1073741824, 1073741824, 1073741824, 1073741824, 202240, 75648, 1073741824, 12800
.fill 8, 4, 0
.long 266128, 12592896, 295168, L_lanetab-L_back_pc_2+9216, 267392, 6656, 640, 960, 3760128, 6971392, 25735168, 28966912, 270336, 492000, 0, 12590080, 635040, 25627648, 25630720, 1073741824, 522240, 91648, 281484, 14080
.fill 8, 4, 0
.long 265904, 12756736, 295168, L_lanetab-L_back_pc_2+3072, 267648, 6400, 640, 960, 3765248, 6971392, 25760768, 29028352, 270336, 532960, 1, 12753920, 1269920, 26651648, 26654720, 1073741824, 524800, 91776, 1073741824, 13824
.fill 8, 4, 0
.long 278924, 12674816, 295168, L_lanetab-L_back_pc_2+12288, 267904, 6400, 384, 960, 3760128, 6971392, 25786368, 29089792, 270336, 573920, 2, 12672000, 297312, 31294464, 31355904, 31355904, 527360, 91904, 1073741824, 13568
.fill 8, 4, 0
.long 1073741824, 12838656, 295168, L_lanetab-L_back_pc_2+3072, 268160, 6144, 0, 960, 3765248, 6971392, 25811968, 29151232, 270336, 614880, 0, 12835840, 1073741824, 1073741824, 1073741824, 1073741824, 529920, 92032, 1073741824, 13312
.fill 8, 4, 0
.long 267152, 12602112, 295424, L_lanetab-L_back_pc_2+9216, 267392, 6656, 640, 960, 4087808, 7659520, 25735168, 28966912, 278528, 819680, 0, 12596224, 635200, 25730048, 25733120, 1073741824, 849920, 108032, 281996, 14592
.fill 8, 4, 0
.long 266928, 12765952, 295424, L_lanetab-L_back_pc_2+3072, 267648, 6400, 640, 960, 4092928, 7659520, 25760768, 29028352, 278528, 860640, 1, 12760064, 1270080, 26897408, 26900480, 1073741824, 852480, 108160, 1073741824, 14336
.fill 8, 4, 0
.long 279180, 12684032, 295424, L_lanetab-L_back_pc_2+12288, 267904, 6400, 384, 960, 4087808, 7659520, 25786368, 29089792, 278528, 901600, 2, 12678144, 297408, 31417344, 31478784, 31478784, 855040, 108288, 1073741824, 14080
.fill 8, 4, 0
.long 1073741824, 12847872, 295424, L_lanetab-L_back_pc_2+3072, 268160, 6144, 0, 960, 4092928, 7659520, 25811968, 29151232, 278528, 942560, 0, 12841984, 1073741824, 1073741824, 1073741824, 1073741824, 857600, 108416, 1073741824, 13824
.fill 8, 4, 0
.long 268176, 12603136, 295680, L_lanetab-L_back_pc_2+9216, 267392, 6656, 640, 960, 4415488, 8347648, 25735168, 28966912, 286720, 1147360, 0, 12600320, 635360, 25832448, 25835520, 1073741824, 1177600, 124416, 282508, 15104
.fill 8, 4, 0
.long 267952, 12766976, 295680, L_lanetab-L_back_pc_2+3072, 267648, 6400, 640, 960, 4420608, 8347648, 25760768, 29028352, 286720, 1188320, 1, 12764160, 1270240, 27143168, 27146240, 1073741824, 1180160, 124544, 1073741824, 14848
.fill 8, 4, 0
.long 279436, 12685056, 295680, L_lanetab-L_back_pc_2+12288, 267904, 6400, 384, 960, 4415488, 8347648, 25786368, 29089792, 286720, 1229280, 2, 12682240, 297504, 31540224, 31601664, 31601664, 1182720, 124672, 1073741824, 14592
.fill 8, 4, 0
.long 1073741824, 12848896, 295680, L_lanetab-L_back_pc_2+3072, 268160, 6144, 0, 960, 4420608, 8347648, 25811968, 29151232, 286720, 1270240, 0, 12846080, 1073741824, 1073741824, 1073741824, 1073741824, 1185280, 124800, 1073741824, 14336
.fill 8, 4, 0
.long 269200, 12612352, 295936, L_lanetab-L_back_pc_2+9216, 267392, 6656, 640, 960, 4743168, 9035776, 25735168, 28966912, 294912, 1475040, 0, 12606464, 635520, 25934848, 25937920, 1073741824, 1505280, 140800, 283020, 15616
.fill 8, 4, 0
.long 268976, 12776192, 295936, L_lanetab-L_back_pc_2+3072, 267648, 6400, 640, 960, 4748288, 9035776, 25760768, 29028352, 294912, 1516000, 1, 12770304, 1270400, 27388928, 27392000, 1073741824, 1507840, 140928, 1073741824, 15360
.fill 8, 4, 0
.long 279692, 12694272, 295936, L_lanetab-L_back_pc_2+12288, 267904, 6400, 384, 960, 4743168, 9035776, 25786368, 29089792, 294912, 1556960, 2, 12688384, 297600, 31663104, 31724544, 31724544, 1510400, 141056, 1073741824, 15104
.fill 8, 4, 0
.long 1073741824, 12858112, 295936, L_lanetab-L_back_pc_2+3072, 268160, 6144, 0, 960, 4748288, 9035776, 25811968, 29151232, 294912, 1597920, 0, 12852224, 1073741824, 1073741824, 1073741824, 1073741824, 1512960, 141184, 1073741824, 14848
.fill 8, 4, 0
.long 270224, 12613376, 296192, L_lanetab-L_back_pc_2+9216, 267392, 6656, 640, 960, 5070848, 9723904, 25735168, 28966912, 303104, 1802720, 0, 12610560, 635680, 26037248, 26040320, 1073741824, 1832960, 157184, 283532, 16128
.fill 8, 4, 0
.long 270000, 12777216, 296192, L_lanetab-L_back_pc_2+3072, 267648, 6400, 640, 960, 5075968, 9723904, 25760768, 29028352, 303104, 1843680, 1, 12774400, 1270560, 27634688, 27637760, 1073741824, 1835520, 157312, 1073741824, 15872
.fill 8, 4, 0
.long 279948, 12695296, 296192, L_lanetab-L_back_pc_2+12288, 267904, 6400, 384, 960, 5070848, 9723904, 25786368, 29089792, 303104, 1884640, 2, 12692480, 297696, 31785984, 31847424, 31847424, 1838080, 157440, 1073741824, 15616
.fill 8, 4, 0
.long 1073741824, 12859136, 296192, L_lanetab-L_back_pc_2+3072, 268160, 6144, 0, 960, 5075968, 9723904, 25811968, 29151232, 303104, 1925600, 0, 12856320, 1073741824, 1073741824, 1073741824, 1073741824, 1840640, 157568, 1073741824, 15360
.fill 8, 4, 0
.long 271248, 12622592, 296448, L_lanetab-L_back_pc_2+9216, 267392, 6656, 640, 960, 5398528, 10412032, 25735168, 28966912, 311296, 2130400, 0, 12616704, 635840, 26139648, 26142720, 1073741824, 2160640, 173568, 284044, 16640
.fill 8, 4, 0
.long 271024, 12786432, 296448, L_lanetab-L_back_pc_2+3072, 267648, 6400, 640, 960, 5403648, 10412032, 25760768, 29028352, 311296, 2171360, 1, 12780544, 1270720, 27880448, 27883520, 1073741824, 2163200, 173696, 1073741824, 16384
.fill 8, 4, 0
.long 280204, 12704512, 296448, L_lanetab-L_back_pc_2+12288, 267904, 6400, 384, 960, 5398528, 10412032, 25786368, 29089792, 311296, 2212320, 2, 12698624, 297792, 31908864, 31970304, 31970304, 2165760, 173824, 1073741824, 16128
.fill 8, 4, 0
.long 1073741824, 12868352, 296448, L_lanetab-L_back_pc_2+3072, 268160, 6144, 0, 960, 5403648, 10412032, 25811968, 29151232, 311296, 2253280, 0, 12862464, 1073741824, 1073741824, 1073741824, 1073741824, 2168320, 173952, 1073741824, 15872
.fill 8, 4, 0
.long 272272, 12623616, 296704, L_lanetab-L_back_pc_2+9216, 267392, 6656, 640, 960, 5726208, 11100160, 25735168, 28966912, 319488, 2458080, 0, 12620800, 636000, 26242048, 26245120, 1073741824, 2488320, 189952, 284556, 17152
.fill 8, 4, 0
.long 272048, 12787456, 296704, L_lanetab-L_back_pc_2+3072, 267648, 6400, 640, 960, 5731328, 11100160, 25760768, 29028352, 319488, 2499040, 1, 12784640, 1270880, 28126208, 28129280, 1073741824, 2490880, 190080, 1073741824, 16896
.fill 8, 4, 0
.long 280460, 12705536, 296704, L_lanetab-L_back_pc_2+12288, 267904, 6400, 384, 960, 5726208, 11100160, 25786368, 29089792, 319488, 2540000, 2, 12702720, 297888, 32031744, 32093184, 32093184, 2493440, 190208, 1073741824, 16640
.fill 8, 4, 0
.long 1073741824, 12869376, 296704, L_lanetab-L_back_pc_2+3072, 268160, 6144, 0, 960, 5731328, 11100160, 25811968, 29151232, 319488, 2580960, 0, 12866560, 1073741824, 1073741824, 1073741824, 1073741824, 2496000, 190336, 1073741824, 16384
.fill 8, 4, 0
.long 264340, 12918784, 294912, L_lanetab-L_back_pc_2+3072, 268416, 6144, 640, 1280, 3196928, 5767168, 25837568, 29212672, 262144, 164480, 1, 12910592, 0, 26247168, 26250240, 1073741824, 204800, 75776, 280976, 12544
.fill 8, 4, 0
.long 264884, 13082624, 294912, L_lanetab-L_back_pc_2+3072, 268672, 5888, 640, 1280, 3202048, 5767168, 25863168, 29274112, 262144, 205440, 1, 13074432, 1310720, 26411008, 26414080, 1073741824, 207360, 75904, 1073741824, 12288
.fill 8, 4, 0
.long 1073741824, 13000704, 294912, L_lanetab-L_back_pc_2+3072, 268928, 5888, 0, 1280, 3196928, 5767168, 25888768, 29335552, 262144, 246400, 0, 12992512, 1073741824, 1073741824, 1073741824, 1073741824, 209920, 76032, 1073741824, 12032
.fill 8, 4, 0
.long 1073741824, 13164544, 294912, L_lanetab-L_back_pc_2+3072, 269184, 5632, 0, 1280, 3202048, 5767168, 25914368, 29396992, 262144, 287360, 0, 13156352, 1073741824, 1073741824, 1073741824, 1073741824, 212480, 76160, 1073741824, 11776
.fill 8, 4, 0
.long 265364, 12919808, 295168, L_lanetab-L_back_pc_2+3072, 268416, 6144, 640, 1280, 3524608, 6455296, 25837568, 29212672, 270336, 492160, 1, 12914688, 160, 26492928, 26496000, 1073741824, 532480, 92160, 281488, 13056
.fill 8, 4, 0
.long 265908, 13083648, 295168, L_lanetab-L_back_pc_2+3072, 268672, 5888, 640, 1280, 3529728, 6455296, 25863168, 29274112, 270336, 533120, 1, 13078528, 1310880, 26656768, 26659840, 1073741824, 535040, 92288, 1073741824, 12800
.fill 8, 4, 0
.long 1073741824, 13001728, 295168, L_lanetab-L_back_pc_2+3072, 268928, 5888, 0, 1280, 3524608, 6455296, 25888768, 29335552, 270336, 574080, 0, 12996608, 1073741824, 1073741824, 1073741824, 1073741824, 537600, 92416, 1073741824, 12544
.fill 8, 4, 0
.long 1073741824, 13165568, 295168, L_lanetab-L_back_pc_2+3072, 269184, 5632, 0, 1280, 3529728, 6455296, 25914368, 29396992, 270336, 615040, 0, 13160448, 1073741824, 1073741824, 1073741824, 1073741824, 540160, 92544, 1073741824, 12288
.fill 8, 4, 0
.long 266388, 12929024, 295424, L_lanetab-L_back_pc_2+3072, 268416, 6144, 640, 1280, 3852288, 7143424, 25837568, 29212672, 278528, 819840, 1, 12920832, 320, 26738688, 26741760, 1073741824, 860160, 108544, 282000, 13568
.fill 8, 4, 0
.long 266932, 13092864, 295424, L_lanetab-L_back_pc_2+3072, 268672, 5888, 640, 1280, 3857408, 7143424, 25863168, 29274112, 278528, 860800, 1, 13084672, 1311040, 26902528, 26905600, 1073741824, 862720, 108672, 1073741824, 13312
.fill 8, 4, 0
.long 1073741824, 13010944, 295424, L_lanetab-L_back_pc_2+3072, 268928, 5888, 0, 1280, 3852288, 7143424, 25888768, 29335552, 278528, 901760, 0, 13002752, 1073741824, 1073741824, 1073741824, 1073741824, 865280, 108800, 1073741824, 13056
.fill 8, 4, 0
.long 1073741824, 13174784, 295424, L_lanetab-L_back_pc_2+3072, 269184, 5632, 0, 1280, 3857408, 7143424, 25914368, 29396992, 278528, 942720, 0, 13166592, 1073741824, 1073741824, 1073741824, 1073741824, 867840, 108928, 1073741824, 12800
.fill 8, 4, 0
.long 267412, 12930048, 295680, L_lanetab-L_back_pc_2+3072, 268416, 6144, 640, 1280, 4179968, 7831552, 25837568, 29212672, 286720, 1147520, 1, 12924928, 480, 26984448, 26987520, 1073741824, 1187840, 124928, 282512, 14080
.fill 8, 4, 0
.long 267956, 13093888, 295680, L_lanetab-L_back_pc_2+3072, 268672, 5888, 640, 1280, 4185088, 7831552, 25863168, 29274112, 286720, 1188480, 1, 13088768, 1311200, 27148288, 27151360, 1073741824, 1190400, 125056, 1073741824, 13824
.fill 8, 4, 0
.long 1073741824, 13011968, 295680, L_lanetab-L_back_pc_2+3072, 268928, 5888, 0, 1280, 4179968, 7831552, 25888768, 29335552, 286720, 1229440, 0, 13006848, 1073741824, 1073741824, 1073741824, 1073741824, 1192960, 125184, 1073741824, 13568
.fill 8, 4, 0
.long 1073741824, 13175808, 295680, L_lanetab-L_back_pc_2+3072, 269184, 5632, 0, 1280, 4185088, 7831552, 25914368, 29396992, 286720, 1270400, 0, 13170688, 1073741824, 1073741824, 1073741824, 1073741824, 1195520, 125312, 1073741824, 13312
.fill 8, 4, 0
.long 268436, 12939264, 295936, L_lanetab-L_back_pc_2+3072, 268416, 6144, 640, 1280, 4507648, 8519680, 25837568, 29212672, 294912, 1475200, 1, 12931072, 640, 27230208, 27233280, 1073741824, 1515520, 141312, 283024, 14592
.fill 8, 4, 0
.long 268980, 13103104, 295936, L_lanetab-L_back_pc_2+3072, 268672, 5888, 640, 1280, 4512768, 8519680, 25863168, 29274112, 294912, 1516160, 1, 13094912, 1311360, 27394048, 27397120, 1073741824, 1518080, 141440, 1073741824, 14336
.fill 8, 4, 0
.long 1073741824, 13021184, 295936, L_lanetab-L_back_pc_2+3072, 268928, 5888, 0, 1280, 4507648, 8519680, 25888768, 29335552, 294912, 1557120, 0, 13012992, 1073741824, 1073741824, 1073741824, 1073741824, 1520640, 141568, 1073741824, 14080
.fill 8, 4, 0
.long 1073741824, 13185024, 295936, L_lanetab-L_back_pc_2+3072, 269184, 5632, 0, 1280, 4512768, 8519680, 25914368, 29396992, 294912, 1598080, 0, 13176832, 1073741824, 1073741824, 1073741824, 1073741824, 1523200, 141696, 1073741824, 13824
.fill 8, 4, 0
.long 269460, 12940288, 296192, L_lanetab-L_back_pc_2+3072, 268416, 6144, 640, 1280, 4835328, 9207808, 25837568, 29212672, 303104, 1802880, 1, 12935168, 800, 27475968, 27479040, 1073741824, 1843200, 157696, 283536, 15104
.fill 8, 4, 0
.long 270004, 13104128, 296192, L_lanetab-L_back_pc_2+3072, 268672, 5888, 640, 1280, 4840448, 9207808, 25863168, 29274112, 303104, 1843840, 1, 13099008, 1311520, 27639808, 27642880, 1073741824, 1845760, 157824, 1073741824, 14848
.fill 8, 4, 0
.long 1073741824, 13022208, 296192, L_lanetab-L_back_pc_2+3072, 268928, 5888, 0, 1280, 4835328, 9207808, 25888768, 29335552, 303104, 1884800, 0, 13017088, 1073741824, 1073741824, 1073741824, 1073741824, 1848320, 157952, 1073741824, 14592
.fill 8, 4, 0
.long 1073741824, 13186048, 296192, L_lanetab-L_back_pc_2+3072, 269184, 5632, 0, 1280, 4840448, 9207808, 25914368, 29396992, 303104, 1925760, 0, 13180928, 1073741824, 1073741824, 1073741824, 1073741824, 1850880, 158080, 1073741824, 14336
.fill 8, 4, 0
.long 270484, 12949504, 296448, L_lanetab-L_back_pc_2+3072, 268416, 6144, 640, 1280, 5163008, 9895936, 25837568, 29212672, 311296, 2130560, 1, 12941312, 960, 27721728, 27724800, 1073741824, 2170880, 174080, 284048, 15616
.fill 8, 4, 0
.long 271028, 13113344, 296448, L_lanetab-L_back_pc_2+3072, 268672, 5888, 640, 1280, 5168128, 9895936, 25863168, 29274112, 311296, 2171520, 1, 13105152, 1311680, 27885568, 27888640, 1073741824, 2173440, 174208, 1073741824, 15360
.fill 8, 4, 0
.long 1073741824, 13031424, 296448, L_lanetab-L_back_pc_2+3072, 268928, 5888, 0, 1280, 5163008, 9895936, 25888768, 29335552, 311296, 2212480, 0, 13023232, 1073741824, 1073741824, 1073741824, 1073741824, 2176000, 174336, 1073741824, 15104
.fill 8, 4, 0
.long 1073741824, 13195264, 296448, L_lanetab-L_back_pc_2+3072, 269184, 5632, 0, 1280, 5168128, 9895936, 25914368, 29396992, 311296, 2253440, 0, 13187072, 1073741824, 1073741824, 1073741824, 1073741824, 2178560, 174464, 1073741824, 14848
.fill 8, 4, 0
.long 271508, 12950528, 296704, L_lanetab-L_back_pc_2+3072, 268416, 6144, 640, 1280, 5490688, 10584064, 25837568, 29212672, 319488, 2458240, 1, 12945408, 1120, 27967488, 27970560, 1073741824, 2498560, 190464, 284560, 16128
.fill 8, 4, 0
.long 272052, 13114368, 296704, L_lanetab-L_back_pc_2+3072, 268672, 5888, 640, 1280, 5495808, 10584064, 25863168, 29274112, 319488, 2499200, 1, 13109248, 1311840, 28131328, 28134400, 1073741824, 2501120, 190592, 1073741824, 15872
.fill 8, 4, 0
.long 1073741824, 13032448, 296704, L_lanetab-L_back_pc_2+3072, 268928, 5888, 0, 1280, 5490688, 10584064, 25888768, 29335552, 319488, 2540160, 0, 13027328, 1073741824, 1073741824, 1073741824, 1073741824, 2503680, 190720, 1073741824, 15616
.fill 8, 4, 0
.long 1073741824, 13196288, 296704, L_lanetab-L_back_pc_2+3072, 269184, 5632, 0, 1280, 5495808, 10584064, 25914368, 29396992, 319488, 2581120, 0, 13191168, 1073741824, 1073741824, 1073741824, 1073741824, 2506240, 190848, 1073741824, 15360
.fill 8, 4, 0
.long 264344, 12919040, 294912, L_lanetab-L_back_pc_2+3072, 269440, 5632, 640, 1600, 3278848, 5939200, 25939968, 29458432, 262144, 164640, 1, 12911616, 40960, 26252288, 26255360, 1073741824, 215040, 76288, 280980, 11520
.fill 8, 4, 0
.long 264888, 13082880, 294912, L_lanetab-L_back_pc_2+3072, 269696, 5376, 640, 1600, 3283968, 5939200, 25965568, 29519872, 262144, 205600, 1, 13075456, 1351680, 26416128, 26419200, 1073741824, 217600, 76416, 1073741824, 11264
.fill 8, 4, 0
.long 1073741824, 13000960, 294912, L_lanetab-L_back_pc_2+3072, 269952, 5376, 0, 1600, 3278848, 5939200, 25991168, 29581312, 262144, 246560, 0, 12993536, 1073741824, 1073741824, 1073741824, 1073741824, 220160, 76544, 1073741824, 11008
.fill 8, 4, 0
.long 1073741824, 13164800, 294912, L_lanetab-L_back_pc_2+3072, 270208, 5120, 0, 1600, 3283968, 5939200, 26016768, 29642752, 262144, 287520, 0, 13157376, 1073741824, 1073741824, 1073741824, 1073741824, 222720, 76672, 1073741824, 10752
.fill 8, 4, 0
.long 265368, 12920064, 295168, L_lanetab-L_back_pc_2+3072, 269440, 5632, 640, 1600, 3606528, 6627328, 25939968, 29458432, 270336, 492320, 1, 12915712, 41120, 26498048, 26501120, 1073741824, 542720, 92672, 281492, 12032
.fill 8, 4, 0
.long 265912, 13083904, 295168, L_lanetab-L_back_pc_2+3072, 269696, 5376, 640, 1600, 3611648, 6627328, 25965568, 29519872, 270336, 533280, 1, 13079552, 1351840, 26661888, 26664960, 1073741824, 545280, 92800, 1073741824, 11776
.fill 8, 4, 0
.long 1073741824, 13001984, 295168, L_lanetab-L_back_pc_2+3072, 269952, 5376, 0, 1600, 3606528, 6627328, 25991168, 29581312, 270336, 574240, 0, 12997632, 1073741824, 1073741824, 1073741824, 1073741824, 547840, 92928, 1073741824, 11520
.fill 8, 4, 0
.long 1073741824, 13165824, 295168, L_lanetab-L_back_pc_2+3072, 270208, 5120, 0, 1600, 3611648, 6627328, 26016768, 29642752, 270336, 615200, 0, 13161472, 1073741824, 1073741824, 1073741824, 1073741824, 550400, 93056, 1073741824, 11264
.fill 8, 4, 0
.long 266392, 12929280, 295424, L_lanetab-L_back_pc_2+3072, 269440, 5632, 640, 1600, 3934208, 7315456, 25939968, 29458432, 278528, 820000, 1, 12921856, 41280, 26743808, 26746880, 1073741824, 870400, 109056, 282004, 12544
.fill 8, 4, 0
.long 266936, 13093120, 295424, L_lanetab-L_back_pc_2+3072, 269696, 5376, 640, 1600, 3939328, 7315456, 25965568, 29519872, 278528, 860960, 1, 13085696, 1352000, 26907648, 26910720, 1073741824, 872960, 109184, 1073741824, 12288
.fill 8, 4, 0
.long 1073741824, 13011200, 295424, L_lanetab-L_back_pc_2+3072, 269952, 5376, 0, 1600, 3934208, 7315456, 25991168, 29581312, 278528, 901920, 0, 13003776, 1073741824, 1073741824, 1073741824, 1073741824, 875520, 109312, 1073741824, 12032
.fill 8, 4, 0
.long 1073741824, 13175040, 295424, L_lanetab-L_back_pc_2+3072, 270208, 5120, 0, 1600, 3939328, 7315456, 26016768, 29642752, 278528, 942880, 0, 13167616, 1073741824, 1073741824, 1073741824, 1073741824, 878080, 109440, 1073741824, 11776
.fill 8, 4, 0
.long 267416, 12930304, 295680, L_lanetab-L_back_pc_2+3072, 269440, 5632, 640, 1600, 4261888, 8003584, 25939968, 29458432, 286720, 1147680, 1, 12925952, 41440, 26989568, 26992640, 1073741824, 1198080, 125440, 282516, 13056
.fill 8, 4, 0
.long 267960, 13094144, 295680, L_lanetab-L_back_pc_2+3072, 269696, 5376, 640, 1600, 4267008, 8003584, 25965568, 29519872, 286720, 1188640, 1, 13089792, 1352160, 27153408, 27156480, 1073741824, 1200640, 125568, 1073741824, 12800
.fill 8, 4, 0
.long 1073741824, 13012224, 295680, L_lanetab-L_back_pc_2+3072, 269952, 5376, 0, 1600, 4261888, 8003584, 25991168, 29581312, 286720, 1229600, 0, 13007872, 1073741824, 1073741824, 1073741824, 1073741824, 1203200, 125696, 1073741824, 12544
.fill 8, 4, 0
.long 1073741824, 13176064, 295680, L_lanetab-L_back_pc_2+3072, 270208, 5120, 0, 1600, 4267008, 8003584, 26016768, 29642752, 286720, 1270560, 0, 13171712, 1073741824, 1073741824, 1073741824, 1073741824, 1205760, 125824, 1073741824, 12288
.fill 8, 4, 0
.long 268440, 12939520, 295936, L_lanetab-L_back_pc_2+3072, 269440, 5632, 640, 1600, 4589568, 8691712, 25939968, 29458432, 294912, 1475360, 1, 12932096, 41600, 27235328, 27238400, 1073741824, 1525760, 141824, 283028, 13568
.fill 8, 4, 0
.long 268984, 13103360, 295936, L_lanetab-L_back_pc_2+3072, 269696, 5376, 640, 1600, 4594688, 8691712, 25965568, 29519872, 294912, 1516320, 1, 13095936, 1352320, 27399168, 27402240, 1073741824, 1528320, 141952, 1073741824, 13312
.fill 8, 4, 0
.long 1073741824, 13021440, 295936, L_lanetab-L_back_pc_2+3072, 269952, 5376, 0, 1600, 4589568, 8691712, 25991168, 29581312, 294912, 1557280, 0, 13014016, 1073741824, 1073741824, 1073741824, 1073741824, 1530880, 142080, 1073741824, 13056
.fill 8, 4, 0
.long 1073741824, 13185280, 295936, L_lanetab-L_back_pc_2+3072, 270208, 5120, 0, 1600, 4594688, 8691712, 26016768, 29642752, 294912, 1598240, 0, 13177856, 1073741824, 1073741824, 1073741824, 1073741824, 1533440, 142208, 1073741824, 12800
.fill 8, 4, 0
.long 269464, 12940544, 296192, L_lanetab-L_back_pc_2+3072, 269440, 5632, 640, 1600, 4917248, 9379840, 25939968, 29458432, 303104, 1803040, 1, 12936192, 41760, 27481088, 27484160, 1073741824, 1853440, 158208, 283540, 14080
.fill 8, 4, 0
.long 270008, 13104384, 296192, L_lanetab-L_back_pc_2+3072, 269696, 5376, 640, 1600, 4922368, 9379840, 25965568, 29519872, 303104, 1844000, 1, 13100032, 1352480, 27644928, 27648000, 1073741824, 1856000, 158336, 1073741824, 13824
.fill 8, 4, 0
.long 1073741824, 13022464, 296192, L_lanetab-L_back_pc_2+3072, 269952, 5376, 0, 1600, 4917248, 9379840, 25991168, 29581312, 303104, 1884960, 0, 13018112, 1073741824, 1073741824, 1073741824, 1073741824, 1858560, 158464, 1073741824, 13568
.fill 8, 4, 0
.long 1073741824, 13186304, 296192, L_lanetab-L_back_pc_2+3072, 270208, 5120, 0, 1600, 4922368, 9379840, 26016768, 29642752, 303104, 1925920, 0, 13181952, 1073741824, 1073741824, 1073741824, 1073741824, 1861120, 158592, 1073741824, 13312
.fill 8, 4, 0
.long 270488, 12949760, 296448, L_lanetab-L_back_pc_2+3072, 269440, 5632, 640, 1600, 5244928, 10067968, 25939968, 29458432, 311296, 2130720, 1, 12942336, 41920, 27726848, 27729920, 1073741824, 2181120, 174592, 284052, 14592
.fill 8, 4, 0
.long 271032, 13113600, 296448, L_lanetab-L_back_pc_2+3072, 269696, 5376, 640, 1600, 5250048, 10067968, 25965568, 29519872, 311296, 2171680, 1, 13106176, 1352640, 27890688, 27893760, 1073741824, 2183680, 174720, 1073741824, 14336
.fill 8, 4, 0
.long 1073741824, 13031680, 296448, L_lanetab-L_back_pc_2+3072, 269952, 5376, 0, 1600, 5244928, 10067968, 25991168, 29581312, 311296, 2212640, 0, 13024256, 1073741824, 1073741824, 1073741824, 1073741824, 2186240, 174848, 1073741824, 14080
.fill 8, 4, 0
.long 1073741824, 13195520, 296448, L_lanetab-L_back_pc_2+3072, 270208, 5120, 0, 1600, 5250048, 10067968, 26016768, 29642752, 311296, 2253600, 0, 13188096, 1073741824, 1073741824, 1073741824, 1073741824, 2188800, 174976, 1073741824, 13824
.fill 8, 4, 0
.long 271512, 12950784, 296704, L_lanetab-L_back_pc_2+3072, 269440, 5632, 640, 1600, 5572608, 10756096, 25939968, 29458432, 319488, 2458400, 1, 12946432, 42080, 27972608, 27975680, 1073741824, 2508800, 190976, 284564, 15104
.fill 8, 4, 0
.long 272056, 13114624, 296704, L_lanetab-L_back_pc_2+3072, 269696, 5376, 640, 1600, 5577728, 10756096, 25965568, 29519872, 319488, 2499360, 1, 13110272, 1352800, 28136448, 28139520, 1073741824, 2511360, 191104, 1073741824, 14848
.fill 8, 4, 0
.long 1073741824, 13032704, 296704, L_lanetab-L_back_pc_2+3072, 269952, 5376, 0, 1600, 5572608, 10756096, 25991168, 29581312, 319488, 2540320, 0, 13028352, 1073741824, 1073741824, 1073741824, 1073741824, 2513920, 191232, 1073741824, 14592
.fill 8, 4, 0
.long 1073741824, 13196544, 296704, L_lanetab-L_back_pc_2+3072, 270208, 5120, 0, 1600, 5577728, 10756096, 26016768, 29642752, 319488, 2581280, 0, 13192192, 1073741824, 1073741824, 1073741824, 1073741824, 2516480, 191360, 1073741824, 14336
.fill 8, 4, 0
.long 264348, 12919296, 294912, L_lanetab-L_back_pc_2+3072, 270464, 5120, 640, 1920, 3360768, 6111232, 26042368, 29704192, 262144, 164800, 1, 12912640, 81920, 26257408, 26260480, 1073741824, 225280, 76800, 280984, 10496
.fill 8, 4, 0
.long 264892, 13083136, 294912, L_lanetab-L_back_pc_2+3072, 270720, 4864, 640, 1920, 3365888, 6111232, 26067968, 29765632, 262144, 205760, 1, 13076480, 1392640, 26421248, 26424320, 1073741824, 227840, 76928, 1073741824, 10240
.fill 8, 4, 0
.long 1073741824, 13001216, 294912, L_lanetab-L_back_pc_2+3072, 270976, 4864, 0, 1920, 3360768, 6111232, 26093568, 29827072, 262144, 246720, 0, 12994560, 1073741824, 1073741824, 1073741824, 1073741824, 230400, 77056, 1073741824, 9984
.fill 8, 4, 0
.long 1073741824, 13165056, 294912, L_lanetab-L_back_pc_2+3072, 271232, 4608, 0, 1920, 3365888, 6111232, 26119168, 29888512, 262144, 287680, 0, 13158400, 1073741824, 1073741824, 1073741824, 1073741824, 232960, 77184, 1073741824, 9728
.fill 8, 4, 0
.long 265372, 12920320, 295168, L_lanetab-L_back_pc_2+3072, 270464, 5120, 640, 1920, 3688448, 6799360, 26042368, 29704192, 270336, 492480, 1, 12916736, 82080, 26503168, 26506240, 1073741824, 552960, 93184, 281496, 11008
.fill 8, 4, 0
.long 265916, 13084160, 295168, L_lanetab-L_back_pc_2+3072, 270720, 4864, 640, 1920, 3693568, 6799360, 26067968, 29765632, 270336, 533440, 1, 13080576, 1392800, 26667008, 26670080, 1073741824, 555520, 93312, 1073741824, 10752
.fill 8, 4, 0
.long 1073741824, 13002240, 295168, L_lanetab-L_back_pc_2+3072, 270976, 4864, 0, 1920, 3688448, 6799360, 26093568, 29827072, 270336, 574400, 0, 12998656, 1073741824, 1073741824, 1073741824, 1073741824, 558080, 93440, 1073741824, 10496
.fill 8, 4, 0
.long 1073741824, 13166080, 295168, L_lanetab-L_back_pc_2+3072, 271232, 4608, 0, 1920, 3693568, 6799360, 26119168, 29888512, 270336, 615360, 0, 13162496, 1073741824, 1073741824, 1073741824, 1073741824, 560640, 93568, 1073741824, 10240
.fill 8, 4, 0
.long 266396, 12929536, 295424, L_lanetab-L_back_pc_2+3072, 270464, 5120, 640, 1920, 4016128, 7487488, 26042368, 29704192, 278528, 820160, 1, 12922880, 82240, 26748928, 26752000, 1073741824, 880640, 109568, 282008, 11520
.fill 8, 4, 0
.long 266940, 13093376, 295424, L_lanetab-L_back_pc_2+3072, 270720, 4864, 640, 1920, 4021248, 7487488, 26067968, 29765632, 278528, 861120, 1, 13086720, 1392960, 26912768, 26915840, 1073741824, 883200, 109696, 1073741824, 11264
.fill 8, 4, 0
.long 1073741824, 13011456, 295424, L_lanetab-L_back_pc_2+3072, 270976, 4864, 0, 1920, 4016128, 7487488, 26093568, 29827072, 278528, 902080, 0, 13004800, 1073741824, 1073741824, 1073741824, 1073741824, 885760, 109824, 1073741824, 11008
.fill 8, 4, 0
.long 1073741824, 13175296, 295424, L_lanetab-L_back_pc_2+3072, 271232, 4608, 0, 1920, 4021248, 7487488, 26119168, 29888512, 278528, 943040, 0, 13168640, 1073741824, 1073741824, 1073741824, 1073741824, 888320, 109952, 1073741824, 10752
.fill 8, 4, 0
.long 267420, 12930560, 295680, L_lanetab-L_back_pc_2+3072, 270464, 5120, 640, 1920, 4343808, 8175616, 26042368, 29704192, 286720, 1147840, 1, 12926976, 82400, 26994688, 26997760, 1073741824, 1208320, 125952, 282520, 12032
.fill 8, 4, 0
.long 267964, 13094400, 295680, L_lanetab-L_back_pc_2+3072, 270720, 4864, 640, 1920, 4348928, 8175616, 26067968, 29765632, 286720, 1188800, 1, 13090816, 1393120, 27158528, 27161600, 1073741824, 1210880, 126080, 1073741824, 11776
.fill 8, 4, 0
.long 1073741824, 13012480, 295680, L_lanetab-L_back_pc_2+3072, 270976, 4864, 0, 1920, 4343808, 8175616, 26093568, 29827072, 286720, 1229760, 0, 13008896, 1073741824, 1073741824, 1073741824, 1073741824, 1213440, 126208, 1073741824, 11520
.fill 8, 4, 0
.long 1073741824, 13176320, 295680, L_lanetab-L_back_pc_2+3072, 271232, 4608, 0, 1920, 4348928, 8175616, 26119168, 29888512, 286720, 1270720, 0, 13172736, 1073741824, 1073741824, 1073741824, 1073741824, 1216000, 126336, 1073741824, 11264
.fill 8, 4, 0
.long 268444, 12939776, 295936, L_lanetab-L_back_pc_2+3072, 270464, 5120, 640, 1920, 4671488, 8863744, 26042368, 29704192, 294912, 1475520, 1, 12933120, 82560, 27240448, 27243520, 1073741824, 1536000, 142336, 283032, 12544
.fill 8, 4, 0
.long 268988, 13103616, 295936, L_lanetab-L_back_pc_2+3072, 270720, 4864, 640, 1920, 4676608, 8863744, 26067968, 29765632, 294912, 1516480, 1, 13096960, 1393280, 27404288, 27407360, 1073741824, 1538560, 142464, 1073741824, 12288
.fill 8, 4, 0
.long 1073741824, 13021696, 295936, L_lanetab-L_back_pc_2+3072, 270976, 4864, 0, 1920, 4671488, 8863744, 26093568, 29827072, 294912, 1557440, 0, 13015040, 1073741824, 1073741824, 1073741824, 1073741824, 1541120, 142592, 1073741824, 12032
.fill 8, 4, 0
.long 1073741824, 13185536, 295936, L_lanetab-L_back_pc_2+3072, 271232, 4608, 0, 1920, 4676608, 8863744, 26119168, 29888512, 294912, 1598400, 0, 13178880, 1073741824, 1073741824, 1073741824, 1073741824, 1543680, 142720, 1073741824, 11776
.fill 8, 4, 0
.long 269468, 12940800, 296192, L_lanetab-L_back_pc_2+3072, 270464, 5120, 640, 1920, 4999168, 9551872, 26042368, 29704192, 303104, 1803200, 1, 12937216, 82720, 27486208, 27489280, 1073741824, 1863680, 158720, 283544, 13056
.fill 8, 4, 0
.long 270012, 13104640, 296192, L_lanetab-L_back_pc_2+3072, 270720, 4864, 640, 1920, 5004288, 9551872, 26067968, 29765632, 303104, 1844160, 1, 13101056, 1393440, 27650048, 27653120, 1073741824, 1866240, 158848, 1073741824, 12800
.fill 8, 4, 0
.long 1073741824, 13022720, 296192, L_lanetab-L_back_pc_2+3072, 270976, 4864, 0, 1920, 4999168, 9551872, 26093568, 29827072, 303104, 1885120, 0, 13019136, 1073741824, 1073741824, 1073741824, 1073741824, 1868800, 158976, 1073741824, 12544
.fill 8, 4, 0
.long 1073741824, 13186560, 296192, L_lanetab-L_back_pc_2+3072, 271232, 4608, 0, 1920, 5004288, 9551872, 26119168, 29888512, 303104, 1926080, 0, 13182976, 1073741824, 1073741824, 1073741824, 1073741824, 1871360, 159104, 1073741824, 12288
.fill 8, 4, 0
.long 270492, 12950016, 296448, L_lanetab-L_back_pc_2+3072, 270464, 5120, 640, 1920, 5326848, 10240000, 26042368, 29704192, 311296, 2130880, 1, 12943360, 82880, 27731968, 27735040, 1073741824, 2191360, 175104, 284056, 13568
.fill 8, 4, 0
.long 271036, 13113856, 296448, L_lanetab-L_back_pc_2+3072, 270720, 4864, 640, 1920, 5331968, 10240000, 26067968, 29765632, 311296, 2171840, 1, 13107200, 1393600, 27895808, 27898880, 1073741824, 2193920, 175232, 1073741824, 13312
.fill 8, 4, 0
.long 1073741824, 13031936, 296448, L_lanetab-L_back_pc_2+3072, 270976, 4864, 0, 1920, 5326848, 10240000, 26093568, 29827072, 311296, 2212800, 0, 13025280, 1073741824, 1073741824, 1073741824, 1073741824, 2196480, 175360, 1073741824, 13056
.fill 8, 4, 0
.long 1073741824, 13195776, 296448, L_lanetab-L_back_pc_2+3072, 271232, 4608, 0, 1920, 5331968, 10240000, 26119168, 29888512, 311296, 2253760, 0, 13189120, 1073741824, 1073741824, 1073741824, 1073741824, 2199040, 175488, 1073741824, 12800
.fill 8, 4, 0
.long 271516, 12951040, 296704, L_lanetab-L_back_pc_2+3072, 270464, 5120, 640, 1920, 5654528, 10928128, 26042368, 29704192, 319488, 2458560, 1, 12947456, 83040, 27977728, 27980800, 1073741824, 2519040, 191488, 284568, 14080
.fill 8, 4, 0
.long 272060, 13114880, 296704, L_lanetab-L_back_pc_2+3072, 270720, 4864, 640, 1920, 5659648, 10928128, 26067968, 29765632, 319488, 2499520, 1, 13111296, 1393760, 28141568, 28144640, 1073741824, 2521600, 191616, 1073741824, 13824
.fill 8, 4, 0
.long 1073741824, 13032960, 296704, L_lanetab-L_back_pc_2+3072, 270976, 4864, 0, 1920, 5654528, 10928128, 26093568, 29827072, 319488, 2540480, 0, 13029376, 1073741824, 1073741824, 1073741824, 1073741824, 2524160, 191744, 1073741824, 13568
.fill 8, 4, 0
.long 1073741824, 13196800, 296704, L_lanetab-L_back_pc_2+3072, 271232, 4608, 0, 1920, 5659648, 10928128, 26119168, 29888512, 319488, 2581440, 0, 13193216, 1073741824, 1073741824, 1073741824, 1073741824, 2526720, 191872, 1073741824, 13312
.fill 8, 4, 0
.long 264352, 12919552, 294912, L_lanetab-L_back_pc_2+3072, 271488, 4608, 640, 2240, 3442688, 6283264, 26144768, 29949952, 262144, 164960, 1, 12913664, 122880, 26262528, 26265600, 1073741824, 235520, 77312, 280988, 9472
.fill 8, 4, 0
.long 264896, 13083392, 294912, L_lanetab-L_back_pc_2+3072, 271744, 4352, 640, 2240, 3447808, 6283264, 26170368, 30011392, 262144, 205920, 1, 13077504, 1433600, 26426368, 26429440, 1073741824, 238080, 77440, 1073741824, 9216
.fill 8, 4, 0
.long 1073741824, 13001472, 294912, L_lanetab-L_back_pc_2+3072, 272000, 4352, 0, 2240, 3442688, 6283264, 26195968, 30072832, 262144, 246880, 0, 12995584, 1073741824, 1073741824, 1073741824, 1073741824, 240640, 77568, 1073741824, 8960
.fill 8, 4, 0
.long 1073741824, 13165312, 294912, L_lanetab-L_back_pc_2+3072, 272256, 4096, 0, 2240, 3447808, 6283264, 26221568, 30134272, 262144, 287840, 0, 13159424, 1073741824, 1073741824, 1073741824, 1073741824, 243200, 77696, 1073741824, 8704
.fill 8, 4, 0
.long 265376, 12920576, 295168, L_lanetab-L_back_pc_2+3072, 271488, 4608, 640, 2240, 3770368, 6971392, 26144768, 29949952, 270336, 492640, 1, 12917760, 123040, 26508288, 26511360, 1073741824, 563200, 93696, 281500, 9984
.fill 8, 4, 0
.long 265920, 13084416, 295168, L_lanetab-L_back_pc_2+3072, 271744, 4352, 640, 2240, 3775488, 6971392, 26170368, 30011392, 270336, 533600, 1, 13081600, 1433760, 26672128, 26675200, 1073741824, 565760, 93824, 1073741824, 9728
.fill 8, 4, 0
.long 1073741824, 13002496, 295168, L_lanetab-L_back_pc_2+3072, 272000, 4352, 0, 2240, 3770368, 6971392, 26195968, 30072832, 270336, 574560, 0, 12999680, 1073741824, 1073741824, 1073741824, 1073741824, 568320, 93952, 1073741824, 9472
.fill 8, 4, 0
.long 1073741824, 13166336, 295168, L_lanetab-L_back_pc_2+3072, 272256, 4096, 0, 2240, 3775488, 6971392, 26221568, 30134272, 270336, 615520, 0, 13163520, 1073741824, 1073741824, 1073741824, 1073741824, 570880, 94080, 1073741824, 9216
.fill 8, 4, 0
.long 266400, 12929792, 295424, L_lanetab-L_back_pc_2+3072, 271488, 4608, 640, 2240, 4098048, 7659520, 26144768, 29949952, 278528, 820320, 1, 12923904, 123200, 26754048, 26757120, 1073741824, 890880, 110080, 282012, 10496
.fill 8, 4, 0
.long 266944, 13093632, 295424, L_lanetab-L_back_pc_2+3072, 271744, 4352, 640, 2240, 4103168, 7659520, 26170368, 30011392, 278528, 861280, 1, 13087744, 1433920, 26917888, 26920960, 1073741824, 893440, 110208, 1073741824, 10240
.fill 8, 4, 0
.long 1073741824, 13011712, 295424, L_lanetab-L_back_pc_2+3072, 272000, 4352, 0, 2240, 4098048, 7659520, 26195968, 30072832, 278528, 902240, 0, 13005824, 1073741824, 1073741824, 1073741824, 1073741824, 896000, 110336, 1073741824, 9984
.fill 8, 4, 0
.long 1073741824, 13175552, 295424, L_lanetab-L_back_pc_2+3072, 272256, 4096, 0, 2240, 4103168, 7659520, 26221568, 30134272, 278528, 943200, 0, 13169664, 1073741824, 1073741824, 1073741824, 1073741824, 898560, 110464, 1073741824, 9728
.fill 8, 4, 0
.long 267424, 12930816, 295680, L_lanetab-L_back_pc_2+3072, 271488, 4608, 640, 2240, 4425728, 8347648, 26144768, 29949952, 286720, 1148000, 1, 12928000, 123360, 26999808, 27002880, 1073741824, 1218560, 126464, 282524, 11008
.fill 8, 4, 0
.long 267968, 13094656, 295680, L_lanetab-L_back_pc_2+3072, 271744, 4352, 640, 2240, 4430848, 8347648, 26170368, 30011392, 286720, 1188960, 1, 13091840, 1434080, 27163648, 27166720, 1073741824, 1221120, 126592, 1073741824, 10752
.fill 8, 4, 0
.long 1073741824, 13012736, 295680, L_lanetab-L_back_pc_2+3072, 272000, 4352, 0, 2240, 4425728, 8347648, 26195968, 30072832, 286720, 1229920, 0, 13009920, 1073741824, 1073741824, 1073741824, 1073741824, 1223680, 126720, 1073741824, 10496
.fill 8, 4, 0
.long 1073741824, 13176576, 295680, L_lanetab-L_back_pc_2+3072, 272256, 4096, 0, 2240, 4430848, 8347648, 26221568, 30134272, 286720, 1270880, 0, 13173760, 1073741824, 1073741824, 1073741824, 1073741824, 1226240, 126848, 1073741824, 10240
.fill 8, 4, 0
.long 268448, 12940032, 295936, L_lanetab-L_back_pc_2+3072, 271488, 4608, 640, 2240, 4753408, 9035776, 26144768, 29949952, 294912, 1475680, 1, 12934144, 123520, 27245568, 27248640, 1073741824, 1546240, 142848, 283036, 11520
.fill 8, 4, 0
.long 268992, 13103872, 295936, L_lanetab-L_back_pc_2+3072, 271744, 4352, 640, 2240, 4758528, 9035776, 26170368, 30011392, 294912, 1516640, 1, 13097984, 1434240, 27409408, 27412480, 1073741824, 1548800, 142976, 1073741824, 11264
.fill 8, 4, 0
.long 1073741824, 13021952, 295936, L_lanetab-L_back_pc_2+3072, 272000, 4352, 0, 2240, 4753408, 9035776, 26195968, 30072832, 294912, 1557600, 0, 13016064, 1073741824, 1073741824, 1073741824, 1073741824, 1551360, 143104, 1073741824, 11008
.fill 8, 4, 0
.long 1073741824, 13185792, 295936, L_lanetab-L_back_pc_2+3072, 272256, 4096, 0, 2240, 4758528, 9035776, 26221568, 30134272, 294912, 1598560, 0, 13179904, 1073741824, 1073741824, 1073741824, 1073741824, 1553920, 143232, 1073741824, 10752
.fill 8, 4, 0
.long 269472, 12941056, 296192, L_lanetab-L_back_pc_2+3072, 271488, 4608, 640, 2240, 5081088, 9723904, 26144768, 29949952, 303104, 1803360, 1, 12938240, 123680, 27491328, 27494400, 1073741824, 1873920, 159232, 283548, 12032
.fill 8, 4, 0
.long 270016, 13104896, 296192, L_lanetab-L_back_pc_2+3072, 271744, 4352, 640, 2240, 5086208, 9723904, 26170368, 30011392, 303104, 1844320, 1, 13102080, 1434400, 27655168, 27658240, 1073741824, 1876480, 159360, 1073741824, 11776
.fill 8, 4, 0
.long 1073741824, 13022976, 296192, L_lanetab-L_back_pc_2+3072, 272000, 4352, 0, 2240, 5081088, 9723904, 26195968, 30072832, 303104, 1885280, 0, 13020160, 1073741824, 1073741824, 1073741824, 1073741824, 1879040, 159488, 1073741824, 11520
.fill 8, 4, 0
.long 1073741824, 13186816, 296192, L_lanetab-L_back_pc_2+3072, 272256, 4096, 0, 2240, 5086208, 9723904, 26221568, 30134272, 303104, 1926240, 0, 13184000, 1073741824, 1073741824, 1073741824, 1073741824, 1881600, 159616, 1073741824, 11264
.fill 8, 4, 0
.long 270496, 12950272, 296448, L_lanetab-L_back_pc_2+3072, 271488, 4608, 640, 2240, 5408768, 10412032, 26144768, 29949952, 311296, 2131040, 1, 12944384, 123840, 27737088, 27740160, 1073741824, 2201600, 175616, 284060, 12544
.fill 8, 4, 0
.long 271040, 13114112, 296448, L_lanetab-L_back_pc_2+3072, 271744, 4352, 640, 2240, 5413888, 10412032, 26170368, 30011392, 311296, 2172000, 1, 13108224, 1434560, 27900928, 27904000, 1073741824, 2204160, 175744, 1073741824, 12288
.fill 8, 4, 0
.long 1073741824, 13032192, 296448, L_lanetab-L_back_pc_2+3072, 272000, 4352, 0, 2240, 5408768, 10412032, 26195968, 30072832, 311296, 2212960, 0, 13026304, 1073741824, 1073741824, 1073741824, 1073741824, 2206720, 175872, 1073741824, 12032
.fill 8, 4, 0
.long 1073741824, 13196032, 296448, L_lanetab-L_back_pc_2+3072, 272256, 4096, 0, 2240, 5413888, 10412032, 26221568, 30134272, 311296, 2253920, 0, 13190144, 1073741824, 1073741824, 1073741824, 1073741824, 2209280, 176000, 1073741824, 11776
.fill 8, 4, 0
.long 271520, 12951296, 296704, L_lanetab-L_back_pc_2+3072, 271488, 4608, 640, 2240, 5736448, 11100160, 26144768, 29949952, 319488, 2458720, 1, 12948480, 124000, 27982848, 27985920, 1073741824, 2529280, 192000, 284572, 13056
.fill 8, 4, 0
.long 272064, 13115136, 296704, L_lanetab-L_back_pc_2+3072, 271744, 4352, 640, 2240, 5741568, 11100160, 26170368, 30011392, 319488, 2499680, 1, 13112320, 1434720, 28146688, 28149760, 1073741824, 2531840, 192128, 1073741824, 12800
.fill 8, 4, 0
.long 1073741824, 13033216, 296704, L_lanetab-L_back_pc_2+3072, 272000, 4352, 0, 2240, 5736448, 11100160, 26195968, 30072832, 319488, 2540640, 0, 13030400, 1073741824, 1073741824, 1073741824, 1073741824, 2534400, 192256, 1073741824, 12544
.fill 8, 4, 0
.long 1073741824, 13197056, 296704, L_lanetab-L_back_pc_2+3072, 272256, 4096, 0, 2240, 5741568, 11100160, 26221568, 30134272, 319488, 2581600, 0, 13194240, 1073741824, 1073741824, 1073741824, 1073741824, 2536960, 192384, 1073741824, 12288
.fill 8, 4, 0
.long 264356, 13246464, 294912, L_lanetab-L_back_pc_2+3072, 264320, 12288, 640, 0, 3207168, 5767168, 25427968, 30195712, 262144, 184320, 1, 13238272, 163840, 26267648, 26270720, 1073741824, 245760, 77824, 280992, 16640
.fill 8, 4, 0
.long 265108, 13410304, 294912, L_lanetab-L_back_pc_2+3072, 264576, 12032, 640, 0, 3212288, 5767168, 25453568, 30257152, 262144, 225280, 1, 13402112, 1474560, 26431488, 26434560, 1073741824, 248320, 77952, 1073741824, 16384
.fill 8, 4, 0
.long 1073741824, 13328384, 294912, L_lanetab-L_back_pc_2+3072, 264832, 12032, 0, 0, 3207168, 5767168, 25479168, 30318592, 262144, 266240, 0, 13320192, 1073741824, 1073741824, 1073741824, 1073741824, 250880, 78080, 1073741824, 16128
.fill 8, 4, 0
.long 1073741824, 13492224, 294912, L_lanetab-L_back_pc_2+3072, 265088, 11776, 0, 0, 3212288, 5767168, 25504768, 30380032, 262144, 307200, 0, 13484032, 1073741824, 1073741824, 1073741824, 1073741824, 253440, 78208, 1073741824, 15872
.fill 8, 4, 0
.long 265380, 13247488, 295168, L_lanetab-L_back_pc_2+3072, 264320, 12288, 640, 0, 3534848, 6455296, 25427968, 30195712, 270336, 512000, 1, 13242368, 164000, 26513408, 26516480, 1073741824, 573440, 94208, 281504, 17152
.fill 8, 4, 0
.long 266132, 13411328, 295168, L_lanetab-L_back_pc_2+3072, 264576, 12032, 640, 0, 3539968, 6455296, 25453568, 30257152, 270336, 552960, 1, 13406208, 1474720, 26677248, 26680320, 1073741824, 576000, 94336, 1073741824, 16896
.fill 8, 4, 0
.long 1073741824, 13329408, 295168, L_lanetab-L_back_pc_2+3072, 264832, 12032, 0, 0, 3534848, 6455296, 25479168, 30318592, 270336, 593920, 0, 13324288, 1073741824, 1073741824, 1073741824, 1073741824, 578560, 94464, 1073741824, 16640
.fill 8, 4, 0
.long 1073741824, 13493248, 295168, L_lanetab-L_back_pc_2+3072, 265088, 11776, 0, 0, 3539968, 6455296, 25504768, 30380032, 270336, 634880, 0, 13488128, 1073741824, 1073741824, 1073741824, 1073741824, 581120, 94592, 1073741824, 16384
.fill 8, 4, 0
.long 266404, 13256704, 295424, L_lanetab-L_back_pc_2+3072, 264320, 12288, 640, 0, 3862528, 7143424, 25427968, 30195712, 278528, 839680, 1, 13248512, 164160, 26759168, 26762240, 1073741824, 901120, 110592, 282016, 17664
.fill 8, 4, 0
.long 267156, 13420544, 295424, L_lanetab-L_back_pc_2+3072, 264576, 12032, 640, 0, 3867648, 7143424, 25453568, 30257152, 278528, 880640, 1, 13412352, 1474880, 26923008, 26926080, 1073741824, 903680, 110720, 1073741824, 17408
.fill 8, 4, 0
.long 1073741824, 13338624, 295424, L_lanetab-L_back_pc_2+3072, 264832, 12032, 0, 0, 3862528, 7143424, 25479168, 30318592, 278528, 921600, 0, 13330432, 1073741824, 1073741824, 1073741824, 1073741824, 906240, 110848, 1073741824, 17152
.fill 8, 4, 0
.long 1073741824, 13502464, 295424, L_lanetab-L_back_pc_2+3072, 265088, 11776, 0, 0, 3867648, 7143424, 25504768, 30380032, 278528, 962560, 0, 13494272, 1073741824, 1073741824, 1073741824, 1073741824, 908800, 110976, 1073741824, 16896
.fill 8, 4, 0
.long 267428, 13257728, 295680, L_lanetab-L_back_pc_2+3072, 264320, 12288, 640, 0, 4190208, 7831552, 25427968, 30195712, 286720, 1167360, 1, 13252608, 164320, 27004928, 27008000, 1073741824, 1228800, 126976, 282528, 18176
.fill 8, 4, 0
.long 268180, 13421568, 295680, L_lanetab-L_back_pc_2+3072, 264576, 12032, 640, 0, 4195328, 7831552, 25453568, 30257152, 286720, 1208320, 1, 13416448, 1475040, 27168768, 27171840, 1073741824, 1231360, 127104, 1073741824, 17920
.fill 8, 4, 0
.long 1073741824, 13339648, 295680, L_lanetab-L_back_pc_2+3072, 264832, 12032, 0, 0, 4190208, 7831552, 25479168, 30318592, 286720, 1249280, 0, 13334528, 1073741824, 1073741824, 1073741824, 1073741824, 1233920, 127232, 1073741824, 17664
.fill 8, 4, 0
.long 1073741824, 13503488, 295680, L_lanetab-L_back_pc_2+3072, 265088, 11776, 0, 0, 4195328, 7831552, 25504768, 30380032, 286720, 1290240, 0, 13498368, 1073741824, 1073741824, 1073741824, 1073741824, 1236480, 127360, 1073741824, 17408
.fill 8, 4, 0
.long 268452, 13266944, 295936, L_lanetab-L_back_pc_2+3072, 264320, 12288, 640, 0, 4517888, 8519680, 25427968, 30195712, 294912, 1495040, 1, 13258752, 164480, 27250688, 27253760, 1073741824, 1556480, 143360, 283040, 18688
.fill 8, 4, 0
.long 269204, 13430784, 295936, L_lanetab-L_back_pc_2+3072, 264576, 12032, 640, 0, 4523008, 8519680, 25453568, 30257152, 294912, 1536000, 1, 13422592, 1475200, 27414528, 27417600, 1073741824, 1559040, 143488, 1073741824, 18432
.fill 8, 4, 0
.long 1073741824, 13348864, 295936, L_lanetab-L_back_pc_2+3072, 264832, 12032, 0, 0, 4517888, 8519680, 25479168, 30318592, 294912, 1576960, 0, 13340672, 1073741824, 1073741824, 1073741824, 1073741824, 1561600, 143616, 1073741824, 18176
.fill 8, 4, 0
.long 1073741824, 13512704, 295936, L_lanetab-L_back_pc_2+3072, 265088, 11776, 0, 0, 4523008, 8519680, 25504768, 30380032, 294912, 1617920, 0, 13504512, 1073741824, 1073741824, 1073741824, 1073741824, 1564160, 143744, 1073741824, 17920
.fill 8, 4, 0
.long 269476, 13267968, 296192, L_lanetab-L_back_pc_2+3072, 264320, 12288, 640, 0, 4845568, 9207808, 25427968, 30195712, 303104, 1822720, 1, 13262848, 164640, 27496448, 27499520, 1073741824, 1884160, 159744, 283552, 19200
.fill 8, 4, 0
.long 270228, 13431808, 296192, L_lanetab-L_back_pc_2+3072, 264576, 12032, 640, 0, 4850688, 9207808, 25453568, 30257152, 303104, 1863680, 1, 13426688, 1475360, 27660288, 27663360, 1073741824, 1886720, 159872, 1073741824, 18944
.fill 8, 4, 0
.long 1073741824, 13349888, 296192, L_lanetab-L_back_pc_2+3072, 264832, 12032, 0, 0, 4845568, 9207808, 25479168, 30318592, 303104, 1904640, 0, 13344768, 1073741824, 1073741824, 1073741824, 1073741824, 1889280, 160000, 1073741824, 18688
.fill 8, 4, 0
.long 1073741824, 13513728, 296192, L_lanetab-L_back_pc_2+3072, 265088, 11776, 0, 0, 4850688, 9207808, 25504768, 30380032, 303104, 1945600, 0, 13508608, 1073741824, 1073741824, 1073741824, 1073741824, 1891840, 160128, 1073741824, 18432
.fill 8, 4, 0
.long 270500, 13277184, 296448, L_lanetab-L_back_pc_2+3072, 264320, 12288, 640, 0, 5173248, 9895936, 25427968, 30195712, 311296, 2150400, 1, 13268992, 164800, 27742208, 27745280, 1073741824, 2211840, 176128, 284064, 19712
.fill 8, 4, 0
.long 271252, 13441024, 296448, L_lanetab-L_back_pc_2+3072, 264576, 12032, 640, 0, 5178368, 9895936, 25453568, 30257152, 311296, 2191360, 1, 13432832, 1475520, 27906048, 27909120, 1073741824, 2214400, 176256, 1073741824, 19456
.fill 8, 4, 0
.long 1073741824, 13359104, 296448, L_lanetab-L_back_pc_2+3072, 264832, 12032, 0, 0, 5173248, 9895936, 25479168, 30318592, 311296, 2232320, 0, 13350912, 1073741824, 1073741824, 1073741824, 1073741824, 2216960, 176384, 1073741824, 19200
.fill 8, 4, 0
.long 1073741824, 13522944, 296448, L_lanetab-L_back_pc_2+3072, 265088, 11776, 0, 0, 5178368, 9895936, 25504768, 30380032, 311296, 2273280, 0, 13514752, 1073741824, 1073741824, 1073741824, 1073741824, 2219520, 176512, 1073741824, 18944
.fill 8, 4, 0
.long 271524, 13278208, 296704, L_lanetab-L_back_pc_2+3072, 264320, 12288, 640, 0, 5500928, 10584064, 25427968, 30195712, 319488, 2478080, 1, 13273088, 164960, 27987968, 27991040, 1073741824, 2539520, 192512, 284576, 20224
.fill 8, 4, 0
.long 272276, 13442048, 296704, L_lanetab-L_back_pc_2+3072, 264576, 12032, 640, 0, 5506048, 10584064, 25453568, 30257152, 319488, 2519040, 1, 13436928, 1475680, 28151808, 28154880, 1073741824, 2542080, 192640, 1073741824, 19968
.fill 8, 4, 0
.long 1073741824, 13360128, 296704, L_lanetab-L_back_pc_2+3072, 264832, 12032, 0, 0, 5500928, 10584064, 25479168, 30318592, 319488, 2560000, 0, 13355008, 1073741824, 1073741824, 1073741824, 1073741824, 2544640, 192768, 1073741824, 19712
.fill 8, 4, 0
.long 1073741824, 13523968, 296704, L_lanetab-L_back_pc_2+3072, 265088, 11776, 0, 0, 5506048, 10584064, 25504768, 30380032, 319488, 2600960, 0, 13518848, 1073741824, 1073741824, 1073741824, 1073741824, 2547200, 192896, 1073741824, 19456
.fill 8, 4, 0
.long 264360, 13246720, 294912, L_lanetab-L_back_pc_2+3072, 265344, 11776, 640, 320, 3289088, 5939200, 25530368, 30441472, 262144, 184480, 1, 13239296, 204800, 26272768, 26275840, 1073741824, 256000, 78336, 280996, 15616
.fill 8, 4, 0
.long 265112, 13410560, 294912, L_lanetab-L_back_pc_2+3072, 265600, 11520, 640, 320, 3294208, 5939200, 25555968, 30502912, 262144, 225440, 1, 13403136, 1515520, 26436608, 26439680, 1073741824, 258560, 78464, 1073741824, 15360
.fill 8, 4, 0
.long 1073741824, 13328640, 294912, L_lanetab-L_back_pc_2+3072, 265856, 11520, 0, 320, 3289088, 5939200, 25581568, 30564352, 262144, 266400, 0, 13321216, 1073741824, 1073741824, 1073741824, 1073741824, 261120, 78592, 1073741824, 15104
.fill 8, 4, 0
.long 1073741824, 13492480, 294912, L_lanetab-L_back_pc_2+3072, 266112, 11264, 0, 320, 3294208, 5939200, 25607168, 30625792, 262144, 307360, 0, 13485056, 1073741824, 1073741824, 1073741824, 1073741824, 263680, 78720, 1073741824, 14848
.fill 8, 4, 0
.long 265384, 13247744, 295168, L_lanetab-L_back_pc_2+3072, 265344, 11776, 640, 320, 3616768, 6627328, 25530368, 30441472, 270336, 512160, 1, 13243392, 204960, 26518528, 26521600, 1073741824, 583680, 94720, 281508, 16128
.fill 8, 4, 0
.long 266136, 13411584, 295168, L_lanetab-L_back_pc_2+3072, 265600, 11520, 640, 320, 3621888, 6627328, 25555968, 30502912, 270336, 553120, 1, 13407232, 1515680, 26682368, 26685440, 1073741824, 586240, 94848, 1073741824, 15872
.fill 8, 4, 0
.long 1073741824, 13329664, 295168, L_lanetab-L_back_pc_2+3072, 265856, 11520, 0, 320, 3616768, 6627328, 25581568, 30564352, 270336, 594080, 0, 13325312, 1073741824, 1073741824, 1073741824, 1073741824, 588800, 94976, 1073741824, 15616
.fill 8, 4, 0
.long 1073741824, 13493504, 295168, L_lanetab-L_back_pc_2+3072, 266112, 11264, 0, 320, 3621888, 6627328, 25607168, 30625792, 270336, 635040, 0, 13489152, 1073741824, 1073741824, 1073741824, 1073741824, 591360, 95104, 1073741824, 15360
.fill 8, 4, 0
.long 266408, 13256960, 295424, L_lanetab-L_back_pc_2+3072, 265344, 11776, 640, 320, 3944448, 7315456, 25530368, 30441472, 278528, 839840, 1, 13249536, 205120, 26764288, 26767360, 1073741824, 911360, 111104, 282020, 16640
.fill 8, 4, 0
.long 267160, 13420800, 295424, L_lanetab-L_back_pc_2+3072, 265600, 11520, 640, 320, 3949568, 7315456, 25555968, 30502912, 278528, 880800, 1, 13413376, 1515840, 26928128, 26931200, 1073741824, 913920, 111232, 1073741824, 16384
.fill 8, 4, 0
.long 1073741824, 13338880, 295424, L_lanetab-L_back_pc_2+3072, 265856, 11520, 0, 320, 3944448, 7315456, 25581568, 30564352, 278528, 921760, 0, 13331456, 1073741824, 1073741824, 1073741824, 1073741824, 916480, 111360, 1073741824, 16128
.fill 8, 4, 0
.long 1073741824, 13502720, 295424, L_lanetab-L_back_pc_2+3072, 266112, 11264, 0, 320, 3949568, 7315456, 25607168, 30625792, 278528, 962720, 0, 13495296, 1073741824, 1073741824, 1073741824, 1073741824, 919040, 111488, 1073741824, 15872
.fill 8, 4, 0
.long 267432, 13257984, 295680, L_lanetab-L_back_pc_2+3072, 265344, 11776, 640, 320, 4272128, 8003584, 25530368, 30441472, 286720, 1167520, 1, 13253632, 205280, 27010048, 27013120, 1073741824, 1239040, 127488, 282532, 17152
.fill 8, 4, 0
.long 268184, 13421824, 295680, L_lanetab-L_back_pc_2+3072, 265600, 11520, 640, 320, 4277248, 8003584, 25555968, 30502912, 286720, 1208480, 1, 13417472, 1516000, 27173888, 27176960, 1073741824, 1241600, 127616, 1073741824, 16896
.fill 8, 4, 0
.long 1073741824, 13339904, 295680, L_lanetab-L_back_pc_2+3072, 265856, 11520, 0, 320, 4272128, 8003584, 25581568, 30564352, 286720, 1249440, 0, 13335552, 1073741824, 1073741824, 1073741824, 1073741824, 1244160, 127744, 1073741824, 16640
.fill 8, 4, 0
.long 1073741824, 13503744, 295680, L_lanetab-L_back_pc_2+3072, 266112, 11264, 0, 320, 4277248, 8003584, 25607168, 30625792, 286720, 1290400, 0, 13499392, 1073741824, 1073741824, 1073741824, 1073741824, 1246720, 127872, 1073741824, 16384
.fill 8, 4, 0
.long 268456, 13267200, 295936, L_lanetab-L_back_pc_2+3072, 265344, 11776, 640, 320, 4599808, 8691712, 25530368, 30441472, 294912, 1495200, 1, 13259776, 205440, 27255808, 27258880, 1073741824, 1566720, 143872, 283044, 17664
.fill 8, 4, 0
.long 269208, 13431040, 295936, L_lanetab-L_back_pc_2+3072, 265600, 11520, 640, 320, 4604928, 8691712, 25555968, 30502912, 294912, 1536160, 1, 13423616, 1516160, 27419648, 27422720, 1073741824, 1569280, 144000, 1073741824, 17408
.fill 8, 4, 0
.long 1073741824, 13349120, 295936, L_lanetab-L_back_pc_2+3072, 265856, 11520, 0, 320, 4599808, 8691712, 25581568, 30564352, 294912, 1577120, 0, 13341696, 1073741824, 1073741824, 1073741824, 1073741824, 1571840, 144128, 1073741824, 17152
.fill 8, 4, 0
.long 1073741824, 13512960, 295936, L_lanetab-L_back_pc_2+3072, 266112, 11264, 0, 320, 4604928, 8691712, 25607168, 30625792, 294912, 1618080, 0, 13505536, 1073741824, 1073741824, 1073741824, 1073741824, 1574400, 144256, 1073741824, 16896
.fill 8, 4, 0
.long 269480, 13268224, 296192, L_lanetab-L_back_pc_2+3072, 265344, 11776, 640, 320, 4927488, 9379840, 25530368, 30441472, 303104, 1822880, 1, 13263872, 205600, 27501568, 27504640, 1073741824, 1894400, 160256, 283556, 18176
.fill 8, 4, 0
.long 270232, 13432064, 296192, L_lanetab-L_back_pc_2+3072, 265600, 11520, 640, 320, 4932608, 9379840, 25555968, 30502912, 303104, 1863840, 1, 13427712, 1516320, 27665408, 27668480, 1073741824, 1896960, 160384, 1073741824, 17920
.fill 8, 4, 0
.long 1073741824, 13350144, 296192, L_lanetab-L_back_pc_2+3072, 265856, 11520, 0, 320, 4927488, 9379840, 25581568, 30564352, 303104, 1904800, 0, 13345792, 1073741824, 1073741824, 1073741824, 1073741824, 1899520, 160512, 1073741824, 17664
.fill 8, 4, 0
.long 1073741824, 13513984, 296192, L_lanetab-L_back_pc_2+3072, 266112, 11264, 0, 320, 4932608, 9379840, 25607168, 30625792, 303104, 1945760, 0, 13509632, 1073741824, 1073741824, 1073741824, 1073741824, 1902080, 160640, 1073741824, 17408
.fill 8, 4, 0
.long 270504, 13277440, 296448, L_lanetab-L_back_pc_2+3072, 265344, 11776, 640, 320, 5255168, 10067968, 25530368, 30441472, 311296, 2150560, 1, 13270016, 205760, 27747328, 27750400, 1073741824, 2222080, 176640, 284068, 18688
.fill 8, 4, 0
.long 271256, 13441280, 296448, L_lanetab-L_back_pc_2+3072, 265600, 11520, 640, 320, 5260288, 10067968, 25555968, 30502912, 311296, 2191520, 1, 13433856, 1516480, 27911168, 27914240, 1073741824, 2224640, 176768, 1073741824, 18432
.fill 8, 4, 0
.long 1073741824, 13359360, 296448, L_lanetab-L_back_pc_2+3072, 265856, 11520, 0, 320, 5255168, 10067968, 25581568, 30564352, 311296, 2232480, 0, 13351936, 1073741824, 1073741824, 1073741824, 1073741824, 2227200, 176896, 1073741824, 18176
.fill 8, 4, 0
.long 1073741824, 13523200, 296448, L_lanetab-L_back_pc_2+3072, 266112, 11264, 0, 320, 5260288, 10067968, 25607168, 30625792, 311296, 2273440, 0, 13515776, 1073741824, 1073741824, 1073741824, 1073741824, 2229760, 177024, 1073741824, 17920
.fill 8, 4, 0
.long 271528, 13278464, 296704, L_lanetab-L_back_pc_2+3072, 265344, 11776, 640, 320, 5582848, 10756096, 25530368, 30441472, 319488, 2478240, 1, 13274112, 205920, 27993088, 27996160, 1073741824, 2549760, 193024, 284580, 19200
.fill 8, 4, 0
.long 272280, 13442304, 296704, L_lanetab-L_back_pc_2+3072, 265600, 11520, 640, 320, 5587968, 10756096, 25555968, 30502912, 319488, 2519200, 1, 13437952, 1516640, 28156928, 28160000, 1073741824, 2552320, 193152, 1073741824, 18944
.fill 8, 4, 0
.long 1073741824, 13360384, 296704, L_lanetab-L_back_pc_2+3072, 265856, 11520, 0, 320, 5582848, 10756096, 25581568, 30564352, 319488, 2560160, 0, 13356032, 1073741824, 1073741824, 1073741824, 1073741824, 2554880, 193280, 1073741824, 18688
.fill 8, 4, 0
.long 1073741824, 13524224, 296704, L_lanetab-L_back_pc_2+3072, 266112, 11264, 0, 320, 5587968, 10756096, 25607168, 30625792, 319488, 2601120, 0, 13519872, 1073741824, 1073741824, 1073741824, 1073741824, 2557440, 193408, 1073741824, 18432
.fill 8, 4, 0
.long 264364, 13246976, 294912, L_lanetab-L_back_pc_2+3072, 266368, 11264, 640, 640, 3371008, 6111232, 25632768, 30687232, 262144, 184640, 1, 13240320, 245760, 26277888, 26280960, 1073741824, 266240, 78848, 281000, 14592
.fill 8, 4, 0
.long 265116, 13410816, 294912, L_lanetab-L_back_pc_2+3072, 266624, 11008, 640, 640, 3376128, 6111232, 25658368, 30748672, 262144, 225600, 1, 13404160, 1556480, 26441728, 26444800, 1073741824, 268800, 78976, 1073741824, 14336
.fill 8, 4, 0
.long 1073741824, 13328896, 294912, L_lanetab-L_back_pc_2+3072, 266880, 11008, 0, 640, 3371008, 6111232, 25683968, 30810112, 262144, 266560, 0, 13322240, 1073741824, 1073741824, 1073741824, 1073741824, 271360, 79104, 1073741824, 14080
.fill 8, 4, 0
.long 1073741824, 13492736, 294912, L_lanetab-L_back_pc_2+3072, 267136, 10752, 0, 640, 3376128, 6111232, 25709568, 30871552, 262144, 307520, 0, 13486080, 1073741824, 1073741824, 1073741824, 1073741824, 273920, 79232, 1073741824, 13824
.fill 8, 4, 0
.long 265388, 13248000, 295168, L_lanetab-L_back_pc_2+3072, 266368, 11264, 640, 640, 3698688, 6799360, 25632768, 30687232, 270336, 512320, 1, 13244416, 245920, 26523648, 26526720, 1073741824, 593920, 95232, 281512, 15104
.fill 8, 4, 0
.long 266140, 13411840, 295168, L_lanetab-L_back_pc_2+3072, 266624, 11008, 640, 640, 3703808, 6799360, 25658368, 30748672, 270336, 553280, 1, 13408256, 1556640, 26687488, 26690560, 1073741824, 596480, 95360, 1073741824, 14848
.fill 8, 4, 0
.long 1073741824, 13329920, 295168, L_lanetab-L_back_pc_2+3072, 266880, 11008, 0, 640, 3698688, 6799360, 25683968, 30810112, 270336, 594240, 0, 13326336, 1073741824, 1073741824, 1073741824, 1073741824, 599040, 95488, 1073741824, 14592
.fill 8, 4, 0
.long 1073741824, 13493760, 295168, L_lanetab-L_back_pc_2+3072, 267136, 10752, 0, 640, 3703808, 6799360, 25709568, 30871552, 270336, 635200, 0, 13490176, 1073741824, 1073741824, 1073741824, 1073741824, 601600, 95616, 1073741824, 14336
.fill 8, 4, 0
.long 266412, 13257216, 295424, L_lanetab-L_back_pc_2+3072, 266368, 11264, 640, 640, 4026368, 7487488, 25632768, 30687232, 278528, 840000, 1, 13250560, 246080, 26769408, 26772480, 1073741824, 921600, 111616, 282024, 15616
.fill 8, 4, 0
.long 267164, 13421056, 295424, L_lanetab-L_back_pc_2+3072, 266624, 11008, 640, 640, 4031488, 7487488, 25658368, 30748672, 278528, 880960, 1, 13414400, 1556800, 26933248, 26936320, 1073741824, 924160, 111744, 1073741824, 15360
.fill 8, 4, 0
.long 1073741824, 13339136, 295424, L_lanetab-L_back_pc_2+3072, 266880, 11008, 0, 640, 4026368, 7487488, 25683968, 30810112, 278528, 921920, 0, 13332480, 1073741824, 1073741824, 1073741824, 1073741824, 926720, 111872, 1073741824, 15104
.fill 8, 4, 0
.long 1073741824, 13502976, 295424, L_lanetab-L_back_pc_2+3072, 267136, 10752, 0, 640, 4031488, 7487488, 25709568, 30871552, 278528, 962880, 0, 13496320, 1073741824, 1073741824, 1073741824, 1073741824, 929280, 112000, 1073741824, 14848
.fill 8, 4, 0
.long 267436, 13258240, 295680, L_lanetab-L_back_pc_2+3072, 266368, 11264, 640, 640, 4354048, 8175616, 25632768, 30687232, 286720, 1167680, 1, 13254656, 246240, 27015168, 27018240, 1073741824, 1249280, 128000, 282536, 16128
.fill 8, 4, 0
.long 268188, 13422080, 295680, L_lanetab-L_back_pc_2+3072, 266624, 11008, 640, 640, 4359168, 8175616, 25658368, 30748672, 286720, 1208640, 1, 13418496, 1556960, 27179008, 27182080, 1073741824, 1251840, 128128, 1073741824, 15872
.fill 8, 4, 0
.long 1073741824, 13340160, 295680, L_lanetab-L_back_pc_2+3072, 266880, 11008, 0, 640, 4354048, 8175616, 25683968, 30810112, 286720, 1249600, 0, 13336576, 1073741824, 1073741824, 1073741824, 1073741824, 1254400, 128256, 1073741824, 15616
.fill 8, 4, 0
.long 1073741824, 13504000, 295680, L_lanetab-L_back_pc_2+3072, 267136, 10752, 0, 640, 4359168, 8175616, 25709568, 30871552, 286720, 1290560, 0, 13500416, 1073741824, 1073741824, 1073741824, 1073741824, 1256960, 128384, 1073741824, 15360
.fill 8, 4, 0
.long 268460, 13267456, 295936, L_lanetab-L_back_pc_2+3072, 266368, 11264, 640, 640, 4681728, 8863744, 25632768, 30687232, 294912, 1495360, 1, 13260800, 246400, 27260928, 27264000, 1073741824, 1576960, 144384, 283048, 16640
.fill 8, 4, 0
.long 269212, 13431296, 295936, L_lanetab-L_back_pc_2+3072, 266624, 11008, 640, 640, 4686848, 8863744, 25658368, 30748672, 294912, 1536320, 1, 13424640, 1557120, 27424768, 27427840, 1073741824, 1579520, 144512, 1073741824, 16384
.fill 8, 4, 0
.long 1073741824, 13349376, 295936, L_lanetab-L_back_pc_2+3072, 266880, 11008, 0, 640, 4681728, 8863744, 25683968, 30810112, 294912, 1577280, 0, 13342720, 1073741824, 1073741824, 1073741824, 1073741824, 1582080, 144640, 1073741824, 16128
.fill 8, 4, 0
.long 1073741824, 13513216, 295936, L_lanetab-L_back_pc_2+3072, 267136, 10752, 0, 640, 4686848, 8863744, 25709568, 30871552, 294912, 1618240, 0, 13506560, 1073741824, 1073741824, 1073741824, 1073741824, 1584640, 144768, 1073741824, 15872
.fill 8, 4, 0
.long 269484, 13268480, 296192, L_lanetab-L_back_pc_2+3072, 266368, 11264, 640, 640, 5009408, 9551872, 25632768, 30687232, 303104, 1823040, 1, 13264896, 246560, 27506688, 27509760, 1073741824, 1904640, 160768, 283560, 17152
.fill 8, 4, 0
.long 270236, 13432320, 296192, L_lanetab-L_back_pc_2+3072, 266624, 11008, 640, 640, 5014528, 9551872, 25658368, 30748672, 303104, 1864000, 1, 13428736, 1557280, 27670528, 27673600, 1073741824, 1907200, 160896, 1073741824, 16896
.fill 8, 4, 0
.long 1073741824, 13350400, 296192, L_lanetab-L_back_pc_2+3072, 266880, 11008, 0, 640, 5009408, 9551872, 25683968, 30810112, 303104, 1904960, 0, 13346816, 1073741824, 1073741824, 1073741824, 1073741824, 1909760, 161024, 1073741824, 16640
.fill 8, 4, 0
.long 1073741824, 13514240, 296192, L_lanetab-L_back_pc_2+3072, 267136, 10752, 0, 640, 5014528, 9551872, 25709568, 30871552, 303104, 1945920, 0, 13510656, 1073741824, 1073741824, 1073741824, 1073741824, 1912320, 161152, 1073741824, 16384
.fill 8, 4, 0
.long 270508, 13277696, 296448, L_lanetab-L_back_pc_2+3072, 266368, 11264, 640, 640, 5337088, 10240000, 25632768, 30687232, 311296, 2150720, 1, 13271040, 246720, 27752448, 27755520, 1073741824, 2232320, 177152, 284072, 17664
.fill 8, 4, 0
.long 271260, 13441536, 296448, L_lanetab-L_back_pc_2+3072, 266624, 11008, 640, 640, 5342208, 10240000, 25658368, 30748672, 311296, 2191680, 1, 13434880, 1557440, 27916288, 27919360, 1073741824, 2234880, 177280, 1073741824, 17408
.fill 8, 4, 0
.long 1073741824, 13359616, 296448, L_lanetab-L_back_pc_2+3072, 266880, 11008, 0, 640, 5337088, 10240000, 25683968, 30810112, 311296, 2232640, 0, 13352960, 1073741824, 1073741824, 1073741824, 1073741824, 2237440, 177408, 1073741824, 17152
.fill 8, 4, 0
.long 1073741824, 13523456, 296448, L_lanetab-L_back_pc_2+3072, 267136, 10752, 0, 640, 5342208, 10240000, 25709568, 30871552, 311296, 2273600, 0, 13516800, 1073741824, 1073741824, 1073741824, 1073741824, 2240000, 177536, 1073741824, 16896
.fill 8, 4, 0
.long 271532, 13278720, 296704, L_lanetab-L_back_pc_2+3072, 266368, 11264, 640, 640, 5664768, 10928128, 25632768, 30687232, 319488, 2478400, 1, 13275136, 246880, 27998208, 28001280, 1073741824, 2560000, 193536, 284584, 18176
.fill 8, 4, 0
.long 272284, 13442560, 296704, L_lanetab-L_back_pc_2+3072, 266624, 11008, 640, 640, 5669888, 10928128, 25658368, 30748672, 319488, 2519360, 1, 13438976, 1557600, 28162048, 28165120, 1073741824, 2562560, 193664, 1073741824, 17920
.fill 8, 4, 0
.long 1073741824, 13360640, 296704, L_lanetab-L_back_pc_2+3072, 266880, 11008, 0, 640, 5664768, 10928128, 25683968, 30810112, 319488, 2560320, 0, 13357056, 1073741824, 1073741824, 1073741824, 1073741824, 2565120, 193792, 1073741824, 17664
.fill 8, 4, 0
.long 1073741824, 13524480, 296704, L_lanetab-L_back_pc_2+3072, 267136, 10752, 0, 640, 5669888, 10928128, 25709568, 30871552, 319488, 2601280, 0, 13520896, 1073741824, 1073741824, 1073741824, 1073741824, 2567680, 193920, 1073741824, 17408
.fill 8, 4, 0
.long 264368, 13247232, 294912, L_lanetab-L_back_pc_2+3072, 267392, 10752, 640, 960, 3452928, 6283264, 25735168, 30932992, 262144, 184800, 1, 13241344, 286720, 26283008, 26286080, 1073741824, 276480, 79360, 281004, 13568
.fill 8, 4, 0
.long 265120, 13411072, 294912, L_lanetab-L_back_pc_2+3072, 267648, 10496, 640, 960, 3458048, 6283264, 25760768, 30994432, 262144, 225760, 1, 13405184, 1597440, 26446848, 26449920, 1073741824, 279040, 79488, 1073741824, 13312
.fill 8, 4, 0
.long 1073741824, 13329152, 294912, L_lanetab-L_back_pc_2+3072, 267904, 10496, 0, 960, 3452928, 6283264, 25786368, 31055872, 262144, 266720, 0, 13323264, 1073741824, 1073741824, 1073741824, 1073741824, 281600, 79616, 1073741824, 13056
.fill 8, 4, 0
.long 1073741824, 13492992, 294912, L_lanetab-L_back_pc_2+3072, 268160, 10240, 0, 960, 3458048, 6283264, 25811968, 31117312, 262144, 307680, 0, 13487104, 1073741824, 1073741824, 1073741824, 1073741824, 284160, 79744, 1073741824, 12800
.fill 8, 4, 0
.long 265392, 13248256, 295168, L_lanetab-L_back_pc_2+3072, 267392, 10752, 640, 960, 3780608, 6971392, 25735168, 30932992, 270336, 512480, 1, 13245440, 286880, 26528768, 26531840, 1073741824, 604160, 95744, 281516, 14080
.fill 8, 4, 0
.long 266144, 13412096, 295168, L_lanetab-L_back_pc_2+3072, 267648, 10496, 640, 960, 3785728, 6971392, 25760768, 30994432, 270336, 553440, 1, 13409280, 1597600, 26692608, 26695680, 1073741824, 606720, 95872, 1073741824, 13824
.fill 8, 4, 0
.long 1073741824, 13330176, 295168, L_lanetab-L_back_pc_2+3072, 267904, 10496, 0, 960, 3780608, 6971392, 25786368, 31055872, 270336, 594400, 0, 13327360, 1073741824, 1073741824, 1073741824, 1073741824, 609280, 96000, 1073741824, 13568
.fill 8, 4, 0
.long 1073741824, 13494016, 295168, L_lanetab-L_back_pc_2+3072, 268160, 10240, 0, 960, 3785728, 6971392, 25811968, 31117312, 270336, 635360, 0, 13491200, 1073741824, 1073741824, 1073741824, 1073741824, 611840, 96128, 1073741824, 13312
.fill 8, 4, 0
.long 266416, 13257472, 295424, L_lanetab-L_back_pc_2+3072, 267392, 10752, 640, 960, 4108288, 7659520, 25735168, 30932992, 278528, 840160, 1, 13251584, 287040, 26774528, 26777600, 1073741824, 931840, 112128, 282028, 14592
.fill 8, 4, 0
.long 267168, 13421312, 295424, L_lanetab-L_back_pc_2+3072, 267648, 10496, 640, 960, 4113408, 7659520, 25760768, 30994432, 278528, 881120, 1, 13415424, 1597760, 26938368, 26941440, 1073741824, 934400, 112256, 1073741824, 14336
.fill 8, 4, 0
.long 1073741824, 13339392, 295424, L_lanetab-L_back_pc_2+3072, 267904, 10496, 0, 960, 4108288, 7659520, 25786368, 31055872, 278528, 922080, 0, 13333504, 1073741824, 1073741824, 1073741824, 1073741824, 936960, 112384, 1073741824, 14080
.fill 8, 4, 0
.long 1073741824, 13503232, 295424, L_lanetab-L_back_pc_2+3072, 268160, 10240, 0, 960, 4113408, 7659520, 25811968, 31117312, 278528, 963040, 0, 13497344, 1073741824, 1073741824, 1073741824, 1073741824, 939520, 112512, 1073741824, 13824
.fill 8, 4, 0
.long 267440, 13258496, 295680, L_lanetab-L_back_pc_2+3072, 267392, 10752, 640, 960, 4435968, 8347648, 25735168, 30932992, 286720, 1167840, 1, 13255680, 287200, 27020288, 27023360, 1073741824, 1259520, 128512, 282540, 15104
.fill 8, 4, 0
.long 268192, 13422336, 295680, L_lanetab-L_back_pc_2+3072, 267648, 10496, 640, 960, 4441088, 8347648, 25760768, 30994432, 286720, 1208800, 1, 13419520, 1597920, 27184128, 27187200, 1073741824, 1262080, 128640, 1073741824, 14848
.fill 8, 4, 0
.long 1073741824, 13340416, 295680, L_lanetab-L_back_pc_2+3072, 267904, 10496, 0, 960, 4435968, 8347648, 25786368, 31055872, 286720, 1249760, 0, 13337600, 1073741824, 1073741824, 1073741824, 1073741824, 1264640, 128768, 1073741824, 14592
.fill 8, 4, 0
.long 1073741824, 13504256, 295680, L_lanetab-L_back_pc_2+3072, 268160, 10240, 0, 960, 4441088, 8347648, 25811968, 31117312, 286720, 1290720, 0, 13501440, 1073741824, 1073741824, 1073741824, 1073741824, 1267200, 128896, 1073741824, 14336
.fill 8, 4, 0
.long 268464, 13267712, 295936, L_lanetab-L_back_pc_2+3072, 267392, 10752, 640, 960, 4763648, 9035776, 25735168, 30932992, 294912, 1495520, 1, 13261824, 287360, 27266048, 27269120, 1073741824, 1587200, 144896, 283052, 15616
.fill 8, 4, 0
.long 269216, 13431552, 295936, L_lanetab-L_back_pc_2+3072, 267648, 10496, 640, 960, 4768768, 9035776, 25760768, 30994432, 294912, 1536480, 1, 13425664, 1598080, 27429888, 27432960, 1073741824, 1589760, 145024, 1073741824, 15360
.fill 8, 4, 0
.long 1073741824, 13349632, 295936, L_lanetab-L_back_pc_2+3072, 267904, 10496, 0, 960, 4763648, 9035776, 25786368, 31055872, 294912, 1577440, 0, 13343744, 1073741824, 1073741824, 1073741824, 1073741824, 1592320, 145152, 1073741824, 15104
.fill 8, 4, 0
.long 1073741824, 13513472, 295936, L_lanetab-L_back_pc_2+3072, 268160, 10240, 0, 960, 4768768, 9035776, 25811968, 31117312, 294912, 1618400, 0, 13507584, 1073741824, 1073741824, 1073741824, 1073741824, 1594880, 145280, 1073741824, 14848
.fill 8, 4, 0
.long 269488, 13268736, 296192, L_lanetab-L_back_pc_2+3072, 267392, 10752, 640, 960, 5091328, 9723904, 25735168, 30932992, 303104, 1823200, 1, 13265920, 287520, 27511808, 27514880, 1073741824, 1914880, 161280, 283564, 16128
.fill 8, 4, 0
.long 270240, 13432576, 296192, L_lanetab-L_back_pc_2+3072, 267648, 10496, 640, 960, 5096448, 9723904, 25760768, 30994432, 303104, 1864160, 1, 13429760, 1598240, 27675648, 27678720, 1073741824, 1917440, 161408, 1073741824, 15872
.fill 8, 4, 0
.long 1073741824, 13350656, 296192, L_lanetab-L_back_pc_2+3072, 267904, 10496, 0, 960, 5091328, 9723904, 25786368, 31055872, 303104, 1905120, 0, 13347840, 1073741824, 1073741824, 1073741824, 1073741824, 1920000, 161536, 1073741824, 15616
.fill 8, 4, 0
.long 1073741824, 13514496, 296192, L_lanetab-L_back_pc_2+3072, 268160, 10240, 0, 960, 5096448, 9723904, 25811968, 31117312, 303104, 1946080, 0, 13511680, 1073741824, 1073741824, 1073741824, 1073741824, 1922560, 161664, 1073741824, 15360
.fill 8, 4, 0
.long 270512, 13277952, 296448, L_lanetab-L_back_pc_2+3072, 267392, 10752, 640, 960, 5419008, 10412032, 25735168, 30932992, 311296, 2150880, 1, 13272064, 287680, 27757568, 27760640, 1073741824, 2242560, 177664, 284076, 16640
.fill 8, 4, 0
.long 271264, 13441792, 296448, L_lanetab-L_back_pc_2+3072, 267648, 10496, 640, 960, 5424128, 10412032, 25760768, 30994432, 311296, 2191840, 1, 13435904, 1598400, 27921408, 27924480, 1073741824, 2245120, 177792, 1073741824, 16384
.fill 8, 4, 0
.long 1073741824, 13359872, 296448, L_lanetab-L_back_pc_2+3072, 267904, 10496, 0, 960, 5419008, 10412032, 25786368, 31055872, 311296, 2232800, 0, 13353984, 1073741824, 1073741824, 1073741824, 1073741824, 2247680, 177920, 1073741824, 16128
.fill 8, 4, 0
.long 1073741824, 13523712, 296448, L_lanetab-L_back_pc_2+3072, 268160, 10240, 0, 960, 5424128, 10412032, 25811968, 31117312, 311296, 2273760, 0, 13517824, 1073741824, 1073741824, 1073741824, 1073741824, 2250240, 178048, 1073741824, 15872
.fill 8, 4, 0
.long 271536, 13278976, 296704, L_lanetab-L_back_pc_2+3072, 267392, 10752, 640, 960, 5746688, 11100160, 25735168, 30932992, 319488, 2478560, 1, 13276160, 287840, 28003328, 28006400, 1073741824, 2570240, 194048, 284588, 17152
.fill 8, 4, 0
.long 272288, 13442816, 296704, L_lanetab-L_back_pc_2+3072, 267648, 10496, 640, 960, 5751808, 11100160, 25760768, 30994432, 319488, 2519520, 1, 13440000, 1598560, 28167168, 28170240, 1073741824, 2572800, 194176, 1073741824, 16896
.fill 8, 4, 0
.long 1073741824, 13360896, 296704, L_lanetab-L_back_pc_2+3072, 267904, 10496, 0, 960, 5746688, 11100160, 25786368, 31055872, 319488, 2560480, 0, 13358080, 1073741824, 1073741824, 1073741824, 1073741824, 2575360, 194304, 1073741824, 16640
.fill 8, 4, 0
.long 1073741824, 13524736, 296704, L_lanetab-L_back_pc_2+3072, 268160, 10240, 0, 960, 5751808, 11100160, 25811968, 31117312, 319488, 2601440, 0, 13521920, 1073741824, 1073741824, 1073741824, 1073741824, 2577920, 194432, 1073741824, 16384
.fill 8, 4, 0
.long 264372, 13574144, 294912, L_lanetab-L_back_pc_2+3072, 268416, 10240, 640, 1280, 3217408, 5767168, 25837568, 31178752, 262144, 184960, 1, 13565952, 327680, 26288128, 26291200, 1073741824, 286720, 79872, 281008, 12544
.fill 8, 4, 0
.long 265124, 13737984, 294912, L_lanetab-L_back_pc_2+3072, 268672, 9984, 640, 1280, 3222528, 5767168, 25863168, 31240192, 262144, 225920, 1, 13729792, 1638400, 26451968, 26455040, 1073741824, 289280, 80000, 1073741824, 12288
.fill 8, 4, 0
.long 1073741824, 13656064, 294912, L_lanetab-L_back_pc_2+3072, 268928, 9984, 0, 1280, 3217408, 5767168, 25888768, 31301632, 262144, 266880, 0, 13647872, 1073741824, 1073741824, 1073741824, 1073741824, 291840, 80128, 1073741824, 12032
.fill 8, 4, 0
.long 1073741824, 13819904, 294912, L_lanetab-L_back_pc_2+3072, 269184, 9728, 0, 1280, 3222528, 5767168, 25914368, 31363072, 262144, 307840, 0, 13811712, 1073741824, 1073741824, 1073741824, 1073741824, 294400, 80256, 1073741824, 11776
.fill 8, 4, 0
.long 265396, 13575168, 295168, L_lanetab-L_back_pc_2+3072, 268416, 10240, 640, 1280, 3545088, 6455296, 25837568, 31178752, 270336, 512640, 1, 13570048, 327840, 26533888, 26536960, 1073741824, 614400, 96256, 281520, 13056
.fill 8, 4, 0
.long 266148, 13739008, 295168, L_lanetab-L_back_pc_2+3072, 268672, 9984, 640, 1280, 3550208, 6455296, 25863168, 31240192, 270336, 553600, 1, 13733888, 1638560, 26697728, 26700800, 1073741824, 616960, 96384, 1073741824, 12800
.fill 8, 4, 0
.long 1073741824, 13657088, 295168, L_lanetab-L_back_pc_2+3072, 268928, 9984, 0, 1280, 3545088, 6455296, 25888768, 31301632, 270336, 594560, 0, 13651968, 1073741824, 1073741824, 1073741824, 1073741824, 619520, 96512, 1073741824, 12544
.fill 8, 4, 0
.long 1073741824, 13820928, 295168, L_lanetab-L_back_pc_2+3072, 269184, 9728, 0, 1280, 3550208, 6455296, 25914368, 31363072, 270336, 635520, 0, 13815808, 1073741824, 1073741824, 1073741824, 1073741824, 622080, 96640, 1073741824, 12288
.fill 8, 4, 0
.long 266420, 13584384, 295424, L_lanetab-L_back_pc_2+3072, 268416, 10240, 640, 1280, 3872768, 7143424, 25837568, 31178752, 278528, 840320, 1, 13576192, 328000, 26779648, 26782720, 1073741824, 942080, 112640, 282032, 13568
.fill 8, 4, 0
.long 267172, 13748224, 295424, L_lanetab-L_back_pc_2+3072, 268672, 9984, 640, 1280, 3877888, 7143424, 25863168, 31240192, 278528, 881280, 1, 13740032, 1638720, 26943488, 26946560, 1073741824, 944640, 112768, 1073741824, 13312
.fill 8, 4, 0
.long 1073741824, 13666304, 295424, L_lanetab-L_back_pc_2+3072, 268928, 9984, 0, 1280, 3872768, 7143424, 25888768, 31301632, 278528, 922240, 0, 13658112, 1073741824, 1073741824, 1073741824, 1073741824, 947200, 112896, 1073741824, 13056
.fill 8, 4, 0
.long 1073741824, 13830144, 295424, L_lanetab-L_back_pc_2+3072, 269184, 9728, 0, 1280, 3877888, 7143424, 25914368, 31363072, 278528, 963200, 0, 13821952, 1073741824, 1073741824, 1073741824, 1073741824, 949760, 113024, 1073741824, 12800
.fill 8, 4, 0
.long 267444, 13585408, 295680, L_lanetab-L_back_pc_2+3072, 268416, 10240, 640, 1280, 4200448, 7831552, 25837568, 31178752, 286720, 1168000, 1, 13580288, 328160, 27025408, 27028480, 1073741824, 1269760, 129024, 282544, 14080
.fill 8, 4, 0
.long 268196, 13749248, 295680, L_lanetab-L_back_pc_2+3072, 268672, 9984, 640, 1280, 4205568, 7831552, 25863168, 31240192, 286720, 1208960, 1, 13744128, 1638880, 27189248, 27192320, 1073741824, 1272320, 129152, 1073741824, 13824
.fill 8, 4, 0
.long 1073741824, 13667328, 295680, L_lanetab-L_back_pc_2+3072, 268928, 9984, 0, 1280, 4200448, 7831552, 25888768, 31301632, 286720, 1249920, 0, 13662208, 1073741824, 1073741824, 1073741824, 1073741824, 1274880, 129280, 1073741824, 13568
.fill 8, 4, 0
.long 1073741824, 13831168, 295680, L_lanetab-L_back_pc_2+3072, 269184, 9728, 0, 1280, 4205568, 7831552, 25914368, 31363072, 286720, 1290880, 0, 13826048, 1073741824, 1073741824, 1073741824, 1073741824, 1277440, 129408, 1073741824, 13312
.fill 8, 4, 0
.long 268468, 13594624, 295936, L_lanetab-L_back_pc_2+3072, 268416, 10240, 640, 1280, 4528128, 8519680, 25837568, 31178752, 294912, 1495680, 1, 13586432, 328320, 27271168, 27274240, 1073741824, 1597440, 145408, 283056, 14592
.fill 8, 4, 0
.long 269220, 13758464, 295936, L_lanetab-L_back_pc_2+3072, 268672, 9984, 640, 1280, 4533248, 8519680, 25863168, 31240192, 294912, 1536640, 1, 13750272, 1639040, 27435008, 27438080, 1073741824, 1600000, 145536, 1073741824, 14336
.fill 8, 4, 0
.long 1073741824, 13676544, 295936, L_lanetab-L_back_pc_2+3072, 268928, 9984, 0, 1280, 4528128, 8519680, 25888768, 31301632, 294912, 1577600, 0, 13668352, 1073741824, 1073741824, 1073741824, 1073741824, 1602560, 145664, 1073741824, 14080
.fill 8, 4, 0
.long 1073741824, 13840384, 295936, L_lanetab-L_back_pc_2+3072, 269184, 9728, 0, 1280, 4533248, 8519680, 25914368, 31363072, 294912, 1618560, 0, 13832192, 1073741824, 1073741824, 1073741824, 1073741824, 1605120, 145792, 1073741824, 13824
.fill 8, 4, 0
.long 269492, 13595648, 296192, L_lanetab-L_back_pc_2+3072, 268416, 10240, 640, 1280, 4855808, 9207808, 25837568, 31178752, 303104, 1823360, 1, 13590528, 328480, 27516928, 27520000, 1073741824, 1925120, 161792, 283568, 15104
.fill 8, 4, 0
.long 270244, 13759488, 296192, L_lanetab-L_back_pc_2+3072, 268672, 9984, 640, 1280, 4860928, 9207808, 25863168, 31240192, 303104, 1864320, 1, 13754368, 1639200, 27680768, 27683840, 1073741824, 1927680, 161920, 1073741824, 14848
.fill 8, 4, 0
.long 1073741824, 13677568, 296192, L_lanetab-L_back_pc_2+3072, 268928, 9984, 0, 1280, 4855808, 9207808, 25888768, 31301632, 303104, 1905280, 0, 13672448, 1073741824, 1073741824, 1073741824, 1073741824, 1930240, 162048, 1073741824, 14592
.fill 8, 4, 0
.long 1073741824, 13841408, 296192, L_lanetab-L_back_pc_2+3072, 269184, 9728, 0, 1280, 4860928, 9207808, 25914368, 31363072, 303104, 1946240, 0, 13836288, 1073741824, 1073741824, 1073741824, 1073741824, 1932800, 162176, 1073741824, 14336
.fill 8, 4, 0
.long 270516, 13604864, 296448, L_lanetab-L_back_pc_2+3072, 268416, 10240, 640, 1280, 5183488, 9895936, 25837568, 31178752, 311296, 2151040, 1, 13596672, 328640, 27762688, 27765760, 1073741824, 2252800, 178176, 284080, 15616
.fill 8, 4, 0
.long 271268, 13768704, 296448, L_lanetab-L_back_pc_2+3072, 268672, 9984, 640, 1280, 5188608, 9895936, 25863168, 31240192, 311296, 2192000, 1, 13760512, 1639360, 27926528, 27929600, 1073741824, 2255360, 178304, 1073741824, 15360
.fill 8, 4, 0
.long 1073741824, 13686784, 296448, L_lanetab-L_back_pc_2+3072, 268928, 9984, 0, 1280, 5183488, 9895936, 25888768, 31301632, 311296, 2232960, 0, 13678592, 1073741824, 1073741824, 1073741824, 1073741824, 2257920, 178432, 1073741824, 15104
.fill 8, 4, 0
.long 1073741824, 13850624, 296448, L_lanetab-L_back_pc_2+3072, 269184, 9728, 0, 1280, 5188608, 9895936, 25914368, 31363072, 311296, 2273920, 0, 13842432, 1073741824, 1073741824, 1073741824, 1073741824, 2260480, 178560, 1073741824, 14848
.fill 8, 4, 0
.long 271540, 13605888, 296704, L_lanetab-L_back_pc_2+3072, 268416, 10240, 640, 1280, 5511168, 10584064, 25837568, 31178752, 319488, 2478720, 1, 13600768, 328800, 28008448, 28011520, 1073741824, 2580480, 194560, 284592, 16128
.fill 8, 4, 0
.long 272292, 13769728, 296704, L_lanetab-L_back_pc_2+3072, 268672, 9984, 640, 1280, 5516288, 10584064, 25863168, 31240192, 319488, 2519680, 1, 13764608, 1639520, 28172288, 28175360, 1073741824, 2583040, 194688, 1073741824, 15872
.fill 8, 4, 0
.long 1073741824, 13687808, 296704, L_lanetab-L_back_pc_2+3072, 268928, 9984, 0, 1280, 5511168, 10584064, 25888768, 31301632, 319488, 2560640, 0, 13682688, 1073741824, 1073741824, 1073741824, 1073741824, 2585600, 194816, 1073741824, 15616
.fill 8, 4, 0
.long 1073741824, 13851648, 296704, L_lanetab-L_back_pc_2+3072, 269184, 9728, 0, 1280, 5516288, 10584064, 25914368, 31363072, 319488, 2601600, 0, 13846528, 1073741824, 1073741824, 1073741824, 1073741824, 2588160, 194944, 1073741824, 15360
.fill 8, 4, 0
.long 264376, 13574400, 294912, L_lanetab-L_back_pc_2+3072, 269440, 9728, 640, 1600, 3299328, 5939200, 25939968, 31424512, 262144, 185120, 1, 13566976, 368640, 26293248, 26296320, 1073741824, 296960, 80384, 281012, 11520
.fill 8, 4, 0
.long 265128, 13738240, 294912, L_lanetab-L_back_pc_2+3072, 269696, 9472, 640, 1600, 3304448, 5939200, 25965568, 31485952, 262144, 226080, 1, 13730816, 1679360, 26457088, 26460160, 1073741824, 299520, 80512, 1073741824, 11264
.fill 8, 4, 0
.long 1073741824, 13656320, 294912, L_lanetab-L_back_pc_2+3072, 269952, 9472, 0, 1600, 3299328, 5939200, 25991168, 31547392, 262144, 267040, 0, 13648896, 1073741824, 1073741824, 1073741824, 1073741824, 302080, 80640, 1073741824, 11008
.fill 8, 4, 0
.long 1073741824, 13820160, 294912, L_lanetab-L_back_pc_2+3072, 270208, 9216, 0, 1600, 3304448, 5939200, 26016768, 31608832, 262144, 308000, 0, 13812736, 1073741824, 1073741824, 1073741824, 1073741824, 304640, 80768, 1073741824, 10752
.fill 8, 4, 0
.long 265400, 13575424, 295168, L_lanetab-L_back_pc_2+3072, 269440, 9728, 640, 1600, 3627008, 6627328, 25939968, 31424512, 270336, 512800, 1, 13571072, 368800, 26539008, 26542080, 1073741824, 624640, 96768, 281524, 12032
.fill 8, 4, 0
.long 266152, 13739264, 295168, L_lanetab-L_back_pc_2+3072, 269696, 9472, 640, 1600, 3632128, 6627328, 25965568, 31485952, 270336, 553760, 1, 13734912, 1679520, 26702848, 26705920, 1073741824, 627200, 96896, 1073741824, 11776
.fill 8, 4, 0
.long 1073741824, 13657344, 295168, L_lanetab-L_back_pc_2+3072, 269952, 9472, 0, 1600, 3627008, 6627328, 25991168, 31547392, 270336, 594720, 0, 13652992, 1073741824, 1073741824, 1073741824, 1073741824, 629760, 97024, 1073741824, 11520
.fill 8, 4, 0
.long 1073741824, 13821184, 295168, L_lanetab-L_back_pc_2+3072, 270208, 9216, 0, 1600, 3632128, 6627328, 26016768, 31608832, 270336, 635680, 0, 13816832, 1073741824, 1073741824, 1073741824, 1073741824, 632320, 97152, 1073741824, 11264
.fill 8, 4, 0
.long 266424, 13584640, 295424, L_lanetab-L_back_pc_2+3072, 269440, 9728, 640, 1600, 3954688, 7315456, 25939968, 31424512, 278528, 840480, 1, 13577216, 368960, 26784768, 26787840, 1073741824, 952320, 113152, 282036, 12544
.fill 8, 4, 0
.long 267176, 13748480, 295424, L_lanetab-L_back_pc_2+3072, 269696, 9472, 640, 1600, 3959808, 7315456, 25965568, 31485952, 278528, 881440, 1, 13741056, 1679680, 26948608, 26951680, 1073741824, 954880, 113280, 1073741824, 12288
.fill 8, 4, 0
.long 1073741824, 13666560, 295424, L_lanetab-L_back_pc_2+3072, 269952, 9472, 0, 1600, 3954688, 7315456, 25991168, 31547392, 278528, 922400, 0, 13659136, 1073741824, 1073741824, 1073741824, 1073741824, 957440, 113408, 1073741824, 12032
.fill 8, 4, 0
.long 1073741824, 13830400, 295424, L_lanetab-L_back_pc_2+3072, 270208, 9216, 0, 1600, 3959808, 7315456, 26016768, 31608832, 278528, 963360, 0, 13822976, 1073741824, 1073741824, 1073741824, 1073741824, 960000, 113536, 1073741824, 11776
.fill 8, 4, 0
.long 267448, 13585664, 295680, L_lanetab-L_back_pc_2+3072, 269440, 9728, 640, 1600, 4282368, 8003584, 25939968, 31424512, 286720, 1168160, 1, 13581312, 369120, 27030528, 27033600, 1073741824, 1280000, 129536, 282548, 13056
.fill 8, 4, 0
.long 268200, 13749504, 295680, L_lanetab-L_back_pc_2+3072, 269696, 9472, 640, 1600, 4287488, 8003584, 25965568, 31485952, 286720, 1209120, 1, 13745152, 1679840, 27194368, 27197440, 1073741824, 1282560, 129664, 1073741824, 12800
.fill 8, 4, 0
.long 1073741824, 13667584, 295680, L_lanetab-L_back_pc_2+3072, 269952, 9472, 0, 1600, 4282368, 8003584, 25991168, 31547392, 286720, 1250080, 0, 13663232, 1073741824, 1073741824, 1073741824, 1073741824, 1285120, 129792, 1073741824, 12544
.fill 8, 4, 0
.long 1073741824, 13831424, 295680, L_lanetab-L_back_pc_2+3072, 270208, 9216, 0, 1600, 4287488, 8003584, 26016768, 31608832, 286720, 1291040, 0, 13827072, 1073741824, 1073741824, 1073741824, 1073741824, 1287680, 129920, 1073741824, 12288
.fill 8, 4, 0
.long 268472, 13594880, 295936, L_lanetab-L_back_pc_2+3072, 269440, 9728, 640, 1600, 4610048, 8691712, 25939968, 31424512, 294912, 1495840, 1, 13587456, 369280, 27276288, 27279360, 1073741824, 1607680, 145920, 283060, 13568
.fill 8, 4, 0
.long 269224, 13758720, 295936, L_lanetab-L_back_pc_2+3072, 269696, 9472, 640, 1600, 4615168, 8691712, 25965568, 31485952, 294912, 1536800, 1, 13751296, 1680000, 27440128, 27443200, 1073741824, 1610240, 146048, 1073741824, 13312
.fill 8, 4, 0
.long 1073741824, 13676800, 295936, L_lanetab-L_back_pc_2+3072, 269952, 9472, 0, 1600, 4610048, 8691712, 25991168, 31547392, 294912, 1577760, 0, 13669376, 1073741824, 1073741824, 1073741824, 1073741824, 1612800, 146176, 1073741824, 13056
.fill 8, 4, 0
.long 1073741824, 13840640, 295936, L_lanetab-L_back_pc_2+3072, 270208, 9216, 0, 1600, 4615168, 8691712, 26016768, 31608832, 294912, 1618720, 0, 13833216, 1073741824, 1073741824, 1073741824, 1073741824, 1615360, 146304, 1073741824, 12800
.fill 8, 4, 0
.long 269496, 13595904, 296192, L_lanetab-L_back_pc_2+3072, 269440, 9728, 640, 1600, 4937728, 9379840, 25939968, 31424512, 303104, 1823520, 1, 13591552, 369440, 27522048, 27525120, 1073741824, 1935360, 162304, 283572, 14080
.fill 8, 4, 0
.long 270248, 13759744, 296192, L_lanetab-L_back_pc_2+3072, 269696, 9472, 640, 1600, 4942848, 9379840, 25965568, 31485952, 303104, 1864480, 1, 13755392, 1680160, 27685888, 27688960, 1073741824, 1937920, 162432, 1073741824, 13824
.fill 8, 4, 0
.long 1073741824, 13677824, 296192, L_lanetab-L_back_pc_2+3072, 269952, 9472, 0, 1600, 4937728, 9379840, 25991168, 31547392, 303104, 1905440, 0, 13673472, 1073741824, 1073741824, 1073741824, 1073741824, 1940480, 162560, 1073741824, 13568
.fill 8, 4, 0
.long 1073741824, 13841664, 296192, L_lanetab-L_back_pc_2+3072, 270208, 9216, 0, 1600, 4942848, 9379840, 26016768, 31608832, 303104, 1946400, 0, 13837312, 1073741824, 1073741824, 1073741824, 1073741824, 1943040, 162688, 1073741824, 13312
.fill 8, 4, 0
.long 270520, 13605120, 296448, L_lanetab-L_back_pc_2+3072, 269440, 9728, 640, 1600, 5265408, 10067968, 25939968, 31424512, 311296, 2151200, 1, 13597696, 369600, 27767808, 27770880, 1073741824, 2263040, 178688, 284084, 14592
.fill 8, 4, 0
.long 271272, 13768960, 296448, L_lanetab-L_back_pc_2+3072, 269696, 9472, 640, 1600, 5270528, 10067968, 25965568, 31485952, 311296, 2192160, 1, 13761536, 1680320, 27931648, 27934720, 1073741824, 2265600, 178816, 1073741824, 14336
.fill 8, 4, 0
.long 1073741824, 13687040, 296448, L_lanetab-L_back_pc_2+3072, 269952, 9472, 0, 1600, 5265408, 10067968, 25991168, 31547392, 311296, 2233120, 0, 13679616, 1073741824, 1073741824, 1073741824, 1073741824, 2268160, 178944, 1073741824, 14080
.fill 8, 4, 0
.long 1073741824, 13850880, 296448, L_lanetab-L_back_pc_2+3072, 270208, 9216, 0, 1600, 5270528, 10067968, 26016768, 31608832, 311296, 2274080, 0, 13843456, 1073741824, 1073741824, 1073741824, 1073741824, 2270720, 179072, 1073741824, 13824
.fill 8, 4, 0
.long 271544, 13606144, 296704, L_lanetab-L_back_pc_2+3072, 269440, 9728, 640, 1600, 5593088, 10756096, 25939968, 31424512, 319488, 2478880, 1, 13601792, 369760, 28013568, 28016640, 1073741824, 2590720, 195072, 284596, 15104
.fill 8, 4, 0
.long 272296, 13769984, 296704, L_lanetab-L_back_pc_2+3072, 269696, 9472, 640, 1600, 5598208, 10756096, 25965568, 31485952, 319488, 2519840, 1, 13765632, 1680480, 28177408, 28180480, 1073741824, 2593280, 195200, 1073741824, 14848
.fill 8, 4, 0
.long 1073741824, 13688064, 296704, L_lanetab-L_back_pc_2+3072, 269952, 9472, 0, 1600, 5593088, 10756096, 25991168, 31547392, 319488, 2560800, 0, 13683712, 1073741824, 1073741824, 1073741824, 1073741824, 2595840, 195328, 1073741824, 14592
.fill 8, 4, 0
.long 1073741824, 13851904, 296704, L_lanetab-L_back_pc_2+3072, 270208, 9216, 0, 1600, 5598208, 10756096, 26016768, 31608832, 319488, 2601760, 0, 13847552, 1073741824, 1073741824, 1073741824, 1073741824, 2598400, 195456, 1073741824, 14336
.fill 8, 4, 0
.long 264380, 13574656, 294912, L_lanetab-L_back_pc_2+3072, 270464, 9216, 640, 1920, 3381248, 6111232, 26042368, 31670272, 262144, 185280, 1, 13568000, 409600, 26298368, 26301440, 1073741824, 307200, 80896, 281016, 10496
.fill 8, 4, 0
.long 265132, 13738496, 294912, L_lanetab-L_back_pc_2+3072, 270720, 8960, 640, 1920, 3386368, 6111232, 26067968, 31731712, 262144, 226240, 1, 13731840, 1720320, 26462208, 26465280, 1073741824, 309760, 81024, 1073741824, 10240
.fill 8, 4, 0
.long 1073741824, 13656576, 294912, L_lanetab-L_back_pc_2+3072, 270976, 8960, 0, 1920, 3381248, 6111232, 26093568, 31793152, 262144, 267200, 0, 13649920, 1073741824, 1073741824, 1073741824, 1073741824, 312320, 81152, 1073741824, 9984
.fill 8, 4, 0
.long 1073741824, 13820416, 294912, L_lanetab-L_back_pc_2+3072, 271232, 8704, 0, 1920, 3386368, 6111232, 26119168, 31854592, 262144, 308160, 0, 13813760, 1073741824, 1073741824, 1073741824, 1073741824, 314880, 81280, 1073741824, 9728
.fill 8, 4, 0
.long 265404, 13575680, 295168, L_lanetab-L_back_pc_2+3072, 270464, 9216, 640, 1920, 3708928, 6799360, 26042368, 31670272, 270336, 512960, 1, 13572096, 409760, 26544128, 26547200, 1073741824, 634880, 97280, 281528, 11008
.fill 8, 4, 0
.long 266156, 13739520, 295168, L_lanetab-L_back_pc_2+3072, 270720, 8960, 640, 1920, 3714048, 6799360, 26067968, 31731712, 270336, 553920, 1, 13735936, 1720480, 26707968, 26711040, 1073741824, 637440, 97408, 1073741824, 10752
.fill 8, 4, 0
.long 1073741824, 13657600, 295168, L_lanetab-L_back_pc_2+3072, 270976, 8960, 0, 1920, 3708928, 6799360, 26093568, 31793152, 270336, 594880, 0, 13654016, 1073741824, 1073741824, 1073741824, 1073741824, 640000, 97536, 1073741824, 10496
.fill 8, 4, 0
.long 1073741824, 13821440, 295168, L_lanetab-L_back_pc_2+3072, 271232, 8704, 0, 1920, 3714048, 6799360, 26119168, 31854592, 270336, 635840, 0, 13817856, 1073741824, 1073741824, 1073741824, 1073741824, 642560, 97664, 1073741824, 10240
.fill 8, 4, 0
.long 266428, 13584896, 295424, L_lanetab-L_back_pc_2+3072, 270464, 9216, 640, 1920, 4036608, 7487488, 26042368, 31670272, 278528, 840640, 1, 13578240, 409920, 26789888, 26792960, 1073741824, 962560, 113664, 282040, 11520
.fill 8, 4, 0
.long 267180, 13748736, 295424, L_lanetab-L_back_pc_2+3072, 270720, 8960, 640, 1920, 4041728, 7487488, 26067968, 31731712, 278528, 881600, 1, 13742080, 1720640, 26953728, 26956800, 1073741824, 965120, 113792, 1073741824, 11264
.fill 8, 4, 0
.long 1073741824, 13666816, 295424, L_lanetab-L_back_pc_2+3072, 270976, 8960, 0, 1920, 4036608, 7487488, 26093568, 31793152, 278528, 922560, 0, 13660160, 1073741824, 1073741824, 1073741824, 1073741824, 967680, 113920, 1073741824, 11008
.fill 8, 4, 0
.long 1073741824, 13830656, 295424, L_lanetab-L_back_pc_2+3072, 271232, 8704, 0, 1920, 4041728, 7487488, 26119168, 31854592, 278528, 963520, 0, 13824000, 1073741824, 1073741824, 1073741824, 1073741824, 970240, 114048, 1073741824, 10752
.fill 8, 4, 0
.long 267452, 13585920, 295680, L_lanetab-L_back_pc_2+3072, 270464, 9216, 640, 1920, 4364288, 8175616, 26042368, 31670272, 286720, 1168320, 1, 13582336, 410080, 27035648, 27038720, 1073741824, 1290240, 130048, 282552, 12032
.fill 8, 4, 0
.long 268204, 13749760, 295680, L_lanetab-L_back_pc_2+3072, 270720, 8960, 640, 1920, 4369408, 8175616, 26067968, 31731712, 286720, 1209280, 1, 13746176, 1720800, 27199488, 27202560, 1073741824, 1292800, 130176, 1073741824, 11776
.fill 8, 4, 0
.long 1073741824, 13667840, 295680, L_lanetab-L_back_pc_2+3072, 270976, 8960, 0, 1920, 4364288, 8175616, 26093568, 31793152, 286720, 1250240, 0, 13664256, 1073741824, 1073741824, 1073741824, 1073741824, 1295360, 130304, 1073741824, 11520
.fill 8, 4, 0
.long 1073741824, 13831680, 295680, L_lanetab-L_back_pc_2+3072, 271232, 8704, 0, 1920, 4369408, 8175616, 26119168, 31854592, 286720, 1291200, 0, 13828096, 1073741824, 1073741824, 1073741824, 1073741824, 1297920, 130432, 1073741824, 11264
.fill 8, 4, 0
.long 268476, 13595136, 295936, L_lanetab-L_back_pc_2+3072, 270464, 9216, 640, 1920, 4691968, 8863744, 26042368, 31670272, 294912, 1496000, 1, 13588480, 410240, 27281408, 27284480, 1073741824, 1617920, 146432, 283064, 12544
.fill 8, 4, 0
.long 269228, 13758976, 295936, L_lanetab-L_back_pc_2+3072, 270720, 8960, 640, 1920, 4697088, 8863744, 26067968, 31731712, 294912, 1536960, 1, 13752320, 1720960, 27445248, 27448320, 1073741824, 1620480, 146560, 1073741824, 12288
.fill 8, 4, 0
.long 1073741824, 13677056, 295936, L_lanetab-L_back_pc_2+3072, 270976, 8960, 0, 1920, 4691968, 8863744, 26093568, 31793152, 294912, 1577920, 0, 13670400, 1073741824, 1073741824, 1073741824, 1073741824, 1623040, 146688, 1073741824, 12032
.fill 8, 4, 0
.long 1073741824, 13840896, 295936, L_lanetab-L_back_pc_2+3072, 271232, 8704, 0, 1920, 4697088, 8863744, 26119168, 31854592, 294912, 1618880, 0, 13834240, 1073741824, 1073741824, 1073741824, 1073741824, 1625600, 146816, 1073741824, 11776
.fill 8, 4, 0
.long 269500, 13596160, 296192, L_lanetab-L_back_pc_2+3072, 270464, 9216, 640, 1920, 5019648, 9551872, 26042368, 31670272, 303104, 1823680, 1, 13592576, 410400, 27527168, 27530240, 1073741824, 1945600, 162816, 283576, 13056
.fill 8, 4, 0
.long 270252, 13760000, 296192, L_lanetab-L_back_pc_2+3072, 270720, 8960, 640, 1920, 5024768, 9551872, 26067968, 31731712, 303104, 1864640, 1, 13756416, 1721120, 27691008, 27694080, 1073741824, 1948160, 162944, 1073741824, 12800
.fill 8, 4, 0
.long 1073741824, 13678080, 296192, L_lanetab-L_back_pc_2+3072, 270976, 8960, 0, 1920, 5019648, 9551872, 26093568, 31793152, 303104, 1905600, 0, 13674496, 1073741824, 1073741824, 1073741824, 1073741824, 1950720, 163072, 1073741824, 12544
.fill 8, 4, 0
.long 1073741824, 13841920, 296192, L_lanetab-L_back_pc_2+3072, 271232, 8704, 0, 1920, 5024768, 9551872, 26119168, 31854592, 303104, 1946560, 0, 13838336, 1073741824, 1073741824, 1073741824, 1073741824, 1953280, 163200, 1073741824, 12288
.fill 8, 4, 0
.long 270524, 13605376, 296448, L_lanetab-L_back_pc_2+3072, 270464, 9216, 640, 1920, 5347328, 10240000, 26042368, 31670272, 311296, 2151360, 1, 13598720, 410560, 27772928, 27776000, 1073741824, 2273280, 179200, 284088, 13568
.fill 8, 4, 0
.long 271276, 13769216, 296448, L_lanetab-L_back_pc_2+3072, 270720, 8960, 640, 1920, 5352448, 10240000, 26067968, 31731712, 311296, 2192320, 1, 13762560, 1721280, 27936768, 27939840, 1073741824, 2275840, 179328, 1073741824, 13312
.fill 8, 4, 0
.long 1073741824, 13687296, 296448, L_lanetab-L_back_pc_2+3072, 270976, 8960, 0, 1920, 5347328, 10240000, 26093568, 31793152, 311296, 2233280, 0, 13680640, 1073741824, 1073741824, 1073741824, 1073741824, 2278400, 179456, 1073741824, 13056
.fill 8, 4, 0
.long 1073741824, 13851136, 296448, L_lanetab-L_back_pc_2+3072, 271232, 8704, 0, 1920, 5352448, 10240000, 26119168, 31854592, 311296, 2274240, 0, 13844480, 1073741824, 1073741824, 1073741824, 1073741824, 2280960, 179584, 1073741824, 12800
.fill 8, 4, 0
.long 271548, 13606400, 296704, L_lanetab-L_back_pc_2+3072, 270464, 9216, 640, 1920, 5675008, 10928128, 26042368, 31670272, 319488, 2479040, 1, 13602816, 410720, 28018688, 28021760, 1073741824, 2600960, 195584, 284600, 14080
.fill 8, 4, 0
.long 272300, 13770240, 296704, L_lanetab-L_back_pc_2+3072, 270720, 8960, 640, 1920, 5680128, 10928128, 26067968, 31731712, 319488, 2520000, 1, 13766656, 1721440, 28182528, 28185600, 1073741824, 2603520, 195712, 1073741824, 13824
.fill 8, 4, 0
.long 1073741824, 13688320, 296704, L_lanetab-L_back_pc_2+3072, 270976, 8960, 0, 1920, 5675008, 10928128, 26093568, 31793152, 319488, 2560960, 0, 13684736, 1073741824, 1073741824, 1073741824, 1073741824, 2606080, 195840, 1073741824, 13568
.fill 8, 4, 0
.long 1073741824, 13852160, 296704, L_lanetab-L_back_pc_2+3072, 271232, 8704, 0, 1920, 5680128, 10928128, 26119168, 31854592, 319488, 2601920, 0, 13848576, 1073741824, 1073741824, 1073741824, 1073741824, 2608640, 195968, 1073741824, 13312
.fill 8, 4, 0
.long 264384, 13574912, 294912, L_lanetab-L_back_pc_2+3072, 271488, 8704, 640, 2240, 3463168, 6283264, 26144768, 31916032, 262144, 185440, 1, 13569024, 450560, 26303488, 26306560, 1073741824, 317440, 81408, 281020, 9472
.fill 8, 4, 0
.long 265136, 13738752, 294912, L_lanetab-L_back_pc_2+3072, 271744, 8448, 640, 2240, 3468288, 6283264, 26170368, 31977472, 262144, 226400, 1, 13732864, 1761280, 26467328, 26470400, 1073741824, 320000, 81536, 1073741824, 9216
.fill 8, 4, 0
.long 1073741824, 13656832, 294912, L_lanetab-L_back_pc_2+3072, 272000, 8448, 0, 2240, 3463168, 6283264, 26195968, 32038912, 262144, 267360, 0, 13650944, 1073741824, 1073741824, 1073741824, 1073741824, 322560, 81664, 1073741824, 8960
.fill 8, 4, 0
.long 1073741824, 13820672, 294912, L_lanetab-L_back_pc_2+3072, 272256, 8192, 0, 2240, 3468288, 6283264, 26221568, 32100352, 262144, 308320, 0, 13814784, 1073741824, 1073741824, 1073741824, 1073741824, 325120, 81792, 1073741824, 8704
.fill 8, 4, 0
.long 265408, 13575936, 295168, L_lanetab-L_back_pc_2+3072, 271488, 8704, 640, 2240, 3790848, 6971392, 26144768, 31916032, 270336, 513120, 1, 13573120, 450720, 26549248, 26552320, 1073741824, 645120, 97792, 281532, 9984
.fill 8, 4, 0
.long 266160, 13739776, 295168, L_lanetab-L_back_pc_2+3072, 271744, 8448, 640, 2240, 3795968, 6971392, 26170368, 31977472, 270336, 554080, 1, 13736960, 1761440, 26713088, 26716160, 1073741824, 647680, 97920, 1073741824, 9728
.fill 8, 4, 0
.long 1073741824, 13657856, 295168, L_lanetab-L_back_pc_2+3072, 272000, 8448, 0, 2240, 3790848, 6971392, 26195968, 32038912, 270336, 595040, 0, 13655040, 1073741824, 1073741824, 1073741824, 1073741824, 650240, 98048, 1073741824, 9472
.fill 8, 4, 0
.long 1073741824, 13821696, 295168, L_lanetab-L_back_pc_2+3072, 272256, 8192, 0, 2240, 3795968, 6971392, 26221568, 32100352, 270336, 636000, 0, 13818880, 1073741824, 1073741824, 1073741824, 1073741824, 652800, 98176, 1073741824, 9216
.fill 8, 4, 0
.long 266432, 13585152, 295424, L_lanetab-L_back_pc_2+3072, 271488, 8704, 640, 2240, 4118528, 7659520, 26144768, 31916032, 278528, 840800, 1, 13579264, 450880, 26795008, 26798080, 1073741824, 972800, 114176, 282044, 10496
.fill 8, 4, 0
.long 267184, 13748992, 295424, L_lanetab-L_back_pc_2+3072, 271744, 8448, 640, 2240, 4123648, 7659520, 26170368, 31977472, 278528, 881760, 1, 13743104, 1761600, 26958848, 26961920, 1073741824, 975360, 114304, 1073741824, 10240
.fill 8, 4, 0
.long 1073741824, 13667072, 295424, L_lanetab-L_back_pc_2+3072, 272000, 8448, 0, 2240, 4118528, 7659520, 26195968, 32038912, 278528, 922720, 0, 13661184, 1073741824, 1073741824, 1073741824, 1073741824, 977920, 114432, 1073741824, 9984
.fill 8, 4, 0
.long 1073741824, 13830912, 295424, L_lanetab-L_back_pc_2+3072, 272256, 8192, 0, 2240, 4123648, 7659520, 26221568, 32100352, 278528, 963680, 0, 13825024, 1073741824, 1073741824, 1073741824, 1073741824, 980480, 114560, 1073741824, 9728
.fill 8, 4, 0
.long 267456, 13586176, 295680, L_lanetab-L_back_pc_2+3072, 271488, 8704, 640, 2240, 4446208, 8347648, 26144768, 31916032, 286720, 1168480, 1, 13583360, 451040, 27040768, 27043840, 1073741824, 1300480, 130560, 282556, 11008
.fill 8, 4, 0
.long 268208, 13750016, 295680, L_lanetab-L_back_pc_2+3072, 271744, 8448, 640, 2240, 4451328, 8347648, 26170368, 31977472, 286720, 1209440, 1, 13747200, 1761760, 27204608, 27207680, 1073741824, 1303040, 130688, 1073741824, 10752
.fill 8, 4, 0
.long 1073741824, 13668096, 295680, L_lanetab-L_back_pc_2+3072, 272000, 8448, 0, 2240, 4446208, 8347648, 26195968, 32038912, 286720, 1250400, 0, 13665280, 1073741824, 1073741824, 1073741824, 1073741824, 1305600, 130816, 1073741824, 10496
.fill 8, 4, 0
.long 1073741824, 13831936, 295680, L_lanetab-L_back_pc_2+3072, 272256, 8192, 0, 2240, 4451328, 8347648, 26221568, 32100352, 286720, 1291360, 0, 13829120, 1073741824, 1073741824, 1073741824, 1073741824, 1308160, 130944, 1073741824, 10240
.fill 8, 4, 0
.long 268480, 13595392, 295936, L_lanetab-L_back_pc_2+3072, 271488, 8704, 640, 2240, 4773888, 9035776, 26144768, 31916032, 294912, 1496160, 1, 13589504, 451200, 27286528, 27289600, 1073741824, 1628160, 146944, 283068, 11520
.fill 8, 4, 0
.long 269232, 13759232, 295936, L_lanetab-L_back_pc_2+3072, 271744, 8448, 640, 2240, 4779008, 9035776, 26170368, 31977472, 294912, 1537120, 1, 13753344, 1761920, 27450368, 27453440, 1073741824, 1630720, 147072, 1073741824, 11264
.fill 8, 4, 0
.long 1073741824, 13677312, 295936, L_lanetab-L_back_pc_2+3072, 272000, 8448, 0, 2240, 4773888, 9035776, 26195968, 32038912, 294912, 1578080, 0, 13671424, 1073741824, 1073741824, 1073741824, 1073741824, 1633280, 147200, 1073741824, 11008
.fill 8, 4, 0
.long 1073741824, 13841152, 295936, L_lanetab-L_back_pc_2+3072, 272256, 8192, 0, 2240, 4779008, 9035776, 26221568, 32100352, 294912, 1619040, 0, 13835264, 1073741824, 1073741824, 1073741824, 1073741824, 1635840, 147328, 1073741824, 10752
.fill 8, 4, 0
.long 269504, 13596416, 296192, L_lanetab-L_back_pc_2+3072, 271488, 8704, 640, 2240, 5101568, 9723904, 26144768, 31916032, 303104, 1823840, 1, 13593600, 451360, 27532288, 27535360, 1073741824, 1955840, 163328, 283580, 12032
.fill 8, 4, 0
.long 270256, 13760256, 296192, L_lanetab-L_back_pc_2+3072, 271744, 8448, 640, 2240, 5106688, 9723904, 26170368, 31977472, 303104, 1864800, 1, 13757440, 1762080, 27696128, 27699200, 1073741824, 1958400, 163456, 1073741824, 11776
.fill 8, 4, 0
.long 1073741824, 13678336, 296192, L_lanetab-L_back_pc_2+3072, 272000, 8448, 0, 2240, 5101568, 9723904, 26195968, 32038912, 303104, 1905760, 0, 13675520, 1073741824, 1073741824, 1073741824, 1073741824, 1960960, 163584, 1073741824, 11520
.fill 8, 4, 0
.long 1073741824, 13842176, 296192, L_lanetab-L_back_pc_2+3072, 272256, 8192, 0, 2240, 5106688, 9723904, 26221568, 32100352, 303104, 1946720, 0, 13839360, 1073741824, 1073741824, 1073741824, 1073741824, 1963520, 163712, 1073741824, 11264
.fill 8, 4, 0
.long 270528, 13605632, 296448, L_lanetab-L_back_pc_2+3072, 271488, 8704, 640, 2240, 5429248, 10412032, 26144768, 31916032, 311296, 2151520, 1, 13599744, 451520, 27778048, 27781120, 1073741824, 2283520, 179712, 284092, 12544
.fill 8, 4, 0
.long 271280, 13769472, 296448, L_lanetab-L_back_pc_2+3072, 271744, 8448, 640, 2240, 5434368, 10412032, 26170368, 31977472, 311296, 2192480, 1, 13763584, 1762240, 27941888, 27944960, 1073741824, 2286080, 179840, 1073741824, 12288
.fill 8, 4, 0
.long 1073741824, 13687552, 296448, L_lanetab-L_back_pc_2+3072, 272000, 8448, 0, 2240, 5429248, 10412032, 26195968, 32038912, 311296, 2233440, 0, 13681664, 1073741824, 1073741824, 1073741824, 1073741824, 2288640, 179968, 1073741824, 12032
.fill 8, 4, 0
.long 1073741824, 13851392, 296448, L_lanetab-L_back_pc_2+3072, 272256, 8192, 0, 2240, 5434368, 10412032, 26221568, 32100352, 311296, 2274400, 0, 13845504, 1073741824, 1073741824, 1073741824, 1073741824, 2291200, 180096, 1073741824, 11776
.fill 8, 4, 0
.long 271552, 13606656, 296704, L_lanetab-L_back_pc_2+3072, 271488, 8704, 640, 2240, 5756928, 11100160, 26144768, 31916032, 319488, 2479200, 1, 13603840, 451680, 28023808, 28026880, 1073741824, 2611200, 196096, 284604, 13056
.fill 8, 4, 0
.long 272304, 13770496, 296704, L_lanetab-L_back_pc_2+3072, 271744, 8448, 640, 2240, 5762048, 11100160, 26170368, 31977472, 319488, 2520160, 1, 13767680, 1762400, 28187648, 28190720, 1073741824, 2613760, 196224, 1073741824, 12800
.fill 8, 4, 0
.long 1073741824, 13688576, 296704, L_lanetab-L_back_pc_2+3072, 272000, 8448, 0, 2240, 5756928, 11100160, 26195968, 32038912, 319488, 2561120, 0, 13685760, 1073741824, 1073741824, 1073741824, 1073741824, 2616320, 196352, 1073741824, 12544
.fill 8, 4, 0
.long 1073741824, 13852416, 296704, L_lanetab-L_back_pc_2+3072, 272256, 8192, 0, 2240, 5762048, 11100160, 26221568, 32100352, 319488, 2602080, 0, 13849600, 1073741824, 1073741824, 1073741824, 1073741824, 2618880, 196480, 1073741824, 12288
.fill 8, 4, 0
L_text_end:
.section .rodata,"a"
.p2align 6
.amdhsa_kernel front_kernel
  .amdhsa_next_free_vgpr 512
  .amdhsa_next_free_sgpr 102
  .amdhsa_accum_offset 256
  .amdhsa_group_segment_fixed_size 0
  .amdhsa_kernarg_size 96
  .amdhsa_user_sgpr_count 2
  .amdhsa_user_sgpr_kernarg_segment_ptr 1
  .amdhsa_system_sgpr_workgroup_id_x 1
.end_amdhsa_kernel
.p2align 6
.amdhsa_kernel back_kernel
  .amdhsa_next_free_vgpr 512
  .amdhsa_next_free_sgpr 102
  .amdhsa_accum_offset 256
  .amdhsa_group_segment_fixed_size 0
  .amdhsa_kernarg_size 96
  .amdhsa_user_sgpr_count 2
  .amdhsa_user_sgpr_kernarg_segment_ptr 1
  .amdhsa_system_sgpr_workgroup_id_x 1
.end_amdhsa_kernel
```
